```python
import torch

def _softmax(x, axis=-1):
    return torch.softmax(x, dim=axis)
def _gelu(x):
    return torch.nn.functional.gelu(x, approximate="tanh")
def _silu(x):
    return torch.nn.functional.silu(x)
def _sigmoid(x):
    return torch.sigmoid(x)
def _layernorm(x, axis=-1, eps=1e-5):
    m = x.mean(dim=axis, keepdim=True)
    v = x.var(dim=axis, keepdim=True, unbiased=False)
    return (x - m) / torch.sqrt(v + eps)
def _scatter_add(tgt, idx, src, axis=0):
    return tgt.clone().index_add_(axis, idx, src)
def _segment_sum(src, seg, n):
    out = torch.zeros((n,) + src.shape[1:], dtype=src.dtype)
    return out.index_add_(0, seg, src)
def _pad(x, pw):
    flat = tuple(v for pair in reversed(pw) for v in pair)
    return torch.nn.functional.pad(x, flat)

kernel_name = 'gated_mix__sliding_local_dilated__dense_activation_relu__prompt'

def setup_inputs():

    _w = (lambda a: (lambda t: t.to(torch.bfloat16) if t.is_floating_point() else t)(torch.as_tensor(a)))
    def _A_setup():
        B, S, D = 1, 2048, 1024
        return {
            "x": _w((lambda *s: torch.randn(*s, dtype=torch.bfloat16) * 0.05)(B, S, D)),
            "wqkv": _w((lambda *s: torch.randn(*s, dtype=torch.bfloat16) * 0.8)(D, 3 * D)),
            "wo": _w((lambda *s: torch.randn(*s, dtype=torch.bfloat16) * 0.05)(D, D)),
        }
    _A_in = _A_setup()

    def _B_setup():
        B, S, D, Dff = 1, 2048, 1024, 3584
        return {
            "x": _w((lambda *s: torch.randn(*s, dtype=torch.bfloat16) * 0.05)(B, S, D)),
            "w1": _w((lambda *s: torch.randn(*s, dtype=torch.bfloat16) * 0.2)(D, Dff)),
            "w2": _w((lambda *s: torch.randn(*s, dtype=torch.bfloat16) * 0.2)(Dff, D)),
        }
    _B_in = _B_setup()

    return {
        "A_x": _A_in["x"],
        "A_wqkv": _A_in["wqkv"],
        "A_wo": _A_in["wo"],
        "B_x": _B_in["x"],
        "B_w1": _B_in["w1"],
        "B_w2": _B_in["w2"],
        "gate_w": _w((lambda *s: torch.randn(*s, dtype=torch.bfloat16) * 0.05)(1024) * 16.0),
    }

def reference(A_x, A_wqkv, A_wo, B_x, B_w1, B_w2, gate_w):
    def _A_ref(x, wqkv, wo):
        B, S, D = x.shape
        H = 32; Dh = D // H
        W, dil = 8, 2
        qkv = (lambda x, *d: x.permute(*d))((x @ wqkv).reshape(B, S, 3, H, Dh), 2, 0, 3, 1, 4)
        q, k, v = qkv[0], qkv[1], qkv[2]
        scale = Dh ** -0.5
        pos = torch.arange(S)
        off = torch.arange(W) * dil
        idx = pos[:, None] - off[None, :]
        mask = idx >= 0
        idx_c = torch.where(mask, idx, 0).reshape(-1)
        kg = k[:, :, idx_c, :].reshape(B, H, S, W, Dh)
        vg = v[:, :, idx_c, :].reshape(B, H, S, W, Dh)
        logits = torch.einsum("bhsd,bhswd->bhsw", q, kg) * scale
        logits = torch.where(mask[None, None, :, :], logits, -1e9)
        attn = _softmax(logits, axis=-1)
        o = torch.einsum("bhsw,bhswd->bhsd", attn, vg)
        return (lambda x, *d: x.permute(*d))(o, 0, 2, 1, 3).reshape(B, S, D) @ wo

    def _B_ref(x, w1, w2):
        h = torch.einsum("bsd,df->bsf", x, w1)
        zero = torch.zeros_like(h)
        h = torch.maximum(h, zero)
        return torch.einsum("bsf,fd->bsd", h, w2)

    x = A_x
    g = _sigmoid((x * gate_w).sum(-1, keepdims=True))
    a = _A_ref(x, A_wqkv, A_wo)
    b = _B_ref(x, B_w1, B_w2)
    return g * a + (1 - g) * b
```

```asm
; @launch grid=(256,1,1) block=(256,1,1) lds=163840
.amdgcn_target "amdgcn-amd-amdhsa--gfx950"
.text
.globl gated_mix__sliding_local_dilated__dense_activation_relu__prompt_kernel
.p2align 8
.type gated_mix__sliding_local_dilated__dense_activation_relu__prompt_kernel,@function
gated_mix__sliding_local_dilated__dense_activation_relu__prompt_kernel:
 s_cmp_ge_u32 s2, 256
 s_cbranch_scc1 L1_end
 s_load_dwordx4 s[4:7], s[0:1], 0
 s_load_dwordx4 s[8:11], s[0:1], 32
 s_load_dwordx2 s[24:25], s[0:1], 48
 s_load_dwordx2 s[20:21], s[0:1], 72
 s_load_dwordx2 s[72:73], s[0:1], 16
 s_load_dwordx2 s[60:61], s[0:1], 64
 s_getreg_b32 s3, hwreg(HW_REG_XCC_ID)
 s_mov_b32 s62, 256
 s_mov_b32 s63, 0x20000
 s_getpc_b64 s[92:93]
L1_pc:
 s_sub_u32 s92, s92, L1_pc-gated_mix__sliding_local_dilated__dense_activation_relu__prompt_kernel
 s_subb_u32 s93, s93, 0
 s_mov_b32 s94, L1_end-gated_mix__sliding_local_dilated__dense_activation_relu__prompt_kernel
 s_mov_b32 s95, 0x20000
 s_lshr_b32 s91, s2, 3
 s_lshl_b32 s91, s91, 12
 v_subrev_u32 v1, 192, v0
 v_lshlrev_b32 v1, 6, v1
 buffer_load_dword a204, v1, s[92:95], s91 offen
 v_and_b32 v224, 63, v0
 v_lshrrev_b32 v1, 6, v0
 s_and_b32 s30, s2, 7
 s_lshr_b32 s31, s2, 3
 v_readfirstlane_b32 s33, v1
 s_lshr_b32 s34, s30, 2
 s_lshl_b32 s34, s34, 2
 s_and_b32 s35, s31, 3
 s_add_u32 s34, s34, s35
 s_and_b32 s35, s30, 3
 s_lshl_b32 s35, s35, 2
 s_lshr_b32 s36, s31, 2
 s_and_b32 s36, s36, 3
 s_add_u32 s35, s35, s36
 s_lshr_b32 s32, s31, 4
 s_and_b32 s34, s30, 6
 s_and_b32 s35, s31, 1
 s_add_u32 s34, s34, s35
 s_lshr_b32 s36, s31, 1
 s_and_b32 s37, s30, 1
 s_mul_i32 s40, s37, 9
 s_add_u32 s41, s36, s40
 s_sub_u32 s42, s41, 9
 s_mul_i32 s40, s37, 2
 s_sub_u32 s40, 9, s40
 s_lshl_b32 s29, s37, 4
 s_add_u32 s29, s29, s36
 s_lshl_b32 s28, s34, 5
 s_add_u32 s29, s29, s28
 s_cmp_lt_u32 s36, s40
 s_cselect_b32 s35, s41, s42
 s_cselect_b32 s32, 1, 0
 s_lshr_b32 s36, s33, 1
 s_and_b32 s37, s33, 1
 v_lshrrev_b32 v232, 3, v224
 v_lshrrev_b32 v233, 4, v224
 v_and_b32 v234, 7, v224
 v_xor_b32 v235, v234, v233
 v_lshlrev_b32 v237, 11, v232
 v_lshl_add_u32 v235, v235, 4, v237
 s_and_b32 s40, s30, 3
 s_lshl_b32 s40, s40, 9
 s_lshr_b32 s41, s30, 2
 s_lshl_b32 s41, s41, 10
 s_add_u32 s71, s40, s41
 s_and_b32 s71, s71, 0
 s_lshl_b32 s38, s34, 19
 s_mov_b32 s50, 0
 s_mov_b32 s51, 0
 s_mov_b32 s14, 0x400000
 s_mov_b32 s15, 0x20000
 s_mov_b32 s19, 0x20000
 s_cmp_eq_u32 s32, 1
 s_cbranch_scc1 L1_h
 s_cmp_lg_u32 s33, 3
 s_cbranch_scc1 L1q_dma
 s_waitcnt lgkmcnt(0)
 s_mov_b32 s12, s4
 s_mov_b32 s13, s5
 s_mov_b32 s16, s6
 s_mov_b32 s17, s7
 s_mov_b32 s18, 0x600000
 s_lshl_b32 s40, s2, 14
 v_lshrrev_b32 v232, 1, v224
 v_lshlrev_b32 v232, 11, v232
 v_and_b32 v233, 1, v224
 v_lshl_add_u32 v232, v233, 6, v232
 v_add_u32 v232, s40, v232
 v_mov_b32 v234, 0x80000000
 v_cmp_gt_u32 vcc, 16, v224
    s_nop 1
 v_cndmask_b32 v239, v234, v232, vcc
 s_lshl_b32 s40, s34, 4
 s_add_u32 s40, s40, s35
 s_mul_i32 s40, s40, 3072
 v_lshl_add_u32 v232, v224, 6, s40
 v_cmp_gt_u32 vcc, 48, v224
    s_nop 1
 v_cndmask_b32 v252, v234, v232, vcc
 s_mov_b32 s74, 0x200000
 s_mov_b32 s75, 0x20000
 s_mov_b32 s76, s10
 s_mov_b32 s77, s11
 s_mov_b32 s78, 0x700000
 s_mov_b32 s79, 0x20000
 s_lshl_b32 s40, s2, 10
 s_mul_i32 s41, s2, 3584
 v_lshlrev_b32 v232, 6, v224
 v_add_u32 v233, s40, v232
 v_cmp_gt_u32 vcc, 16, v224
    s_nop 1
 v_cndmask_b32 v253, v234, v233, vcc
 v_add_u32 v233, s41, v232
 v_cmp_gt_u32 vcc, 56, v224
    s_nop 1
 v_cndmask_b32 v254, v234, v233, vcc
 s_mov_b32 s54, 4294443008
 s_mov_b32 s55, 4293132288
 s_movk_i32 s50, 512
 s_mov_b32 s51, 1572864
 v_and_b32 v232, 15, v224
 v_lshrrev_b32 v233, 4, v224
 v_lshrrev_b32 v234, 1, v232
 v_xor_b32 v235, v233, v234
 v_xor_b32 v236, 4, v235
 v_lshlrev_b32 v235, 4, v235
 v_lshlrev_b32 v236, 4, v236
 s_lshl_b32 s40, s36, 14
 v_lshl_add_u32 v237, v232, 7, s40
 v_add_u32 v225, v237, v235
 v_add_u32 v226, v237, v236
 v_add_u32 v227, 49152, v225
 v_add_u32 v228, 49152, v226
 s_mul_i32 s40, s36, -34816
 s_add_i32 s40, s40, 0x8000
 v_add_u32 v208, s40, v225
 v_add_u32 v209, s40, v226
 v_add_u32 v210, s40, v227
 v_add_u32 v211, s40, v228
 v_lshrrev_b32 v232, 4, v224
 v_bfe_u32 v233, v224, 2, 2
 v_and_b32 v234, 3, v224
 v_mul_u32_u24 v235, 3072, v232
 v_mul_u32_u24 v236, 384, v233
 v_add_u32 v235, v235, v236
 v_lshl_add_u32 v235, v234, 3, v235
 v_lshrrev_b32 v236, 1, v233
 v_and_b32 v237, 1, v232
 v_lshl_or_b32 v236, v237, 1, v236
 s_lshl_b32 s40, s37, 1
 s_add_u32 s41, s40, 0
 v_xor_b32 v237, s41, v236
 v_lshl_add_u32 v229, v237, 5, v235
 s_add_u32 s41, s40, 1
 v_xor_b32 v237, s41, v236
 v_lshl_add_u32 v230, v237, 5, v235
 s_mov_b32 s22, 0x10000000
 s_mov_b32 s23, 0x20000
 s_mov_b32 s26, 2048
 s_mov_b32 s27, 0x20000
 v_and_b32 v238, 15, v224
 v_lshlrev_b32 v238, 4, v238
 v_lshrrev_b32 v232, 4, v224
 v_lshl_add_u32 v255, v232, 11, v238
 s_mov_b32 s39, s29
 s_lshl_b32 s56, s29, 14
 s_add_u32 s58, s56, 8192
 s_mov_b32 s57, 0
 s_mov_b32 s64, s4
 s_mov_b32 s65, s5
 s_mov_b32 s66, 0x400000
 s_mov_b32 s67, 0x20000
 s_mov_b32 s68, 0xffff0000
 s_mov_b32 s69, 0x3f803f80
 v_mov_b32 v236, 0
 v_mov_b32 v237, 0
 v_lshrrev_b32 v232, 4, v224
 v_and_b32 v233, 15, v224
 v_lshrrev_b32 v234, 5, v224
 s_lshl_b32 s40, s33, 1
 v_add_u32 v234, s40, v234
 v_lshlrev_b32 v234, 4, v234
 v_lshlrev_b32 v223, 3, v233
 v_xor_b32 v234, v234, v223
 v_lshl_add_u32 v234, v232, 7, v234
 s_lshl_b32 s40, s35, 11
 s_lshl_b32 s41, s33, 9
 s_add_u32 s40, s40, s41
 v_add_u32 v213, s40, v234
 v_add_u32 v214, 49152, v213
 v_add_u32 v212, 159744, v223
 v_lshl_add_u32 v222, v232, 11, v223
 s_lshl_b32 s56, s40, 4
 s_add_u32 s56, s56, s38
 v_mov_b32 v215, 0
 s_mov_b32 s68, 0xffff0000
 s_mov_b32 s69, 0x3f803f80
 s_lshl_b32 s39, s34, 4
 s_add_u32 s39, s39, s35
 s_lshl_b32 s39, s39, 2
 s_add_u32 s39, s39, s33
 v_lshlrev_b32 v221, 4, v224
 s_lshl_b32 s40, s30, 1
 s_and_b32 s41, s31, 1
 s_add_u32 s40, s40, s41
 s_lshl_b32 s40, s40, 8
 s_lshr_b32 s41, s31, 1
 s_lshl_b32 s41, s41, 2
 s_add_u32 s40, s40, s41
 s_add_u32 s40, s40, 18939904
 s_lshr_b32 s41, s30, 1
 s_lshl_b32 s41, s41, 5
 s_add_u32 s41, s41, s31
 s_lshl_b32 s41, s41, 8
 s_add_u32 s41, s41, 18944000
 s_and_b32 s42, s30, 1
 s_cmp_eq_u32 s42, 1
 s_cselect_b32 s41, s41, s40
 v_mov_b32 v232, 0
 buffer_store_dword v232, off, s[20:23], s40 sc1
 buffer_store_dword v232, off, s[20:23], s40 offset:128 sc1
 buffer_store_dword v232, off, s[20:23], s41 sc1
 s_and_b32 s3, s3, 15
 s_mul_i32 s40, s3, s3
 s_lshl_b32 s40, s40, 16
 s_lshl_b32 s41, s3, 8
 s_add_u32 s40, s40, s41
 s_add_u32 s40, s40, 1
 v_mov_b32 v232, s40
 v_accvgpr_write_b32 a252, v232
 s_lshl_b32 s59, s30, 2
 s_mul_i32 s40, s31, 52429
 s_lshr_b32 s40, s40, 19
 s_mul_i32 s40, s40, 10
 s_sub_u32 s28, s31, s40
 s_mov_b32 m0, 159744
    s_nop 0
 buffer_load_dwordx4 v221, s[24:27], 0 offen lds
 buffer_load_dwordx4 v221, s[24:27], 0 offen offset:1024 lds
 buffer_load_dwordx2 a[208:209], v223, s[24:27], 0 offen offset:1664
 buffer_load_dwordx2 a[210:211], v222, s[12:15], s56 offen offset:1664
 buffer_load_dwordx2 a[212:213], v223, s[24:27], 0 offen offset:1792
 buffer_load_dwordx2 a[214:215], v222, s[12:15], s56 offen offset:1792
 buffer_load_dwordx2 a[216:217], v223, s[24:27], 0 offen offset:1920
 buffer_load_dwordx2 a[218:219], v222, s[12:15], s56 offen offset:1920
 s_barrier
 ds_read_b64_tr_b16 a[36:37], v229 offset:0
 ds_read_b64_tr_b16 a[38:39], v229 offset:1536
 ds_read_b128 a[32:35], v210
 ds_read_b64_tr_b16 a[40:41], v230 offset:0
 ds_read_b64_tr_b16 a[42:43], v230 offset:1536
 ds_read_b128 a[0:3], v227 offset:0
 ds_read_b64_tr_b16 a[44:45], v229 offset:128
 ds_read_b64_tr_b16 a[46:47], v229 offset:1664
 ds_read_b128 a[4:7], v227 offset:2048
 ds_read_b64_tr_b16 a[48:49], v230 offset:128
 ds_read_b64_tr_b16 a[50:51], v230 offset:1664
 ds_read_b128 a[8:11], v227 offset:4096
 ds_read_b64_tr_b16 a[52:53], v229 offset:256
 ds_read_b64_tr_b16 a[54:55], v229 offset:1792
 ds_read_b128 a[12:15], v227 offset:6144
 ds_read_b64_tr_b16 a[56:57], v230 offset:256
 ds_read_b64_tr_b16 a[58:59], v230 offset:1792
 ds_read_b128 a[16:19], v227 offset:8192
 ds_read_b128 a[20:23], v227 offset:10240
 ds_read_b128 a[24:27], v227 offset:12288
 ds_read_b128 a[28:31], v227 offset:14336
 s_waitcnt lgkmcnt(0)
 s_waitcnt vmcnt(6)
 s_barrier
 v_mfma_f32_16x16x32_bf16 v[64:67], a[44:47], a[32:35], 0
 ds_read_b64_tr_b16 a[96:97], v229 offset:12288
 v_mfma_f32_16x16x32_bf16 v[68:71], a[48:51], a[32:35], 0
 ds_read_b64_tr_b16 a[98:99], v229 offset:13824
 v_mfma_f32_16x16x32_bf16 v[136:139], a[32:35], a[52:55], 0
 ds_read_b128 a[92:95], v211
 v_mfma_f32_16x16x32_bf16 v[172:175], a[32:35], a[56:59], 0
 v_mfma_f32_16x16x32_bf16 v[72:75], a[44:47], a[0:3], 0
 ds_read_b64_tr_b16 a[100:101], v230 offset:12288
 v_mfma_f32_16x16x32_bf16 v[80:83], a[44:47], a[4:7], 0
 buffer_load_dword a204, v252, s[16:19], s51 offen
 s_add_u32 s51, s51, 393216
 v_mfma_f32_16x16x32_bf16 v[84:87], a[48:51], a[4:7], 0
 ds_read_b64_tr_b16 a[102:103], v230 offset:13824
 v_mfma_f32_16x16x32_bf16 v[76:79], a[48:51], a[0:3], 0
 v_mfma_f32_16x16x32_bf16 v[0:3], a[36:39], a[0:3], 0
 ds_read_b128 a[60:63], v228 offset:0
 v_mfma_f32_16x16x32_bf16 v[8:11], a[36:39], a[4:7], 0
 v_mfma_f32_16x16x32_bf16 v[12:15], a[40:43], a[4:7], 0
 ds_read_b64_tr_b16 a[104:105], v229 offset:12416
 v_mfma_f32_16x16x32_bf16 v[4:7], a[40:43], a[0:3], 0
 v_mfma_f32_16x16x32_bf16 v[140:143], a[0:3], a[52:55], 0
 ds_read_b64_tr_b16 a[106:107], v229 offset:13952
 v_mfma_f32_16x16x32_bf16 v[144:147], a[4:7], a[52:55], 0
 v_mfma_f32_16x16x32_bf16 v[180:183], a[4:7], a[56:59], 0
 ds_read_b128 a[64:67], v228 offset:2048
 v_mfma_f32_16x16x32_bf16 v[176:179], a[0:3], a[56:59], 0
 v_mfma_f32_16x16x32_bf16 v[184:187], a[8:11], a[56:59], 0
 ds_read_b64_tr_b16 a[108:109], v230 offset:12416
 v_mfma_f32_16x16x32_bf16 v[188:191], a[12:15], a[56:59], 0
 v_mfma_f32_16x16x32_bf16 v[152:155], a[12:15], a[52:55], 0
 ds_read_b64_tr_b16 a[110:111], v230 offset:13952
 v_mfma_f32_16x16x32_bf16 v[148:151], a[8:11], a[52:55], 0
 v_mfma_f32_16x16x32_bf16 v[20:23], a[40:43], a[8:11], 0
 ds_read_b128 a[68:71], v228 offset:4096
 v_mfma_f32_16x16x32_bf16 v[28:31], a[40:43], a[12:15], 0
 v_mfma_f32_16x16x32_bf16 v[24:27], a[36:39], a[12:15], 0
 ds_read_b64_tr_b16 a[112:113], v229 offset:12544
 v_mfma_f32_16x16x32_bf16 v[16:19], a[36:39], a[8:11], 0
 v_mfma_f32_16x16x32_bf16 v[92:95], a[48:51], a[8:11], 0
 ds_read_b64_tr_b16 a[114:115], v229 offset:14080
 v_mfma_f32_16x16x32_bf16 v[100:103], a[48:51], a[12:15], 0
 v_mfma_f32_16x16x32_bf16 v[96:99], a[44:47], a[12:15], 0
 ds_read_b128 a[72:75], v228 offset:6144
 s_cmp_lt_u32 s50, 2048
 s_cselect_b32 s14, 0x400000, 0
 v_mfma_f32_16x16x32_bf16 v[88:91], a[44:47], a[8:11], 0
 buffer_load_dword a205, v239, s[12:15], s50 offen
 s_add_u32 s50, s50, 128
 v_mfma_f32_16x16x32_bf16 v[104:107], a[44:47], a[16:19], 0
 ds_read_b64_tr_b16 a[116:117], v230 offset:12544
 v_mfma_f32_16x16x32_bf16 v[112:115], a[44:47], a[20:23], 0
 v_mfma_f32_16x16x32_bf16 v[116:119], a[48:51], a[20:23], 0
 ds_read_b64_tr_b16 a[118:119], v230 offset:14080
 v_mfma_f32_16x16x32_bf16 v[108:111], a[48:51], a[16:19], 0
 v_mfma_f32_16x16x32_bf16 v[32:35], a[36:39], a[16:19], 0
 ds_read_b128 a[76:79], v228 offset:8192
 v_mfma_f32_16x16x32_bf16 v[40:43], a[36:39], a[20:23], 0
 v_mfma_f32_16x16x32_bf16 v[44:47], a[40:43], a[20:23], 0
 ds_read_b128 a[80:83], v228 offset:10240
 v_mfma_f32_16x16x32_bf16 v[36:39], a[40:43], a[16:19], 0
 v_mfma_f32_16x16x32_bf16 v[156:159], a[16:19], a[52:55], 0
 ds_read_b128 a[84:87], v228 offset:12288
 v_mfma_f32_16x16x32_bf16 v[160:163], a[20:23], a[52:55], 0
 v_mfma_f32_16x16x32_bf16 v[196:199], a[20:23], a[56:59], 0
 ds_read_b128 a[88:91], v228 offset:14336
 v_mfma_f32_16x16x32_bf16 v[192:195], a[16:19], a[56:59], 0
 v_mfma_f32_16x16x32_bf16 v[200:203], a[24:27], a[56:59], 0
 v_mfma_f32_16x16x32_bf16 v[204:207], a[28:31], a[56:59], 0
 v_mfma_f32_16x16x32_bf16 v[168:171], a[28:31], a[52:55], 0
 v_mfma_f32_16x16x32_bf16 v[164:167], a[24:27], a[52:55], 0
 v_mfma_f32_16x16x32_bf16 v[52:55], a[40:43], a[24:27], 0
 v_mfma_f32_16x16x32_bf16 v[60:63], a[40:43], a[28:31], 0
 v_mfma_f32_16x16x32_bf16 v[56:59], a[36:39], a[28:31], 0
 ds_read_b64 v[216:217], v212
 ds_read_b64 v[218:219], v214
 v_add_u32 v212, 128, v212
 v_mfma_f32_16x16x32_bf16 v[48:51], a[36:39], a[24:27], 0
 v_mfma_f32_16x16x32_bf16 v[124:127], a[48:51], a[24:27], 0
 v_mfma_f32_16x16x32_bf16 v[132:135], a[48:51], a[28:31], 0
 v_mfma_f32_16x16x32_bf16 v[128:131], a[44:47], a[28:31], 0
 v_mfma_f32_16x16x32_bf16 v[120:123], a[44:47], a[24:27], 0
 s_waitcnt lgkmcnt(0)
 s_barrier
 v_mfma_f32_16x16x32_bf16 v[64:67], a[104:107], a[92:95], v[64:67]
 v_add_u32 v227, 86016, v225
 v_add_u32 v228, 86016, v226
 v_add_u32 v210, 86016, v208
 ds_read_b64_tr_b16 a[36:37], v229 offset:24576
 v_mfma_f32_16x16x32_bf16 v[68:71], a[108:111], a[92:95], v[68:71]
 v_add_u32 v211, 86016, v209
 v_add_u32 v214, 86016, v213
 ds_read_b64_tr_b16 a[38:39], v229 offset:26112
 v_mfma_f32_16x16x32_bf16 v[136:139], a[92:95], a[112:115], v[136:139]
 ds_read_b128 a[32:35], v210
 v_mfma_f32_16x16x32_bf16 v[172:175], a[92:95], a[116:119], v[172:175]
 v_mfma_f32_16x16x32_bf16 v[72:75], a[104:107], a[60:63], v[72:75]
 ds_read_b64_tr_b16 a[40:41], v230 offset:24576
 v_lshlrev_b32 v220, 16, v216
 v_mfma_f32_16x16x32_bf16 v[80:83], a[104:107], a[64:67], v[80:83]
 buffer_load_dword a204, v252, s[16:19], s51 offen
 s_add_u32 s51, s51, 393216
 v_mfma_f32_16x16x32_bf16 v[84:87], a[108:111], a[64:67], v[84:87]
 ds_read_b64_tr_b16 a[42:43], v230 offset:26112
 v_mfma_f32_16x16x32_bf16 v[76:79], a[108:111], a[60:63], v[76:79]
 v_mfma_f32_16x16x32_bf16 v[0:3], a[96:99], a[60:63], v[0:3]
 ds_read_b128 a[0:3], v227 offset:0
 v_mfma_f32_16x16x32_bf16 v[8:11], a[96:99], a[64:67], v[8:11]
 v_mfma_f32_16x16x32_bf16 v[12:15], a[100:103], a[64:67], v[12:15]
 ds_read_b64_tr_b16 a[44:45], v229 offset:24704
 v_and_b32 v216, s68, v216
 v_mfma_f32_16x16x32_bf16 v[4:7], a[100:103], a[60:63], v[4:7]
 v_mfma_f32_16x16x32_bf16 v[140:143], a[60:63], a[112:115], v[140:143]
 ds_read_b64_tr_b16 a[46:47], v229 offset:26240
 v_mfma_f32_16x16x32_bf16 v[144:147], a[64:67], a[112:115], v[144:147]
 v_mfma_f32_16x16x32_bf16 v[180:183], a[64:67], a[116:119], v[180:183]
 ds_read_b128 a[4:7], v227 offset:2048
 v_mfma_f32_16x16x32_bf16 v[176:179], a[60:63], a[116:119], v[176:179]
 v_mfma_f32_16x16x32_bf16 v[184:187], a[68:71], a[116:119], v[184:187]
 ds_read_b64_tr_b16 a[48:49], v230 offset:24704
 v_lshlrev_b32 v221, 16, v218
 v_mfma_f32_16x16x32_bf16 v[188:191], a[72:75], a[116:119], v[188:191]
 v_mfma_f32_16x16x32_bf16 v[152:155], a[72:75], a[112:115], v[152:155]
 ds_read_b64_tr_b16 a[50:51], v230 offset:26240
 v_mfma_f32_16x16x32_bf16 v[148:151], a[68:71], a[112:115], v[148:151]
 v_mfma_f32_16x16x32_bf16 v[20:23], a[100:103], a[68:71], v[20:23]
 ds_read_b128 a[8:11], v227 offset:4096
 v_mfma_f32_16x16x32_bf16 v[28:31], a[100:103], a[72:75], v[28:31]
 v_mfma_f32_16x16x32_bf16 v[24:27], a[96:99], a[72:75], v[24:27]
 ds_read_b64_tr_b16 a[52:53], v229 offset:24832
 v_and_b32 v218, s68, v218
 v_mfma_f32_16x16x32_bf16 v[16:19], a[96:99], a[68:71], v[16:19]
 v_mfma_f32_16x16x32_bf16 v[92:95], a[108:111], a[68:71], v[92:95]
 ds_read_b64_tr_b16 a[54:55], v229 offset:26368
 v_mfma_f32_16x16x32_bf16 v[100:103], a[108:111], a[72:75], v[100:103]
 v_mfma_f32_16x16x32_bf16 v[96:99], a[104:107], a[72:75], v[96:99]
 ds_read_b128 a[12:15], v227 offset:6144
 s_cmp_lt_u32 s50, 2048
 s_cselect_b32 s14, 0x400000, 0
 v_mfma_f32_16x16x32_bf16 v[88:91], a[104:107], a[68:71], v[88:91]
 buffer_load_dword a205, v239, s[12:15], s50 offen
 s_add_u32 s50, s50, 128
 v_mfma_f32_16x16x32_bf16 v[104:107], a[104:107], a[76:79], v[104:107]
 ds_read_b64_tr_b16 a[56:57], v230 offset:24832
 v_mul_f32 v221, v221, v220
 v_mfma_f32_16x16x32_bf16 v[112:115], a[104:107], a[80:83], v[112:115]
 v_mfma_f32_16x16x32_bf16 v[116:119], a[108:111], a[80:83], v[116:119]
 ds_read_b64_tr_b16 a[58:59], v230 offset:26368
 v_mfma_f32_16x16x32_bf16 v[108:111], a[108:111], a[76:79], v[108:111]
 v_mfma_f32_16x16x32_bf16 v[32:35], a[96:99], a[76:79], v[32:35]
 ds_read_b128 a[16:19], v227 offset:8192
 v_mfma_f32_16x16x32_bf16 v[40:43], a[96:99], a[80:83], v[40:43]
 v_mfma_f32_16x16x32_bf16 v[44:47], a[100:103], a[80:83], v[44:47]
 ds_read_b128 a[20:23], v227 offset:10240
 v_mul_f32 v218, v218, v216
 v_mfma_f32_16x16x32_bf16 v[36:39], a[100:103], a[76:79], v[36:39]
 v_mfma_f32_16x16x32_bf16 v[156:159], a[76:79], a[112:115], v[156:159]
 ds_read_b128 a[24:27], v227 offset:12288
 v_mfma_f32_16x16x32_bf16 v[160:163], a[80:83], a[112:115], v[160:163]
 v_mfma_f32_16x16x32_bf16 v[196:199], a[80:83], a[116:119], v[196:199]
 ds_read_b128 a[28:31], v227 offset:14336
 v_mfma_f32_16x16x32_bf16 v[192:195], a[76:79], a[116:119], v[192:195]
 v_mfma_f32_16x16x32_bf16 v[200:203], a[84:87], a[116:119], v[200:203]
 v_cvt_pk_bf16_f32 v221, v221, v218
 v_mfma_f32_16x16x32_bf16 v[204:207], a[88:91], a[116:119], v[204:207]
 v_mfma_f32_16x16x32_bf16 v[168:171], a[88:91], a[112:115], v[168:171]
 v_mfma_f32_16x16x32_bf16 v[164:167], a[84:87], a[112:115], v[164:167]
 v_mfma_f32_16x16x32_bf16 v[52:55], a[100:103], a[84:87], v[52:55]
 v_mfma_f32_16x16x32_bf16 v[60:63], a[100:103], a[88:91], v[60:63]
 v_mfma_f32_16x16x32_bf16 v[56:59], a[96:99], a[88:91], v[56:59]
 v_dot2_f32_bf16 v215, v221, s69, v215
 v_mfma_f32_16x16x32_bf16 v[48:51], a[96:99], a[84:87], v[48:51]
 v_mfma_f32_16x16x32_bf16 v[124:127], a[108:111], a[84:87], v[124:127]
 v_mfma_f32_16x16x32_bf16 v[132:135], a[108:111], a[88:91], v[132:135]
 v_mfma_f32_16x16x32_bf16 v[128:131], a[104:107], a[88:91], v[128:131]
 v_mfma_f32_16x16x32_bf16 v[120:123], a[104:107], a[84:87], v[120:123]
 s_waitcnt lgkmcnt(0)
 s_waitcnt vmcnt(4)
 s_barrier
 v_mfma_f32_16x16x32_bf16 v[64:67], a[44:47], a[32:35], v[64:67]
 ds_read_b64_tr_b16 a[96:97], v229 offset:36864
 v_mfma_f32_16x16x32_bf16 v[68:71], a[48:51], a[32:35], v[68:71]
 ds_read_b64_tr_b16 a[98:99], v229 offset:38400
 v_mfma_f32_16x16x32_bf16 v[136:139], a[32:35], a[52:55], v[136:139]
 ds_read_b128 a[92:95], v211
 v_mfma_f32_16x16x32_bf16 v[172:175], a[32:35], a[56:59], v[172:175]
 v_mfma_f32_16x16x32_bf16 v[72:75], a[44:47], a[0:3], v[72:75]
 ds_read_b64_tr_b16 a[100:101], v230 offset:36864
 v_lshlrev_b32 v220, 16, v217
 v_mfma_f32_16x16x32_bf16 v[80:83], a[44:47], a[4:7], v[80:83]
 buffer_load_dword a204, v252, s[16:19], s51 offen
 s_add_u32 s51, s51, 393216
 v_mfma_f32_16x16x32_bf16 v[84:87], a[48:51], a[4:7], v[84:87]
 ds_read_b64_tr_b16 a[102:103], v230 offset:38400
 v_and_b32 v217, s68, v217
 v_mfma_f32_16x16x32_bf16 v[76:79], a[48:51], a[0:3], v[76:79]
 v_mfma_f32_16x16x32_bf16 v[0:3], a[36:39], a[0:3], v[0:3]
 ds_read_b128 a[60:63], v228 offset:0
 v_mfma_f32_16x16x32_bf16 v[8:11], a[36:39], a[4:7], v[8:11]
 v_lshlrev_b32 v221, 16, v219
 v_mfma_f32_16x16x32_bf16 v[12:15], a[40:43], a[4:7], v[12:15]
 ds_read_b64_tr_b16 a[104:105], v229 offset:36992
 v_mfma_f32_16x16x32_bf16 v[4:7], a[40:43], a[0:3], v[4:7]
 v_and_b32 v219, s68, v219
 v_mfma_f32_16x16x32_bf16 v[140:143], a[0:3], a[52:55], v[140:143]
 ds_read_b64_tr_b16 a[106:107], v229 offset:38528
 v_mfma_f32_16x16x32_bf16 v[144:147], a[4:7], a[52:55], v[144:147]
 v_mfma_f32_16x16x32_bf16 v[180:183], a[4:7], a[56:59], v[180:183]
 ds_read_b128 a[64:67], v228 offset:2048
 v_mul_f32 v221, v221, v220
 v_mfma_f32_16x16x32_bf16 v[176:179], a[0:3], a[56:59], v[176:179]
 v_mfma_f32_16x16x32_bf16 v[184:187], a[8:11], a[56:59], v[184:187]
 ds_read_b64_tr_b16 a[108:109], v230 offset:36992
 v_mul_f32 v219, v219, v217
 v_mfma_f32_16x16x32_bf16 v[188:191], a[12:15], a[56:59], v[188:191]
 v_mfma_f32_16x16x32_bf16 v[152:155], a[12:15], a[52:55], v[152:155]
 ds_read_b64_tr_b16 a[110:111], v230 offset:38528
 v_mfma_f32_16x16x32_bf16 v[148:151], a[8:11], a[52:55], v[148:151]
 v_cvt_pk_bf16_f32 v221, v221, v219
 v_mfma_f32_16x16x32_bf16 v[20:23], a[40:43], a[8:11], v[20:23]
 ds_read_b128 a[68:71], v228 offset:4096
 v_mfma_f32_16x16x32_bf16 v[28:31], a[40:43], a[12:15], v[28:31]
 v_dot2_f32_bf16 v215, v221, s69, v215
 v_mfma_f32_16x16x32_bf16 v[24:27], a[36:39], a[12:15], v[24:27]
 ds_read_b64_tr_b16 a[112:113], v229 offset:37120
 v_mfma_f32_16x16x32_bf16 v[16:19], a[36:39], a[8:11], v[16:19]
 v_mfma_f32_16x16x32_bf16 v[92:95], a[48:51], a[8:11], v[92:95]
 ds_read_b64_tr_b16 a[114:115], v229 offset:38656
 ds_read_b64 v[216:217], v212
 ds_read_b64 v[218:219], v214
 v_add_u32 v212, 128, v212
 v_mfma_f32_16x16x32_bf16 v[100:103], a[48:51], a[12:15], v[100:103]
 v_mfma_f32_16x16x32_bf16 v[96:99], a[44:47], a[12:15], v[96:99]
 ds_read_b128 a[72:75], v228 offset:6144
 s_cmp_lt_u32 s50, 2048
 s_cselect_b32 s14, 0x400000, 0
 v_accvgpr_read_b32 v222, a208
 v_mfma_f32_16x16x32_bf16 v[88:91], a[44:47], a[8:11], v[88:91]
 buffer_load_dword a205, v239, s[12:15], s50 offen
 s_add_u32 s50, s50, 128
 v_mfma_f32_16x16x32_bf16 v[104:107], a[44:47], a[16:19], v[104:107]
 ds_read_b64_tr_b16 a[116:117], v230 offset:37120
 v_mfma_f32_16x16x32_bf16 v[112:115], a[44:47], a[20:23], v[112:115]
 v_accvgpr_read_b32 v223, a210
 v_mfma_f32_16x16x32_bf16 v[116:119], a[48:51], a[20:23], v[116:119]
 ds_read_b64_tr_b16 a[118:119], v230 offset:38656
 v_mfma_f32_16x16x32_bf16 v[108:111], a[48:51], a[16:19], v[108:111]
 v_lshlrev_b32 v220, 16, v222
 v_mfma_f32_16x16x32_bf16 v[32:35], a[36:39], a[16:19], v[32:35]
 ds_read_b128 a[76:79], v228 offset:8192
 v_mfma_f32_16x16x32_bf16 v[40:43], a[36:39], a[20:23], v[40:43]
 v_mfma_f32_16x16x32_bf16 v[44:47], a[40:43], a[20:23], v[44:47]
 ds_read_b128 a[80:83], v228 offset:10240
 v_and_b32 v222, s68, v222
 v_mfma_f32_16x16x32_bf16 v[36:39], a[40:43], a[16:19], v[36:39]
 v_mfma_f32_16x16x32_bf16 v[156:159], a[16:19], a[52:55], v[156:159]
 ds_read_b128 a[84:87], v228 offset:12288
 v_lshlrev_b32 v221, 16, v223
 v_mfma_f32_16x16x32_bf16 v[160:163], a[20:23], a[52:55], v[160:163]
 v_mfma_f32_16x16x32_bf16 v[196:199], a[20:23], a[56:59], v[196:199]
 ds_read_b128 a[88:91], v228 offset:14336
 v_mfma_f32_16x16x32_bf16 v[192:195], a[16:19], a[56:59], v[192:195]
 v_and_b32 v223, s68, v223
 v_mfma_f32_16x16x32_bf16 v[200:203], a[24:27], a[56:59], v[200:203]
 v_mfma_f32_16x16x32_bf16 v[204:207], a[28:31], a[56:59], v[204:207]
 v_mul_f32 v221, v221, v220
 v_mfma_f32_16x16x32_bf16 v[168:171], a[28:31], a[52:55], v[168:171]
 v_mfma_f32_16x16x32_bf16 v[164:167], a[24:27], a[52:55], v[164:167]
 v_mfma_f32_16x16x32_bf16 v[52:55], a[40:43], a[24:27], v[52:55]
 v_mul_f32 v223, v223, v222
 v_mfma_f32_16x16x32_bf16 v[60:63], a[40:43], a[28:31], v[60:63]
 v_mfma_f32_16x16x32_bf16 v[56:59], a[36:39], a[28:31], v[56:59]
 v_cvt_pk_bf16_f32 v221, v221, v223
 v_mfma_f32_16x16x32_bf16 v[48:51], a[36:39], a[24:27], v[48:51]
 v_mfma_f32_16x16x32_bf16 v[124:127], a[48:51], a[24:27], v[124:127]
 v_mfma_f32_16x16x32_bf16 v[132:135], a[48:51], a[28:31], v[132:135]
 v_dot2_f32_bf16 v215, v221, s69, v215
 v_mfma_f32_16x16x32_bf16 v[128:131], a[44:47], a[28:31], v[128:131]
 v_mfma_f32_16x16x32_bf16 v[120:123], a[44:47], a[24:27], v[120:123]
 s_waitcnt lgkmcnt(0)
 s_barrier
 v_mfma_f32_16x16x32_bf16 v[64:67], a[104:107], a[92:95], v[64:67]
 v_add_u32 v227, 122880, v225
 v_add_u32 v228, 122880, v226
 v_add_u32 v210, 122880, v208
 ds_read_b64_tr_b16 a[36:37], v229 offset:0
 v_mfma_f32_16x16x32_bf16 v[68:71], a[108:111], a[92:95], v[68:71]
 v_add_u32 v211, 122880, v209
 v_add_u32 v214, 122880, v213
 s_mov_b32 s46, 122880
 ds_read_b64_tr_b16 a[38:39], v229 offset:1536
 v_mfma_f32_16x16x32_bf16 v[136:139], a[92:95], a[112:115], v[136:139]
 s_mov_b32 s47, 49152
 s_mov_b32 s48, 86016
 s_mov_b32 s52, 5
 ds_read_b128 a[32:35], v210
 v_mfma_f32_16x16x32_bf16 v[172:175], a[92:95], a[116:119], v[172:175]
 v_mfma_f32_16x16x32_bf16 v[72:75], a[104:107], a[60:63], v[72:75]
 ds_read_b64_tr_b16 a[40:41], v230 offset:0
 v_lshlrev_b32 v220, 16, v216
 v_mfma_f32_16x16x32_bf16 v[80:83], a[104:107], a[64:67], v[80:83]
 buffer_load_dword a204, v252, s[16:19], s51 offen
 s_add_u32 s51, s51, 393216
 v_mfma_f32_16x16x32_bf16 v[84:87], a[108:111], a[64:67], v[84:87]
 ds_read_b64_tr_b16 a[42:43], v230 offset:1536
 v_and_b32 v216, s68, v216
 v_mfma_f32_16x16x32_bf16 v[76:79], a[108:111], a[60:63], v[76:79]
 v_mfma_f32_16x16x32_bf16 v[0:3], a[96:99], a[60:63], v[0:3]
 ds_read_b128 a[0:3], v227 offset:0
 v_mfma_f32_16x16x32_bf16 v[8:11], a[96:99], a[64:67], v[8:11]
 v_lshlrev_b32 v221, 16, v218
 v_mfma_f32_16x16x32_bf16 v[12:15], a[100:103], a[64:67], v[12:15]
 ds_read_b64_tr_b16 a[44:45], v229 offset:128
 v_mfma_f32_16x16x32_bf16 v[4:7], a[100:103], a[60:63], v[4:7]
 v_mfma_f32_16x16x32_bf16 v[140:143], a[60:63], a[112:115], v[140:143]
 ds_read_b64_tr_b16 a[46:47], v229 offset:1664
 v_and_b32 v218, s68, v218
 v_mfma_f32_16x16x32_bf16 v[144:147], a[64:67], a[112:115], v[144:147]
 v_mfma_f32_16x16x32_bf16 v[180:183], a[64:67], a[116:119], v[180:183]
 ds_read_b128 a[4:7], v227 offset:2048
 v_mul_f32 v221, v221, v220
 v_mfma_f32_16x16x32_bf16 v[176:179], a[60:63], a[116:119], v[176:179]
 v_mfma_f32_16x16x32_bf16 v[184:187], a[68:71], a[116:119], v[184:187]
 ds_read_b64_tr_b16 a[48:49], v230 offset:128
 v_mfma_f32_16x16x32_bf16 v[188:191], a[72:75], a[116:119], v[188:191]
 v_mul_f32 v218, v218, v216
 v_mfma_f32_16x16x32_bf16 v[152:155], a[72:75], a[112:115], v[152:155]
 ds_read_b64_tr_b16 a[50:51], v230 offset:1664
 v_mfma_f32_16x16x32_bf16 v[148:151], a[68:71], a[112:115], v[148:151]
 v_mfma_f32_16x16x32_bf16 v[20:23], a[100:103], a[68:71], v[20:23]
 ds_read_b128 a[8:11], v227 offset:4096
 v_cvt_pk_bf16_f32 v221, v221, v218
 v_mfma_f32_16x16x32_bf16 v[28:31], a[100:103], a[72:75], v[28:31]
 v_mfma_f32_16x16x32_bf16 v[24:27], a[96:99], a[72:75], v[24:27]
 ds_read_b64_tr_b16 a[52:53], v229 offset:256
 v_dot2_f32_bf16 v215, v221, s69, v215
 v_mfma_f32_16x16x32_bf16 v[16:19], a[96:99], a[68:71], v[16:19]
 v_mfma_f32_16x16x32_bf16 v[92:95], a[108:111], a[68:71], v[92:95]
 ds_read_b64_tr_b16 a[54:55], v229 offset:1792
 v_mfma_f32_16x16x32_bf16 v[100:103], a[108:111], a[72:75], v[100:103]
 v_accvgpr_read_b32 v222, a209
 v_mfma_f32_16x16x32_bf16 v[96:99], a[104:107], a[72:75], v[96:99]
 ds_read_b128 a[12:15], v227 offset:6144
 s_cmp_lt_u32 s50, 2048
 s_cselect_b32 s14, 0x400000, 0
 v_mfma_f32_16x16x32_bf16 v[88:91], a[104:107], a[68:71], v[88:91]
 buffer_load_dword a205, v239, s[12:15], s50 offen
 s_add_u32 s50, s50, 128
 v_mfma_f32_16x16x32_bf16 v[104:107], a[104:107], a[76:79], v[104:107]
 ds_read_b64_tr_b16 a[56:57], v230 offset:256
 v_accvgpr_read_b32 v223, a211
 v_mfma_f32_16x16x32_bf16 v[112:115], a[104:107], a[80:83], v[112:115]
 v_mfma_f32_16x16x32_bf16 v[116:119], a[108:111], a[80:83], v[116:119]
 ds_read_b64_tr_b16 a[58:59], v230 offset:1792
 v_lshlrev_b32 v220, 16, v222
 v_mfma_f32_16x16x32_bf16 v[108:111], a[108:111], a[76:79], v[108:111]
 v_mfma_f32_16x16x32_bf16 v[32:35], a[96:99], a[76:79], v[32:35]
 ds_read_b128 a[16:19], v227 offset:8192
 v_mfma_f32_16x16x32_bf16 v[40:43], a[96:99], a[80:83], v[40:43]
 v_and_b32 v222, s68, v222
 v_mfma_f32_16x16x32_bf16 v[44:47], a[100:103], a[80:83], v[44:47]
 ds_read_b128 a[20:23], v227 offset:10240
 v_mfma_f32_16x16x32_bf16 v[36:39], a[100:103], a[76:79], v[36:39]
 v_mfma_f32_16x16x32_bf16 v[156:159], a[76:79], a[112:115], v[156:159]
 ds_read_b128 a[24:27], v227 offset:12288
 v_lshlrev_b32 v221, 16, v223
 v_mfma_f32_16x16x32_bf16 v[160:163], a[80:83], a[112:115], v[160:163]
 v_mfma_f32_16x16x32_bf16 v[196:199], a[80:83], a[116:119], v[196:199]
 ds_read_b128 a[28:31], v227 offset:14336
 v_and_b32 v223, s68, v223
 v_mfma_f32_16x16x32_bf16 v[192:195], a[76:79], a[116:119], v[192:195]
 v_mfma_f32_16x16x32_bf16 v[200:203], a[84:87], a[116:119], v[200:203]
 v_mfma_f32_16x16x32_bf16 v[204:207], a[88:91], a[116:119], v[204:207]
 v_mul_f32 v221, v221, v220
 v_mfma_f32_16x16x32_bf16 v[168:171], a[88:91], a[112:115], v[168:171]
 v_mfma_f32_16x16x32_bf16 v[164:167], a[84:87], a[112:115], v[164:167]
 v_mfma_f32_16x16x32_bf16 v[52:55], a[100:103], a[84:87], v[52:55]
 v_mul_f32 v223, v223, v222
 v_mfma_f32_16x16x32_bf16 v[60:63], a[100:103], a[88:91], v[60:63]
 v_mfma_f32_16x16x32_bf16 v[56:59], a[96:99], a[88:91], v[56:59]
 v_cvt_pk_bf16_f32 v221, v221, v223
 v_mfma_f32_16x16x32_bf16 v[48:51], a[96:99], a[84:87], v[48:51]
 v_mfma_f32_16x16x32_bf16 v[124:127], a[108:111], a[84:87], v[124:127]
 v_mfma_f32_16x16x32_bf16 v[132:135], a[108:111], a[88:91], v[132:135]
 v_dot2_f32_bf16 v215, v221, s69, v215
 v_mfma_f32_16x16x32_bf16 v[128:131], a[104:107], a[88:91], v[128:131]
 v_mfma_f32_16x16x32_bf16 v[120:123], a[104:107], a[84:87], v[120:123]
.p2align 6
L1qP_loop:
 s_waitcnt lgkmcnt(0)
 s_barrier
 v_mfma_f32_16x16x32_bf16 v[64:67], a[44:47], a[32:35], v[64:67]
 ds_read_b64_tr_b16 a[96:97], v229 offset:12288
 v_mfma_f32_16x16x32_bf16 v[68:71], a[48:51], a[32:35], v[68:71]
 ds_read_b64_tr_b16 a[98:99], v229 offset:13824
 v_mfma_f32_16x16x32_bf16 v[136:139], a[32:35], a[52:55], v[136:139]
 ds_read_b128 a[92:95], v211
 v_mfma_f32_16x16x32_bf16 v[172:175], a[32:35], a[56:59], v[172:175]
 v_mfma_f32_16x16x32_bf16 v[72:75], a[44:47], a[0:3], v[72:75]
 ds_read_b64_tr_b16 a[100:101], v230 offset:12288
 v_lshlrev_b32 v220, 16, v217
 v_mfma_f32_16x16x32_bf16 v[80:83], a[44:47], a[4:7], v[80:83]
 buffer_load_dword a206, v253, s[72:75], s54 offen
 s_add_u32 s54, s54, 262144
 v_mfma_f32_16x16x32_bf16 v[84:87], a[48:51], a[4:7], v[84:87]
 ds_read_b64_tr_b16 a[102:103], v230 offset:13824
 v_mfma_f32_16x16x32_bf16 v[76:79], a[48:51], a[0:3], v[76:79]
 v_mfma_f32_16x16x32_bf16 v[0:3], a[36:39], a[0:3], v[0:3]
 ds_read_b128 a[60:63], v228 offset:0
 v_mfma_f32_16x16x32_bf16 v[8:11], a[36:39], a[4:7], v[8:11]
 v_and_b32 v217, s68, v217
 v_mfma_f32_16x16x32_bf16 v[12:15], a[40:43], a[4:7], v[12:15]
 ds_read_b64_tr_b16 a[104:105], v229 offset:12416
 v_mfma_f32_16x16x32_bf16 v[4:7], a[40:43], a[0:3], v[4:7]
 v_mfma_f32_16x16x32_bf16 v[140:143], a[0:3], a[52:55], v[140:143]
 ds_read_b64_tr_b16 a[106:107], v229 offset:13952
 v_mfma_f32_16x16x32_bf16 v[144:147], a[4:7], a[52:55], v[144:147]
 v_mfma_f32_16x16x32_bf16 v[180:183], a[4:7], a[56:59], v[180:183]
 ds_read_b128 a[64:67], v228 offset:2048
 v_lshlrev_b32 v221, 16, v219
 v_mfma_f32_16x16x32_bf16 v[176:179], a[0:3], a[56:59], v[176:179]
 v_mfma_f32_16x16x32_bf16 v[184:187], a[8:11], a[56:59], v[184:187]
 ds_read_b64_tr_b16 a[108:109], v230 offset:12416
 v_mfma_f32_16x16x32_bf16 v[188:191], a[12:15], a[56:59], v[188:191]
 v_mfma_f32_16x16x32_bf16 v[152:155], a[12:15], a[52:55], v[152:155]
 ds_read_b64_tr_b16 a[110:111], v230 offset:13952
 v_mfma_f32_16x16x32_bf16 v[148:151], a[8:11], a[52:55], v[148:151]
 v_mfma_f32_16x16x32_bf16 v[20:23], a[40:43], a[8:11], v[20:23]
 ds_read_b128 a[68:71], v228 offset:4096
 v_and_b32 v219, s68, v219
 v_mfma_f32_16x16x32_bf16 v[28:31], a[40:43], a[12:15], v[28:31]
 v_mfma_f32_16x16x32_bf16 v[24:27], a[36:39], a[12:15], v[24:27]
 ds_read_b64_tr_b16 a[112:113], v229 offset:12544
 v_mfma_f32_16x16x32_bf16 v[16:19], a[36:39], a[8:11], v[16:19]
 v_mfma_f32_16x16x32_bf16 v[92:95], a[48:51], a[8:11], v[92:95]
 ds_read_b64_tr_b16 a[114:115], v229 offset:14080
 v_mfma_f32_16x16x32_bf16 v[100:103], a[48:51], a[12:15], v[100:103]
 v_mul_f32 v221, v221, v220
 v_mfma_f32_16x16x32_bf16 v[96:99], a[44:47], a[12:15], v[96:99]
 ds_read_b128 a[72:75], v228 offset:6144
 v_mfma_f32_16x16x32_bf16 v[88:91], a[44:47], a[8:11], v[88:91]
 buffer_load_dword a207, v254, s[76:79], s55 offen
 s_add_u32 s55, s55, 917504
 v_mfma_f32_16x16x32_bf16 v[104:107], a[44:47], a[16:19], v[104:107]
 ds_read_b64_tr_b16 a[116:117], v230 offset:12544
 v_mfma_f32_16x16x32_bf16 v[112:115], a[44:47], a[20:23], v[112:115]
 v_mfma_f32_16x16x32_bf16 v[116:119], a[48:51], a[20:23], v[116:119]
 ds_read_b64_tr_b16 a[118:119], v230 offset:14080
 v_mul_f32 v219, v219, v217
 v_mfma_f32_16x16x32_bf16 v[108:111], a[48:51], a[16:19], v[108:111]
 v_mfma_f32_16x16x32_bf16 v[32:35], a[36:39], a[16:19], v[32:35]
 ds_read_b128 a[76:79], v228 offset:8192
 v_mfma_f32_16x16x32_bf16 v[40:43], a[36:39], a[20:23], v[40:43]
 v_mfma_f32_16x16x32_bf16 v[44:47], a[40:43], a[20:23], v[44:47]
 ds_read_b128 a[80:83], v228 offset:10240
 v_mfma_f32_16x16x32_bf16 v[36:39], a[40:43], a[16:19], v[36:39]
 v_mfma_f32_16x16x32_bf16 v[156:159], a[16:19], a[52:55], v[156:159]
 ds_read_b128 a[84:87], v228 offset:12288
 v_cvt_pk_bf16_f32 v221, v221, v219
 v_mfma_f32_16x16x32_bf16 v[160:163], a[20:23], a[52:55], v[160:163]
 v_mfma_f32_16x16x32_bf16 v[196:199], a[20:23], a[56:59], v[196:199]
 ds_read_b128 a[88:91], v228 offset:14336
 v_mfma_f32_16x16x32_bf16 v[192:195], a[16:19], a[56:59], v[192:195]
 v_mfma_f32_16x16x32_bf16 v[200:203], a[24:27], a[56:59], v[200:203]
 v_mfma_f32_16x16x32_bf16 v[204:207], a[28:31], a[56:59], v[204:207]
 v_dot2_f32_bf16 v215, v221, s69, v215
 v_mfma_f32_16x16x32_bf16 v[168:171], a[28:31], a[52:55], v[168:171]
 v_mfma_f32_16x16x32_bf16 v[164:167], a[24:27], a[52:55], v[164:167]
 v_mfma_f32_16x16x32_bf16 v[52:55], a[40:43], a[24:27], v[52:55]
 v_mfma_f32_16x16x32_bf16 v[60:63], a[40:43], a[28:31], v[60:63]
 v_mfma_f32_16x16x32_bf16 v[56:59], a[36:39], a[28:31], v[56:59]
 ds_read_b64 v[216:217], v212
 ds_read_b64 v[218:219], v214
 v_add_u32 v212, 128, v212
 v_mfma_f32_16x16x32_bf16 v[48:51], a[36:39], a[24:27], v[48:51]
 v_mfma_f32_16x16x32_bf16 v[124:127], a[48:51], a[24:27], v[124:127]
 v_mfma_f32_16x16x32_bf16 v[132:135], a[48:51], a[28:31], v[132:135]
 v_mfma_f32_16x16x32_bf16 v[128:131], a[44:47], a[28:31], v[128:131]
 v_mfma_f32_16x16x32_bf16 v[120:123], a[44:47], a[24:27], v[120:123]
 s_waitcnt lgkmcnt(0)
 s_barrier
 v_mfma_f32_16x16x32_bf16 v[64:67], a[104:107], a[92:95], v[64:67]
 v_add_u32 v227, s47, v225
 v_add_u32 v210, s47, v208
 v_add_u32 v228, s47, v226
 ds_read_b64_tr_b16 a[36:37], v229 offset:24576
 v_mfma_f32_16x16x32_bf16 v[68:71], a[108:111], a[92:95], v[68:71]
 v_add_u32 v211, s47, v209
 v_add_u32 v214, s47, v213
 s_mov_b32 s53, s46
 ds_read_b64_tr_b16 a[38:39], v229 offset:26112
 v_mfma_f32_16x16x32_bf16 v[136:139], a[92:95], a[112:115], v[136:139]
 s_mov_b32 s46, s47
 s_mov_b32 s47, s48
 s_mov_b32 s48, s53
 ds_read_b128 a[32:35], v210
 v_mfma_f32_16x16x32_bf16 v[172:175], a[92:95], a[116:119], v[172:175]
 v_mfma_f32_16x16x32_bf16 v[72:75], a[104:107], a[60:63], v[72:75]
 ds_read_b64_tr_b16 a[40:41], v230 offset:24576
 v_lshlrev_b32 v220, 16, v216
 v_mfma_f32_16x16x32_bf16 v[80:83], a[104:107], a[64:67], v[80:83]
 buffer_load_dword a204, v252, s[16:19], s51 offen
 s_add_u32 s51, s51, 393216
 v_mfma_f32_16x16x32_bf16 v[84:87], a[108:111], a[64:67], v[84:87]
 ds_read_b64_tr_b16 a[42:43], v230 offset:26112
 v_mfma_f32_16x16x32_bf16 v[76:79], a[108:111], a[60:63], v[76:79]
 v_mfma_f32_16x16x32_bf16 v[0:3], a[96:99], a[60:63], v[0:3]
 ds_read_b128 a[0:3], v227 offset:0
 v_mfma_f32_16x16x32_bf16 v[8:11], a[96:99], a[64:67], v[8:11]
 v_and_b32 v216, s68, v216
 v_mfma_f32_16x16x32_bf16 v[12:15], a[100:103], a[64:67], v[12:15]
 ds_read_b64_tr_b16 a[44:45], v229 offset:24704
 v_mfma_f32_16x16x32_bf16 v[4:7], a[100:103], a[60:63], v[4:7]
 v_mfma_f32_16x16x32_bf16 v[140:143], a[60:63], a[112:115], v[140:143]
 ds_read_b64_tr_b16 a[46:47], v229 offset:26240
 v_mfma_f32_16x16x32_bf16 v[144:147], a[64:67], a[112:115], v[144:147]
 v_mfma_f32_16x16x32_bf16 v[180:183], a[64:67], a[116:119], v[180:183]
 ds_read_b128 a[4:7], v227 offset:2048
 v_lshlrev_b32 v221, 16, v218
 v_mfma_f32_16x16x32_bf16 v[176:179], a[60:63], a[116:119], v[176:179]
 v_mfma_f32_16x16x32_bf16 v[184:187], a[68:71], a[116:119], v[184:187]
 ds_read_b64_tr_b16 a[48:49], v230 offset:24704
 v_mfma_f32_16x16x32_bf16 v[188:191], a[72:75], a[116:119], v[188:191]
 v_mfma_f32_16x16x32_bf16 v[152:155], a[72:75], a[112:115], v[152:155]
 ds_read_b64_tr_b16 a[50:51], v230 offset:26240
 v_mfma_f32_16x16x32_bf16 v[148:151], a[68:71], a[112:115], v[148:151]
 v_mfma_f32_16x16x32_bf16 v[20:23], a[100:103], a[68:71], v[20:23]
 ds_read_b128 a[8:11], v227 offset:4096
 v_and_b32 v218, s68, v218
 v_mfma_f32_16x16x32_bf16 v[28:31], a[100:103], a[72:75], v[28:31]
 v_mfma_f32_16x16x32_bf16 v[24:27], a[96:99], a[72:75], v[24:27]
 ds_read_b64_tr_b16 a[52:53], v229 offset:24832
 v_mfma_f32_16x16x32_bf16 v[16:19], a[96:99], a[68:71], v[16:19]
 v_mfma_f32_16x16x32_bf16 v[92:95], a[108:111], a[68:71], v[92:95]
 ds_read_b64_tr_b16 a[54:55], v229 offset:26368
 v_mfma_f32_16x16x32_bf16 v[100:103], a[108:111], a[72:75], v[100:103]
 v_mul_f32 v221, v221, v220
 v_mfma_f32_16x16x32_bf16 v[96:99], a[104:107], a[72:75], v[96:99]
 ds_read_b128 a[12:15], v227 offset:6144
 s_cmp_lt_u32 s50, 2048
 s_cselect_b32 s14, 0x400000, 0
 v_mfma_f32_16x16x32_bf16 v[88:91], a[104:107], a[68:71], v[88:91]
 buffer_load_dword a205, v239, s[12:15], s50 offen
 s_add_u32 s50, s50, 128
 v_mfma_f32_16x16x32_bf16 v[104:107], a[104:107], a[76:79], v[104:107]
 ds_read_b64_tr_b16 a[56:57], v230 offset:24832
 v_mfma_f32_16x16x32_bf16 v[112:115], a[104:107], a[80:83], v[112:115]
 v_mfma_f32_16x16x32_bf16 v[116:119], a[108:111], a[80:83], v[116:119]
 ds_read_b64_tr_b16 a[58:59], v230 offset:26368
 v_mul_f32 v218, v218, v216
 v_mfma_f32_16x16x32_bf16 v[108:111], a[108:111], a[76:79], v[108:111]
 v_mfma_f32_16x16x32_bf16 v[32:35], a[96:99], a[76:79], v[32:35]
 ds_read_b128 a[16:19], v227 offset:8192
 v_mfma_f32_16x16x32_bf16 v[40:43], a[96:99], a[80:83], v[40:43]
 v_mfma_f32_16x16x32_bf16 v[44:47], a[100:103], a[80:83], v[44:47]
 ds_read_b128 a[20:23], v227 offset:10240
 v_mfma_f32_16x16x32_bf16 v[36:39], a[100:103], a[76:79], v[36:39]
 v_mfma_f32_16x16x32_bf16 v[156:159], a[76:79], a[112:115], v[156:159]
 ds_read_b128 a[24:27], v227 offset:12288
 v_cvt_pk_bf16_f32 v221, v221, v218
 v_mfma_f32_16x16x32_bf16 v[160:163], a[80:83], a[112:115], v[160:163]
 v_mfma_f32_16x16x32_bf16 v[196:199], a[80:83], a[116:119], v[196:199]
 ds_read_b128 a[28:31], v227 offset:14336
 v_mfma_f32_16x16x32_bf16 v[192:195], a[76:79], a[116:119], v[192:195]
 v_mfma_f32_16x16x32_bf16 v[200:203], a[84:87], a[116:119], v[200:203]
 v_mfma_f32_16x16x32_bf16 v[204:207], a[88:91], a[116:119], v[204:207]
 v_dot2_f32_bf16 v215, v221, s69, v215
 v_mfma_f32_16x16x32_bf16 v[168:171], a[88:91], a[112:115], v[168:171]
 v_mfma_f32_16x16x32_bf16 v[164:167], a[84:87], a[112:115], v[164:167]
 v_mfma_f32_16x16x32_bf16 v[52:55], a[100:103], a[84:87], v[52:55]
 v_mfma_f32_16x16x32_bf16 v[60:63], a[100:103], a[88:91], v[60:63]
 v_mfma_f32_16x16x32_bf16 v[56:59], a[96:99], a[88:91], v[56:59]
 s_cmp_eq_u32 s28, 0
 s_cselect_b32 s29, s59, 0x1000
 s_mov_b64 exec, 1
 buffer_atomic_add a252, off, s[60:63], s29 sc1
 s_mov_b64 exec, -1
 s_sub_u32 s28, s28, 1
 v_mfma_f32_16x16x32_bf16 v[48:51], a[96:99], a[84:87], v[48:51]
 v_mfma_f32_16x16x32_bf16 v[124:127], a[108:111], a[84:87], v[124:127]
 v_mfma_f32_16x16x32_bf16 v[132:135], a[108:111], a[88:91], v[132:135]
 v_mfma_f32_16x16x32_bf16 v[128:131], a[104:107], a[88:91], v[128:131]
 v_mfma_f32_16x16x32_bf16 v[120:123], a[104:107], a[84:87], v[120:123]
 s_waitcnt lgkmcnt(0)
 s_barrier
 v_mfma_f32_16x16x32_bf16 v[64:67], a[44:47], a[32:35], v[64:67]
 s_sub_u32 s52, s52, 1
 ds_read_b64_tr_b16 a[96:97], v229 offset:36864
 v_mfma_f32_16x16x32_bf16 v[68:71], a[48:51], a[32:35], v[68:71]
 ds_read_b64_tr_b16 a[98:99], v229 offset:38400
 v_mfma_f32_16x16x32_bf16 v[136:139], a[32:35], a[52:55], v[136:139]
 ds_read_b128 a[92:95], v211
 v_mfma_f32_16x16x32_bf16 v[172:175], a[32:35], a[56:59], v[172:175]
 v_mfma_f32_16x16x32_bf16 v[72:75], a[44:47], a[0:3], v[72:75]
 ds_read_b64_tr_b16 a[100:101], v230 offset:36864
 v_lshlrev_b32 v220, 16, v217
 v_mfma_f32_16x16x32_bf16 v[80:83], a[44:47], a[4:7], v[80:83]
 buffer_load_dword a206, v253, s[72:75], s54 offen
 s_add_u32 s54, s54, 262144
 v_mfma_f32_16x16x32_bf16 v[84:87], a[48:51], a[4:7], v[84:87]
 ds_read_b64_tr_b16 a[102:103], v230 offset:38400
 v_mfma_f32_16x16x32_bf16 v[76:79], a[48:51], a[0:3], v[76:79]
 v_mfma_f32_16x16x32_bf16 v[0:3], a[36:39], a[0:3], v[0:3]
 ds_read_b128 a[60:63], v228 offset:0
 v_mfma_f32_16x16x32_bf16 v[8:11], a[36:39], a[4:7], v[8:11]
 v_and_b32 v217, s68, v217
 v_mfma_f32_16x16x32_bf16 v[12:15], a[40:43], a[4:7], v[12:15]
 ds_read_b64_tr_b16 a[104:105], v229 offset:36992
 v_mfma_f32_16x16x32_bf16 v[4:7], a[40:43], a[0:3], v[4:7]
 v_mfma_f32_16x16x32_bf16 v[140:143], a[0:3], a[52:55], v[140:143]
 ds_read_b64_tr_b16 a[106:107], v229 offset:38528
 v_mfma_f32_16x16x32_bf16 v[144:147], a[4:7], a[52:55], v[144:147]
 v_mfma_f32_16x16x32_bf16 v[180:183], a[4:7], a[56:59], v[180:183]
 ds_read_b128 a[64:67], v228 offset:2048
 v_lshlrev_b32 v221, 16, v219
 v_mfma_f32_16x16x32_bf16 v[176:179], a[0:3], a[56:59], v[176:179]
 v_mfma_f32_16x16x32_bf16 v[184:187], a[8:11], a[56:59], v[184:187]
 ds_read_b64_tr_b16 a[108:109], v230 offset:36992
 v_mfma_f32_16x16x32_bf16 v[188:191], a[12:15], a[56:59], v[188:191]
 v_mfma_f32_16x16x32_bf16 v[152:155], a[12:15], a[52:55], v[152:155]
 ds_read_b64_tr_b16 a[110:111], v230 offset:38528
 v_mfma_f32_16x16x32_bf16 v[148:151], a[8:11], a[52:55], v[148:151]
 v_mfma_f32_16x16x32_bf16 v[20:23], a[40:43], a[8:11], v[20:23]
 ds_read_b128 a[68:71], v228 offset:4096
 v_and_b32 v219, s68, v219
 v_mfma_f32_16x16x32_bf16 v[28:31], a[40:43], a[12:15], v[28:31]
 v_mfma_f32_16x16x32_bf16 v[24:27], a[36:39], a[12:15], v[24:27]
 ds_read_b64_tr_b16 a[112:113], v229 offset:37120
 v_mfma_f32_16x16x32_bf16 v[16:19], a[36:39], a[8:11], v[16:19]
 v_mfma_f32_16x16x32_bf16 v[92:95], a[48:51], a[8:11], v[92:95]
 ds_read_b64_tr_b16 a[114:115], v229 offset:38656
 v_mfma_f32_16x16x32_bf16 v[100:103], a[48:51], a[12:15], v[100:103]
 v_mul_f32 v221, v221, v220
 v_mfma_f32_16x16x32_bf16 v[96:99], a[44:47], a[12:15], v[96:99]
 ds_read_b128 a[72:75], v228 offset:6144
 v_mfma_f32_16x16x32_bf16 v[88:91], a[44:47], a[8:11], v[88:91]
 buffer_load_dword a207, v254, s[76:79], s55 offen
 s_add_u32 s55, s55, 917504
 v_mfma_f32_16x16x32_bf16 v[104:107], a[44:47], a[16:19], v[104:107]
 ds_read_b64_tr_b16 a[116:117], v230 offset:37120
 v_mfma_f32_16x16x32_bf16 v[112:115], a[44:47], a[20:23], v[112:115]
 v_mfma_f32_16x16x32_bf16 v[116:119], a[48:51], a[20:23], v[116:119]
 ds_read_b64_tr_b16 a[118:119], v230 offset:38656
 v_mul_f32 v219, v219, v217
 v_mfma_f32_16x16x32_bf16 v[108:111], a[48:51], a[16:19], v[108:111]
 v_mfma_f32_16x16x32_bf16 v[32:35], a[36:39], a[16:19], v[32:35]
 ds_read_b128 a[76:79], v228 offset:8192
 v_mfma_f32_16x16x32_bf16 v[40:43], a[36:39], a[20:23], v[40:43]
 v_mfma_f32_16x16x32_bf16 v[44:47], a[40:43], a[20:23], v[44:47]
 ds_read_b128 a[80:83], v228 offset:10240
 v_mfma_f32_16x16x32_bf16 v[36:39], a[40:43], a[16:19], v[36:39]
 v_mfma_f32_16x16x32_bf16 v[156:159], a[16:19], a[52:55], v[156:159]
 ds_read_b128 a[84:87], v228 offset:12288
 v_cvt_pk_bf16_f32 v221, v221, v219
 v_mfma_f32_16x16x32_bf16 v[160:163], a[20:23], a[52:55], v[160:163]
 v_mfma_f32_16x16x32_bf16 v[196:199], a[20:23], a[56:59], v[196:199]
 ds_read_b128 a[88:91], v228 offset:14336
 v_mfma_f32_16x16x32_bf16 v[192:195], a[16:19], a[56:59], v[192:195]
 v_mfma_f32_16x16x32_bf16 v[200:203], a[24:27], a[56:59], v[200:203]
 v_mfma_f32_16x16x32_bf16 v[204:207], a[28:31], a[56:59], v[204:207]
 v_dot2_f32_bf16 v215, v221, s69, v215
 v_mfma_f32_16x16x32_bf16 v[168:171], a[28:31], a[52:55], v[168:171]
 v_mfma_f32_16x16x32_bf16 v[164:167], a[24:27], a[52:55], v[164:167]
 v_mfma_f32_16x16x32_bf16 v[52:55], a[40:43], a[24:27], v[52:55]
 v_mfma_f32_16x16x32_bf16 v[60:63], a[40:43], a[28:31], v[60:63]
 v_mfma_f32_16x16x32_bf16 v[56:59], a[36:39], a[28:31], v[56:59]
 ds_read_b64 v[216:217], v212
 ds_read_b64 v[218:219], v214
 v_add_u32 v212, 128, v212
 v_mfma_f32_16x16x32_bf16 v[48:51], a[36:39], a[24:27], v[48:51]
 v_mfma_f32_16x16x32_bf16 v[124:127], a[48:51], a[24:27], v[124:127]
 v_mfma_f32_16x16x32_bf16 v[132:135], a[48:51], a[28:31], v[132:135]
 v_mfma_f32_16x16x32_bf16 v[128:131], a[44:47], a[28:31], v[128:131]
 v_mfma_f32_16x16x32_bf16 v[120:123], a[44:47], a[24:27], v[120:123]
 s_waitcnt lgkmcnt(0)
 s_barrier
 v_mfma_f32_16x16x32_bf16 v[64:67], a[104:107], a[92:95], v[64:67]
 v_add_u32 v227, s47, v225
 v_add_u32 v210, s47, v208
 v_add_u32 v228, s47, v226
 ds_read_b64_tr_b16 a[36:37], v229 offset:0
 v_mfma_f32_16x16x32_bf16 v[68:71], a[108:111], a[92:95], v[68:71]
 v_add_u32 v211, s47, v209
 v_add_u32 v214, s47, v213
 s_mov_b32 s53, s46
 ds_read_b64_tr_b16 a[38:39], v229 offset:1536
 v_mfma_f32_16x16x32_bf16 v[136:139], a[92:95], a[112:115], v[136:139]
 s_mov_b32 s46, s47
 s_mov_b32 s47, s48
 s_mov_b32 s48, s53
 ds_read_b128 a[32:35], v210
 v_mfma_f32_16x16x32_bf16 v[172:175], a[92:95], a[116:119], v[172:175]
 v_mfma_f32_16x16x32_bf16 v[72:75], a[104:107], a[60:63], v[72:75]
 ds_read_b64_tr_b16 a[40:41], v230 offset:0
 v_lshlrev_b32 v220, 16, v216
 v_mfma_f32_16x16x32_bf16 v[80:83], a[104:107], a[64:67], v[80:83]
 buffer_load_dword a204, v252, s[16:19], s51 offen
 s_add_u32 s51, s51, 393216
 v_mfma_f32_16x16x32_bf16 v[84:87], a[108:111], a[64:67], v[84:87]
 ds_read_b64_tr_b16 a[42:43], v230 offset:1536
 v_mfma_f32_16x16x32_bf16 v[76:79], a[108:111], a[60:63], v[76:79]
 v_mfma_f32_16x16x32_bf16 v[0:3], a[96:99], a[60:63], v[0:3]
 ds_read_b128 a[0:3], v227 offset:0
 v_mfma_f32_16x16x32_bf16 v[8:11], a[96:99], a[64:67], v[8:11]
 v_and_b32 v216, s68, v216
 v_mfma_f32_16x16x32_bf16 v[12:15], a[100:103], a[64:67], v[12:15]
 ds_read_b64_tr_b16 a[44:45], v229 offset:128
 v_mfma_f32_16x16x32_bf16 v[4:7], a[100:103], a[60:63], v[4:7]
 v_mfma_f32_16x16x32_bf16 v[140:143], a[60:63], a[112:115], v[140:143]
 ds_read_b64_tr_b16 a[46:47], v229 offset:1664
 v_mfma_f32_16x16x32_bf16 v[144:147], a[64:67], a[112:115], v[144:147]
 v_mfma_f32_16x16x32_bf16 v[180:183], a[64:67], a[116:119], v[180:183]
 ds_read_b128 a[4:7], v227 offset:2048
 v_lshlrev_b32 v221, 16, v218
 v_mfma_f32_16x16x32_bf16 v[176:179], a[60:63], a[116:119], v[176:179]
 v_mfma_f32_16x16x32_bf16 v[184:187], a[68:71], a[116:119], v[184:187]
 ds_read_b64_tr_b16 a[48:49], v230 offset:128
 v_mfma_f32_16x16x32_bf16 v[188:191], a[72:75], a[116:119], v[188:191]
 v_mfma_f32_16x16x32_bf16 v[152:155], a[72:75], a[112:115], v[152:155]
 ds_read_b64_tr_b16 a[50:51], v230 offset:1664
 v_mfma_f32_16x16x32_bf16 v[148:151], a[68:71], a[112:115], v[148:151]
 v_mfma_f32_16x16x32_bf16 v[20:23], a[100:103], a[68:71], v[20:23]
 ds_read_b128 a[8:11], v227 offset:4096
 v_and_b32 v218, s68, v218
 v_mfma_f32_16x16x32_bf16 v[28:31], a[100:103], a[72:75], v[28:31]
 v_mfma_f32_16x16x32_bf16 v[24:27], a[96:99], a[72:75], v[24:27]
 ds_read_b64_tr_b16 a[52:53], v229 offset:256
 v_mfma_f32_16x16x32_bf16 v[16:19], a[96:99], a[68:71], v[16:19]
 v_mfma_f32_16x16x32_bf16 v[92:95], a[108:111], a[68:71], v[92:95]
 ds_read_b64_tr_b16 a[54:55], v229 offset:1792
 v_mfma_f32_16x16x32_bf16 v[100:103], a[108:111], a[72:75], v[100:103]
 v_mul_f32 v221, v221, v220
 v_mfma_f32_16x16x32_bf16 v[96:99], a[104:107], a[72:75], v[96:99]
 ds_read_b128 a[12:15], v227 offset:6144
 s_cmp_lt_u32 s50, 2048
 s_cselect_b32 s14, 0x400000, 0
 v_mfma_f32_16x16x32_bf16 v[88:91], a[104:107], a[68:71], v[88:91]
 buffer_load_dword a205, v239, s[12:15], s50 offen
 s_add_u32 s50, s50, 128
 v_mfma_f32_16x16x32_bf16 v[104:107], a[104:107], a[76:79], v[104:107]
 ds_read_b64_tr_b16 a[56:57], v230 offset:256
 v_mfma_f32_16x16x32_bf16 v[112:115], a[104:107], a[80:83], v[112:115]
 v_mfma_f32_16x16x32_bf16 v[116:119], a[108:111], a[80:83], v[116:119]
 ds_read_b64_tr_b16 a[58:59], v230 offset:1792
 v_mul_f32 v218, v218, v216
 v_mfma_f32_16x16x32_bf16 v[108:111], a[108:111], a[76:79], v[108:111]
 v_mfma_f32_16x16x32_bf16 v[32:35], a[96:99], a[76:79], v[32:35]
 ds_read_b128 a[16:19], v227 offset:8192
 v_mfma_f32_16x16x32_bf16 v[40:43], a[96:99], a[80:83], v[40:43]
 v_mfma_f32_16x16x32_bf16 v[44:47], a[100:103], a[80:83], v[44:47]
 ds_read_b128 a[20:23], v227 offset:10240
 v_mfma_f32_16x16x32_bf16 v[36:39], a[100:103], a[76:79], v[36:39]
 v_mfma_f32_16x16x32_bf16 v[156:159], a[76:79], a[112:115], v[156:159]
 ds_read_b128 a[24:27], v227 offset:12288
 v_cvt_pk_bf16_f32 v221, v221, v218
 v_mfma_f32_16x16x32_bf16 v[160:163], a[80:83], a[112:115], v[160:163]
 v_mfma_f32_16x16x32_bf16 v[196:199], a[80:83], a[116:119], v[196:199]
 ds_read_b128 a[28:31], v227 offset:14336
 v_mfma_f32_16x16x32_bf16 v[192:195], a[76:79], a[116:119], v[192:195]
 v_mfma_f32_16x16x32_bf16 v[200:203], a[84:87], a[116:119], v[200:203]
 v_mfma_f32_16x16x32_bf16 v[204:207], a[88:91], a[116:119], v[204:207]
 v_dot2_f32_bf16 v215, v221, s69, v215
 v_mfma_f32_16x16x32_bf16 v[168:171], a[88:91], a[112:115], v[168:171]
 v_mfma_f32_16x16x32_bf16 v[164:167], a[84:87], a[112:115], v[164:167]
 v_mfma_f32_16x16x32_bf16 v[52:55], a[100:103], a[84:87], v[52:55]
 v_mfma_f32_16x16x32_bf16 v[60:63], a[100:103], a[88:91], v[60:63]
 v_mfma_f32_16x16x32_bf16 v[56:59], a[96:99], a[88:91], v[56:59]
 s_cmp_eq_u32 s28, 0
 s_cselect_b32 s29, s59, 0x1000
 s_mov_b64 exec, 1
 buffer_atomic_add a252, off, s[60:63], s29 sc1
 s_mov_b64 exec, -1
 s_sub_u32 s28, s28, 1
 v_mfma_f32_16x16x32_bf16 v[48:51], a[96:99], a[84:87], v[48:51]
 v_mfma_f32_16x16x32_bf16 v[124:127], a[108:111], a[84:87], v[124:127]
 v_mfma_f32_16x16x32_bf16 v[132:135], a[108:111], a[88:91], v[132:135]
 v_mfma_f32_16x16x32_bf16 v[128:131], a[104:107], a[88:91], v[128:131]
 v_mfma_f32_16x16x32_bf16 v[120:123], a[104:107], a[84:87], v[120:123]
 s_cmp_lg_u32 s52, 0
 s_cbranch_scc1 L1qP_loop
 s_waitcnt lgkmcnt(0)
 s_barrier
 v_mfma_f32_16x16x32_bf16 v[64:67], a[44:47], a[32:35], v[64:67]
 ds_read_b64_tr_b16 a[96:97], v229 offset:12288
 v_mfma_f32_16x16x32_bf16 v[68:71], a[48:51], a[32:35], v[68:71]
 ds_read_b64_tr_b16 a[98:99], v229 offset:13824
 v_mfma_f32_16x16x32_bf16 v[136:139], a[32:35], a[52:55], v[136:139]
 ds_read_b128 a[92:95], v211
 v_mfma_f32_16x16x32_bf16 v[172:175], a[32:35], a[56:59], v[172:175]
 v_mfma_f32_16x16x32_bf16 v[72:75], a[44:47], a[0:3], v[72:75]
 ds_read_b64_tr_b16 a[100:101], v230 offset:12288
 v_lshlrev_b32 v235, 6, v224
 v_lshlrev_b32 v220, 16, v217
 v_mfma_f32_16x16x32_bf16 v[80:83], a[44:47], a[4:7], v[80:83]
 buffer_load_dword a204, v235, s[92:95], s91 offen
 v_mfma_f32_16x16x32_bf16 v[84:87], a[48:51], a[4:7], v[84:87]
 ds_read_b64_tr_b16 a[102:103], v230 offset:13824
 v_and_b32 v217, s68, v217
 v_mfma_f32_16x16x32_bf16 v[76:79], a[48:51], a[0:3], v[76:79]
 v_mfma_f32_16x16x32_bf16 v[0:3], a[36:39], a[0:3], v[0:3]
 ds_read_b128 a[60:63], v228 offset:0
 v_mfma_f32_16x16x32_bf16 v[8:11], a[36:39], a[4:7], v[8:11]
 v_lshlrev_b32 v221, 16, v219
 v_mfma_f32_16x16x32_bf16 v[12:15], a[40:43], a[4:7], v[12:15]
 ds_read_b64_tr_b16 a[104:105], v229 offset:12416
 v_mfma_f32_16x16x32_bf16 v[4:7], a[40:43], a[0:3], v[4:7]
 v_and_b32 v219, s68, v219
 v_mfma_f32_16x16x32_bf16 v[140:143], a[0:3], a[52:55], v[140:143]
 ds_read_b64_tr_b16 a[106:107], v229 offset:13952
 v_mfma_f32_16x16x32_bf16 v[144:147], a[4:7], a[52:55], v[144:147]
 v_mfma_f32_16x16x32_bf16 v[180:183], a[4:7], a[56:59], v[180:183]
 ds_read_b128 a[64:67], v228 offset:2048
 v_mul_f32 v221, v221, v220
 v_mfma_f32_16x16x32_bf16 v[176:179], a[0:3], a[56:59], v[176:179]
 v_mfma_f32_16x16x32_bf16 v[184:187], a[8:11], a[56:59], v[184:187]
 ds_read_b64_tr_b16 a[108:109], v230 offset:12416
 v_mul_f32 v219, v219, v217
 v_mfma_f32_16x16x32_bf16 v[188:191], a[12:15], a[56:59], v[188:191]
 v_mfma_f32_16x16x32_bf16 v[152:155], a[12:15], a[52:55], v[152:155]
 ds_read_b64_tr_b16 a[110:111], v230 offset:13952
 v_mfma_f32_16x16x32_bf16 v[148:151], a[8:11], a[52:55], v[148:151]
 v_cvt_pk_bf16_f32 v221, v221, v219
 v_mfma_f32_16x16x32_bf16 v[20:23], a[40:43], a[8:11], v[20:23]
 ds_read_b128 a[68:71], v228 offset:4096
 buffer_load_dword a206, v253, s[72:75], s54 offen
 s_add_u32 s54, s54, 262144
 v_mfma_f32_16x16x32_bf16 v[28:31], a[40:43], a[12:15], v[28:31]
 v_dot2_f32_bf16 v215, v221, s69, v215
 v_mfma_f32_16x16x32_bf16 v[24:27], a[36:39], a[12:15], v[24:27]
 ds_read_b64_tr_b16 a[112:113], v229 offset:12544
 v_mfma_f32_16x16x32_bf16 v[16:19], a[36:39], a[8:11], v[16:19]
 v_mfma_f32_16x16x32_bf16 v[92:95], a[48:51], a[8:11], v[92:95]
 ds_read_b64_tr_b16 a[114:115], v229 offset:14080
 ds_read_b64 v[216:217], v212
 ds_read_b64 v[218:219], v214
 v_add_u32 v212, 128, v212
 v_mfma_f32_16x16x32_bf16 v[100:103], a[48:51], a[12:15], v[100:103]
 v_mfma_f32_16x16x32_bf16 v[96:99], a[44:47], a[12:15], v[96:99]
 ds_read_b128 a[72:75], v228 offset:6144
 v_accvgpr_read_b32 v222, a212
 v_mfma_f32_16x16x32_bf16 v[88:91], a[44:47], a[8:11], v[88:91]
 v_mfma_f32_16x16x32_bf16 v[104:107], a[44:47], a[16:19], v[104:107]
 ds_read_b64_tr_b16 a[116:117], v230 offset:12544
 v_mfma_f32_16x16x32_bf16 v[112:115], a[44:47], a[20:23], v[112:115]
 v_accvgpr_read_b32 v223, a214
 v_mfma_f32_16x16x32_bf16 v[116:119], a[48:51], a[20:23], v[116:119]
 ds_read_b64_tr_b16 a[118:119], v230 offset:14080
 v_mfma_f32_16x16x32_bf16 v[108:111], a[48:51], a[16:19], v[108:111]
 v_lshlrev_b32 v220, 16, v222
 v_mfma_f32_16x16x32_bf16 v[32:35], a[36:39], a[16:19], v[32:35]
 ds_read_b128 a[76:79], v228 offset:8192
 v_mfma_f32_16x16x32_bf16 v[40:43], a[36:39], a[20:23], v[40:43]
 v_mfma_f32_16x16x32_bf16 v[44:47], a[40:43], a[20:23], v[44:47]
 ds_read_b128 a[80:83], v228 offset:10240
 v_and_b32 v222, s68, v222
 v_mfma_f32_16x16x32_bf16 v[36:39], a[40:43], a[16:19], v[36:39]
 buffer_load_dword a207, v254, s[76:79], s55 offen
 s_add_u32 s55, s55, 917504
 v_mfma_f32_16x16x32_bf16 v[156:159], a[16:19], a[52:55], v[156:159]
 ds_read_b128 a[84:87], v228 offset:12288
 v_lshlrev_b32 v221, 16, v223
 v_mfma_f32_16x16x32_bf16 v[160:163], a[20:23], a[52:55], v[160:163]
 v_mfma_f32_16x16x32_bf16 v[196:199], a[20:23], a[56:59], v[196:199]
 ds_read_b128 a[88:91], v228 offset:14336
 v_mfma_f32_16x16x32_bf16 v[192:195], a[16:19], a[56:59], v[192:195]
 v_and_b32 v223, s68, v223
 v_mfma_f32_16x16x32_bf16 v[200:203], a[24:27], a[56:59], v[200:203]
 v_mfma_f32_16x16x32_bf16 v[204:207], a[28:31], a[56:59], v[204:207]
 v_mul_f32 v221, v221, v220
 v_mfma_f32_16x16x32_bf16 v[168:171], a[28:31], a[52:55], v[168:171]
 v_mfma_f32_16x16x32_bf16 v[164:167], a[24:27], a[52:55], v[164:167]
 v_mfma_f32_16x16x32_bf16 v[52:55], a[40:43], a[24:27], v[52:55]
 v_mul_f32 v223, v223, v222
 v_mfma_f32_16x16x32_bf16 v[60:63], a[40:43], a[28:31], v[60:63]
 v_mfma_f32_16x16x32_bf16 v[56:59], a[36:39], a[28:31], v[56:59]
 v_cvt_pk_bf16_f32 v221, v221, v223
 v_mfma_f32_16x16x32_bf16 v[48:51], a[36:39], a[24:27], v[48:51]
 v_mfma_f32_16x16x32_bf16 v[124:127], a[48:51], a[24:27], v[124:127]
 v_mfma_f32_16x16x32_bf16 v[132:135], a[48:51], a[28:31], v[132:135]
 v_dot2_f32_bf16 v215, v221, s69, v215
 v_mfma_f32_16x16x32_bf16 v[128:131], a[44:47], a[28:31], v[128:131]
 v_mfma_f32_16x16x32_bf16 v[120:123], a[44:47], a[24:27], v[120:123]
 s_waitcnt lgkmcnt(0)
 s_barrier
 v_mfma_f32_16x16x32_bf16 v[64:67], a[104:107], a[92:95], v[64:67]
 v_add_u32 v227, s47, v225
 v_add_u32 v210, s47, v208
 v_add_u32 v228, s47, v226
 ds_read_b64_tr_b16 a[36:37], v229 offset:24576
 v_mfma_f32_16x16x32_bf16 v[68:71], a[108:111], a[92:95], v[68:71]
 v_add_u32 v211, s47, v209
 v_add_u32 v214, s47, v213
 s_mov_b32 s53, s46
 ds_read_b64_tr_b16 a[38:39], v229 offset:26112
 v_mfma_f32_16x16x32_bf16 v[136:139], a[92:95], a[112:115], v[136:139]
 s_mov_b32 s46, s47
 s_mov_b32 s47, s48
 s_mov_b32 s48, s53
 ds_read_b128 a[32:35], v210
 v_mfma_f32_16x16x32_bf16 v[172:175], a[92:95], a[116:119], v[172:175]
 v_mfma_f32_16x16x32_bf16 v[72:75], a[104:107], a[60:63], v[72:75]
 ds_read_b64_tr_b16 a[40:41], v230 offset:24576
 v_lshlrev_b32 v220, 16, v216
 v_mfma_f32_16x16x32_bf16 v[80:83], a[104:107], a[64:67], v[80:83]
 buffer_load_dword a204, v252, s[16:19], s51 offen
 s_add_u32 s51, s51, 393216
 v_mfma_f32_16x16x32_bf16 v[84:87], a[108:111], a[64:67], v[84:87]
 ds_read_b64_tr_b16 a[42:43], v230 offset:26112
 v_and_b32 v216, s68, v216
 v_mfma_f32_16x16x32_bf16 v[76:79], a[108:111], a[60:63], v[76:79]
 v_mfma_f32_16x16x32_bf16 v[0:3], a[96:99], a[60:63], v[0:3]
 ds_read_b128 a[0:3], v227 offset:0
 v_mfma_f32_16x16x32_bf16 v[8:11], a[96:99], a[64:67], v[8:11]
 v_lshlrev_b32 v221, 16, v218
 v_mfma_f32_16x16x32_bf16 v[12:15], a[100:103], a[64:67], v[12:15]
 ds_read_b64_tr_b16 a[44:45], v229 offset:24704
 v_mfma_f32_16x16x32_bf16 v[4:7], a[100:103], a[60:63], v[4:7]
 v_mfma_f32_16x16x32_bf16 v[140:143], a[60:63], a[112:115], v[140:143]
 ds_read_b64_tr_b16 a[46:47], v229 offset:26240
 v_and_b32 v218, s68, v218
 v_mfma_f32_16x16x32_bf16 v[144:147], a[64:67], a[112:115], v[144:147]
 v_mfma_f32_16x16x32_bf16 v[180:183], a[64:67], a[116:119], v[180:183]
 ds_read_b128 a[4:7], v227 offset:2048
 v_mul_f32 v221, v221, v220
 v_mfma_f32_16x16x32_bf16 v[176:179], a[60:63], a[116:119], v[176:179]
 v_mfma_f32_16x16x32_bf16 v[184:187], a[68:71], a[116:119], v[184:187]
 ds_read_b64_tr_b16 a[48:49], v230 offset:24704
 v_mfma_f32_16x16x32_bf16 v[188:191], a[72:75], a[116:119], v[188:191]
 v_mul_f32 v218, v218, v216
 v_mfma_f32_16x16x32_bf16 v[152:155], a[72:75], a[112:115], v[152:155]
 ds_read_b64_tr_b16 a[50:51], v230 offset:26240
 v_mfma_f32_16x16x32_bf16 v[148:151], a[68:71], a[112:115], v[148:151]
 v_mfma_f32_16x16x32_bf16 v[20:23], a[100:103], a[68:71], v[20:23]
 ds_read_b128 a[8:11], v227 offset:4096
 v_cvt_pk_bf16_f32 v221, v221, v218
 v_mfma_f32_16x16x32_bf16 v[28:31], a[100:103], a[72:75], v[28:31]
 v_mfma_f32_16x16x32_bf16 v[24:27], a[96:99], a[72:75], v[24:27]
 ds_read_b64_tr_b16 a[52:53], v229 offset:24832
 v_dot2_f32_bf16 v215, v221, s69, v215
 v_mfma_f32_16x16x32_bf16 v[16:19], a[96:99], a[68:71], v[16:19]
 v_mfma_f32_16x16x32_bf16 v[92:95], a[108:111], a[68:71], v[92:95]
 ds_read_b64_tr_b16 a[54:55], v229 offset:26368
 v_mfma_f32_16x16x32_bf16 v[100:103], a[108:111], a[72:75], v[100:103]
 v_accvgpr_read_b32 v222, a213
 v_mfma_f32_16x16x32_bf16 v[96:99], a[104:107], a[72:75], v[96:99]
 ds_read_b128 a[12:15], v227 offset:6144
 s_cmp_lt_u32 s50, 2048
 s_cselect_b32 s14, 0x400000, 0
 v_mfma_f32_16x16x32_bf16 v[88:91], a[104:107], a[68:71], v[88:91]
 buffer_load_dword a205, v239, s[12:15], s50 offen
 s_add_u32 s50, s50, 128
 v_mfma_f32_16x16x32_bf16 v[104:107], a[104:107], a[76:79], v[104:107]
 ds_read_b64_tr_b16 a[56:57], v230 offset:24832
 v_accvgpr_read_b32 v223, a215
 v_mfma_f32_16x16x32_bf16 v[112:115], a[104:107], a[80:83], v[112:115]
 v_mfma_f32_16x16x32_bf16 v[116:119], a[108:111], a[80:83], v[116:119]
 ds_read_b64_tr_b16 a[58:59], v230 offset:26368
 v_lshlrev_b32 v220, 16, v222
 v_mfma_f32_16x16x32_bf16 v[108:111], a[108:111], a[76:79], v[108:111]
 v_mfma_f32_16x16x32_bf16 v[32:35], a[96:99], a[76:79], v[32:35]
 ds_read_b128 a[16:19], v227 offset:8192
 v_mfma_f32_16x16x32_bf16 v[40:43], a[96:99], a[80:83], v[40:43]
 v_and_b32 v222, s68, v222
 v_mfma_f32_16x16x32_bf16 v[44:47], a[100:103], a[80:83], v[44:47]
 ds_read_b128 a[20:23], v227 offset:10240
 v_mfma_f32_16x16x32_bf16 v[36:39], a[100:103], a[76:79], v[36:39]
 v_mfma_f32_16x16x32_bf16 v[156:159], a[76:79], a[112:115], v[156:159]
 ds_read_b128 a[24:27], v227 offset:12288
 v_lshlrev_b32 v221, 16, v223
 v_mfma_f32_16x16x32_bf16 v[160:163], a[80:83], a[112:115], v[160:163]
 v_mfma_f32_16x16x32_bf16 v[196:199], a[80:83], a[116:119], v[196:199]
 ds_read_b128 a[28:31], v227 offset:14336
 v_and_b32 v223, s68, v223
 v_mfma_f32_16x16x32_bf16 v[192:195], a[76:79], a[116:119], v[192:195]
 v_mfma_f32_16x16x32_bf16 v[200:203], a[84:87], a[116:119], v[200:203]
 v_mfma_f32_16x16x32_bf16 v[204:207], a[88:91], a[116:119], v[204:207]
 v_mul_f32 v221, v221, v220
 v_mfma_f32_16x16x32_bf16 v[168:171], a[88:91], a[112:115], v[168:171]
 v_mfma_f32_16x16x32_bf16 v[164:167], a[84:87], a[112:115], v[164:167]
 v_mfma_f32_16x16x32_bf16 v[52:55], a[100:103], a[84:87], v[52:55]
 v_mul_f32 v223, v223, v222
 v_mfma_f32_16x16x32_bf16 v[60:63], a[100:103], a[88:91], v[60:63]
 v_mfma_f32_16x16x32_bf16 v[56:59], a[96:99], a[88:91], v[56:59]
 v_cvt_pk_bf16_f32 v221, v221, v223
 v_mfma_f32_16x16x32_bf16 v[48:51], a[96:99], a[84:87], v[48:51]
 v_mfma_f32_16x16x32_bf16 v[124:127], a[108:111], a[84:87], v[124:127]
 v_mfma_f32_16x16x32_bf16 v[132:135], a[108:111], a[88:91], v[132:135]
 v_dot2_f32_bf16 v215, v221, s69, v215
 v_mfma_f32_16x16x32_bf16 v[128:131], a[104:107], a[88:91], v[128:131]
 v_mfma_f32_16x16x32_bf16 v[120:123], a[104:107], a[84:87], v[120:123]
 s_waitcnt lgkmcnt(0)
 s_barrier
 v_mfma_f32_16x16x32_bf16 v[64:67], a[44:47], a[32:35], v[64:67]
 ds_read_b64_tr_b16 a[96:97], v229 offset:36864
 v_mfma_f32_16x16x32_bf16 v[68:71], a[48:51], a[32:35], v[68:71]
 ds_read_b64_tr_b16 a[98:99], v229 offset:38400
 v_mfma_f32_16x16x32_bf16 v[136:139], a[32:35], a[52:55], v[136:139]
 ds_read_b128 a[92:95], v211
 v_mfma_f32_16x16x32_bf16 v[172:175], a[32:35], a[56:59], v[172:175]
 v_mfma_f32_16x16x32_bf16 v[72:75], a[44:47], a[0:3], v[72:75]
 ds_read_b64_tr_b16 a[100:101], v230 offset:36864
 v_lshlrev_b32 v220, 16, v217
 v_mfma_f32_16x16x32_bf16 v[80:83], a[44:47], a[4:7], v[80:83]
 s_and_b32 s43, s30, 6
 s_lshl_b32 s43, s43, 2
 buffer_load_dwordx2 a[250:251], off, s[60:63], s43 sc1
 v_mfma_f32_16x16x32_bf16 v[84:87], a[48:51], a[4:7], v[84:87]
 ds_read_b64_tr_b16 a[102:103], v230 offset:38400
 v_and_b32 v217, s68, v217
 v_mfma_f32_16x16x32_bf16 v[76:79], a[48:51], a[0:3], v[76:79]
 v_mfma_f32_16x16x32_bf16 v[0:3], a[36:39], a[0:3], v[0:3]
 ds_read_b128 a[60:63], v228 offset:0
 v_mfma_f32_16x16x32_bf16 v[8:11], a[36:39], a[4:7], v[8:11]
 v_lshlrev_b32 v221, 16, v219
 v_mfma_f32_16x16x32_bf16 v[12:15], a[40:43], a[4:7], v[12:15]
 ds_read_b64_tr_b16 a[104:105], v229 offset:36992
 v_mfma_f32_16x16x32_bf16 v[4:7], a[40:43], a[0:3], v[4:7]
 v_mfma_f32_16x16x32_bf16 v[140:143], a[0:3], a[52:55], v[140:143]
 ds_read_b64_tr_b16 a[106:107], v229 offset:38528
 v_and_b32 v219, s68, v219
 v_mfma_f32_16x16x32_bf16 v[144:147], a[4:7], a[52:55], v[144:147]
 v_mfma_f32_16x16x32_bf16 v[180:183], a[4:7], a[56:59], v[180:183]
 ds_read_b128 a[64:67], v228 offset:2048
 v_mul_f32 v221, v221, v220
 v_mfma_f32_16x16x32_bf16 v[176:179], a[0:3], a[56:59], v[176:179]
 v_mfma_f32_16x16x32_bf16 v[184:187], a[8:11], a[56:59], v[184:187]
 ds_read_b64_tr_b16 a[108:109], v230 offset:36992
 v_mfma_f32_16x16x32_bf16 v[188:191], a[12:15], a[56:59], v[188:191]
 v_mul_f32 v219, v219, v217
 v_mfma_f32_16x16x32_bf16 v[152:155], a[12:15], a[52:55], v[152:155]
 ds_read_b64_tr_b16 a[110:111], v230 offset:38528
 v_mfma_f32_16x16x32_bf16 v[148:151], a[8:11], a[52:55], v[148:151]
 v_mfma_f32_16x16x32_bf16 v[20:23], a[40:43], a[8:11], v[20:23]
 ds_read_b128 a[68:71], v228 offset:4096
 buffer_load_dword a206, v253, s[72:75], s54 offen
 s_add_u32 s54, s54, 262144
 v_cvt_pk_bf16_f32 v221, v221, v219
 v_mfma_f32_16x16x32_bf16 v[28:31], a[40:43], a[12:15], v[28:31]
 v_mfma_f32_16x16x32_bf16 v[24:27], a[36:39], a[12:15], v[24:27]
 ds_read_b64_tr_b16 a[112:113], v229 offset:37120
 v_dot2_f32_bf16 v215, v221, s69, v215
 v_mfma_f32_16x16x32_bf16 v[16:19], a[36:39], a[8:11], v[16:19]
 v_mfma_f32_16x16x32_bf16 v[92:95], a[48:51], a[8:11], v[92:95]
 ds_read_b64_tr_b16 a[114:115], v229 offset:38656
 v_mfma_f32_16x16x32_bf16 v[100:103], a[48:51], a[12:15], v[100:103]
 v_accvgpr_read_b32 v222, a216
 v_mfma_f32_16x16x32_bf16 v[96:99], a[44:47], a[12:15], v[96:99]
 ds_read_b128 a[72:75], v228 offset:6144
 v_mfma_f32_16x16x32_bf16 v[88:91], a[44:47], a[8:11], v[88:91]
 v_mfma_f32_16x16x32_bf16 v[104:107], a[44:47], a[16:19], v[104:107]
 ds_read_b64_tr_b16 a[116:117], v230 offset:37120
 v_accvgpr_read_b32 v223, a218
 v_mfma_f32_16x16x32_bf16 v[112:115], a[44:47], a[20:23], v[112:115]
 v_mfma_f32_16x16x32_bf16 v[116:119], a[48:51], a[20:23], v[116:119]
 ds_read_b64_tr_b16 a[118:119], v230 offset:38656
 v_lshlrev_b32 v220, 16, v222
 v_mfma_f32_16x16x32_bf16 v[108:111], a[48:51], a[16:19], v[108:111]
 v_mfma_f32_16x16x32_bf16 v[32:35], a[36:39], a[16:19], v[32:35]
 ds_read_b128 a[76:79], v228 offset:8192
 v_mfma_f32_16x16x32_bf16 v[40:43], a[36:39], a[20:23], v[40:43]
 v_and_b32 v222, s68, v222
 v_mfma_f32_16x16x32_bf16 v[44:47], a[40:43], a[20:23], v[44:47]
 ds_read_b128 a[80:83], v228 offset:10240
 v_mfma_f32_16x16x32_bf16 v[36:39], a[40:43], a[16:19], v[36:39]
 buffer_load_dword a207, v254, s[76:79], s55 offen
 s_add_u32 s55, s55, 917504
 v_mfma_f32_16x16x32_bf16 v[156:159], a[16:19], a[52:55], v[156:159]
 ds_read_b128 a[84:87], v228 offset:12288
 v_lshlrev_b32 v221, 16, v223
 v_mfma_f32_16x16x32_bf16 v[160:163], a[20:23], a[52:55], v[160:163]
 v_mfma_f32_16x16x32_bf16 v[196:199], a[20:23], a[56:59], v[196:199]
 ds_read_b128 a[88:91], v228 offset:14336
 v_and_b32 v223, s68, v223
 v_mfma_f32_16x16x32_bf16 v[192:195], a[16:19], a[56:59], v[192:195]
 v_mfma_f32_16x16x32_bf16 v[200:203], a[24:27], a[56:59], v[200:203]
 v_mfma_f32_16x16x32_bf16 v[204:207], a[28:31], a[56:59], v[204:207]
 v_mul_f32 v221, v221, v220
 v_mfma_f32_16x16x32_bf16 v[168:171], a[28:31], a[52:55], v[168:171]
 v_mfma_f32_16x16x32_bf16 v[164:167], a[24:27], a[52:55], v[164:167]
 v_mfma_f32_16x16x32_bf16 v[52:55], a[40:43], a[24:27], v[52:55]
 v_mul_f32 v223, v223, v222
 v_mfma_f32_16x16x32_bf16 v[60:63], a[40:43], a[28:31], v[60:63]
 v_mfma_f32_16x16x32_bf16 v[56:59], a[36:39], a[28:31], v[56:59]
 v_cvt_pk_bf16_f32 v221, v221, v223
 v_mfma_f32_16x16x32_bf16 v[48:51], a[36:39], a[24:27], v[48:51]
 v_mfma_f32_16x16x32_bf16 v[124:127], a[48:51], a[24:27], v[124:127]
 v_mfma_f32_16x16x32_bf16 v[132:135], a[48:51], a[28:31], v[132:135]
 v_dot2_f32_bf16 v215, v221, s69, v215
 v_mfma_f32_16x16x32_bf16 v[128:131], a[44:47], a[28:31], v[128:131]
 v_mfma_f32_16x16x32_bf16 v[120:123], a[44:47], a[24:27], v[120:123]
 s_waitcnt lgkmcnt(0)
 s_barrier
 v_mfma_f32_16x16x32_bf16 v[64:67], a[104:107], a[92:95], v[64:67]
 v_add_u32 v227, s47, v225
 v_add_u32 v210, s47, v208
 v_add_u32 v228, s47, v226
 ds_read_b64_tr_b16 a[0:1], v229 offset:0
 v_mfma_f32_16x16x32_bf16 v[68:71], a[108:111], a[92:95], v[68:71]
 v_add_u32 v211, s47, v209
 v_add_u32 v225, 49152, v225
 v_add_u32 v226, 49152, v226
 ds_read_b64_tr_b16 a[2:3], v229 offset:1536
 v_mfma_f32_16x16x32_bf16 v[136:139], a[92:95], a[112:115], v[136:139]
 v_add_u32 v208, 49152, v208
 v_add_u32 v209, 49152, v209
 ds_read_b64_tr_b16 a[4:5], v230 offset:0
 v_mfma_f32_16x16x32_bf16 v[172:175], a[92:95], a[116:119], v[172:175]
 ds_read_b64_tr_b16 a[6:7], v230 offset:1536
 v_mfma_f32_16x16x32_bf16 v[72:75], a[104:107], a[60:63], v[72:75]
 v_accvgpr_read_b32 v222, a217
 v_mfma_f32_16x16x32_bf16 v[80:83], a[104:107], a[64:67], v[80:83]
 ds_read_b64_tr_b16 a[8:9], v229 offset:128
 v_accvgpr_read_b32 v223, a219
 v_mfma_f32_16x16x32_bf16 v[84:87], a[108:111], a[64:67], v[84:87]
 v_mfma_f32_16x16x32_bf16 v[76:79], a[108:111], a[60:63], v[76:79]
 ds_read_b64_tr_b16 a[10:11], v229 offset:1664
 v_lshlrev_b32 v220, 16, v222
 v_mfma_f32_16x16x32_bf16 v[0:3], a[96:99], a[60:63], v[0:3]
 v_and_b32 v222, s68, v222
 v_mfma_f32_16x16x32_bf16 v[8:11], a[96:99], a[64:67], v[8:11]
 ds_read_b64_tr_b16 a[12:13], v230 offset:128
 v_mfma_f32_16x16x32_bf16 v[12:15], a[100:103], a[64:67], v[12:15]
 v_lshlrev_b32 v221, 16, v223
 v_mfma_f32_16x16x32_bf16 v[4:7], a[100:103], a[60:63], v[4:7]
 ds_read_b64_tr_b16 a[14:15], v230 offset:1664
 v_mfma_f32_16x16x32_bf16 v[140:143], a[60:63], a[112:115], v[140:143]
 v_and_b32 v223, s68, v223
 v_mfma_f32_16x16x32_bf16 v[144:147], a[64:67], a[112:115], v[144:147]
 ds_read_b64_tr_b16 a[16:17], v229 offset:256
 v_mul_f32 v221, v221, v220
 v_mfma_f32_16x16x32_bf16 v[180:183], a[64:67], a[116:119], v[180:183]
 v_mfma_f32_16x16x32_bf16 v[176:179], a[60:63], a[116:119], v[176:179]
 ds_read_b64_tr_b16 a[18:19], v229 offset:1792
 v_mul_f32 v223, v223, v222
 v_mfma_f32_16x16x32_bf16 v[184:187], a[68:71], a[116:119], v[184:187]
 v_cvt_pk_bf16_f32 v221, v221, v223
 v_mfma_f32_16x16x32_bf16 v[188:191], a[72:75], a[116:119], v[188:191]
 ds_read_b64_tr_b16 a[20:21], v230 offset:256
 v_mfma_f32_16x16x32_bf16 v[152:155], a[72:75], a[112:115], v[152:155]
 ds_read_b64_tr_b16 a[22:23], v230 offset:1792
 v_dot2_f32_bf16 v215, v221, s69, v215
 v_mfma_f32_16x16x32_bf16 v[148:151], a[68:71], a[112:115], v[148:151]
 v_mfma_f32_16x16x32_bf16 v[20:23], a[100:103], a[68:71], v[20:23]
 ds_read_b64_tr_b16 a[24:25], v229 offset:12288
 v_add_f32_dpp v215, v215, v215 row_ror:8 row_mask:0xf bank_mask:0xf
 v_mfma_f32_16x16x32_bf16 v[28:31], a[100:103], a[72:75], v[28:31]
    s_nop 0
 v_add_f32_dpp v215, v215, v215 row_ror:4 row_mask:0xf bank_mask:0xf
 v_mfma_f32_16x16x32_bf16 v[24:27], a[96:99], a[72:75], v[24:27]
 ds_read_b64_tr_b16 a[26:27], v229 offset:13824
 v_mfma_f32_16x16x32_bf16 v[16:19], a[96:99], a[68:71], v[16:19]
 v_add_f32_dpp v215, v215, v215 row_ror:2 row_mask:0xf bank_mask:0xf
 v_mfma_f32_16x16x32_bf16 v[92:95], a[108:111], a[68:71], v[92:95]
 ds_read_b64_tr_b16 a[28:29], v230 offset:12288
 v_add_f32_dpp v215, v215, v215 row_ror:1 row_mask:0xf bank_mask:0xf
 v_mfma_f32_16x16x32_bf16 v[100:103], a[108:111], a[72:75], v[100:103]
 v_mfma_f32_16x16x32_bf16 v[96:99], a[104:107], a[72:75], v[96:99]
 ds_read_b64_tr_b16 a[30:31], v230 offset:13824
 v_cvt_pk_bf16_f32 v215, v215, v215
 v_mfma_f32_16x16x32_bf16 v[88:91], a[104:107], a[68:71], v[88:91]
 v_mfma_f32_16x16x32_bf16 v[104:107], a[104:107], a[76:79], v[104:107]
 ds_read_b64_tr_b16 a[32:33], v229 offset:12416
 v_and_b32 v215, s68, v215
 v_mfma_f32_16x16x32_bf16 v[112:115], a[104:107], a[80:83], v[112:115]
 v_mul_f32 v215, 0xbfb8aa3b, v215
 v_mfma_f32_16x16x32_bf16 v[116:119], a[108:111], a[80:83], v[116:119]
 ds_read_b64_tr_b16 a[34:35], v229 offset:13952
 v_mfma_f32_16x16x32_bf16 v[108:111], a[108:111], a[76:79], v[108:111]
 v_exp_f32 v215, v215
 v_mfma_f32_16x16x32_bf16 v[32:35], a[96:99], a[76:79], v[32:35]
 ds_read_b64_tr_b16 a[36:37], v230 offset:12416
 v_add_f32 v215, 1.0, v215
 v_mfma_f32_16x16x32_bf16 v[40:43], a[96:99], a[80:83], v[40:43]
 ds_read_b64_tr_b16 a[38:39], v230 offset:13952
 v_mfma_f32_16x16x32_bf16 v[44:47], a[100:103], a[80:83], v[44:47]
 v_rcp_f32 v215, v215
 v_mfma_f32_16x16x32_bf16 v[36:39], a[100:103], a[76:79], v[36:39]
 ds_read_b64_tr_b16 a[40:41], v229 offset:12544
 v_mfma_f32_16x16x32_bf16 v[156:159], a[76:79], a[112:115], v[156:159]
 v_cvt_pk_bf16_f32 v215, v215, v215
 v_mfma_f32_16x16x32_bf16 v[160:163], a[80:83], a[112:115], v[160:163]
 ds_read_b64_tr_b16 a[42:43], v229 offset:14080
 v_and_b32 v216, s68, v215
 v_mfma_f32_16x16x32_bf16 v[196:199], a[80:83], a[116:119], v[196:199]
 v_mfma_f32_16x16x32_bf16 v[192:195], a[76:79], a[116:119], v[192:195]
 ds_read_b64_tr_b16 a[44:45], v230 offset:12544
 v_sub_f32 v215, 1.0, v216
 v_mfma_f32_16x16x32_bf16 v[200:203], a[84:87], a[116:119], v[200:203]
 v_cvt_pk_bf16_f32 v215, v215, v215
 v_mfma_f32_16x16x32_bf16 v[204:207], a[88:91], a[116:119], v[204:207]
 ds_read_b64_tr_b16 a[46:47], v230 offset:14080
 v_mfma_f32_16x16x32_bf16 v[168:171], a[88:91], a[112:115], v[168:171]
 v_and_b32 v217, s68, v215
 v_mfma_f32_16x16x32_bf16 v[164:167], a[84:87], a[112:115], v[164:167]
 ds_read_b128 a[180:183], v210 offset:0
 v_mfma_f32_16x16x32_bf16 v[52:55], a[100:103], a[84:87], v[52:55]
 s_lshl_b32 s40, s39, 5
 v_mfma_f32_16x16x32_bf16 v[60:63], a[100:103], a[88:91], v[60:63]
 ds_read_b128 a[184:187], v211 offset:0
 s_add_u32 s40, s40, 18874368
 v_mfma_f32_16x16x32_bf16 v[56:59], a[96:99], a[88:91], v[56:59]
 v_mfma_f32_16x16x32_bf16 v[48:51], a[96:99], a[84:87], v[48:51]
 v_lshrrev_b32 v220, 4, v224
 v_mfma_f32_16x16x32_bf16 v[124:127], a[108:111], a[84:87], v[124:127]
 v_lshlrev_b32 v220, 3, v220
 v_mfma_f32_16x16x32_bf16 v[132:135], a[108:111], a[88:91], v[132:135]
 v_mfma_f32_16x16x32_bf16 v[128:131], a[104:107], a[88:91], v[128:131]
 buffer_store_dwordx2 v[216:217], v220, s[20:23], s40 offen sc1
 v_mfma_f32_16x16x32_bf16 v[120:123], a[104:107], a[84:87], v[120:123]
 s_branch L1q_tail
L1q_dma:
 v_xor_b32 v236, 64, v235
 s_mul_i32 s39, s33, 196608
 s_add_u32 s39, s39, s38
 s_mul_i32 s45, s33, 12288
 s_add_u32 s40, s39, 0
 v_add_u32 v239, s40, v235
 s_add_u32 s40, s39, 15360
 v_add_u32 v240, s40, v236
 s_add_u32 s40, s39, 30720
 v_add_u32 v241, s40, v235
 s_add_u32 s40, s39, 46080
 v_add_u32 v242, s40, v236
 s_add_u32 s40, s39, 65536
 v_add_u32 v243, s40, v235
 s_add_u32 s40, s39, 80896
 v_add_u32 v244, s40, v236
 s_add_u32 s40, s39, 98304
 v_add_u32 v245, s40, v235
 s_add_u32 s40, s39, 113664
 v_add_u32 v246, s40, v236
 s_add_u32 s40, s39, 129024
 s_sub_u32 s41, s38, 34816
 s_cmp_eq_u32 s33, 2
 s_cselect_b32 s40, s41, s40
 v_add_u32 v247, s40, v235
 s_add_u32 s40, s39, 144384
 s_sub_u32 s41, s38, 19456
 s_cmp_eq_u32 s33, 2
 s_cselect_b32 s40, s41, s40
 v_add_u32 v248, s40, v236
 s_add_u32 s40, s39, 163840
 s_mov_b32 s41, 0x80000000
 s_cmp_eq_u32 s33, 2
 s_cselect_b32 s40, s41, s40
 v_add_u32 v249, s40, v235
 s_add_u32 s40, s39, 179200
 s_mov_b32 s41, 0x80000000
 s_cmp_eq_u32 s33, 2
 s_cselect_b32 s40, s41, s40
 v_add_u32 v250, s40, v236
 s_waitcnt lgkmcnt(0)
 s_mov_b32 s12, s4
 s_mov_b32 s13, s5
 s_add_u32 m0, s45, 49152
 s_add_u32 s50, s71, 0
 s_and_b32 s50, s50, 2047
 s_mov_b32 s16, s6
 buffer_load_dwordx4 v239, s[12:15], s50 offen offset:0  lds
 s_mov_b32 s17, s7
 s_mov_b32 s18, 0x600000
 s_mul_i32 s40, s33, 256
 s_mul_i32 s41, s35, 128
 s_mov_b32 s42, 6144
 s_mul_i32 s44, s33, 4096
 s_mul_i32 s51, s71, 3072
 buffer_load_dwordx4 v240, s[12:15], s50 offen offset:1024  lds
 v_add_u32 v237, s40, v224
 v_add_u32 v232, 0, v237
 v_mul_u32_u24 v233, 2731, v232
 v_lshrrev_b32 v233, 16, v233
 v_mul_u32_u24 v234, 24, v233
 v_sub_u32 v234, v232, v234
 v_and_b32 v235, 2, v233
 buffer_load_dwordx4 v241, s[12:15], s50 offen offset:2048  lds
 v_lshrrev_b32 v236, 1, v233
 v_and_b32 v236, 4, v236
 v_or_b32 v235, v235, v236
 v_xor_b32 v234, v234, v235
 v_lshrrev_b32 v235, 3, v234
 v_and_b32 v236, 7, v234
 v_lshlrev_b32 v235, 11, v235
 buffer_load_dwordx4 v242, s[12:15], s50 offen offset:3072  lds
 v_lshl_add_u32 v234, v236, 4, v235
 v_mul_lo_u32 v233, v233, s42
 s_sub_u32 s43, s41, 0
 v_add3_u32 v251, v233, v234, s43
 v_add_u32 v232, 64, v237
 v_mul_u32_u24 v233, 2731, v232
 s_add_u32 m0, s45, 53248
 v_lshrrev_b32 v233, 16, v233
 buffer_load_dwordx4 v243, s[12:15], s50 offen offset:0  lds
 v_mul_u32_u24 v234, 24, v233
 v_sub_u32 v234, v232, v234
 v_and_b32 v235, 2, v233
 v_lshrrev_b32 v236, 1, v233
 v_and_b32 v236, 4, v236
 v_or_b32 v235, v235, v236
 v_xor_b32 v234, v234, v235
 buffer_load_dwordx4 v244, s[12:15], s50 offen offset:1024  lds
 v_lshrrev_b32 v235, 3, v234
 v_and_b32 v236, 7, v234
 v_lshlrev_b32 v235, 11, v235
 v_lshl_add_u32 v234, v236, 4, v235
 v_mul_lo_u32 v233, v233, s42
 s_sub_u32 s43, s41, 1024
 s_add_u32 m0, s45, 55296
 s_add_u32 s50, s71, 0
 s_and_b32 s50, s50, 2047
 v_add3_u32 v252, v233, v234, s43
 buffer_load_dwordx4 v245, s[12:15], s50 offen offset:0  lds
 v_add_u32 v232, 128, v237
 v_mul_u32_u24 v233, 2731, v232
 v_lshrrev_b32 v233, 16, v233
 v_mul_u32_u24 v234, 24, v233
 v_sub_u32 v234, v232, v234
 v_and_b32 v235, 2, v233
 v_lshrrev_b32 v236, 1, v233
 buffer_load_dwordx4 v246, s[12:15], s50 offen offset:1024  lds
 v_and_b32 v236, 4, v236
 v_or_b32 v235, v235, v236
 v_xor_b32 v234, v234, v235
 v_lshrrev_b32 v235, 3, v234
 v_and_b32 v236, 7, v234
 v_lshlrev_b32 v235, 11, v235
 v_lshl_add_u32 v234, v236, 4, v235
 buffer_load_dwordx4 v247, s[12:15], s50 offen offset:2048  lds
 v_mul_lo_u32 v233, v233, s42
 s_sub_u32 s43, s41, 2048
 v_add3_u32 v253, v233, v234, s43
 v_add_u32 v232, 192, v237
 v_mul_u32_u24 v233, 2731, v232
 v_lshrrev_b32 v233, 16, v233
 v_mul_u32_u24 v234, 24, v233
 buffer_load_dwordx4 v248, s[12:15], s50 offen offset:3072  lds
 v_sub_u32 v234, v232, v234
 v_and_b32 v235, 2, v233
 v_lshrrev_b32 v236, 1, v233
 v_and_b32 v236, 4, v236
 v_or_b32 v235, v235, v236
 v_xor_b32 v234, v234, v235
 s_add_u32 m0, s45, 59392
 v_lshrrev_b32 v235, 3, v234
 buffer_load_dwordx4 v249, s[12:15], s50 offen offset:0  lds
 v_and_b32 v236, 7, v234
 v_lshlrev_b32 v235, 11, v235
 v_lshl_add_u32 v234, v236, 4, v235
 v_mul_lo_u32 v233, v233, s42
 s_sub_u32 s43, s41, 3072
 v_add3_u32 v254, v233, v234, s43
 buffer_load_dwordx4 v250, s[12:15], s50 offen offset:1024  lds
 s_add_u32 m0, s44, 0
 v_and_b32 v232, 15, v224
 buffer_load_dwordx4 v251, s[16:19], s51 offen offset:0  lds
 v_lshrrev_b32 v233, 4, v224
 v_lshrrev_b32 v234, 1, v232
 v_xor_b32 v235, v233, v234
 v_xor_b32 v236, 4, v235
 v_lshlrev_b32 v235, 4, v235
 v_lshlrev_b32 v236, 4, v236
 s_lshl_b32 s40, s36, 14
 v_lshl_add_u32 v237, v232, 7, s40
 v_add_u32 v225, v237, v235
 buffer_load_dwordx4 v252, s[16:19], s51 offen offset:1024  lds
 v_add_u32 v226, v237, v236
 v_add_u32 v227, 49152, v225
 v_add_u32 v228, 49152, v226
 s_mul_i32 s40, s36, -34816
 s_add_i32 s40, s40, 0x8000
 v_add_u32 v208, s40, v225
 v_add_u32 v209, s40, v226
 v_add_u32 v210, s40, v227
 v_add_u32 v211, s40, v228
 buffer_load_dwordx4 v253, s[16:19], s51 offen offset:2048  lds
 v_lshrrev_b32 v232, 4, v224
 v_bfe_u32 v233, v224, 2, 2
 v_and_b32 v234, 3, v224
 v_mul_u32_u24 v235, 3072, v232
 v_mul_u32_u24 v236, 384, v233
 v_add_u32 v235, v235, v236
 v_lshl_add_u32 v235, v234, 3, v235
 v_lshrrev_b32 v236, 1, v233
 v_and_b32 v237, 1, v232
 buffer_load_dwordx4 v254, s[16:19], s51 offen offset:3072  lds
 s_add_u32 s51, s51, 196608
 s_cmp_eq_u32 s51, 6291456
 s_cselect_b32 s51, 0, s51
 v_lshl_or_b32 v236, v237, 1, v236
 s_lshl_b32 s40, s37, 1
 s_add_u32 s41, s40, 0
 v_xor_b32 v237, s41, v236
 v_lshl_add_u32 v229, v237, 5, v235
 s_add_u32 m0, s44, 12288
 s_add_u32 s41, s40, 1
 buffer_load_dwordx4 v251, s[16:19], s51 offen offset:0  lds
 v_xor_b32 v237, s41, v236
 v_lshl_add_u32 v230, v237, 5, v235
 s_mov_b32 s22, 0x10000000
 s_mov_b32 s23, 0x20000
 s_mov_b32 s26, 2048
 s_mov_b32 s27, 0x20000
 v_lshrrev_b32 v232, 4, v224
 v_and_b32 v233, 15, v224
 v_lshrrev_b32 v234, 5, v224
 buffer_load_dwordx4 v252, s[16:19], s51 offen offset:1024  lds
 s_lshl_b32 s40, s33, 1
 v_add_u32 v234, s40, v234
 v_lshlrev_b32 v234, 4, v234
 v_lshlrev_b32 v223, 3, v233
 v_xor_b32 v234, v234, v223
 v_lshl_add_u32 v234, v232, 7, v234
 s_lshl_b32 s40, s35, 11
 s_lshl_b32 s41, s33, 9
 s_add_u32 s40, s40, s41
 buffer_load_dwordx4 v253, s[16:19], s51 offen offset:2048  lds
 v_add_u32 v213, s40, v234
 v_add_u32 v214, 49152, v213
 v_add_u32 v212, 159744, v223
 v_lshl_add_u32 v222, v232, 11, v223
 s_lshl_b32 s56, s40, 4
 s_add_u32 s56, s56, s38
 v_mov_b32 v215, 0
 s_mov_b32 s68, 0xffff0000
 s_mov_b32 s69, 0x3f803f80
 buffer_load_dwordx4 v254, s[16:19], s51 offen offset:3072  lds
 s_add_u32 s51, s51, 196608
 s_cmp_eq_u32 s51, 6291456
 s_cselect_b32 s51, 0, s51
 s_lshl_b32 s39, s34, 4
 s_add_u32 s39, s39, s35
 s_lshl_b32 s39, s39, 2
 s_add_u32 s39, s39, s33
 v_lshlrev_b32 v221, 4, v224
 s_add_u32 m0, s45, 86016
 s_add_u32 s50, s71, 128
 s_and_b32 s50, s50, 2047
 buffer_load_dwordx4 v239, s[12:15], s50 offen offset:0  lds
 buffer_load_dwordx4 v240, s[12:15], s50 offen offset:1024  lds
 buffer_load_dwordx4 v241, s[12:15], s50 offen offset:2048  lds
 buffer_load_dwordx4 v242, s[12:15], s50 offen offset:3072  lds
 s_add_u32 m0, s45, 90112
    s_nop 0
 buffer_load_dwordx4 v243, s[12:15], s50 offen offset:0  lds
 buffer_load_dwordx4 v244, s[12:15], s50 offen offset:1024  lds
 s_add_u32 m0, s45, 92160
 s_add_u32 s50, s71, 128
 s_and_b32 s50, s50, 2047
 buffer_load_dwordx4 v245, s[12:15], s50 offen offset:0  lds
 buffer_load_dwordx4 v246, s[12:15], s50 offen offset:1024  lds
 buffer_load_dwordx4 v247, s[12:15], s50 offen offset:2048  lds
 buffer_load_dwordx4 v248, s[12:15], s50 offen offset:3072  lds
 s_add_u32 m0, s45, 96256
    s_nop 0
 buffer_load_dwordx4 v249, s[12:15], s50 offen offset:0  lds
 buffer_load_dwordx4 v250, s[12:15], s50 offen offset:1024  lds
 s_add_u32 m0, s44, 24576
    s_nop 0
 buffer_load_dwordx4 v251, s[16:19], s51 offen offset:0  lds
 buffer_load_dwordx4 v252, s[16:19], s51 offen offset:1024  lds
 buffer_load_dwordx4 v253, s[16:19], s51 offen offset:2048  lds
 buffer_load_dwordx4 v254, s[16:19], s51 offen offset:3072  lds
 s_add_u32 s51, s51, 196608
 s_cmp_eq_u32 s51, 6291456
 s_cselect_b32 s51, 0, s51
 buffer_load_dwordx2 a[208:209], v223, s[24:27], 0 offen offset:1664
 buffer_load_dwordx2 a[210:211], v222, s[12:15], s56 offen offset:1664
 buffer_load_dwordx2 a[212:213], v223, s[24:27], 0 offen offset:1792
 buffer_load_dwordx2 a[214:215], v222, s[12:15], s56 offen offset:1792
 buffer_load_dwordx2 a[216:217], v223, s[24:27], 0 offen offset:1920
 buffer_load_dwordx2 a[218:219], v222, s[12:15], s56 offen offset:1920
 s_waitcnt vmcnt(26)
 s_barrier
 ds_read_b64_tr_b16 a[36:37], v229 offset:0
 ds_read_b64_tr_b16 a[38:39], v229 offset:1536
 ds_read_b128 a[32:35], v210
 ds_read_b64_tr_b16 a[40:41], v230 offset:0
 ds_read_b64_tr_b16 a[42:43], v230 offset:1536
 ds_read_b128 a[0:3], v227 offset:0
 ds_read_b64_tr_b16 a[44:45], v229 offset:128
 ds_read_b64_tr_b16 a[46:47], v229 offset:1664
 ds_read_b128 a[4:7], v227 offset:2048
 ds_read_b64_tr_b16 a[48:49], v230 offset:128
 ds_read_b64_tr_b16 a[50:51], v230 offset:1664
 ds_read_b128 a[8:11], v227 offset:4096
 ds_read_b64_tr_b16 a[52:53], v229 offset:256
 ds_read_b64_tr_b16 a[54:55], v229 offset:1792
 ds_read_b128 a[12:15], v227 offset:6144
 ds_read_b64_tr_b16 a[56:57], v230 offset:256
 ds_read_b64_tr_b16 a[58:59], v230 offset:1792
 ds_read_b128 a[16:19], v227 offset:8192
 ds_read_b128 a[20:23], v227 offset:10240
 ds_read_b128 a[24:27], v227 offset:12288
 ds_read_b128 a[28:31], v227 offset:14336
 s_waitcnt lgkmcnt(0)
 s_waitcnt vmcnt(22)
 s_barrier
 v_mfma_f32_16x16x32_bf16 v[64:67], a[44:47], a[32:35], 0
 ds_read_b64_tr_b16 a[96:97], v229 offset:12288
 v_mfma_f32_16x16x32_bf16 v[68:71], a[48:51], a[32:35], 0
 ds_read_b64_tr_b16 a[98:99], v229 offset:13824
 v_mfma_f32_16x16x32_bf16 v[136:139], a[32:35], a[52:55], 0
 ds_read_b128 a[92:95], v211
 v_mfma_f32_16x16x32_bf16 v[172:175], a[32:35], a[56:59], 0
 v_mfma_f32_16x16x32_bf16 v[72:75], a[44:47], a[0:3], 0
 ds_read_b64_tr_b16 a[100:101], v230 offset:12288
 s_add_u32 m0, s44, 36864
 v_mfma_f32_16x16x32_bf16 v[80:83], a[44:47], a[4:7], 0
 buffer_load_dwordx4 v251, s[16:19], s51 offen offset:0  lds
 v_mfma_f32_16x16x32_bf16 v[84:87], a[48:51], a[4:7], 0
 ds_read_b64_tr_b16 a[102:103], v230 offset:13824
 v_mfma_f32_16x16x32_bf16 v[76:79], a[48:51], a[0:3], 0
 v_mfma_f32_16x16x32_bf16 v[0:3], a[36:39], a[0:3], 0
 ds_read_b128 a[60:63], v228 offset:0
 v_mfma_f32_16x16x32_bf16 v[8:11], a[36:39], a[4:7], 0
 buffer_load_dwordx4 v252, s[16:19], s51 offen offset:1024  lds
 v_mfma_f32_16x16x32_bf16 v[12:15], a[40:43], a[4:7], 0
 ds_read_b64_tr_b16 a[104:105], v229 offset:12416
 v_mfma_f32_16x16x32_bf16 v[4:7], a[40:43], a[0:3], 0
 v_mfma_f32_16x16x32_bf16 v[140:143], a[0:3], a[52:55], 0
 ds_read_b64_tr_b16 a[106:107], v229 offset:13952
 v_mfma_f32_16x16x32_bf16 v[144:147], a[4:7], a[52:55], 0
 v_mfma_f32_16x16x32_bf16 v[180:183], a[4:7], a[56:59], 0
 ds_read_b128 a[64:67], v228 offset:2048
 buffer_load_dwordx4 v253, s[16:19], s51 offen offset:2048  lds
 v_mfma_f32_16x16x32_bf16 v[176:179], a[0:3], a[56:59], 0
 v_mfma_f32_16x16x32_bf16 v[184:187], a[8:11], a[56:59], 0
 ds_read_b64_tr_b16 a[108:109], v230 offset:12416
 v_mfma_f32_16x16x32_bf16 v[188:191], a[12:15], a[56:59], 0
 v_mfma_f32_16x16x32_bf16 v[152:155], a[12:15], a[52:55], 0
 ds_read_b64_tr_b16 a[110:111], v230 offset:13952
 buffer_load_dwordx4 v254, s[16:19], s51 offen offset:3072  lds
 s_add_u32 s51, s51, 196608
 s_cmp_eq_u32 s51, 6291456
 s_cselect_b32 s51, 0, s51
 v_mfma_f32_16x16x32_bf16 v[148:151], a[8:11], a[52:55], 0
 v_mfma_f32_16x16x32_bf16 v[20:23], a[40:43], a[8:11], 0
 ds_read_b128 a[68:71], v228 offset:4096
 v_mfma_f32_16x16x32_bf16 v[28:31], a[40:43], a[12:15], 0
 v_mfma_f32_16x16x32_bf16 v[24:27], a[36:39], a[12:15], 0
 ds_read_b64_tr_b16 a[112:113], v229 offset:12544
 s_add_u32 m0, s45, 122880
 s_add_u32 s50, s71, 256
 s_and_b32 s50, s50, 2047
 v_mfma_f32_16x16x32_bf16 v[16:19], a[36:39], a[8:11], 0
 buffer_load_dwordx4 v239, s[12:15], s50 offen offset:0  lds
 v_mfma_f32_16x16x32_bf16 v[92:95], a[48:51], a[8:11], 0
 ds_read_b64_tr_b16 a[114:115], v229 offset:14080
 v_mfma_f32_16x16x32_bf16 v[100:103], a[48:51], a[12:15], 0
 v_mfma_f32_16x16x32_bf16 v[96:99], a[44:47], a[12:15], 0
 ds_read_b128 a[72:75], v228 offset:6144
 v_mfma_f32_16x16x32_bf16 v[88:91], a[44:47], a[8:11], 0
 buffer_load_dwordx4 v240, s[12:15], s50 offen offset:1024  lds
 v_mfma_f32_16x16x32_bf16 v[104:107], a[44:47], a[16:19], 0
 ds_read_b64_tr_b16 a[116:117], v230 offset:12544
 v_mfma_f32_16x16x32_bf16 v[112:115], a[44:47], a[20:23], 0
 v_mfma_f32_16x16x32_bf16 v[116:119], a[48:51], a[20:23], 0
 ds_read_b64_tr_b16 a[118:119], v230 offset:14080
 v_mfma_f32_16x16x32_bf16 v[108:111], a[48:51], a[16:19], 0
 v_mfma_f32_16x16x32_bf16 v[32:35], a[36:39], a[16:19], 0
 ds_read_b128 a[76:79], v228 offset:8192
 buffer_load_dwordx4 v241, s[12:15], s50 offen offset:2048  lds
 v_mfma_f32_16x16x32_bf16 v[40:43], a[36:39], a[20:23], 0
 v_mfma_f32_16x16x32_bf16 v[44:47], a[40:43], a[20:23], 0
 ds_read_b128 a[80:83], v228 offset:10240
 v_mfma_f32_16x16x32_bf16 v[36:39], a[40:43], a[16:19], 0
 v_mfma_f32_16x16x32_bf16 v[156:159], a[16:19], a[52:55], 0
 ds_read_b128 a[84:87], v228 offset:12288
 buffer_load_dwordx4 v242, s[12:15], s50 offen offset:3072  lds
 v_mfma_f32_16x16x32_bf16 v[160:163], a[20:23], a[52:55], 0
 v_mfma_f32_16x16x32_bf16 v[196:199], a[20:23], a[56:59], 0
 ds_read_b128 a[88:91], v228 offset:14336
 v_mfma_f32_16x16x32_bf16 v[192:195], a[16:19], a[56:59], 0
 v_mfma_f32_16x16x32_bf16 v[200:203], a[24:27], a[56:59], 0
 s_add_u32 m0, s45, 126976
 v_mfma_f32_16x16x32_bf16 v[204:207], a[28:31], a[56:59], 0
 buffer_load_dwordx4 v243, s[12:15], s50 offen offset:0  lds
 v_mfma_f32_16x16x32_bf16 v[168:171], a[28:31], a[52:55], 0
 v_mfma_f32_16x16x32_bf16 v[164:167], a[24:27], a[52:55], 0
 v_mfma_f32_16x16x32_bf16 v[52:55], a[40:43], a[24:27], 0
 v_mfma_f32_16x16x32_bf16 v[60:63], a[40:43], a[28:31], 0
 buffer_load_dwordx4 v244, s[12:15], s50 offen offset:1024  lds
 v_mfma_f32_16x16x32_bf16 v[56:59], a[36:39], a[28:31], 0
 ds_read_b64 v[216:217], v212
 ds_read_b64 v[218:219], v214
 v_add_u32 v212, 128, v212
 v_mfma_f32_16x16x32_bf16 v[48:51], a[36:39], a[24:27], 0
 v_mfma_f32_16x16x32_bf16 v[124:127], a[48:51], a[24:27], 0
 v_mfma_f32_16x16x32_bf16 v[132:135], a[48:51], a[28:31], 0
 v_mfma_f32_16x16x32_bf16 v[128:131], a[44:47], a[28:31], 0
 v_mfma_f32_16x16x32_bf16 v[120:123], a[44:47], a[24:27], 0
 s_waitcnt lgkmcnt(0)
 s_waitcnt vmcnt(16)
 s_barrier
 v_mfma_f32_16x16x32_bf16 v[64:67], a[104:107], a[92:95], v[64:67]
 v_add_u32 v227, 86016, v225
 v_add_u32 v228, 86016, v226
 v_add_u32 v210, 86016, v208
 ds_read_b64_tr_b16 a[36:37], v229 offset:24576
 v_mfma_f32_16x16x32_bf16 v[68:71], a[108:111], a[92:95], v[68:71]
 v_add_u32 v211, 86016, v209
 v_add_u32 v214, 86016, v213
 ds_read_b64_tr_b16 a[38:39], v229 offset:26112
 v_mfma_f32_16x16x32_bf16 v[136:139], a[92:95], a[112:115], v[136:139]
 ds_read_b128 a[32:35], v210
 v_mfma_f32_16x16x32_bf16 v[172:175], a[92:95], a[116:119], v[172:175]
 v_mfma_f32_16x16x32_bf16 v[72:75], a[104:107], a[60:63], v[72:75]
 ds_read_b64_tr_b16 a[40:41], v230 offset:24576
 s_add_u32 m0, s44, 0
 v_lshlrev_b32 v220, 16, v216
 v_mfma_f32_16x16x32_bf16 v[80:83], a[104:107], a[64:67], v[80:83]
 buffer_load_dwordx4 v251, s[16:19], s51 offen offset:0  lds
 v_mfma_f32_16x16x32_bf16 v[84:87], a[108:111], a[64:67], v[84:87]
 ds_read_b64_tr_b16 a[42:43], v230 offset:26112
 v_mfma_f32_16x16x32_bf16 v[76:79], a[108:111], a[60:63], v[76:79]
 v_mfma_f32_16x16x32_bf16 v[0:3], a[96:99], a[60:63], v[0:3]
 ds_read_b128 a[0:3], v227 offset:0
 buffer_load_dwordx4 v252, s[16:19], s51 offen offset:1024  lds
 v_mfma_f32_16x16x32_bf16 v[8:11], a[96:99], a[64:67], v[8:11]
 v_mfma_f32_16x16x32_bf16 v[12:15], a[100:103], a[64:67], v[12:15]
 ds_read_b64_tr_b16 a[44:45], v229 offset:24704
 v_and_b32 v216, s68, v216
 v_mfma_f32_16x16x32_bf16 v[4:7], a[100:103], a[60:63], v[4:7]
 buffer_load_dwordx4 v253, s[16:19], s51 offen offset:2048  lds
 v_mfma_f32_16x16x32_bf16 v[140:143], a[60:63], a[112:115], v[140:143]
 ds_read_b64_tr_b16 a[46:47], v229 offset:26240
 v_mfma_f32_16x16x32_bf16 v[144:147], a[64:67], a[112:115], v[144:147]
 v_mfma_f32_16x16x32_bf16 v[180:183], a[64:67], a[116:119], v[180:183]
 ds_read_b128 a[4:7], v227 offset:2048
 buffer_load_dwordx4 v254, s[16:19], s51 offen offset:3072  lds
 s_add_u32 s51, s51, 196608
 s_cmp_eq_u32 s51, 6291456
 s_cselect_b32 s51, 0, s51
 v_mfma_f32_16x16x32_bf16 v[176:179], a[60:63], a[116:119], v[176:179]
 v_mfma_f32_16x16x32_bf16 v[184:187], a[68:71], a[116:119], v[184:187]
 ds_read_b64_tr_b16 a[48:49], v230 offset:24704
 s_add_u32 m0, s45, 129024
 s_add_u32 s50, s71, 256
 s_and_b32 s50, s50, 2047
 v_lshlrev_b32 v221, 16, v218
 v_mfma_f32_16x16x32_bf16 v[188:191], a[72:75], a[116:119], v[188:191]
 buffer_load_dwordx4 v245, s[12:15], s50 offen offset:0  lds
 v_mfma_f32_16x16x32_bf16 v[152:155], a[72:75], a[112:115], v[152:155]
 ds_read_b64_tr_b16 a[50:51], v230 offset:26240
 v_mfma_f32_16x16x32_bf16 v[148:151], a[68:71], a[112:115], v[148:151]
 v_mfma_f32_16x16x32_bf16 v[20:23], a[100:103], a[68:71], v[20:23]
 ds_read_b128 a[8:11], v227 offset:4096
 v_mfma_f32_16x16x32_bf16 v[28:31], a[100:103], a[72:75], v[28:31]
 buffer_load_dwordx4 v246, s[12:15], s50 offen offset:1024  lds
 v_mfma_f32_16x16x32_bf16 v[24:27], a[96:99], a[72:75], v[24:27]
 ds_read_b64_tr_b16 a[52:53], v229 offset:24832
 v_and_b32 v218, s68, v218
 v_mfma_f32_16x16x32_bf16 v[16:19], a[96:99], a[68:71], v[16:19]
 v_mfma_f32_16x16x32_bf16 v[92:95], a[108:111], a[68:71], v[92:95]
 ds_read_b64_tr_b16 a[54:55], v229 offset:26368
 buffer_load_dwordx4 v247, s[12:15], s50 offen offset:2048  lds
 v_mfma_f32_16x16x32_bf16 v[100:103], a[108:111], a[72:75], v[100:103]
 v_mfma_f32_16x16x32_bf16 v[96:99], a[104:107], a[72:75], v[96:99]
 ds_read_b128 a[12:15], v227 offset:6144
 v_mfma_f32_16x16x32_bf16 v[88:91], a[104:107], a[68:71], v[88:91]
 buffer_load_dwordx4 v248, s[12:15], s50 offen offset:3072  lds
 v_mfma_f32_16x16x32_bf16 v[104:107], a[104:107], a[76:79], v[104:107]
 ds_read_b64_tr_b16 a[56:57], v230 offset:24832
 v_mul_f32 v221, v221, v220
 v_mfma_f32_16x16x32_bf16 v[112:115], a[104:107], a[80:83], v[112:115]
 s_add_u32 m0, s45, 133120
 v_mfma_f32_16x16x32_bf16 v[116:119], a[108:111], a[80:83], v[116:119]
 ds_read_b64_tr_b16 a[58:59], v230 offset:26368
 buffer_load_dwordx4 v249, s[12:15], s50 offen offset:0  lds
 v_mfma_f32_16x16x32_bf16 v[108:111], a[108:111], a[76:79], v[108:111]
 v_mfma_f32_16x16x32_bf16 v[32:35], a[96:99], a[76:79], v[32:35]
 ds_read_b128 a[16:19], v227 offset:8192
 v_mfma_f32_16x16x32_bf16 v[40:43], a[96:99], a[80:83], v[40:43]
 buffer_load_dwordx4 v250, s[12:15], s50 offen offset:1024  lds
 v_mfma_f32_16x16x32_bf16 v[44:47], a[100:103], a[80:83], v[44:47]
 ds_read_b128 a[20:23], v227 offset:10240
 v_mul_f32 v218, v218, v216
 v_mfma_f32_16x16x32_bf16 v[36:39], a[100:103], a[76:79], v[36:39]
 v_mfma_f32_16x16x32_bf16 v[156:159], a[76:79], a[112:115], v[156:159]
 ds_read_b128 a[24:27], v227 offset:12288
 s_add_u32 m0, s44, 12288
 v_mfma_f32_16x16x32_bf16 v[160:163], a[80:83], a[112:115], v[160:163]
 buffer_load_dwordx4 v251, s[16:19], s51 offen offset:0  lds
 v_mfma_f32_16x16x32_bf16 v[196:199], a[80:83], a[116:119], v[196:199]
 ds_read_b128 a[28:31], v227 offset:14336
 v_mfma_f32_16x16x32_bf16 v[192:195], a[76:79], a[116:119], v[192:195]
 v_mfma_f32_16x16x32_bf16 v[200:203], a[84:87], a[116:119], v[200:203]
 buffer_load_dwordx4 v252, s[16:19], s51 offen offset:1024  lds
 v_cvt_pk_bf16_f32 v221, v221, v218
 v_mfma_f32_16x16x32_bf16 v[204:207], a[88:91], a[116:119], v[204:207]
 v_mfma_f32_16x16x32_bf16 v[168:171], a[88:91], a[112:115], v[168:171]
 v_mfma_f32_16x16x32_bf16 v[164:167], a[84:87], a[112:115], v[164:167]
 buffer_load_dwordx4 v253, s[16:19], s51 offen offset:2048  lds
 v_mfma_f32_16x16x32_bf16 v[52:55], a[100:103], a[84:87], v[52:55]
 v_mfma_f32_16x16x32_bf16 v[60:63], a[100:103], a[88:91], v[60:63]
 v_mfma_f32_16x16x32_bf16 v[56:59], a[96:99], a[88:91], v[56:59]
 buffer_load_dwordx4 v254, s[16:19], s51 offen offset:3072  lds
 s_add_u32 s51, s51, 196608
 s_cmp_eq_u32 s51, 6291456
 s_cselect_b32 s51, 0, s51
 v_dot2_f32_bf16 v215, v221, s69, v215
 v_mfma_f32_16x16x32_bf16 v[48:51], a[96:99], a[84:87], v[48:51]
 v_mfma_f32_16x16x32_bf16 v[124:127], a[108:111], a[84:87], v[124:127]
 v_mfma_f32_16x16x32_bf16 v[132:135], a[108:111], a[88:91], v[132:135]
 v_mfma_f32_16x16x32_bf16 v[128:131], a[104:107], a[88:91], v[128:131]
 v_mfma_f32_16x16x32_bf16 v[120:123], a[104:107], a[84:87], v[120:123]
 s_waitcnt lgkmcnt(0)
 s_waitcnt vmcnt(20)
 s_barrier
 v_mfma_f32_16x16x32_bf16 v[64:67], a[44:47], a[32:35], v[64:67]
 ds_read_b64_tr_b16 a[96:97], v229 offset:36864
 v_mfma_f32_16x16x32_bf16 v[68:71], a[48:51], a[32:35], v[68:71]
 ds_read_b64_tr_b16 a[98:99], v229 offset:38400
 v_mfma_f32_16x16x32_bf16 v[136:139], a[32:35], a[52:55], v[136:139]
 ds_read_b128 a[92:95], v211
 v_mfma_f32_16x16x32_bf16 v[172:175], a[32:35], a[56:59], v[172:175]
 v_mfma_f32_16x16x32_bf16 v[72:75], a[44:47], a[0:3], v[72:75]
 ds_read_b64_tr_b16 a[100:101], v230 offset:36864
 s_add_u32 m0, s45, 49152
 s_add_u32 s50, s71, 384
 s_and_b32 s50, s50, 2047
 v_lshlrev_b32 v220, 16, v217
 v_mfma_f32_16x16x32_bf16 v[80:83], a[44:47], a[4:7], v[80:83]
 buffer_load_dwordx4 v239, s[12:15], s50 offen offset:0  lds
 v_mfma_f32_16x16x32_bf16 v[84:87], a[48:51], a[4:7], v[84:87]
 ds_read_b64_tr_b16 a[102:103], v230 offset:38400
 v_and_b32 v217, s68, v217
 v_mfma_f32_16x16x32_bf16 v[76:79], a[48:51], a[0:3], v[76:79]
 buffer_load_dwordx4 v240, s[12:15], s50 offen offset:1024  lds
 v_mfma_f32_16x16x32_bf16 v[0:3], a[36:39], a[0:3], v[0:3]
 ds_read_b128 a[60:63], v228 offset:0
 v_mfma_f32_16x16x32_bf16 v[8:11], a[36:39], a[4:7], v[8:11]
 v_lshlrev_b32 v221, 16, v219
 v_mfma_f32_16x16x32_bf16 v[12:15], a[40:43], a[4:7], v[12:15]
 ds_read_b64_tr_b16 a[104:105], v229 offset:36992
 buffer_load_dwordx4 v241, s[12:15], s50 offen offset:2048  lds
 v_mfma_f32_16x16x32_bf16 v[4:7], a[40:43], a[0:3], v[4:7]
 v_and_b32 v219, s68, v219
 v_mfma_f32_16x16x32_bf16 v[140:143], a[0:3], a[52:55], v[140:143]
 ds_read_b64_tr_b16 a[106:107], v229 offset:38528
 v_mfma_f32_16x16x32_bf16 v[144:147], a[4:7], a[52:55], v[144:147]
 buffer_load_dwordx4 v242, s[12:15], s50 offen offset:3072  lds
 v_mfma_f32_16x16x32_bf16 v[180:183], a[4:7], a[56:59], v[180:183]
 ds_read_b128 a[64:67], v228 offset:2048
 v_mul_f32 v221, v221, v220
 v_mfma_f32_16x16x32_bf16 v[176:179], a[0:3], a[56:59], v[176:179]
 s_add_u32 m0, s45, 53248
 v_mfma_f32_16x16x32_bf16 v[184:187], a[8:11], a[56:59], v[184:187]
 ds_read_b64_tr_b16 a[108:109], v230 offset:36992
 buffer_load_dwordx4 v243, s[12:15], s50 offen offset:0  lds
 v_mul_f32 v219, v219, v217
 v_mfma_f32_16x16x32_bf16 v[188:191], a[12:15], a[56:59], v[188:191]
 v_mfma_f32_16x16x32_bf16 v[152:155], a[12:15], a[52:55], v[152:155]
 ds_read_b64_tr_b16 a[110:111], v230 offset:38528
 v_mfma_f32_16x16x32_bf16 v[148:151], a[8:11], a[52:55], v[148:151]
 buffer_load_dwordx4 v244, s[12:15], s50 offen offset:1024  lds
 v_cvt_pk_bf16_f32 v221, v221, v219
 v_mfma_f32_16x16x32_bf16 v[20:23], a[40:43], a[8:11], v[20:23]
 ds_read_b128 a[68:71], v228 offset:4096
 s_add_u32 m0, s44, 24576
 v_mfma_f32_16x16x32_bf16 v[28:31], a[40:43], a[12:15], v[28:31]
 buffer_load_dwordx4 v251, s[16:19], s51 offen offset:0  lds
 v_dot2_f32_bf16 v215, v221, s69, v215
 v_mfma_f32_16x16x32_bf16 v[24:27], a[36:39], a[12:15], v[24:27]
 ds_read_b64_tr_b16 a[112:113], v229 offset:37120
 v_mfma_f32_16x16x32_bf16 v[16:19], a[36:39], a[8:11], v[16:19]
 v_mfma_f32_16x16x32_bf16 v[92:95], a[48:51], a[8:11], v[92:95]
 ds_read_b64_tr_b16 a[114:115], v229 offset:38656
 buffer_load_dwordx4 v252, s[16:19], s51 offen offset:1024  lds
 ds_read_b64 v[216:217], v212
 ds_read_b64 v[218:219], v214
 v_add_u32 v212, 128, v212
 v_mfma_f32_16x16x32_bf16 v[100:103], a[48:51], a[12:15], v[100:103]
 v_mfma_f32_16x16x32_bf16 v[96:99], a[44:47], a[12:15], v[96:99]
 ds_read_b128 a[72:75], v228 offset:6144
 v_accvgpr_read_b32 v222, a208
 v_mfma_f32_16x16x32_bf16 v[88:91], a[44:47], a[8:11], v[88:91]
 buffer_load_dwordx4 v253, s[16:19], s51 offen offset:2048  lds
 v_mfma_f32_16x16x32_bf16 v[104:107], a[44:47], a[16:19], v[104:107]
 ds_read_b64_tr_b16 a[116:117], v230 offset:37120
 v_mfma_f32_16x16x32_bf16 v[112:115], a[44:47], a[20:23], v[112:115]
 v_accvgpr_read_b32 v223, a210
 v_mfma_f32_16x16x32_bf16 v[116:119], a[48:51], a[20:23], v[116:119]
 ds_read_b64_tr_b16 a[118:119], v230 offset:38656
 buffer_load_dwordx4 v254, s[16:19], s51 offen offset:3072  lds
 s_add_u32 s51, s51, 196608
 s_cmp_eq_u32 s51, 6291456
 s_cselect_b32 s51, 0, s51
 v_mfma_f32_16x16x32_bf16 v[108:111], a[48:51], a[16:19], v[108:111]
 v_lshlrev_b32 v220, 16, v222
 v_mfma_f32_16x16x32_bf16 v[32:35], a[36:39], a[16:19], v[32:35]
 ds_read_b128 a[76:79], v228 offset:8192
 s_add_u32 m0, s45, 55296
 s_add_u32 s50, s71, 384
 s_and_b32 s50, s50, 2047
 v_mfma_f32_16x16x32_bf16 v[40:43], a[36:39], a[20:23], v[40:43]
 buffer_load_dwordx4 v245, s[12:15], s50 offen offset:0  lds
 v_mfma_f32_16x16x32_bf16 v[44:47], a[40:43], a[20:23], v[44:47]
 ds_read_b128 a[80:83], v228 offset:10240
 v_and_b32 v222, s68, v222
 v_mfma_f32_16x16x32_bf16 v[36:39], a[40:43], a[16:19], v[36:39]
 buffer_load_dwordx4 v246, s[12:15], s50 offen offset:1024  lds
 v_mfma_f32_16x16x32_bf16 v[156:159], a[16:19], a[52:55], v[156:159]
 ds_read_b128 a[84:87], v228 offset:12288
 v_lshlrev_b32 v221, 16, v223
 v_mfma_f32_16x16x32_bf16 v[160:163], a[20:23], a[52:55], v[160:163]
 v_mfma_f32_16x16x32_bf16 v[196:199], a[20:23], a[56:59], v[196:199]
 ds_read_b128 a[88:91], v228 offset:14336
 buffer_load_dwordx4 v247, s[12:15], s50 offen offset:2048  lds
 v_mfma_f32_16x16x32_bf16 v[192:195], a[16:19], a[56:59], v[192:195]
 v_and_b32 v223, s68, v223
 v_mfma_f32_16x16x32_bf16 v[200:203], a[24:27], a[56:59], v[200:203]
 v_mfma_f32_16x16x32_bf16 v[204:207], a[28:31], a[56:59], v[204:207]
 buffer_load_dwordx4 v248, s[12:15], s50 offen offset:3072  lds
 v_mul_f32 v221, v221, v220
 v_mfma_f32_16x16x32_bf16 v[168:171], a[28:31], a[52:55], v[168:171]
 v_mfma_f32_16x16x32_bf16 v[164:167], a[24:27], a[52:55], v[164:167]
 s_add_u32 m0, s45, 59392
 v_mfma_f32_16x16x32_bf16 v[52:55], a[40:43], a[24:27], v[52:55]
 buffer_load_dwordx4 v249, s[12:15], s50 offen offset:0  lds
 v_mul_f32 v223, v223, v222
 v_mfma_f32_16x16x32_bf16 v[60:63], a[40:43], a[28:31], v[60:63]
 v_mfma_f32_16x16x32_bf16 v[56:59], a[36:39], a[28:31], v[56:59]
 v_cvt_pk_bf16_f32 v221, v221, v223
 v_mfma_f32_16x16x32_bf16 v[48:51], a[36:39], a[24:27], v[48:51]
 buffer_load_dwordx4 v250, s[12:15], s50 offen offset:1024  lds
 v_mfma_f32_16x16x32_bf16 v[124:127], a[48:51], a[24:27], v[124:127]
 v_mfma_f32_16x16x32_bf16 v[132:135], a[48:51], a[28:31], v[132:135]
 v_dot2_f32_bf16 v215, v221, s69, v215
 v_mfma_f32_16x16x32_bf16 v[128:131], a[44:47], a[28:31], v[128:131]
 v_mfma_f32_16x16x32_bf16 v[120:123], a[44:47], a[24:27], v[120:123]
 s_waitcnt lgkmcnt(0)
 s_waitcnt vmcnt(20)
 s_barrier
 v_mfma_f32_16x16x32_bf16 v[64:67], a[104:107], a[92:95], v[64:67]
 v_add_u32 v227, 122880, v225
 v_add_u32 v228, 122880, v226
 v_add_u32 v210, 122880, v208
 ds_read_b64_tr_b16 a[36:37], v229 offset:0
 v_mfma_f32_16x16x32_bf16 v[68:71], a[108:111], a[92:95], v[68:71]
 v_add_u32 v211, 122880, v209
 v_add_u32 v214, 122880, v213
 s_mov_b32 s46, 122880
 ds_read_b64_tr_b16 a[38:39], v229 offset:1536
 v_mfma_f32_16x16x32_bf16 v[136:139], a[92:95], a[112:115], v[136:139]
 s_mov_b32 s47, 49152
 s_mov_b32 s48, 86016
 s_mov_b32 s52, 5
 ds_read_b128 a[32:35], v210
 v_mfma_f32_16x16x32_bf16 v[172:175], a[92:95], a[116:119], v[172:175]
 s_add_u32 s49, s45, 86016
 v_mfma_f32_16x16x32_bf16 v[72:75], a[104:107], a[60:63], v[72:75]
 ds_read_b64_tr_b16 a[40:41], v230 offset:0
 s_add_u32 m0, s45, 86016
 s_add_u32 s50, s71, 512
 s_and_b32 s50, s50, 2047
 v_lshlrev_b32 v220, 16, v216
 v_mfma_f32_16x16x32_bf16 v[80:83], a[104:107], a[64:67], v[80:83]
 buffer_load_dwordx4 v239, s[12:15], s50 offen offset:0  lds
 v_mfma_f32_16x16x32_bf16 v[84:87], a[108:111], a[64:67], v[84:87]
 ds_read_b64_tr_b16 a[42:43], v230 offset:1536
 v_and_b32 v216, s68, v216
 v_mfma_f32_16x16x32_bf16 v[76:79], a[108:111], a[60:63], v[76:79]
 v_mfma_f32_16x16x32_bf16 v[0:3], a[96:99], a[60:63], v[0:3]
 ds_read_b128 a[0:3], v227 offset:0
 v_mfma_f32_16x16x32_bf16 v[8:11], a[96:99], a[64:67], v[8:11]
 buffer_load_dwordx4 v240, s[12:15], s50 offen offset:1024  lds
 v_lshlrev_b32 v221, 16, v218
 v_mfma_f32_16x16x32_bf16 v[12:15], a[100:103], a[64:67], v[12:15]
 ds_read_b64_tr_b16 a[44:45], v229 offset:128
 v_mfma_f32_16x16x32_bf16 v[4:7], a[100:103], a[60:63], v[4:7]
 v_mfma_f32_16x16x32_bf16 v[140:143], a[60:63], a[112:115], v[140:143]
 ds_read_b64_tr_b16 a[46:47], v229 offset:1664
 v_and_b32 v218, s68, v218
 v_mfma_f32_16x16x32_bf16 v[144:147], a[64:67], a[112:115], v[144:147]
 v_mfma_f32_16x16x32_bf16 v[180:183], a[64:67], a[116:119], v[180:183]
 ds_read_b128 a[4:7], v227 offset:2048
 buffer_load_dwordx4 v241, s[12:15], s50 offen offset:2048  lds
 v_mul_f32 v221, v221, v220
 v_mfma_f32_16x16x32_bf16 v[176:179], a[60:63], a[116:119], v[176:179]
 v_mfma_f32_16x16x32_bf16 v[184:187], a[68:71], a[116:119], v[184:187]
 ds_read_b64_tr_b16 a[48:49], v230 offset:128
 v_mfma_f32_16x16x32_bf16 v[188:191], a[72:75], a[116:119], v[188:191]
 v_mul_f32 v218, v218, v216
 v_mfma_f32_16x16x32_bf16 v[152:155], a[72:75], a[112:115], v[152:155]
 ds_read_b64_tr_b16 a[50:51], v230 offset:1664
 buffer_load_dwordx4 v242, s[12:15], s50 offen offset:3072  lds
 v_mfma_f32_16x16x32_bf16 v[148:151], a[68:71], a[112:115], v[148:151]
 v_mfma_f32_16x16x32_bf16 v[20:23], a[100:103], a[68:71], v[20:23]
 ds_read_b128 a[8:11], v227 offset:4096
 v_cvt_pk_bf16_f32 v221, v221, v218
 v_mfma_f32_16x16x32_bf16 v[28:31], a[100:103], a[72:75], v[28:31]
 v_mfma_f32_16x16x32_bf16 v[24:27], a[96:99], a[72:75], v[24:27]
 ds_read_b64_tr_b16 a[52:53], v229 offset:256
 s_add_u32 m0, s45, 90112
 v_dot2_f32_bf16 v215, v221, s69, v215
 v_mfma_f32_16x16x32_bf16 v[16:19], a[96:99], a[68:71], v[16:19]
 buffer_load_dwordx4 v243, s[12:15], s50 offen offset:0  lds
 v_mfma_f32_16x16x32_bf16 v[92:95], a[108:111], a[68:71], v[92:95]
 ds_read_b64_tr_b16 a[54:55], v229 offset:1792
 v_mfma_f32_16x16x32_bf16 v[100:103], a[108:111], a[72:75], v[100:103]
 v_accvgpr_read_b32 v222, a209
 v_mfma_f32_16x16x32_bf16 v[96:99], a[104:107], a[72:75], v[96:99]
 ds_read_b128 a[12:15], v227 offset:6144
 v_mfma_f32_16x16x32_bf16 v[88:91], a[104:107], a[68:71], v[88:91]
 buffer_load_dwordx4 v244, s[12:15], s50 offen offset:1024  lds
 v_mfma_f32_16x16x32_bf16 v[104:107], a[104:107], a[76:79], v[104:107]
 ds_read_b64_tr_b16 a[56:57], v230 offset:256
 v_accvgpr_read_b32 v223, a211
 v_mfma_f32_16x16x32_bf16 v[112:115], a[104:107], a[80:83], v[112:115]
 v_mfma_f32_16x16x32_bf16 v[116:119], a[108:111], a[80:83], v[116:119]
 ds_read_b64_tr_b16 a[58:59], v230 offset:1792
 v_lshlrev_b32 v220, 16, v222
 v_mfma_f32_16x16x32_bf16 v[108:111], a[108:111], a[76:79], v[108:111]
 s_add_u32 m0, s44, 36864
 v_mfma_f32_16x16x32_bf16 v[32:35], a[96:99], a[76:79], v[32:35]
 ds_read_b128 a[16:19], v227 offset:8192
 buffer_load_dwordx4 v251, s[16:19], s51 offen offset:0  lds
 v_mfma_f32_16x16x32_bf16 v[40:43], a[96:99], a[80:83], v[40:43]
 v_and_b32 v222, s68, v222
 v_mfma_f32_16x16x32_bf16 v[44:47], a[100:103], a[80:83], v[44:47]
 ds_read_b128 a[20:23], v227 offset:10240
 v_mfma_f32_16x16x32_bf16 v[36:39], a[100:103], a[76:79], v[36:39]
 v_mfma_f32_16x16x32_bf16 v[156:159], a[76:79], a[112:115], v[156:159]
 ds_read_b128 a[24:27], v227 offset:12288
 buffer_load_dwordx4 v252, s[16:19], s51 offen offset:1024  lds
 v_lshlrev_b32 v221, 16, v223
 v_mfma_f32_16x16x32_bf16 v[160:163], a[80:83], a[112:115], v[160:163]
 v_mfma_f32_16x16x32_bf16 v[196:199], a[80:83], a[116:119], v[196:199]
 ds_read_b128 a[28:31], v227 offset:14336
 v_and_b32 v223, s68, v223
 v_mfma_f32_16x16x32_bf16 v[192:195], a[76:79], a[116:119], v[192:195]
 v_mfma_f32_16x16x32_bf16 v[200:203], a[84:87], a[116:119], v[200:203]
 v_mfma_f32_16x16x32_bf16 v[204:207], a[88:91], a[116:119], v[204:207]
 buffer_load_dwordx4 v253, s[16:19], s51 offen offset:2048  lds
 v_mul_f32 v221, v221, v220
 v_mfma_f32_16x16x32_bf16 v[168:171], a[88:91], a[112:115], v[168:171]
 v_mfma_f32_16x16x32_bf16 v[164:167], a[84:87], a[112:115], v[164:167]
 v_mfma_f32_16x16x32_bf16 v[52:55], a[100:103], a[84:87], v[52:55]
 v_mul_f32 v223, v223, v222
 v_mfma_f32_16x16x32_bf16 v[60:63], a[100:103], a[88:91], v[60:63]
 buffer_load_dwordx4 v254, s[16:19], s51 offen offset:3072  lds
 s_add_u32 s51, s51, 196608
 s_cmp_eq_u32 s51, 6291456
 s_cselect_b32 s51, 0, s51
 v_mfma_f32_16x16x32_bf16 v[56:59], a[96:99], a[88:91], v[56:59]
 v_cvt_pk_bf16_f32 v221, v221, v223
 v_mfma_f32_16x16x32_bf16 v[48:51], a[96:99], a[84:87], v[48:51]
 v_mfma_f32_16x16x32_bf16 v[124:127], a[108:111], a[84:87], v[124:127]
 v_mfma_f32_16x16x32_bf16 v[132:135], a[108:111], a[88:91], v[132:135]
 v_dot2_f32_bf16 v215, v221, s69, v215
 v_mfma_f32_16x16x32_bf16 v[128:131], a[104:107], a[88:91], v[128:131]
 v_mfma_f32_16x16x32_bf16 v[120:123], a[104:107], a[84:87], v[120:123]
.p2align 6
L1qD_loop:
 s_waitcnt lgkmcnt(0)
 s_waitcnt vmcnt(26)
 s_barrier
 v_mfma_f32_16x16x32_bf16 v[64:67], a[44:47], a[32:35], v[64:67]
 ds_read_b64_tr_b16 a[96:97], v229 offset:12288
 v_mfma_f32_16x16x32_bf16 v[68:71], a[48:51], a[32:35], v[68:71]
 ds_read_b64_tr_b16 a[98:99], v229 offset:13824
 v_mfma_f32_16x16x32_bf16 v[136:139], a[32:35], a[52:55], v[136:139]
 ds_read_b128 a[92:95], v211
 v_mfma_f32_16x16x32_bf16 v[172:175], a[32:35], a[56:59], v[172:175]
 v_mfma_f32_16x16x32_bf16 v[72:75], a[44:47], a[0:3], v[72:75]
 ds_read_b64_tr_b16 a[100:101], v230 offset:12288
 s_add_u32 m0, s44, 0
 v_lshlrev_b32 v220, 16, v217
 v_mfma_f32_16x16x32_bf16 v[80:83], a[44:47], a[4:7], v[80:83]
 buffer_load_dwordx4 v251, s[16:19], s51 offen offset:0  lds
 v_mfma_f32_16x16x32_bf16 v[84:87], a[48:51], a[4:7], v[84:87]
 ds_read_b64_tr_b16 a[102:103], v230 offset:13824
 v_mfma_f32_16x16x32_bf16 v[76:79], a[48:51], a[0:3], v[76:79]
 v_mfma_f32_16x16x32_bf16 v[0:3], a[36:39], a[0:3], v[0:3]
 ds_read_b128 a[60:63], v228 offset:0
 v_mfma_f32_16x16x32_bf16 v[8:11], a[36:39], a[4:7], v[8:11]
 buffer_load_dwordx4 v252, s[16:19], s51 offen offset:1024  lds
 v_and_b32 v217, s68, v217
 v_mfma_f32_16x16x32_bf16 v[12:15], a[40:43], a[4:7], v[12:15]
 ds_read_b64_tr_b16 a[104:105], v229 offset:12416
 v_mfma_f32_16x16x32_bf16 v[4:7], a[40:43], a[0:3], v[4:7]
 v_mfma_f32_16x16x32_bf16 v[140:143], a[0:3], a[52:55], v[140:143]
 ds_read_b64_tr_b16 a[106:107], v229 offset:13952
 v_mfma_f32_16x16x32_bf16 v[144:147], a[4:7], a[52:55], v[144:147]
 v_mfma_f32_16x16x32_bf16 v[180:183], a[4:7], a[56:59], v[180:183]
 ds_read_b128 a[64:67], v228 offset:2048
 buffer_load_dwordx4 v253, s[16:19], s51 offen offset:2048  lds
 v_lshlrev_b32 v221, 16, v219
 v_mfma_f32_16x16x32_bf16 v[176:179], a[0:3], a[56:59], v[176:179]
 v_mfma_f32_16x16x32_bf16 v[184:187], a[8:11], a[56:59], v[184:187]
 ds_read_b64_tr_b16 a[108:109], v230 offset:12416
 v_mfma_f32_16x16x32_bf16 v[188:191], a[12:15], a[56:59], v[188:191]
 v_mfma_f32_16x16x32_bf16 v[152:155], a[12:15], a[52:55], v[152:155]
 ds_read_b64_tr_b16 a[110:111], v230 offset:13952
 buffer_load_dwordx4 v254, s[16:19], s51 offen offset:3072  lds
 s_add_u32 s51, s51, 196608
 s_cmp_eq_u32 s51, 6291456
 s_cselect_b32 s51, 0, s51
 v_mfma_f32_16x16x32_bf16 v[148:151], a[8:11], a[52:55], v[148:151]
 v_mfma_f32_16x16x32_bf16 v[20:23], a[40:43], a[8:11], v[20:23]
 ds_read_b128 a[68:71], v228 offset:4096
 v_and_b32 v219, s68, v219
 v_mfma_f32_16x16x32_bf16 v[28:31], a[40:43], a[12:15], v[28:31]
 v_mfma_f32_16x16x32_bf16 v[24:27], a[36:39], a[12:15], v[24:27]
 ds_read_b64_tr_b16 a[112:113], v229 offset:12544
 s_add_u32 m0, s49, 6144
 v_mfma_f32_16x16x32_bf16 v[16:19], a[36:39], a[8:11], v[16:19]
 buffer_load_dwordx4 v245, s[12:15], s50 offen offset:0  lds
 v_mfma_f32_16x16x32_bf16 v[92:95], a[48:51], a[8:11], v[92:95]
 ds_read_b64_tr_b16 a[114:115], v229 offset:14080
 v_mfma_f32_16x16x32_bf16 v[100:103], a[48:51], a[12:15], v[100:103]
 v_mul_f32 v221, v221, v220
 v_mfma_f32_16x16x32_bf16 v[96:99], a[44:47], a[12:15], v[96:99]
 ds_read_b128 a[72:75], v228 offset:6144
 v_mfma_f32_16x16x32_bf16 v[88:91], a[44:47], a[8:11], v[88:91]
 buffer_load_dwordx4 v246, s[12:15], s50 offen offset:1024  lds
 v_mfma_f32_16x16x32_bf16 v[104:107], a[44:47], a[16:19], v[104:107]
 ds_read_b64_tr_b16 a[116:117], v230 offset:12544
 v_mfma_f32_16x16x32_bf16 v[112:115], a[44:47], a[20:23], v[112:115]
 v_mfma_f32_16x16x32_bf16 v[116:119], a[48:51], a[20:23], v[116:119]
 ds_read_b64_tr_b16 a[118:119], v230 offset:14080
 v_mul_f32 v219, v219, v217
 v_mfma_f32_16x16x32_bf16 v[108:111], a[48:51], a[16:19], v[108:111]
 v_mfma_f32_16x16x32_bf16 v[32:35], a[36:39], a[16:19], v[32:35]
 ds_read_b128 a[76:79], v228 offset:8192
 buffer_load_dwordx4 v247, s[12:15], s50 offen offset:2048  lds
 v_mfma_f32_16x16x32_bf16 v[40:43], a[36:39], a[20:23], v[40:43]
 v_mfma_f32_16x16x32_bf16 v[44:47], a[40:43], a[20:23], v[44:47]
 ds_read_b128 a[80:83], v228 offset:10240
 v_mfma_f32_16x16x32_bf16 v[36:39], a[40:43], a[16:19], v[36:39]
 v_mfma_f32_16x16x32_bf16 v[156:159], a[16:19], a[52:55], v[156:159]
 ds_read_b128 a[84:87], v228 offset:12288
 buffer_load_dwordx4 v248, s[12:15], s50 offen offset:3072  lds
 v_cvt_pk_bf16_f32 v221, v221, v219
 v_mfma_f32_16x16x32_bf16 v[160:163], a[20:23], a[52:55], v[160:163]
 v_mfma_f32_16x16x32_bf16 v[196:199], a[20:23], a[56:59], v[196:199]
 ds_read_b128 a[88:91], v228 offset:14336
 v_mfma_f32_16x16x32_bf16 v[192:195], a[16:19], a[56:59], v[192:195]
 v_mfma_f32_16x16x32_bf16 v[200:203], a[24:27], a[56:59], v[200:203]
 s_add_u32 m0, s49, 10240
 v_mfma_f32_16x16x32_bf16 v[204:207], a[28:31], a[56:59], v[204:207]
 buffer_load_dwordx4 v249, s[12:15], s50 offen offset:0  lds
 v_dot2_f32_bf16 v215, v221, s69, v215
 v_mfma_f32_16x16x32_bf16 v[168:171], a[28:31], a[52:55], v[168:171]
 v_mfma_f32_16x16x32_bf16 v[164:167], a[24:27], a[52:55], v[164:167]
 v_mfma_f32_16x16x32_bf16 v[52:55], a[40:43], a[24:27], v[52:55]
 v_mfma_f32_16x16x32_bf16 v[60:63], a[40:43], a[28:31], v[60:63]
 buffer_load_dwordx4 v250, s[12:15], s50 offen offset:1024  lds
 v_mfma_f32_16x16x32_bf16 v[56:59], a[36:39], a[28:31], v[56:59]
 ds_read_b64 v[216:217], v212
 ds_read_b64 v[218:219], v214
 v_add_u32 v212, 128, v212
 v_mfma_f32_16x16x32_bf16 v[48:51], a[36:39], a[24:27], v[48:51]
 v_mfma_f32_16x16x32_bf16 v[124:127], a[48:51], a[24:27], v[124:127]
 v_mfma_f32_16x16x32_bf16 v[132:135], a[48:51], a[28:31], v[132:135]
 v_mfma_f32_16x16x32_bf16 v[128:131], a[44:47], a[28:31], v[128:131]
 v_mfma_f32_16x16x32_bf16 v[120:123], a[44:47], a[24:27], v[120:123]
 s_waitcnt lgkmcnt(0)
 s_waitcnt vmcnt(20)
 s_barrier
 v_mfma_f32_16x16x32_bf16 v[64:67], a[104:107], a[92:95], v[64:67]
 v_add_u32 v227, s47, v225
 v_add_u32 v210, s47, v208
 v_add_u32 v228, s47, v226
 ds_read_b64_tr_b16 a[36:37], v229 offset:24576
 v_mfma_f32_16x16x32_bf16 v[68:71], a[108:111], a[92:95], v[68:71]
 v_add_u32 v211, s47, v209
 v_add_u32 v214, s47, v213
 s_add_u32 s49, s46, s45
 ds_read_b64_tr_b16 a[38:39], v229 offset:26112
 v_mfma_f32_16x16x32_bf16 v[136:139], a[92:95], a[112:115], v[136:139]
 s_add_u32 s50, s50, 128
 s_and_b32 s50, s50, 2047
 s_mov_b32 s53, s46
 ds_read_b128 a[32:35], v210
 v_mfma_f32_16x16x32_bf16 v[172:175], a[92:95], a[116:119], v[172:175]
 s_mov_b32 s46, s47
 s_mov_b32 s47, s48
 s_mov_b32 s48, s53
 v_mfma_f32_16x16x32_bf16 v[72:75], a[104:107], a[60:63], v[72:75]
 ds_read_b64_tr_b16 a[40:41], v230 offset:24576
 s_add_u32 m0, s44, 12288
 v_lshlrev_b32 v220, 16, v216
 v_mfma_f32_16x16x32_bf16 v[80:83], a[104:107], a[64:67], v[80:83]
 buffer_load_dwordx4 v251, s[16:19], s51 offen offset:0  lds
 v_mfma_f32_16x16x32_bf16 v[84:87], a[108:111], a[64:67], v[84:87]
 ds_read_b64_tr_b16 a[42:43], v230 offset:26112
 v_mfma_f32_16x16x32_bf16 v[76:79], a[108:111], a[60:63], v[76:79]
 v_mfma_f32_16x16x32_bf16 v[0:3], a[96:99], a[60:63], v[0:3]
 ds_read_b128 a[0:3], v227 offset:0
 v_mfma_f32_16x16x32_bf16 v[8:11], a[96:99], a[64:67], v[8:11]
 buffer_load_dwordx4 v252, s[16:19], s51 offen offset:1024  lds
 v_mfma_f32_16x16x32_bf16 v[12:15], a[100:103], a[64:67], v[12:15]
 ds_read_b64_tr_b16 a[44:45], v229 offset:24704
 v_and_b32 v216, s68, v216
 v_mfma_f32_16x16x32_bf16 v[4:7], a[100:103], a[60:63], v[4:7]
 v_mfma_f32_16x16x32_bf16 v[140:143], a[60:63], a[112:115], v[140:143]
 ds_read_b64_tr_b16 a[46:47], v229 offset:26240
 v_mfma_f32_16x16x32_bf16 v[144:147], a[64:67], a[112:115], v[144:147]
 v_mfma_f32_16x16x32_bf16 v[180:183], a[64:67], a[116:119], v[180:183]
 ds_read_b128 a[4:7], v227 offset:2048
 buffer_load_dwordx4 v253, s[16:19], s51 offen offset:2048  lds
 v_mfma_f32_16x16x32_bf16 v[176:179], a[60:63], a[116:119], v[176:179]
 v_mfma_f32_16x16x32_bf16 v[184:187], a[68:71], a[116:119], v[184:187]
 ds_read_b64_tr_b16 a[48:49], v230 offset:24704
 v_lshlrev_b32 v221, 16, v218
 v_mfma_f32_16x16x32_bf16 v[188:191], a[72:75], a[116:119], v[188:191]
 v_mfma_f32_16x16x32_bf16 v[152:155], a[72:75], a[112:115], v[152:155]
 ds_read_b64_tr_b16 a[50:51], v230 offset:26240
 buffer_load_dwordx4 v254, s[16:19], s51 offen offset:3072  lds
 s_add_u32 s51, s51, 196608
 s_cmp_eq_u32 s51, 6291456
 s_cselect_b32 s51, 0, s51
 v_mfma_f32_16x16x32_bf16 v[148:151], a[68:71], a[112:115], v[148:151]
 v_mfma_f32_16x16x32_bf16 v[20:23], a[100:103], a[68:71], v[20:23]
 ds_read_b128 a[8:11], v227 offset:4096
 v_mfma_f32_16x16x32_bf16 v[28:31], a[100:103], a[72:75], v[28:31]
 v_mfma_f32_16x16x32_bf16 v[24:27], a[96:99], a[72:75], v[24:27]
 ds_read_b64_tr_b16 a[52:53], v229 offset:24832
 s_add_u32 m0, s49, 0
 v_and_b32 v218, s68, v218
 v_mfma_f32_16x16x32_bf16 v[16:19], a[96:99], a[68:71], v[16:19]
 buffer_load_dwordx4 v239, s[12:15], s50 offen offset:0  lds
 v_mfma_f32_16x16x32_bf16 v[92:95], a[108:111], a[68:71], v[92:95]
 ds_read_b64_tr_b16 a[54:55], v229 offset:26368
 v_mfma_f32_16x16x32_bf16 v[100:103], a[108:111], a[72:75], v[100:103]
 v_mfma_f32_16x16x32_bf16 v[96:99], a[104:107], a[72:75], v[96:99]
 ds_read_b128 a[12:15], v227 offset:6144
 v_mfma_f32_16x16x32_bf16 v[88:91], a[104:107], a[68:71], v[88:91]
 buffer_load_dwordx4 v240, s[12:15], s50 offen offset:1024  lds
 v_mfma_f32_16x16x32_bf16 v[104:107], a[104:107], a[76:79], v[104:107]
 ds_read_b64_tr_b16 a[56:57], v230 offset:24832
 v_mul_f32 v221, v221, v220
 v_mfma_f32_16x16x32_bf16 v[112:115], a[104:107], a[80:83], v[112:115]
 v_mfma_f32_16x16x32_bf16 v[116:119], a[108:111], a[80:83], v[116:119]
 ds_read_b64_tr_b16 a[58:59], v230 offset:26368
 v_mfma_f32_16x16x32_bf16 v[108:111], a[108:111], a[76:79], v[108:111]
 v_mfma_f32_16x16x32_bf16 v[32:35], a[96:99], a[76:79], v[32:35]
 ds_read_b128 a[16:19], v227 offset:8192
 buffer_load_dwordx4 v241, s[12:15], s50 offen offset:2048  lds
 v_mfma_f32_16x16x32_bf16 v[40:43], a[96:99], a[80:83], v[40:43]
 v_mfma_f32_16x16x32_bf16 v[44:47], a[100:103], a[80:83], v[44:47]
 ds_read_b128 a[20:23], v227 offset:10240
 v_mul_f32 v218, v218, v216
 v_mfma_f32_16x16x32_bf16 v[36:39], a[100:103], a[76:79], v[36:39]
 v_mfma_f32_16x16x32_bf16 v[156:159], a[76:79], a[112:115], v[156:159]
 ds_read_b128 a[24:27], v227 offset:12288
 buffer_load_dwordx4 v242, s[12:15], s50 offen offset:3072  lds
 v_mfma_f32_16x16x32_bf16 v[160:163], a[80:83], a[112:115], v[160:163]
 v_mfma_f32_16x16x32_bf16 v[196:199], a[80:83], a[116:119], v[196:199]
 ds_read_b128 a[28:31], v227 offset:14336
 v_mfma_f32_16x16x32_bf16 v[192:195], a[76:79], a[116:119], v[192:195]
 v_mfma_f32_16x16x32_bf16 v[200:203], a[84:87], a[116:119], v[200:203]
 s_add_u32 m0, s49, 4096
 v_cvt_pk_bf16_f32 v221, v221, v218
 v_mfma_f32_16x16x32_bf16 v[204:207], a[88:91], a[116:119], v[204:207]
 buffer_load_dwordx4 v243, s[12:15], s50 offen offset:0  lds
 v_mfma_f32_16x16x32_bf16 v[168:171], a[88:91], a[112:115], v[168:171]
 v_mfma_f32_16x16x32_bf16 v[164:167], a[84:87], a[112:115], v[164:167]
 v_mfma_f32_16x16x32_bf16 v[52:55], a[100:103], a[84:87], v[52:55]
 v_mfma_f32_16x16x32_bf16 v[60:63], a[100:103], a[88:91], v[60:63]
 buffer_load_dwordx4 v244, s[12:15], s50 offen offset:1024  lds
 v_mfma_f32_16x16x32_bf16 v[56:59], a[96:99], a[88:91], v[56:59]
 v_dot2_f32_bf16 v215, v221, s69, v215
 v_mfma_f32_16x16x32_bf16 v[48:51], a[96:99], a[84:87], v[48:51]
 v_mfma_f32_16x16x32_bf16 v[124:127], a[108:111], a[84:87], v[124:127]
 v_mfma_f32_16x16x32_bf16 v[132:135], a[108:111], a[88:91], v[132:135]
 v_mfma_f32_16x16x32_bf16 v[128:131], a[104:107], a[88:91], v[128:131]
 v_mfma_f32_16x16x32_bf16 v[120:123], a[104:107], a[84:87], v[120:123]
 s_waitcnt lgkmcnt(0)
 s_waitcnt vmcnt(20)
 s_barrier
 v_mfma_f32_16x16x32_bf16 v[64:67], a[44:47], a[32:35], v[64:67]
 s_sub_u32 s52, s52, 1
 ds_read_b64_tr_b16 a[96:97], v229 offset:36864
 v_mfma_f32_16x16x32_bf16 v[68:71], a[48:51], a[32:35], v[68:71]
 ds_read_b64_tr_b16 a[98:99], v229 offset:38400
 v_mfma_f32_16x16x32_bf16 v[136:139], a[32:35], a[52:55], v[136:139]
 ds_read_b128 a[92:95], v211
 v_mfma_f32_16x16x32_bf16 v[172:175], a[32:35], a[56:59], v[172:175]
 v_mfma_f32_16x16x32_bf16 v[72:75], a[44:47], a[0:3], v[72:75]
 ds_read_b64_tr_b16 a[100:101], v230 offset:36864
 s_add_u32 m0, s44, 24576
 v_lshlrev_b32 v220, 16, v217
 v_mfma_f32_16x16x32_bf16 v[80:83], a[44:47], a[4:7], v[80:83]
 buffer_load_dwordx4 v251, s[16:19], s51 offen offset:0  lds
 v_mfma_f32_16x16x32_bf16 v[84:87], a[48:51], a[4:7], v[84:87]
 ds_read_b64_tr_b16 a[102:103], v230 offset:38400
 v_mfma_f32_16x16x32_bf16 v[76:79], a[48:51], a[0:3], v[76:79]
 v_mfma_f32_16x16x32_bf16 v[0:3], a[36:39], a[0:3], v[0:3]
 ds_read_b128 a[60:63], v228 offset:0
 v_mfma_f32_16x16x32_bf16 v[8:11], a[36:39], a[4:7], v[8:11]
 buffer_load_dwordx4 v252, s[16:19], s51 offen offset:1024  lds
 v_and_b32 v217, s68, v217
 v_mfma_f32_16x16x32_bf16 v[12:15], a[40:43], a[4:7], v[12:15]
 ds_read_b64_tr_b16 a[104:105], v229 offset:36992
 v_mfma_f32_16x16x32_bf16 v[4:7], a[40:43], a[0:3], v[4:7]
 v_mfma_f32_16x16x32_bf16 v[140:143], a[0:3], a[52:55], v[140:143]
 ds_read_b64_tr_b16 a[106:107], v229 offset:38528
 v_mfma_f32_16x16x32_bf16 v[144:147], a[4:7], a[52:55], v[144:147]
 v_mfma_f32_16x16x32_bf16 v[180:183], a[4:7], a[56:59], v[180:183]
 ds_read_b128 a[64:67], v228 offset:2048
 buffer_load_dwordx4 v253, s[16:19], s51 offen offset:2048  lds
 v_lshlrev_b32 v221, 16, v219
 v_mfma_f32_16x16x32_bf16 v[176:179], a[0:3], a[56:59], v[176:179]
 v_mfma_f32_16x16x32_bf16 v[184:187], a[8:11], a[56:59], v[184:187]
 ds_read_b64_tr_b16 a[108:109], v230 offset:36992
 v_mfma_f32_16x16x32_bf16 v[188:191], a[12:15], a[56:59], v[188:191]
 v_mfma_f32_16x16x32_bf16 v[152:155], a[12:15], a[52:55], v[152:155]
 ds_read_b64_tr_b16 a[110:111], v230 offset:38528
 buffer_load_dwordx4 v254, s[16:19], s51 offen offset:3072  lds
 s_add_u32 s51, s51, 196608
 s_cmp_eq_u32 s51, 6291456
 s_cselect_b32 s51, 0, s51
 v_mfma_f32_16x16x32_bf16 v[148:151], a[8:11], a[52:55], v[148:151]
 v_mfma_f32_16x16x32_bf16 v[20:23], a[40:43], a[8:11], v[20:23]
 ds_read_b128 a[68:71], v228 offset:4096
 v_and_b32 v219, s68, v219
 v_mfma_f32_16x16x32_bf16 v[28:31], a[40:43], a[12:15], v[28:31]
 v_mfma_f32_16x16x32_bf16 v[24:27], a[36:39], a[12:15], v[24:27]
 ds_read_b64_tr_b16 a[112:113], v229 offset:37120
 s_add_u32 m0, s49, 6144
 v_mfma_f32_16x16x32_bf16 v[16:19], a[36:39], a[8:11], v[16:19]
 buffer_load_dwordx4 v245, s[12:15], s50 offen offset:0  lds
 v_mfma_f32_16x16x32_bf16 v[92:95], a[48:51], a[8:11], v[92:95]
 ds_read_b64_tr_b16 a[114:115], v229 offset:38656
 v_mfma_f32_16x16x32_bf16 v[100:103], a[48:51], a[12:15], v[100:103]
 v_mul_f32 v221, v221, v220
 v_mfma_f32_16x16x32_bf16 v[96:99], a[44:47], a[12:15], v[96:99]
 ds_read_b128 a[72:75], v228 offset:6144
 v_mfma_f32_16x16x32_bf16 v[88:91], a[44:47], a[8:11], v[88:91]
 buffer_load_dwordx4 v246, s[12:15], s50 offen offset:1024  lds
 v_mfma_f32_16x16x32_bf16 v[104:107], a[44:47], a[16:19], v[104:107]
 ds_read_b64_tr_b16 a[116:117], v230 offset:37120
 v_mfma_f32_16x16x32_bf16 v[112:115], a[44:47], a[20:23], v[112:115]
 v_mfma_f32_16x16x32_bf16 v[116:119], a[48:51], a[20:23], v[116:119]
 ds_read_b64_tr_b16 a[118:119], v230 offset:38656
 v_mul_f32 v219, v219, v217
 v_mfma_f32_16x16x32_bf16 v[108:111], a[48:51], a[16:19], v[108:111]
 v_mfma_f32_16x16x32_bf16 v[32:35], a[36:39], a[16:19], v[32:35]
 ds_read_b128 a[76:79], v228 offset:8192
 buffer_load_dwordx4 v247, s[12:15], s50 offen offset:2048  lds
 v_mfma_f32_16x16x32_bf16 v[40:43], a[36:39], a[20:23], v[40:43]
 v_mfma_f32_16x16x32_bf16 v[44:47], a[40:43], a[20:23], v[44:47]
 ds_read_b128 a[80:83], v228 offset:10240
 v_mfma_f32_16x16x32_bf16 v[36:39], a[40:43], a[16:19], v[36:39]
 v_mfma_f32_16x16x32_bf16 v[156:159], a[16:19], a[52:55], v[156:159]
 ds_read_b128 a[84:87], v228 offset:12288
 buffer_load_dwordx4 v248, s[12:15], s50 offen offset:3072  lds
 v_cvt_pk_bf16_f32 v221, v221, v219
 v_mfma_f32_16x16x32_bf16 v[160:163], a[20:23], a[52:55], v[160:163]
 v_mfma_f32_16x16x32_bf16 v[196:199], a[20:23], a[56:59], v[196:199]
 ds_read_b128 a[88:91], v228 offset:14336
 v_mfma_f32_16x16x32_bf16 v[192:195], a[16:19], a[56:59], v[192:195]
 v_mfma_f32_16x16x32_bf16 v[200:203], a[24:27], a[56:59], v[200:203]
 s_add_u32 m0, s49, 10240
 v_mfma_f32_16x16x32_bf16 v[204:207], a[28:31], a[56:59], v[204:207]
 buffer_load_dwordx4 v249, s[12:15], s50 offen offset:0  lds
 v_dot2_f32_bf16 v215, v221, s69, v215
 v_mfma_f32_16x16x32_bf16 v[168:171], a[28:31], a[52:55], v[168:171]
 v_mfma_f32_16x16x32_bf16 v[164:167], a[24:27], a[52:55], v[164:167]
 v_mfma_f32_16x16x32_bf16 v[52:55], a[40:43], a[24:27], v[52:55]
 v_mfma_f32_16x16x32_bf16 v[60:63], a[40:43], a[28:31], v[60:63]
 buffer_load_dwordx4 v250, s[12:15], s50 offen offset:1024  lds
 v_mfma_f32_16x16x32_bf16 v[56:59], a[36:39], a[28:31], v[56:59]
 ds_read_b64 v[216:217], v212
 ds_read_b64 v[218:219], v214
 v_add_u32 v212, 128, v212
 v_mfma_f32_16x16x32_bf16 v[48:51], a[36:39], a[24:27], v[48:51]
 v_mfma_f32_16x16x32_bf16 v[124:127], a[48:51], a[24:27], v[124:127]
 v_mfma_f32_16x16x32_bf16 v[132:135], a[48:51], a[28:31], v[132:135]
 v_mfma_f32_16x16x32_bf16 v[128:131], a[44:47], a[28:31], v[128:131]
 v_mfma_f32_16x16x32_bf16 v[120:123], a[44:47], a[24:27], v[120:123]
 s_waitcnt lgkmcnt(0)
 s_waitcnt vmcnt(20)
 s_barrier
 v_mfma_f32_16x16x32_bf16 v[64:67], a[104:107], a[92:95], v[64:67]
 v_add_u32 v227, s47, v225
 v_add_u32 v210, s47, v208
 v_add_u32 v228, s47, v226
 ds_read_b64_tr_b16 a[36:37], v229 offset:0
 v_mfma_f32_16x16x32_bf16 v[68:71], a[108:111], a[92:95], v[68:71]
 v_add_u32 v211, s47, v209
 v_add_u32 v214, s47, v213
 s_add_u32 s49, s46, s45
 ds_read_b64_tr_b16 a[38:39], v229 offset:1536
 v_mfma_f32_16x16x32_bf16 v[136:139], a[92:95], a[112:115], v[136:139]
 s_add_u32 s50, s50, 128
 s_and_b32 s50, s50, 2047
 s_mov_b32 s53, s46
 ds_read_b128 a[32:35], v210
 v_mfma_f32_16x16x32_bf16 v[172:175], a[92:95], a[116:119], v[172:175]
 s_mov_b32 s46, s47
 s_mov_b32 s47, s48
 s_mov_b32 s48, s53
 v_mfma_f32_16x16x32_bf16 v[72:75], a[104:107], a[60:63], v[72:75]
 ds_read_b64_tr_b16 a[40:41], v230 offset:0
 s_add_u32 m0, s44, 36864
 v_lshlrev_b32 v220, 16, v216
 v_mfma_f32_16x16x32_bf16 v[80:83], a[104:107], a[64:67], v[80:83]
 buffer_load_dwordx4 v251, s[16:19], s51 offen offset:0  lds
 v_mfma_f32_16x16x32_bf16 v[84:87], a[108:111], a[64:67], v[84:87]
 ds_read_b64_tr_b16 a[42:43], v230 offset:1536
 v_mfma_f32_16x16x32_bf16 v[76:79], a[108:111], a[60:63], v[76:79]
 v_mfma_f32_16x16x32_bf16 v[0:3], a[96:99], a[60:63], v[0:3]
 ds_read_b128 a[0:3], v227 offset:0
 v_mfma_f32_16x16x32_bf16 v[8:11], a[96:99], a[64:67], v[8:11]
 buffer_load_dwordx4 v252, s[16:19], s51 offen offset:1024  lds
 v_mfma_f32_16x16x32_bf16 v[12:15], a[100:103], a[64:67], v[12:15]
 ds_read_b64_tr_b16 a[44:45], v229 offset:128
 v_and_b32 v216, s68, v216
 v_mfma_f32_16x16x32_bf16 v[4:7], a[100:103], a[60:63], v[4:7]
 v_mfma_f32_16x16x32_bf16 v[140:143], a[60:63], a[112:115], v[140:143]
 ds_read_b64_tr_b16 a[46:47], v229 offset:1664
 v_mfma_f32_16x16x32_bf16 v[144:147], a[64:67], a[112:115], v[144:147]
 v_mfma_f32_16x16x32_bf16 v[180:183], a[64:67], a[116:119], v[180:183]
 ds_read_b128 a[4:7], v227 offset:2048
 buffer_load_dwordx4 v253, s[16:19], s51 offen offset:2048  lds
 v_mfma_f32_16x16x32_bf16 v[176:179], a[60:63], a[116:119], v[176:179]
 v_mfma_f32_16x16x32_bf16 v[184:187], a[68:71], a[116:119], v[184:187]
 ds_read_b64_tr_b16 a[48:49], v230 offset:128
 v_lshlrev_b32 v221, 16, v218
 v_mfma_f32_16x16x32_bf16 v[188:191], a[72:75], a[116:119], v[188:191]
 v_mfma_f32_16x16x32_bf16 v[152:155], a[72:75], a[112:115], v[152:155]
 ds_read_b64_tr_b16 a[50:51], v230 offset:1664
 buffer_load_dwordx4 v254, s[16:19], s51 offen offset:3072  lds
 s_add_u32 s51, s51, 196608
 s_cmp_eq_u32 s51, 6291456
 s_cselect_b32 s51, 0, s51
 v_mfma_f32_16x16x32_bf16 v[148:151], a[68:71], a[112:115], v[148:151]
 v_mfma_f32_16x16x32_bf16 v[20:23], a[100:103], a[68:71], v[20:23]
 ds_read_b128 a[8:11], v227 offset:4096
 v_mfma_f32_16x16x32_bf16 v[28:31], a[100:103], a[72:75], v[28:31]
 v_mfma_f32_16x16x32_bf16 v[24:27], a[96:99], a[72:75], v[24:27]
 ds_read_b64_tr_b16 a[52:53], v229 offset:256
 s_add_u32 m0, s49, 0
 v_and_b32 v218, s68, v218
 v_mfma_f32_16x16x32_bf16 v[16:19], a[96:99], a[68:71], v[16:19]
 buffer_load_dwordx4 v239, s[12:15], s50 offen offset:0  lds
 v_mfma_f32_16x16x32_bf16 v[92:95], a[108:111], a[68:71], v[92:95]
 ds_read_b64_tr_b16 a[54:55], v229 offset:1792
 v_mfma_f32_16x16x32_bf16 v[100:103], a[108:111], a[72:75], v[100:103]
 v_mfma_f32_16x16x32_bf16 v[96:99], a[104:107], a[72:75], v[96:99]
 ds_read_b128 a[12:15], v227 offset:6144
 v_mfma_f32_16x16x32_bf16 v[88:91], a[104:107], a[68:71], v[88:91]
 buffer_load_dwordx4 v240, s[12:15], s50 offen offset:1024  lds
 v_mfma_f32_16x16x32_bf16 v[104:107], a[104:107], a[76:79], v[104:107]
 ds_read_b64_tr_b16 a[56:57], v230 offset:256
 v_mul_f32 v221, v221, v220
 v_mfma_f32_16x16x32_bf16 v[112:115], a[104:107], a[80:83], v[112:115]
 v_mfma_f32_16x16x32_bf16 v[116:119], a[108:111], a[80:83], v[116:119]
 ds_read_b64_tr_b16 a[58:59], v230 offset:1792
 v_mfma_f32_16x16x32_bf16 v[108:111], a[108:111], a[76:79], v[108:111]
 v_mfma_f32_16x16x32_bf16 v[32:35], a[96:99], a[76:79], v[32:35]
 ds_read_b128 a[16:19], v227 offset:8192
 buffer_load_dwordx4 v241, s[12:15], s50 offen offset:2048  lds
 v_mfma_f32_16x16x32_bf16 v[40:43], a[96:99], a[80:83], v[40:43]
 v_mfma_f32_16x16x32_bf16 v[44:47], a[100:103], a[80:83], v[44:47]
 ds_read_b128 a[20:23], v227 offset:10240
 v_mul_f32 v218, v218, v216
 v_mfma_f32_16x16x32_bf16 v[36:39], a[100:103], a[76:79], v[36:39]
 v_mfma_f32_16x16x32_bf16 v[156:159], a[76:79], a[112:115], v[156:159]
 ds_read_b128 a[24:27], v227 offset:12288
 buffer_load_dwordx4 v242, s[12:15], s50 offen offset:3072  lds
 v_mfma_f32_16x16x32_bf16 v[160:163], a[80:83], a[112:115], v[160:163]
 v_mfma_f32_16x16x32_bf16 v[196:199], a[80:83], a[116:119], v[196:199]
 ds_read_b128 a[28:31], v227 offset:14336
 v_mfma_f32_16x16x32_bf16 v[192:195], a[76:79], a[116:119], v[192:195]
 v_mfma_f32_16x16x32_bf16 v[200:203], a[84:87], a[116:119], v[200:203]
 s_add_u32 m0, s49, 4096
 v_cvt_pk_bf16_f32 v221, v221, v218
 v_mfma_f32_16x16x32_bf16 v[204:207], a[88:91], a[116:119], v[204:207]
 buffer_load_dwordx4 v243, s[12:15], s50 offen offset:0  lds
 v_mfma_f32_16x16x32_bf16 v[168:171], a[88:91], a[112:115], v[168:171]
 v_mfma_f32_16x16x32_bf16 v[164:167], a[84:87], a[112:115], v[164:167]
 v_mfma_f32_16x16x32_bf16 v[52:55], a[100:103], a[84:87], v[52:55]
 v_mfma_f32_16x16x32_bf16 v[60:63], a[100:103], a[88:91], v[60:63]
 buffer_load_dwordx4 v244, s[12:15], s50 offen offset:1024  lds
 v_mfma_f32_16x16x32_bf16 v[56:59], a[96:99], a[88:91], v[56:59]
 v_dot2_f32_bf16 v215, v221, s69, v215
 v_mfma_f32_16x16x32_bf16 v[48:51], a[96:99], a[84:87], v[48:51]
 v_mfma_f32_16x16x32_bf16 v[124:127], a[108:111], a[84:87], v[124:127]
 v_mfma_f32_16x16x32_bf16 v[132:135], a[108:111], a[88:91], v[132:135]
 v_mfma_f32_16x16x32_bf16 v[128:131], a[104:107], a[88:91], v[128:131]
 v_mfma_f32_16x16x32_bf16 v[120:123], a[104:107], a[84:87], v[120:123]
 s_cmp_lg_u32 s52, 0
 s_cbranch_scc1 L1qD_loop
 s_waitcnt lgkmcnt(0)
 s_waitcnt vmcnt(26)
 s_barrier
 v_mfma_f32_16x16x32_bf16 v[64:67], a[44:47], a[32:35], v[64:67]
 ds_read_b64_tr_b16 a[96:97], v229 offset:12288
 v_mfma_f32_16x16x32_bf16 v[68:71], a[48:51], a[32:35], v[68:71]
 ds_read_b64_tr_b16 a[98:99], v229 offset:13824
 v_mfma_f32_16x16x32_bf16 v[136:139], a[32:35], a[52:55], v[136:139]
 ds_read_b128 a[92:95], v211
 v_mfma_f32_16x16x32_bf16 v[172:175], a[32:35], a[56:59], v[172:175]
 v_mfma_f32_16x16x32_bf16 v[72:75], a[44:47], a[0:3], v[72:75]
 ds_read_b64_tr_b16 a[100:101], v230 offset:12288
 s_add_u32 m0, s44, 0
 v_lshlrev_b32 v220, 16, v217
 v_mfma_f32_16x16x32_bf16 v[80:83], a[44:47], a[4:7], v[80:83]
 buffer_load_dwordx4 v251, s[16:19], s51 offen offset:0  lds
 v_mfma_f32_16x16x32_bf16 v[84:87], a[48:51], a[4:7], v[84:87]
 ds_read_b64_tr_b16 a[102:103], v230 offset:13824
 v_and_b32 v217, s68, v217
 v_mfma_f32_16x16x32_bf16 v[76:79], a[48:51], a[0:3], v[76:79]
 v_mfma_f32_16x16x32_bf16 v[0:3], a[36:39], a[0:3], v[0:3]
 ds_read_b128 a[60:63], v228 offset:0
 v_mfma_f32_16x16x32_bf16 v[8:11], a[36:39], a[4:7], v[8:11]
 buffer_load_dwordx4 v252, s[16:19], s51 offen offset:1024  lds
 v_lshlrev_b32 v221, 16, v219
 v_mfma_f32_16x16x32_bf16 v[12:15], a[40:43], a[4:7], v[12:15]
 ds_read_b64_tr_b16 a[104:105], v229 offset:12416
 v_mfma_f32_16x16x32_bf16 v[4:7], a[40:43], a[0:3], v[4:7]
 v_and_b32 v219, s68, v219
 v_mfma_f32_16x16x32_bf16 v[140:143], a[0:3], a[52:55], v[140:143]
 ds_read_b64_tr_b16 a[106:107], v229 offset:13952
 v_mfma_f32_16x16x32_bf16 v[144:147], a[4:7], a[52:55], v[144:147]
 v_mfma_f32_16x16x32_bf16 v[180:183], a[4:7], a[56:59], v[180:183]
 ds_read_b128 a[64:67], v228 offset:2048
 buffer_load_dwordx4 v253, s[16:19], s51 offen offset:2048  lds
 v_mul_f32 v221, v221, v220
 v_mfma_f32_16x16x32_bf16 v[176:179], a[0:3], a[56:59], v[176:179]
 v_mfma_f32_16x16x32_bf16 v[184:187], a[8:11], a[56:59], v[184:187]
 ds_read_b64_tr_b16 a[108:109], v230 offset:12416
 v_mul_f32 v219, v219, v217
 v_mfma_f32_16x16x32_bf16 v[188:191], a[12:15], a[56:59], v[188:191]
 v_mfma_f32_16x16x32_bf16 v[152:155], a[12:15], a[52:55], v[152:155]
 ds_read_b64_tr_b16 a[110:111], v230 offset:13952
 buffer_load_dwordx4 v254, s[16:19], s51 offen offset:3072  lds
 s_add_u32 s51, s51, 196608
 s_cmp_eq_u32 s51, 6291456
 s_cselect_b32 s51, 0, s51
 v_mfma_f32_16x16x32_bf16 v[148:151], a[8:11], a[52:55], v[148:151]
 v_cvt_pk_bf16_f32 v221, v221, v219
 v_mfma_f32_16x16x32_bf16 v[20:23], a[40:43], a[8:11], v[20:23]
 ds_read_b128 a[68:71], v228 offset:4096
 v_mfma_f32_16x16x32_bf16 v[28:31], a[40:43], a[12:15], v[28:31]
 v_dot2_f32_bf16 v215, v221, s69, v215
 v_mfma_f32_16x16x32_bf16 v[24:27], a[36:39], a[12:15], v[24:27]
 ds_read_b64_tr_b16 a[112:113], v229 offset:12544
 s_add_u32 m0, s49, 6144
 v_mfma_f32_16x16x32_bf16 v[16:19], a[36:39], a[8:11], v[16:19]
 buffer_load_dwordx4 v245, s[12:15], s50 offen offset:0  lds
 v_mfma_f32_16x16x32_bf16 v[92:95], a[48:51], a[8:11], v[92:95]
 ds_read_b64_tr_b16 a[114:115], v229 offset:14080
 ds_read_b64 v[216:217], v212
 ds_read_b64 v[218:219], v214
 v_add_u32 v212, 128, v212
 v_mfma_f32_16x16x32_bf16 v[100:103], a[48:51], a[12:15], v[100:103]
 v_mfma_f32_16x16x32_bf16 v[96:99], a[44:47], a[12:15], v[96:99]
 ds_read_b128 a[72:75], v228 offset:6144
 v_accvgpr_read_b32 v222, a212
 v_mfma_f32_16x16x32_bf16 v[88:91], a[44:47], a[8:11], v[88:91]
 buffer_load_dwordx4 v246, s[12:15], s50 offen offset:1024  lds
 v_mfma_f32_16x16x32_bf16 v[104:107], a[44:47], a[16:19], v[104:107]
 ds_read_b64_tr_b16 a[116:117], v230 offset:12544
 v_mfma_f32_16x16x32_bf16 v[112:115], a[44:47], a[20:23], v[112:115]
 v_accvgpr_read_b32 v223, a214
 v_mfma_f32_16x16x32_bf16 v[116:119], a[48:51], a[20:23], v[116:119]
 ds_read_b64_tr_b16 a[118:119], v230 offset:14080
 v_mfma_f32_16x16x32_bf16 v[108:111], a[48:51], a[16:19], v[108:111]
 v_lshlrev_b32 v220, 16, v222
 v_mfma_f32_16x16x32_bf16 v[32:35], a[36:39], a[16:19], v[32:35]
 ds_read_b128 a[76:79], v228 offset:8192
 buffer_load_dwordx4 v247, s[12:15], s50 offen offset:2048  lds
 v_mfma_f32_16x16x32_bf16 v[40:43], a[36:39], a[20:23], v[40:43]
 v_mfma_f32_16x16x32_bf16 v[44:47], a[40:43], a[20:23], v[44:47]
 ds_read_b128 a[80:83], v228 offset:10240
 v_and_b32 v222, s68, v222
 v_mfma_f32_16x16x32_bf16 v[36:39], a[40:43], a[16:19], v[36:39]
 v_mfma_f32_16x16x32_bf16 v[156:159], a[16:19], a[52:55], v[156:159]
 ds_read_b128 a[84:87], v228 offset:12288
 buffer_load_dwordx4 v248, s[12:15], s50 offen offset:3072  lds
 v_lshlrev_b32 v221, 16, v223
 v_mfma_f32_16x16x32_bf16 v[160:163], a[20:23], a[52:55], v[160:163]
 v_mfma_f32_16x16x32_bf16 v[196:199], a[20:23], a[56:59], v[196:199]
 ds_read_b128 a[88:91], v228 offset:14336
 v_mfma_f32_16x16x32_bf16 v[192:195], a[16:19], a[56:59], v[192:195]
 v_and_b32 v223, s68, v223
 v_mfma_f32_16x16x32_bf16 v[200:203], a[24:27], a[56:59], v[200:203]
 s_add_u32 m0, s49, 10240
 v_mfma_f32_16x16x32_bf16 v[204:207], a[28:31], a[56:59], v[204:207]
 buffer_load_dwordx4 v249, s[12:15], s50 offen offset:0  lds
 v_mul_f32 v221, v221, v220
 v_mfma_f32_16x16x32_bf16 v[168:171], a[28:31], a[52:55], v[168:171]
 v_mfma_f32_16x16x32_bf16 v[164:167], a[24:27], a[52:55], v[164:167]
 v_mfma_f32_16x16x32_bf16 v[52:55], a[40:43], a[24:27], v[52:55]
 v_mul_f32 v223, v223, v222
 v_mfma_f32_16x16x32_bf16 v[60:63], a[40:43], a[28:31], v[60:63]
 buffer_load_dwordx4 v250, s[12:15], s50 offen offset:1024  lds
 v_mfma_f32_16x16x32_bf16 v[56:59], a[36:39], a[28:31], v[56:59]
 v_cvt_pk_bf16_f32 v221, v221, v223
 v_mfma_f32_16x16x32_bf16 v[48:51], a[36:39], a[24:27], v[48:51]
 v_mfma_f32_16x16x32_bf16 v[124:127], a[48:51], a[24:27], v[124:127]
 v_mfma_f32_16x16x32_bf16 v[132:135], a[48:51], a[28:31], v[132:135]
 v_dot2_f32_bf16 v215, v221, s69, v215
 v_mfma_f32_16x16x32_bf16 v[128:131], a[44:47], a[28:31], v[128:131]
 v_mfma_f32_16x16x32_bf16 v[120:123], a[44:47], a[24:27], v[120:123]
 s_waitcnt lgkmcnt(0)
 s_waitcnt vmcnt(20)
 s_barrier
 v_mfma_f32_16x16x32_bf16 v[64:67], a[104:107], a[92:95], v[64:67]
 v_add_u32 v227, s47, v225
 v_add_u32 v210, s47, v208
 v_add_u32 v228, s47, v226
 ds_read_b64_tr_b16 a[36:37], v229 offset:24576
 v_mfma_f32_16x16x32_bf16 v[68:71], a[108:111], a[92:95], v[68:71]
 v_add_u32 v211, s47, v209
 v_add_u32 v214, s47, v213
 s_add_u32 s49, s46, s45
 ds_read_b64_tr_b16 a[38:39], v229 offset:26112
 v_mfma_f32_16x16x32_bf16 v[136:139], a[92:95], a[112:115], v[136:139]
 s_add_u32 s50, s50, 128
 s_and_b32 s50, s50, 2047
 s_mov_b32 s53, s46
 ds_read_b128 a[32:35], v210
 v_mfma_f32_16x16x32_bf16 v[172:175], a[92:95], a[116:119], v[172:175]
 s_mov_b32 s46, s47
 s_mov_b32 s47, s48
 s_mov_b32 s48, s53
 v_mfma_f32_16x16x32_bf16 v[72:75], a[104:107], a[60:63], v[72:75]
 ds_read_b64_tr_b16 a[40:41], v230 offset:24576
 s_add_u32 m0, s44, 12288
 v_lshlrev_b32 v220, 16, v216
 v_mfma_f32_16x16x32_bf16 v[80:83], a[104:107], a[64:67], v[80:83]
 buffer_load_dwordx4 v251, s[16:19], s51 offen offset:0  lds
 v_mfma_f32_16x16x32_bf16 v[84:87], a[108:111], a[64:67], v[84:87]
 ds_read_b64_tr_b16 a[42:43], v230 offset:26112
 v_and_b32 v216, s68, v216
 v_mfma_f32_16x16x32_bf16 v[76:79], a[108:111], a[60:63], v[76:79]
 v_mfma_f32_16x16x32_bf16 v[0:3], a[96:99], a[60:63], v[0:3]
 ds_read_b128 a[0:3], v227 offset:0
 v_mfma_f32_16x16x32_bf16 v[8:11], a[96:99], a[64:67], v[8:11]
 buffer_load_dwordx4 v252, s[16:19], s51 offen offset:1024  lds
 v_lshlrev_b32 v221, 16, v218
 v_mfma_f32_16x16x32_bf16 v[12:15], a[100:103], a[64:67], v[12:15]
 ds_read_b64_tr_b16 a[44:45], v229 offset:24704
 v_mfma_f32_16x16x32_bf16 v[4:7], a[100:103], a[60:63], v[4:7]
 v_mfma_f32_16x16x32_bf16 v[140:143], a[60:63], a[112:115], v[140:143]
 ds_read_b64_tr_b16 a[46:47], v229 offset:26240
 v_and_b32 v218, s68, v218
 v_mfma_f32_16x16x32_bf16 v[144:147], a[64:67], a[112:115], v[144:147]
 v_mfma_f32_16x16x32_bf16 v[180:183], a[64:67], a[116:119], v[180:183]
 ds_read_b128 a[4:7], v227 offset:2048
 buffer_load_dwordx4 v253, s[16:19], s51 offen offset:2048  lds
 v_mul_f32 v221, v221, v220
 v_mfma_f32_16x16x32_bf16 v[176:179], a[60:63], a[116:119], v[176:179]
 v_mfma_f32_16x16x32_bf16 v[184:187], a[68:71], a[116:119], v[184:187]
 ds_read_b64_tr_b16 a[48:49], v230 offset:24704
 v_mfma_f32_16x16x32_bf16 v[188:191], a[72:75], a[116:119], v[188:191]
 v_mul_f32 v218, v218, v216
 v_mfma_f32_16x16x32_bf16 v[152:155], a[72:75], a[112:115], v[152:155]
 ds_read_b64_tr_b16 a[50:51], v230 offset:26240
 buffer_load_dwordx4 v254, s[16:19], s51 offen offset:3072  lds
 s_add_u32 s51, s51, 196608
 s_cmp_eq_u32 s51, 6291456
 s_cselect_b32 s51, 0, s51
 v_mfma_f32_16x16x32_bf16 v[148:151], a[68:71], a[112:115], v[148:151]
 v_mfma_f32_16x16x32_bf16 v[20:23], a[100:103], a[68:71], v[20:23]
 ds_read_b128 a[8:11], v227 offset:4096
 v_cvt_pk_bf16_f32 v221, v221, v218
 v_mfma_f32_16x16x32_bf16 v[28:31], a[100:103], a[72:75], v[28:31]
 v_mfma_f32_16x16x32_bf16 v[24:27], a[96:99], a[72:75], v[24:27]
 ds_read_b64_tr_b16 a[52:53], v229 offset:24832
 s_add_u32 m0, s49, 0
 v_dot2_f32_bf16 v215, v221, s69, v215
 v_mfma_f32_16x16x32_bf16 v[16:19], a[96:99], a[68:71], v[16:19]
 buffer_load_dwordx4 v239, s[12:15], s50 offen offset:0  lds
 v_mfma_f32_16x16x32_bf16 v[92:95], a[108:111], a[68:71], v[92:95]
 ds_read_b64_tr_b16 a[54:55], v229 offset:26368
 v_mfma_f32_16x16x32_bf16 v[100:103], a[108:111], a[72:75], v[100:103]
 v_accvgpr_read_b32 v222, a213
 v_mfma_f32_16x16x32_bf16 v[96:99], a[104:107], a[72:75], v[96:99]
 ds_read_b128 a[12:15], v227 offset:6144
 v_mfma_f32_16x16x32_bf16 v[88:91], a[104:107], a[68:71], v[88:91]
 buffer_load_dwordx4 v240, s[12:15], s50 offen offset:1024  lds
 v_mfma_f32_16x16x32_bf16 v[104:107], a[104:107], a[76:79], v[104:107]
 ds_read_b64_tr_b16 a[56:57], v230 offset:24832
 v_accvgpr_read_b32 v223, a215
 v_mfma_f32_16x16x32_bf16 v[112:115], a[104:107], a[80:83], v[112:115]
 v_mfma_f32_16x16x32_bf16 v[116:119], a[108:111], a[80:83], v[116:119]
 ds_read_b64_tr_b16 a[58:59], v230 offset:26368
 v_lshlrev_b32 v220, 16, v222
 v_mfma_f32_16x16x32_bf16 v[108:111], a[108:111], a[76:79], v[108:111]
 v_mfma_f32_16x16x32_bf16 v[32:35], a[96:99], a[76:79], v[32:35]
 ds_read_b128 a[16:19], v227 offset:8192
 buffer_load_dwordx4 v241, s[12:15], s50 offen offset:2048  lds
 v_mfma_f32_16x16x32_bf16 v[40:43], a[96:99], a[80:83], v[40:43]
 v_and_b32 v222, s68, v222
 v_mfma_f32_16x16x32_bf16 v[44:47], a[100:103], a[80:83], v[44:47]
 ds_read_b128 a[20:23], v227 offset:10240
 v_mfma_f32_16x16x32_bf16 v[36:39], a[100:103], a[76:79], v[36:39]
 v_mfma_f32_16x16x32_bf16 v[156:159], a[76:79], a[112:115], v[156:159]
 ds_read_b128 a[24:27], v227 offset:12288
 buffer_load_dwordx4 v242, s[12:15], s50 offen offset:3072  lds
 v_lshlrev_b32 v221, 16, v223
 v_mfma_f32_16x16x32_bf16 v[160:163], a[80:83], a[112:115], v[160:163]
 v_mfma_f32_16x16x32_bf16 v[196:199], a[80:83], a[116:119], v[196:199]
 ds_read_b128 a[28:31], v227 offset:14336
 v_and_b32 v223, s68, v223
 v_mfma_f32_16x16x32_bf16 v[192:195], a[76:79], a[116:119], v[192:195]
 v_mfma_f32_16x16x32_bf16 v[200:203], a[84:87], a[116:119], v[200:203]
 s_add_u32 m0, s49, 4096
 v_mfma_f32_16x16x32_bf16 v[204:207], a[88:91], a[116:119], v[204:207]
 buffer_load_dwordx4 v243, s[12:15], s50 offen offset:0  lds
 v_mul_f32 v221, v221, v220
 v_mfma_f32_16x16x32_bf16 v[168:171], a[88:91], a[112:115], v[168:171]
 v_mfma_f32_16x16x32_bf16 v[164:167], a[84:87], a[112:115], v[164:167]
 v_mfma_f32_16x16x32_bf16 v[52:55], a[100:103], a[84:87], v[52:55]
 v_mul_f32 v223, v223, v222
 v_mfma_f32_16x16x32_bf16 v[60:63], a[100:103], a[88:91], v[60:63]
 buffer_load_dwordx4 v244, s[12:15], s50 offen offset:1024  lds
 v_mfma_f32_16x16x32_bf16 v[56:59], a[96:99], a[88:91], v[56:59]
 v_cvt_pk_bf16_f32 v221, v221, v223
 v_mfma_f32_16x16x32_bf16 v[48:51], a[96:99], a[84:87], v[48:51]
 v_mfma_f32_16x16x32_bf16 v[124:127], a[108:111], a[84:87], v[124:127]
 v_mfma_f32_16x16x32_bf16 v[132:135], a[108:111], a[88:91], v[132:135]
 v_dot2_f32_bf16 v215, v221, s69, v215
 v_mfma_f32_16x16x32_bf16 v[128:131], a[104:107], a[88:91], v[128:131]
 v_mfma_f32_16x16x32_bf16 v[120:123], a[104:107], a[84:87], v[120:123]
 s_waitcnt lgkmcnt(0)
 s_waitcnt vmcnt(26)
 s_barrier
 v_mfma_f32_16x16x32_bf16 v[64:67], a[44:47], a[32:35], v[64:67]
 ds_read_b64_tr_b16 a[96:97], v229 offset:36864
 v_mfma_f32_16x16x32_bf16 v[68:71], a[48:51], a[32:35], v[68:71]
 ds_read_b64_tr_b16 a[98:99], v229 offset:38400
 v_mfma_f32_16x16x32_bf16 v[136:139], a[32:35], a[52:55], v[136:139]
 ds_read_b128 a[92:95], v211
 v_mfma_f32_16x16x32_bf16 v[172:175], a[32:35], a[56:59], v[172:175]
 v_mfma_f32_16x16x32_bf16 v[72:75], a[44:47], a[0:3], v[72:75]
 ds_read_b64_tr_b16 a[100:101], v230 offset:36864
 v_lshlrev_b32 v220, 16, v217
 v_mfma_f32_16x16x32_bf16 v[80:83], a[44:47], a[4:7], v[80:83]
 s_and_b32 s43, s30, 6
 s_lshl_b32 s43, s43, 2
 buffer_load_dwordx2 a[250:251], off, s[60:63], s43 sc1
 v_mfma_f32_16x16x32_bf16 v[84:87], a[48:51], a[4:7], v[84:87]
 ds_read_b64_tr_b16 a[102:103], v230 offset:38400
 v_and_b32 v217, s68, v217
 v_mfma_f32_16x16x32_bf16 v[76:79], a[48:51], a[0:3], v[76:79]
 v_mfma_f32_16x16x32_bf16 v[0:3], a[36:39], a[0:3], v[0:3]
 ds_read_b128 a[60:63], v228 offset:0
 s_add_u32 m0, s44, 24576
 v_mfma_f32_16x16x32_bf16 v[8:11], a[36:39], a[4:7], v[8:11]
 buffer_load_dwordx4 v251, s[16:19], s51 offen offset:0  lds
 v_lshlrev_b32 v221, 16, v219
 v_mfma_f32_16x16x32_bf16 v[12:15], a[40:43], a[4:7], v[12:15]
 ds_read_b64_tr_b16 a[104:105], v229 offset:36992
 v_mfma_f32_16x16x32_bf16 v[4:7], a[40:43], a[0:3], v[4:7]
 v_mfma_f32_16x16x32_bf16 v[140:143], a[0:3], a[52:55], v[140:143]
 ds_read_b64_tr_b16 a[106:107], v229 offset:38528
 v_and_b32 v219, s68, v219
 v_mfma_f32_16x16x32_bf16 v[144:147], a[4:7], a[52:55], v[144:147]
 buffer_load_dwordx4 v252, s[16:19], s51 offen offset:1024  lds
 v_mfma_f32_16x16x32_bf16 v[180:183], a[4:7], a[56:59], v[180:183]
 ds_read_b128 a[64:67], v228 offset:2048
 v_mul_f32 v221, v221, v220
 v_mfma_f32_16x16x32_bf16 v[176:179], a[0:3], a[56:59], v[176:179]
 v_mfma_f32_16x16x32_bf16 v[184:187], a[8:11], a[56:59], v[184:187]
 ds_read_b64_tr_b16 a[108:109], v230 offset:36992
 v_mfma_f32_16x16x32_bf16 v[188:191], a[12:15], a[56:59], v[188:191]
 buffer_load_dwordx4 v253, s[16:19], s51 offen offset:2048  lds
 v_mul_f32 v219, v219, v217
 v_mfma_f32_16x16x32_bf16 v[152:155], a[12:15], a[52:55], v[152:155]
 ds_read_b64_tr_b16 a[110:111], v230 offset:38528
 v_mfma_f32_16x16x32_bf16 v[148:151], a[8:11], a[52:55], v[148:151]
 v_mfma_f32_16x16x32_bf16 v[20:23], a[40:43], a[8:11], v[20:23]
 ds_read_b128 a[68:71], v228 offset:4096
 v_cvt_pk_bf16_f32 v221, v221, v219
 v_mfma_f32_16x16x32_bf16 v[28:31], a[40:43], a[12:15], v[28:31]
 buffer_load_dwordx4 v254, s[16:19], s51 offen offset:3072  lds
 s_add_u32 s51, s51, 196608
 s_cmp_eq_u32 s51, 6291456
 s_cselect_b32 s51, 0, s51
 v_mfma_f32_16x16x32_bf16 v[24:27], a[36:39], a[12:15], v[24:27]
 ds_read_b64_tr_b16 a[112:113], v229 offset:37120
 v_dot2_f32_bf16 v215, v221, s69, v215
 v_mfma_f32_16x16x32_bf16 v[16:19], a[36:39], a[8:11], v[16:19]
 v_mfma_f32_16x16x32_bf16 v[92:95], a[48:51], a[8:11], v[92:95]
 ds_read_b64_tr_b16 a[114:115], v229 offset:38656
 s_add_u32 m0, s49, 6144
 v_mfma_f32_16x16x32_bf16 v[100:103], a[48:51], a[12:15], v[100:103]
 buffer_load_dwordx4 v245, s[12:15], s50 offen offset:0  lds
 v_accvgpr_read_b32 v222, a216
 v_mfma_f32_16x16x32_bf16 v[96:99], a[44:47], a[12:15], v[96:99]
 ds_read_b128 a[72:75], v228 offset:6144
 v_mfma_f32_16x16x32_bf16 v[88:91], a[44:47], a[8:11], v[88:91]
 v_mfma_f32_16x16x32_bf16 v[104:107], a[44:47], a[16:19], v[104:107]
 ds_read_b64_tr_b16 a[116:117], v230 offset:37120
 v_accvgpr_read_b32 v223, a218
 v_mfma_f32_16x16x32_bf16 v[112:115], a[44:47], a[20:23], v[112:115]
 buffer_load_dwordx4 v246, s[12:15], s50 offen offset:1024  lds
 v_mfma_f32_16x16x32_bf16 v[116:119], a[48:51], a[20:23], v[116:119]
 ds_read_b64_tr_b16 a[118:119], v230 offset:38656
 v_lshlrev_b32 v220, 16, v222
 v_mfma_f32_16x16x32_bf16 v[108:111], a[48:51], a[16:19], v[108:111]
 v_mfma_f32_16x16x32_bf16 v[32:35], a[36:39], a[16:19], v[32:35]
 ds_read_b128 a[76:79], v228 offset:8192
 v_mfma_f32_16x16x32_bf16 v[40:43], a[36:39], a[20:23], v[40:43]
 buffer_load_dwordx4 v247, s[12:15], s50 offen offset:2048  lds
 v_and_b32 v222, s68, v222
 v_mfma_f32_16x16x32_bf16 v[44:47], a[40:43], a[20:23], v[44:47]
 ds_read_b128 a[80:83], v228 offset:10240
 v_mfma_f32_16x16x32_bf16 v[36:39], a[40:43], a[16:19], v[36:39]
 v_mfma_f32_16x16x32_bf16 v[156:159], a[16:19], a[52:55], v[156:159]
 ds_read_b128 a[84:87], v228 offset:12288
 v_lshlrev_b32 v221, 16, v223
 v_mfma_f32_16x16x32_bf16 v[160:163], a[20:23], a[52:55], v[160:163]
 buffer_load_dwordx4 v248, s[12:15], s50 offen offset:3072  lds
 v_mfma_f32_16x16x32_bf16 v[196:199], a[20:23], a[56:59], v[196:199]
 ds_read_b128 a[88:91], v228 offset:14336
 v_and_b32 v223, s68, v223
 v_mfma_f32_16x16x32_bf16 v[192:195], a[16:19], a[56:59], v[192:195]
 v_mfma_f32_16x16x32_bf16 v[200:203], a[24:27], a[56:59], v[200:203]
 s_add_u32 m0, s49, 10240
 v_mfma_f32_16x16x32_bf16 v[204:207], a[28:31], a[56:59], v[204:207]
 buffer_load_dwordx4 v249, s[12:15], s50 offen offset:0  lds
 v_mul_f32 v221, v221, v220
 v_mfma_f32_16x16x32_bf16 v[168:171], a[28:31], a[52:55], v[168:171]
 v_mfma_f32_16x16x32_bf16 v[164:167], a[24:27], a[52:55], v[164:167]
 v_mfma_f32_16x16x32_bf16 v[52:55], a[40:43], a[24:27], v[52:55]
 v_mul_f32 v223, v223, v222
 v_mfma_f32_16x16x32_bf16 v[60:63], a[40:43], a[28:31], v[60:63]
 buffer_load_dwordx4 v250, s[12:15], s50 offen offset:1024  lds
 v_mfma_f32_16x16x32_bf16 v[56:59], a[36:39], a[28:31], v[56:59]
 v_cvt_pk_bf16_f32 v221, v221, v223
 v_mfma_f32_16x16x32_bf16 v[48:51], a[36:39], a[24:27], v[48:51]
 v_mfma_f32_16x16x32_bf16 v[124:127], a[48:51], a[24:27], v[124:127]
 v_mfma_f32_16x16x32_bf16 v[132:135], a[48:51], a[28:31], v[132:135]
 v_dot2_f32_bf16 v215, v221, s69, v215
 v_mfma_f32_16x16x32_bf16 v[128:131], a[44:47], a[28:31], v[128:131]
 v_mfma_f32_16x16x32_bf16 v[120:123], a[44:47], a[24:27], v[120:123]
 s_waitcnt lgkmcnt(0)
 s_waitcnt vmcnt(17)
 s_barrier
 v_mfma_f32_16x16x32_bf16 v[64:67], a[104:107], a[92:95], v[64:67]
 v_add_u32 v227, s47, v225
 v_add_u32 v210, s47, v208
 v_add_u32 v228, s47, v226
 ds_read_b64_tr_b16 a[0:1], v229 offset:0
 v_mfma_f32_16x16x32_bf16 v[68:71], a[108:111], a[92:95], v[68:71]
 v_add_u32 v211, s47, v209
 v_add_u32 v225, 49152, v225
 v_add_u32 v226, 49152, v226
 ds_read_b64_tr_b16 a[2:3], v229 offset:1536
 v_mfma_f32_16x16x32_bf16 v[136:139], a[92:95], a[112:115], v[136:139]
 v_add_u32 v208, 49152, v208
 v_add_u32 v209, 49152, v209
 ds_read_b64_tr_b16 a[4:5], v230 offset:0
 v_mfma_f32_16x16x32_bf16 v[172:175], a[92:95], a[116:119], v[172:175]
 ds_read_b64_tr_b16 a[6:7], v230 offset:1536
 v_mfma_f32_16x16x32_bf16 v[72:75], a[104:107], a[60:63], v[72:75]
 s_add_u32 m0, s44, 36864
 v_accvgpr_read_b32 v222, a217
 v_mfma_f32_16x16x32_bf16 v[80:83], a[104:107], a[64:67], v[80:83]
 ds_read_b64_tr_b16 a[8:9], v229 offset:128
 buffer_load_dwordx4 v251, s[16:19], s51 offen offset:0  lds
 v_accvgpr_read_b32 v223, a219
 v_mfma_f32_16x16x32_bf16 v[84:87], a[108:111], a[64:67], v[84:87]
 v_mfma_f32_16x16x32_bf16 v[76:79], a[108:111], a[60:63], v[76:79]
 ds_read_b64_tr_b16 a[10:11], v229 offset:1664
 v_lshlrev_b32 v220, 16, v222
 v_mfma_f32_16x16x32_bf16 v[0:3], a[96:99], a[60:63], v[0:3]
 v_and_b32 v222, s68, v222
 v_mfma_f32_16x16x32_bf16 v[8:11], a[96:99], a[64:67], v[8:11]
 ds_read_b64_tr_b16 a[12:13], v230 offset:128
 v_mfma_f32_16x16x32_bf16 v[12:15], a[100:103], a[64:67], v[12:15]
 v_lshlrev_b32 v221, 16, v223
 v_mfma_f32_16x16x32_bf16 v[4:7], a[100:103], a[60:63], v[4:7]
 ds_read_b64_tr_b16 a[14:15], v230 offset:1664
 v_mfma_f32_16x16x32_bf16 v[140:143], a[60:63], a[112:115], v[140:143]
 v_and_b32 v223, s68, v223
 v_mfma_f32_16x16x32_bf16 v[144:147], a[64:67], a[112:115], v[144:147]
 ds_read_b64_tr_b16 a[16:17], v229 offset:256
 v_mul_f32 v221, v221, v220
 v_mfma_f32_16x16x32_bf16 v[180:183], a[64:67], a[116:119], v[180:183]
 v_mfma_f32_16x16x32_bf16 v[176:179], a[60:63], a[116:119], v[176:179]
 ds_read_b64_tr_b16 a[18:19], v229 offset:1792
 v_mul_f32 v223, v223, v222
 v_mfma_f32_16x16x32_bf16 v[184:187], a[68:71], a[116:119], v[184:187]
 buffer_load_dwordx4 v252, s[16:19], s51 offen offset:1024  lds
 v_cvt_pk_bf16_f32 v221, v221, v223
 v_mfma_f32_16x16x32_bf16 v[188:191], a[72:75], a[116:119], v[188:191]
 ds_read_b64_tr_b16 a[20:21], v230 offset:256
 v_mfma_f32_16x16x32_bf16 v[152:155], a[72:75], a[112:115], v[152:155]
 ds_read_b64_tr_b16 a[22:23], v230 offset:1792
 v_dot2_f32_bf16 v215, v221, s69, v215
 v_mfma_f32_16x16x32_bf16 v[148:151], a[68:71], a[112:115], v[148:151]
 v_mfma_f32_16x16x32_bf16 v[20:23], a[100:103], a[68:71], v[20:23]
 ds_read_b64_tr_b16 a[24:25], v229 offset:12288
 v_add_f32_dpp v215, v215, v215 row_ror:8 row_mask:0xf bank_mask:0xf
 v_mfma_f32_16x16x32_bf16 v[28:31], a[100:103], a[72:75], v[28:31]
    s_nop 0
 v_add_f32_dpp v215, v215, v215 row_ror:4 row_mask:0xf bank_mask:0xf
 v_mfma_f32_16x16x32_bf16 v[24:27], a[96:99], a[72:75], v[24:27]
 ds_read_b64_tr_b16 a[26:27], v229 offset:13824
 v_mfma_f32_16x16x32_bf16 v[16:19], a[96:99], a[68:71], v[16:19]
 v_add_f32_dpp v215, v215, v215 row_ror:2 row_mask:0xf bank_mask:0xf
 v_mfma_f32_16x16x32_bf16 v[92:95], a[108:111], a[68:71], v[92:95]
 ds_read_b64_tr_b16 a[28:29], v230 offset:12288
 v_add_f32_dpp v215, v215, v215 row_ror:1 row_mask:0xf bank_mask:0xf
 v_mfma_f32_16x16x32_bf16 v[100:103], a[108:111], a[72:75], v[100:103]
 v_mfma_f32_16x16x32_bf16 v[96:99], a[104:107], a[72:75], v[96:99]
 ds_read_b64_tr_b16 a[30:31], v230 offset:13824
 v_cvt_pk_bf16_f32 v215, v215, v215
 v_mfma_f32_16x16x32_bf16 v[88:91], a[104:107], a[68:71], v[88:91]
 buffer_load_dwordx4 v253, s[16:19], s51 offen offset:2048  lds
 v_mfma_f32_16x16x32_bf16 v[104:107], a[104:107], a[76:79], v[104:107]
 ds_read_b64_tr_b16 a[32:33], v229 offset:12416
 v_and_b32 v215, s68, v215
 v_mfma_f32_16x16x32_bf16 v[112:115], a[104:107], a[80:83], v[112:115]
 v_mul_f32 v215, 0xbfb8aa3b, v215
 v_mfma_f32_16x16x32_bf16 v[116:119], a[108:111], a[80:83], v[116:119]
 ds_read_b64_tr_b16 a[34:35], v229 offset:13952
 v_mfma_f32_16x16x32_bf16 v[108:111], a[108:111], a[76:79], v[108:111]
 v_exp_f32 v215, v215
 v_mfma_f32_16x16x32_bf16 v[32:35], a[96:99], a[76:79], v[32:35]
 ds_read_b64_tr_b16 a[36:37], v230 offset:12416
 v_add_f32 v215, 1.0, v215
 v_mfma_f32_16x16x32_bf16 v[40:43], a[96:99], a[80:83], v[40:43]
 ds_read_b64_tr_b16 a[38:39], v230 offset:13952
 v_mfma_f32_16x16x32_bf16 v[44:47], a[100:103], a[80:83], v[44:47]
 v_rcp_f32 v215, v215
 v_mfma_f32_16x16x32_bf16 v[36:39], a[100:103], a[76:79], v[36:39]
 ds_read_b64_tr_b16 a[40:41], v229 offset:12544
 v_mfma_f32_16x16x32_bf16 v[156:159], a[76:79], a[112:115], v[156:159]
 v_cvt_pk_bf16_f32 v215, v215, v215
 v_mfma_f32_16x16x32_bf16 v[160:163], a[80:83], a[112:115], v[160:163]
 ds_read_b64_tr_b16 a[42:43], v229 offset:14080
 v_and_b32 v216, s68, v215
 v_mfma_f32_16x16x32_bf16 v[196:199], a[80:83], a[116:119], v[196:199]
 buffer_load_dwordx4 v254, s[16:19], s51 offen offset:3072  lds
 s_add_u32 s51, s51, 196608
 s_cmp_eq_u32 s51, 6291456
 s_cselect_b32 s51, 0, s51
 v_mfma_f32_16x16x32_bf16 v[192:195], a[76:79], a[116:119], v[192:195]
 ds_read_b64_tr_b16 a[44:45], v230 offset:12544
 v_sub_f32 v215, 1.0, v216
 v_mfma_f32_16x16x32_bf16 v[200:203], a[84:87], a[116:119], v[200:203]
 v_cvt_pk_bf16_f32 v215, v215, v215
 v_mfma_f32_16x16x32_bf16 v[204:207], a[88:91], a[116:119], v[204:207]
 ds_read_b64_tr_b16 a[46:47], v230 offset:14080
 v_mfma_f32_16x16x32_bf16 v[168:171], a[88:91], a[112:115], v[168:171]
 v_and_b32 v217, s68, v215
 v_mfma_f32_16x16x32_bf16 v[164:167], a[84:87], a[112:115], v[164:167]
 ds_read_b128 a[180:183], v210 offset:0
 v_mfma_f32_16x16x32_bf16 v[52:55], a[100:103], a[84:87], v[52:55]
 s_lshl_b32 s40, s39, 5
 v_mfma_f32_16x16x32_bf16 v[60:63], a[100:103], a[88:91], v[60:63]
 ds_read_b128 a[184:187], v211 offset:0
 s_add_u32 s40, s40, 18874368
 v_mfma_f32_16x16x32_bf16 v[56:59], a[96:99], a[88:91], v[56:59]
 v_mfma_f32_16x16x32_bf16 v[48:51], a[96:99], a[84:87], v[48:51]
 v_lshrrev_b32 v220, 4, v224
 v_mfma_f32_16x16x32_bf16 v[124:127], a[108:111], a[84:87], v[124:127]
 v_lshlrev_b32 v220, 3, v220
 v_mfma_f32_16x16x32_bf16 v[132:135], a[108:111], a[88:91], v[132:135]
 v_mfma_f32_16x16x32_bf16 v[128:131], a[104:107], a[88:91], v[128:131]
 buffer_store_dwordx2 v[216:217], v220, s[20:23], s40 offen sc1
 v_mfma_f32_16x16x32_bf16 v[120:123], a[104:107], a[84:87], v[120:123]
 s_waitcnt vmcnt(0)
L1q_tail:
 s_waitcnt lgkmcnt(0)
 s_barrier
 v_mfma_f32_16x16x32_bf16 v[64:67], a[8:11], a[180:183], v[64:67]
 ds_read_b128 a[188:191], v208 offset:0
 ds_read_b128 a[192:195], v209 offset:0
 ds_read_b64_tr_b16 a[120:121], v229 offset:24576
 ds_read_b64_tr_b16 a[122:123], v229 offset:26112
 ds_read_b64_tr_b16 a[124:125], v230 offset:24576
 ds_read_b64_tr_b16 a[126:127], v230 offset:26112
 v_mfma_f32_16x16x32_bf16 v[68:71], a[12:15], a[180:183], v[68:71]
 ds_read_b64_tr_b16 a[128:129], v229 offset:24704
 ds_read_b64_tr_b16 a[130:131], v229 offset:26240
 ds_read_b64_tr_b16 a[132:133], v230 offset:24704
 ds_read_b64_tr_b16 a[134:135], v230 offset:26240
 ds_read_b64_tr_b16 a[136:137], v229 offset:24832
 v_lshlrev_b32 v232, 4, v224
 s_lshl_b32 s40, s34, 1
 s_add_u32 s40, s40, s36
 s_mul_i32 s40, s40, 1179648
 v_mfma_f32_16x16x32_bf16 v[136:139], a[180:183], a[16:19], v[136:139]
 ds_read_b64_tr_b16 a[138:139], v229 offset:26368
 ds_read_b64_tr_b16 a[140:141], v230 offset:24832
 ds_read_b64_tr_b16 a[142:143], v230 offset:26368
 ds_read_b64_tr_b16 a[144:145], v229 offset:36864
 ds_read_b64_tr_b16 a[146:147], v229 offset:38400
 s_lshl_b32 s41, s35, 1
 s_add_u32 s41, s41, s37
 s_lshl_b32 s41, s41, 13
 s_add_u32 s40, s40, s41
 v_mfma_f32_16x16x32_bf16 v[172:175], a[180:183], a[20:23], v[172:175]
 ds_read_b64_tr_b16 a[148:149], v230 offset:36864
 ds_read_b64_tr_b16 a[150:151], v230 offset:38400
 ds_read_b64_tr_b16 a[152:153], v229 offset:36992
 ds_read_b64_tr_b16 a[154:155], v229 offset:38528
 ds_read_b64_tr_b16 a[156:157], v230 offset:36992
 v_and_b32 v233, 15, v224
 v_lshrrev_b32 v234, 4, v224
 v_and_b32 v235, 1, v233
 v_cmp_eq_u32 s[56:57], 1, v235
 v_mfma_f32_16x16x32_bf16 v[64:67], a[32:35], a[184:187], v[64:67]
 ds_read_b64_tr_b16 a[158:159], v230 offset:38528
 ds_read_b64_tr_b16 a[160:161], v229 offset:37120
 ds_read_b64_tr_b16 a[162:163], v229 offset:38656
 ds_read_b64_tr_b16 a[164:165], v230 offset:37120
 ds_read_b64_tr_b16 a[166:167], v230 offset:38656
 v_lshl_add_u32 v236, v234, 2, v235
 v_cmp_le_u32 s[58:59], v236, v233
 v_add_u32 v236, 2, v236
 v_cmp_le_u32 s[60:61], v236, v233
 v_mfma_f32_16x16x32_bf16 v[68:71], a[36:39], a[184:187], v[68:71]
 s_or_b32 s41, s34, s36
 s_cmp_eq_u32 s41, 0
 s_cselect_b64 s[62:63], -1, 0
 v_mov_b32 v237, 0x0c0c0c0c
 v_mfma_f32_16x16x32_bf16 v[136:139], a[184:187], a[40:43], v[136:139]
 v_mov_b32 v235, 0x0c0c0100
 v_mov_b32 v236, 0x01000c0c
 v_cndmask_b32 v238, v235, v236, s[56:57]
 s_andn2_b64 s[64:65], s[62:63], s[58:59]
 v_mfma_f32_16x16x32_bf16 v[172:175], a[184:187], a[44:47], v[172:175]
 s_waitcnt lgkmcnt(0)
 s_andn2_b64 s[66:67], s[62:63], s[60:61]
 v_cndmask_b32 v239, v238, v237, s[58:59]
 v_cndmask_b32 v241, v237, v238, s[58:59]
 v_mov_b32 v235, 0x0c0c0302
 v_mfma_f32_16x16x32_bf16 v[64:67], a[128:131], a[188:191], v[64:67]
 ds_read_b128 a[60:63], v227 offset:0
 v_mov_b32 v236, 0x03020c0c
 v_cndmask_b32 v238, v235, v236, s[56:57]
 v_cndmask_b32 v240, v238, v237, s[60:61]
 v_cndmask_b32 v242, v237, v238, s[60:61]
 v_mfma_f32_16x16x32_bf16 v[68:71], a[132:135], a[188:191], v[68:71]
 ds_read_b128 a[64:67], v228 offset:0
 s_mov_b32 s68, 0xffff0000
 s_mov_b32 s69, 1043662067
 s_mov_b32 s70, 1069066811
 v_mov_b32 v237, 3463342888
 v_mfma_f32_16x16x32_bf16 v[136:139], a[188:191], a[136:139], v[136:139]
 ds_read_b128 a[68:71], v225 offset:0
 s_and_b32 s74, s30, 1
 s_and_b32 s75, s31, 7
 s_lshl_b32 s44, s33, 12
 s_mul_i32 s46, s74, 917504
 v_mfma_f32_16x16x32_bf16 v[172:175], a[188:191], a[140:143], v[172:175]
 ds_read_b128 a[72:75], v226 offset:0
 s_sub_u32 s16, s72, 4096
 s_subb_u32 s17, s73, 0
 s_mov_b32 s18, 2101248
 v_lshrrev_b32 v254, 4, v224
 v_and_b32 v255, 15, v224
 v_mfma_f32_16x16x32_bf16 v[64:67], a[152:155], a[192:195], v[64:67]
 s_lshl_b32 s76, s33, 14
 s_lshl_b32 s77, s75, 8
 s_add_u32 s76, s76, s77
 v_lshl_add_u32 v252, v254, 1, 0
 v_mfma_f32_16x16x32_bf16 v[68:71], a[156:159], a[192:195], v[68:71]
 v_xor_b32 v252, v252, v255
 v_lshlrev_b32 v252, 4, v252
 v_lshl_add_u32 v252, v254, 11, v252
 s_add_u32 s77, s76, 2048
 v_mfma_f32_16x16x32_bf16 v[136:139], a[192:195], a[160:163], v[136:139]
 v_add_u32 v252, s77, v252
 v_lshl_add_u32 v253, v254, 1, 8
 v_xor_b32 v253, v253, v255
 v_lshlrev_b32 v253, 4, v253
 v_mfma_f32_16x16x32_bf16 v[172:175], a[192:195], a[164:167], v[172:175]
 v_lshl_add_u32 v253, v254, 11, v253
 s_add_u32 s77, s76, 9216
 v_add_u32 v253, s77, v253
 s_waitcnt lgkmcnt(0)
 s_barrier
 v_mfma_f32_16x16x32_bf16 v[72:75], a[8:11], a[60:63], v[72:75]
 ds_read_b128 a[180:183], v227 offset:2048
 v_mfma_f32_16x16x32_bf16 v[76:79], a[12:15], a[60:63], v[76:79]
 ds_read_b128 a[184:187], v228 offset:2048
 v_cvt_pk_bf16_f32 v64, v64, v65
 v_mfma_f32_16x16x32_bf16 v[0:3], a[0:3], a[60:63], v[0:3]
 v_mfma_f32_16x16x32_bf16 v[4:7], a[4:7], a[60:63], v[4:7]
 ds_read_b128 a[188:191], v225 offset:2048
 v_cvt_pk_bf16_f32 v65, v66, v67
 v_mfma_f32_16x16x32_bf16 v[140:143], a[60:63], a[16:19], v[140:143]
 v_mfma_f32_16x16x32_bf16 v[176:179], a[60:63], a[20:23], v[176:179]
 ds_read_b128 a[192:195], v226 offset:2048
 v_mfma_f32_16x16x32_bf16 v[72:75], a[32:35], a[64:67], v[72:75]
 v_cvt_pk_bf16_f32 v66, v68, v69
 v_mfma_f32_16x16x32_bf16 v[76:79], a[36:39], a[64:67], v[76:79]
 v_mfma_f32_16x16x32_bf16 v[0:3], a[24:27], a[64:67], v[0:3]
 v_mfma_f32_16x16x32_bf16 v[4:7], a[28:31], a[64:67], v[4:7]
 v_cvt_pk_bf16_f32 v67, v70, v71
 v_mfma_f32_16x16x32_bf16 v[140:143], a[64:67], a[40:43], v[140:143]
 v_mfma_f32_16x16x32_bf16 v[176:179], a[64:67], a[44:47], v[176:179]
 v_mfma_f32_16x16x32_bf16 v[72:75], a[128:131], a[68:71], v[72:75]
 v_cvt_pk_bf16_f32 v136, v136, v137
 v_mfma_f32_16x16x32_bf16 v[76:79], a[132:135], a[68:71], v[76:79]
 v_mfma_f32_16x16x32_bf16 v[0:3], a[120:123], a[68:71], v[0:3]
 v_mfma_f32_16x16x32_bf16 v[4:7], a[124:127], a[68:71], v[4:7]
 v_cvt_pk_bf16_f32 v137, v138, v139
 v_mfma_f32_16x16x32_bf16 v[140:143], a[68:71], a[136:139], v[140:143]
 v_mfma_f32_16x16x32_bf16 v[176:179], a[68:71], a[140:143], v[176:179]
 v_mfma_f32_16x16x32_bf16 v[72:75], a[152:155], a[72:75], v[72:75]
 v_cvt_pk_bf16_f32 v172, v172, v173
 v_mfma_f32_16x16x32_bf16 v[76:79], a[156:159], a[72:75], v[76:79]
 v_mfma_f32_16x16x32_bf16 v[0:3], a[144:147], a[72:75], v[0:3]
 v_mfma_f32_16x16x32_bf16 v[4:7], a[148:151], a[72:75], v[4:7]
 v_cvt_pk_bf16_f32 v173, v174, v175
 v_mfma_f32_16x16x32_bf16 v[140:143], a[72:75], a[160:163], v[140:143]
 v_mfma_f32_16x16x32_bf16 v[176:179], a[72:75], a[164:167], v[176:179]
 s_waitcnt lgkmcnt(0)
 v_mfma_f32_16x16x32_bf16 v[80:83], a[8:11], a[180:183], v[80:83]
 ds_read_b128 a[60:63], v227 offset:4096
 v_mfma_f32_16x16x32_bf16 v[84:87], a[12:15], a[180:183], v[84:87]
 ds_read_b128 a[64:67], v228 offset:4096
 v_cvt_pk_bf16_f32 v72, v72, v73
 v_mfma_f32_16x16x32_bf16 v[8:11], a[0:3], a[180:183], v[8:11]
 v_cvt_pk_bf16_f32 v73, v74, v75
 v_mfma_f32_16x16x32_bf16 v[12:15], a[4:7], a[180:183], v[12:15]
 ds_read_b128 a[68:71], v225 offset:4096
 v_cvt_pk_bf16_f32 v74, v76, v77
 v_mfma_f32_16x16x32_bf16 v[144:147], a[180:183], a[16:19], v[144:147]
 v_mfma_f32_16x16x32_bf16 v[180:183], a[180:183], a[20:23], v[180:183]
 ds_read_b128 a[72:75], v226 offset:4096
 v_cvt_pk_bf16_f32 v75, v78, v79
 v_mfma_f32_16x16x32_bf16 v[80:83], a[32:35], a[184:187], v[80:83]
 s_add_u32 m0, s44, 0
 s_add_u32 s78, s46, 0
 buffer_load_dwordx4 v252, s[16:19], s78 offen offset:2048  lds
 v_mfma_f32_16x16x32_bf16 v[84:87], a[36:39], a[184:187], v[84:87]
 v_mfma_f32_16x16x32_bf16 v[8:11], a[24:27], a[184:187], v[8:11]
 v_cvt_pk_bf16_f32 v0, v0, v1
 v_mfma_f32_16x16x32_bf16 v[12:15], a[28:31], a[184:187], v[12:15]
 v_cvt_pk_bf16_f32 v1, v2, v3
 v_mfma_f32_16x16x32_bf16 v[144:147], a[184:187], a[40:43], v[144:147]
 v_mfma_f32_16x16x32_bf16 v[180:183], a[184:187], a[44:47], v[180:183]
 v_cvt_pk_bf16_f32 v2, v4, v5
 v_mfma_f32_16x16x32_bf16 v[80:83], a[128:131], a[188:191], v[80:83]
 v_cvt_pk_bf16_f32 v3, v6, v7
 v_mfma_f32_16x16x32_bf16 v[84:87], a[132:135], a[188:191], v[84:87]
 v_cvt_pk_bf16_f32 v138, v140, v141
 v_mfma_f32_16x16x32_bf16 v[8:11], a[120:123], a[188:191], v[8:11]
 v_mfma_f32_16x16x32_bf16 v[12:15], a[124:127], a[188:191], v[12:15]
 buffer_load_dwordx4 v253, s[16:19], s78 offen offset:3072  lds
 v_mfma_f32_16x16x32_bf16 v[144:147], a[188:191], a[136:139], v[144:147]
 v_cvt_pk_bf16_f32 v139, v142, v143
 v_mfma_f32_16x16x32_bf16 v[180:183], a[188:191], a[140:143], v[180:183]
 v_mfma_f32_16x16x32_bf16 v[80:83], a[152:155], a[192:195], v[80:83]
 v_cvt_pk_bf16_f32 v174, v176, v177
 v_mfma_f32_16x16x32_bf16 v[84:87], a[156:159], a[192:195], v[84:87]
 v_cvt_pk_bf16_f32 v175, v178, v179
 v_mfma_f32_16x16x32_bf16 v[8:11], a[144:147], a[192:195], v[8:11]
 v_mfma_f32_16x16x32_bf16 v[12:15], a[148:151], a[192:195], v[12:15]
 v_mfma_f32_16x16x32_bf16 v[4:7], v[64:67], v[0:3], 0
 v_mfma_f32_16x16x32_bf16 v[144:147], a[192:195], a[160:163], v[144:147]
 v_mfma_f32_16x16x32_bf16 v[76:79], v[72:75], v[0:3], 0
 v_mfma_f32_16x16x32_bf16 v[180:183], a[192:195], a[164:167], v[180:183]
 s_waitcnt lgkmcnt(0)
 v_mfma_f32_16x16x32_bf16 v[88:91], a[8:11], a[60:63], v[88:91]
 ds_read_b128 a[180:183], v227 offset:6144
 v_mfma_f32_16x16x32_bf16 v[92:95], a[12:15], a[60:63], v[92:95]
 ds_read_b128 a[184:187], v228 offset:6144
 v_cvt_pk_bf16_f32 v80, v80, v81
 v_mfma_f32_16x16x32_bf16 v[16:19], a[0:3], a[60:63], v[16:19]
 v_cvt_pk_bf16_f32 v81, v82, v83
 v_mfma_f32_16x16x32_bf16 v[20:23], a[4:7], a[60:63], v[20:23]
 ds_read_b128 a[188:191], v225 offset:6144
 v_cvt_pk_bf16_f32 v82, v84, v85
 v_mfma_f32_16x16x32_bf16 v[148:151], a[60:63], a[16:19], v[148:151]
 v_mfma_f32_16x16x32_bf16 v[184:187], a[60:63], a[20:23], v[184:187]
 ds_read_b128 a[192:195], v226 offset:6144
 v_cvt_pk_bf16_f32 v83, v86, v87
 v_mfma_f32_16x16x32_bf16 v[88:91], a[32:35], a[64:67], v[88:91]
 s_add_u32 m0, s44, 16384
 s_add_u32 s78, s46, 65536
 buffer_load_dwordx4 v252, s[16:19], s78 offen offset:2048  lds
 v_mfma_f32_16x16x32_bf16 v[92:95], a[36:39], a[64:67], v[92:95]
 v_mfma_f32_16x16x32_bf16 v[16:19], a[24:27], a[64:67], v[16:19]
 v_cvt_pk_bf16_f32 v8, v8, v9
 v_mfma_f32_16x16x32_bf16 v[20:23], a[28:31], a[64:67], v[20:23]
 v_cvt_pk_bf16_f32 v9, v10, v11
 v_mfma_f32_16x16x32_bf16 v[148:151], a[64:67], a[40:43], v[148:151]
 v_mfma_f32_16x16x32_bf16 v[184:187], a[64:67], a[44:47], v[184:187]
 v_cvt_pk_bf16_f32 v10, v12, v13
 v_mfma_f32_16x16x32_bf16 v[88:91], a[128:131], a[68:71], v[88:91]
 v_cvt_pk_bf16_f32 v11, v14, v15
 v_mfma_f32_16x16x32_bf16 v[92:95], a[132:135], a[68:71], v[92:95]
 v_cvt_pk_bf16_f32 v140, v144, v145
 v_mfma_f32_16x16x32_bf16 v[16:19], a[120:123], a[68:71], v[16:19]
 v_mfma_f32_16x16x32_bf16 v[20:23], a[124:127], a[68:71], v[20:23]
 buffer_load_dwordx4 v253, s[16:19], s78 offen offset:3072  lds
 v_mfma_f32_16x16x32_bf16 v[148:151], a[68:71], a[136:139], v[148:151]
 v_cvt_pk_bf16_f32 v141, v146, v147
 v_mfma_f32_16x16x32_bf16 v[184:187], a[68:71], a[140:143], v[184:187]
 v_mfma_f32_16x16x32_bf16 v[88:91], a[152:155], a[72:75], v[88:91]
 v_cvt_pk_bf16_f32 v176, v180, v181
 v_mfma_f32_16x16x32_bf16 v[92:95], a[156:159], a[72:75], v[92:95]
 v_cvt_pk_bf16_f32 v177, v182, v183
 v_mfma_f32_16x16x32_bf16 v[16:19], a[144:147], a[72:75], v[16:19]
 v_mfma_f32_16x16x32_bf16 v[20:23], a[148:151], a[72:75], v[20:23]
 v_mfma_f32_16x16x32_bf16 v[12:15], v[72:75], v[8:11], 0
 v_mfma_f32_16x16x32_bf16 v[148:151], a[72:75], a[160:163], v[148:151]
 v_mfma_f32_16x16x32_bf16 v[84:87], v[80:83], v[8:11], 0
 v_mfma_f32_16x16x32_bf16 v[184:187], a[72:75], a[164:167], v[184:187]
 s_waitcnt lgkmcnt(0)
 v_mfma_f32_16x16x32_bf16 v[96:99], a[8:11], a[180:183], v[96:99]
 ds_read_b128 a[60:63], v227 offset:8192
 v_mfma_f32_16x16x32_bf16 v[100:103], a[12:15], a[180:183], v[100:103]
 ds_read_b128 a[64:67], v228 offset:8192
 v_cndmask_b32 v4, v4, v5, s[56:57]
 v_cndmask_b32 v12, v12, v13, s[56:57]
 v_cvt_pk_bf16_f32 v88, v88, v89
 v_mfma_f32_16x16x32_bf16 v[24:27], a[0:3], a[180:183], v[24:27]
 v_cndmask_b32 v5, v6, v7, s[56:57]
 v_cndmask_b32 v13, v14, v15, s[56:57]
 v_mfma_f32_16x16x32_bf16 v[28:31], a[4:7], a[180:183], v[28:31]
 ds_read_b128 a[68:71], v225 offset:8192
 v_cndmask_b32 v76, v76, v77, s[56:57]
 v_cvt_pk_bf16_f32 v89, v90, v91
 v_cndmask_b32 v84, v84, v85, s[56:57]
 v_mfma_f32_16x16x32_bf16 v[152:155], a[180:183], a[16:19], v[152:155]
 v_cndmask_b32 v77, v78, v79, s[56:57]
 v_cndmask_b32 v85, v86, v87, s[56:57]
 v_mfma_f32_16x16x32_bf16 v[188:191], a[180:183], a[20:23], v[188:191]
 ds_read_b128 a[72:75], v226 offset:8192
 v_cvt_pk_bf16_f32 v90, v92, v93
 v_cndmask_b32 v4, v4, v76, s[58:59]
 v_mfma_f32_16x16x32_bf16 v[96:99], a[32:35], a[184:187], v[96:99]
 v_cndmask_b32 v12, v12, v84, s[58:59]
 v_cvt_pk_bf16_f32 v91, v94, v95
 v_cndmask_b32 v5, v5, v77, s[60:61]
 v_mfma_f32_16x16x32_bf16 v[100:103], a[36:39], a[184:187], v[100:103]
 v_cndmask_b32 v13, v13, v85, s[60:61]
 v_cvt_pk_bf16_f32 v76, v4, v5
 v_mfma_f32_16x16x32_bf16 v[24:27], a[24:27], a[184:187], v[24:27]
 s_add_u32 m0, s44, 32768
 s_add_u32 s78, s46, 131072
 buffer_load_dwordx4 v252, s[16:19], s78 offen offset:2048  lds
 v_cvt_pk_bf16_f32 v16, v16, v17
 v_mfma_f32_16x16x32_bf16 v[28:31], a[28:31], a[184:187], v[28:31]
 v_cvt_pk_bf16_f32 v84, v12, v13
 v_lshlrev_b32 v4, 16, v76
 v_lshlrev_b32 v12, 16, v84
 v_mfma_f32_16x16x32_bf16 v[152:155], a[184:187], a[40:43], v[152:155]
 v_cvt_pk_bf16_f32 v17, v18, v19
 v_and_b32 v5, s68, v76
 v_mfma_f32_16x16x32_bf16 v[188:191], a[184:187], a[44:47], v[188:191]
 v_and_b32 v13, s68, v84
 v_cvt_pk_bf16_f32 v18, v20, v21
 v_mfma_f32_16x16x32_bf16 v[96:99], a[128:131], a[188:191], v[96:99]
 v_mul_f32 v4, s69, v4
 v_mul_f32 v12, s69, v12
 v_mul_f32 v5, s69, v5
 v_mfma_f32_16x16x32_bf16 v[100:103], a[132:135], a[188:191], v[100:103]
 v_cvt_pk_bf16_f32 v19, v22, v23
 v_mul_f32 v13, s69, v13
 v_mfma_f32_16x16x32_bf16 v[24:27], a[120:123], a[188:191], v[24:27]
 v_cvt_pk_bf16_f32 v76, v4, v5
 v_cvt_pk_bf16_f32 v84, v12, v13
 v_mfma_f32_16x16x32_bf16 v[28:31], a[124:127], a[188:191], v[28:31]
 v_cvt_pk_bf16_f32 v142, v148, v149
 v_lshlrev_b32 v4, 16, v76
 buffer_load_dwordx4 v253, s[16:19], s78 offen offset:3072  lds
 v_mfma_f32_16x16x32_bf16 v[152:155], a[188:191], a[136:139], v[152:155]
 v_lshlrev_b32 v12, 16, v84
 v_and_b32 v5, s68, v76
 v_mfma_f32_16x16x32_bf16 v[188:191], a[188:191], a[140:143], v[188:191]
 v_cvt_pk_bf16_f32 v143, v150, v151
 v_and_b32 v13, s68, v84
 v_mfma_f32_16x16x32_bf16 v[96:99], a[152:155], a[192:195], v[96:99]
 v_cndmask_b32 v4, v4, v237, s[64:65]
 v_cvt_pk_bf16_f32 v178, v184, v185
 v_cndmask_b32 v5, v5, v237, s[66:67]
 v_mfma_f32_16x16x32_bf16 v[100:103], a[156:159], a[192:195], v[100:103]
 v_max_f32 v76, v4, v5
 v_max_f32 v84, v12, v13
 v_mfma_f32_16x16x32_bf16 v[24:27], a[144:147], a[192:195], v[24:27]
 v_cvt_pk_bf16_f32 v179, v186, v187
 v_permlane32_swap_b32 v76, v84
 v_mfma_f32_16x16x32_bf16 v[28:31], a[148:151], a[192:195], v[28:31]
 v_max_f32 v76, v76, v84
 v_mov_b32 v84, v76
 v_mfma_f32_16x16x32_bf16 v[20:23], v[80:83], v[16:19], 0
 v_mfma_f32_16x16x32_bf16 v[152:155], a[192:195], a[160:163], v[152:155]
 v_permlane16_swap_b32 v76, v84
 v_max_f32 v76, v76, v84
 v_mfma_f32_16x16x32_bf16 v[188:191], a[192:195], a[164:167], v[188:191]
 v_mfma_f32_16x16x32_bf16 v[92:95], v[88:91], v[16:19], 0
 v_mul_f32 v76, s70, v76
 s_waitcnt lgkmcnt(0)
 v_mfma_f32_16x16x32_bf16 v[104:107], a[8:11], a[60:63], v[104:107]
 ds_read_b128 a[180:183], v227 offset:10240
 v_mfma_f32_16x16x32_bf16 v[108:111], a[12:15], a[60:63], v[108:111]
 ds_read_b128 a[184:187], v228 offset:10240
 v_mov_b32 v84, v76
    s_nop 1
 v_permlane32_swap_b32 v76, v84
 v_cvt_pk_bf16_f32 v96, v96, v97
 v_mfma_f32_16x16x32_bf16 v[32:35], a[0:3], a[60:63], v[32:35]
 v_fma_f32 v4, v4, s70, -v76
 v_fma_f32 v5, v5, s70, -v76
 v_mfma_f32_16x16x32_bf16 v[36:39], a[4:7], a[60:63], v[36:39]
 ds_read_b128 a[188:191], v225 offset:10240
 v_fma_f32 v12, v12, s70, -v84
 v_cvt_pk_bf16_f32 v97, v98, v99
 v_fma_f32 v13, v13, s70, -v84
 v_mfma_f32_16x16x32_bf16 v[156:159], a[60:63], a[16:19], v[156:159]
 v_exp_f32 v4, v4
 v_exp_f32 v5, v5
 v_mfma_f32_16x16x32_bf16 v[192:195], a[60:63], a[20:23], v[192:195]
 ds_read_b128 a[192:195], v226 offset:10240
 v_cvt_pk_bf16_f32 v98, v100, v101
 v_exp_f32 v12, v12
 v_mfma_f32_16x16x32_bf16 v[104:107], a[32:35], a[64:67], v[104:107]
 v_exp_f32 v13, v13
 v_cvt_pk_bf16_f32 v99, v102, v103
 v_add_f32 v76, v4, v5
 v_mfma_f32_16x16x32_bf16 v[108:111], a[36:39], a[64:67], v[108:111]
 v_add_f32 v84, v12, v13
    s_nop 1
 v_permlane32_swap_b32 v76, v84
 v_mfma_f32_16x16x32_bf16 v[32:35], a[24:27], a[64:67], v[32:35]
 s_add_u32 m0, s44, 98304
 s_add_u32 s78, s46, 393216
 buffer_load_dwordx4 v252, s[16:19], s78 offen offset:2048  lds
 v_cvt_pk_bf16_f32 v24, v24, v25
 v_mfma_f32_16x16x32_bf16 v[36:39], a[28:31], a[64:67], v[36:39]
 v_add_f32 v76, v76, v84
 v_mov_b32 v84, v76
    s_nop 1
 v_permlane16_swap_b32 v76, v84
 v_mfma_f32_16x16x32_bf16 v[156:159], a[64:67], a[40:43], v[156:159]
 v_cvt_pk_bf16_f32 v25, v26, v27
 v_add_f32 v76, v76, v84
 v_mfma_f32_16x16x32_bf16 v[192:195], a[64:67], a[44:47], v[192:195]
 v_rcp_f32 v76, v76
 v_cvt_pk_bf16_f32 v26, v28, v29
 v_mfma_f32_16x16x32_bf16 v[104:107], a[128:131], a[68:71], v[104:107]
 v_mov_b32 v84, v76
    s_nop 1
 v_permlane32_swap_b32 v76, v84
 v_mul_f32 v4, v4, v76
 v_mfma_f32_16x16x32_bf16 v[108:111], a[132:135], a[68:71], v[108:111]
 v_cvt_pk_bf16_f32 v27, v30, v31
 v_mul_f32 v5, v5, v76
 v_mfma_f32_16x16x32_bf16 v[32:35], a[120:123], a[68:71], v[32:35]
 v_mul_f32 v12, v12, v84
 v_mul_f32 v13, v13, v84
 v_mfma_f32_16x16x32_bf16 v[36:39], a[124:127], a[68:71], v[36:39]
 v_cvt_pk_bf16_f32 v144, v152, v153
 v_cvt_pk_bf16_f32 v76, v4, v5
 buffer_load_dwordx4 v253, s[16:19], s78 offen offset:3072  lds
 v_mfma_f32_16x16x32_bf16 v[156:159], a[68:71], a[136:139], v[156:159]
 v_cvt_pk_bf16_f32 v84, v12, v13
 v_perm_b32 v4, v76, v76, v239
 v_mfma_f32_16x16x32_bf16 v[192:195], a[68:71], a[140:143], v[192:195]
 v_cvt_pk_bf16_f32 v145, v154, v155
 v_perm_b32 v12, v84, v84, v239
 v_mfma_f32_16x16x32_bf16 v[104:107], a[152:155], a[72:75], v[104:107]
 v_perm_b32 v5, v76, v76, v240
 v_cvt_pk_bf16_f32 v180, v188, v189
 v_perm_b32 v13, v84, v84, v240
 v_mfma_f32_16x16x32_bf16 v[108:111], a[156:159], a[72:75], v[108:111]
 v_perm_b32 v6, v76, v76, v241
 v_perm_b32 v14, v84, v84, v241
 v_mfma_f32_16x16x32_bf16 v[32:35], a[144:147], a[72:75], v[32:35]
 v_cvt_pk_bf16_f32 v181, v190, v191
 v_perm_b32 v7, v76, v76, v242
 v_mfma_f32_16x16x32_bf16 v[36:39], a[148:151], a[72:75], v[36:39]
 v_perm_b32 v15, v84, v84, v242
 v_mfma_f32_16x16x32_bf16 v[0:3], v[136:139], v[4:7], 0
 v_mfma_f32_16x16x32_bf16 v[28:31], v[88:91], v[24:27], 0
 v_mfma_f32_16x16x32_bf16 v[156:159], a[72:75], a[160:163], v[156:159]
 v_mfma_f32_16x16x32_bf16 v[76:79], v[172:175], v[4:7], 0
 v_mfma_f32_16x16x32_bf16 v[8:11], v[138:141], v[12:15], 0
 v_mfma_f32_16x16x32_bf16 v[192:195], a[72:75], a[164:167], v[192:195]
 v_mfma_f32_16x16x32_bf16 v[100:103], v[96:99], v[24:27], 0
 v_mfma_f32_16x16x32_bf16 v[84:87], v[174:177], v[12:15], 0
 s_waitcnt lgkmcnt(0)
 v_mfma_f32_16x16x32_bf16 v[112:115], a[8:11], a[180:183], v[112:115]
 ds_read_b128 a[60:63], v227 offset:12288
 v_mfma_f32_16x16x32_bf16 v[116:119], a[12:15], a[180:183], v[116:119]
 ds_read_b128 a[64:67], v228 offset:12288
 v_cndmask_b32 v20, v20, v21, s[56:57]
 v_cndmask_b32 v28, v28, v29, s[56:57]
 v_cvt_pk_bf16_f32 v104, v104, v105
 v_mfma_f32_16x16x32_bf16 v[40:43], a[0:3], a[180:183], v[40:43]
 v_cndmask_b32 v21, v22, v23, s[56:57]
 v_cndmask_b32 v29, v30, v31, s[56:57]
 v_cvt_pk_bf16_f32 v0, v0, v1
 v_mfma_f32_16x16x32_bf16 v[44:47], a[4:7], a[180:183], v[44:47]
 ds_read_b128 a[68:71], v225 offset:12288
 v_cndmask_b32 v92, v92, v93, s[56:57]
 v_cvt_pk_bf16_f32 v105, v106, v107
 v_mfma_f32_16x16x32_bf16 v[160:163], a[180:183], a[16:19], v[160:163]
 v_cndmask_b32 v100, v100, v101, s[56:57]
 v_cndmask_b32 v93, v94, v95, s[56:57]
 v_cvt_pk_bf16_f32 v106, v108, v109
 v_mfma_f32_16x16x32_bf16 v[196:199], a[180:183], a[20:23], v[196:199]
 ds_read_b128 a[72:75], v226 offset:12288
 v_cndmask_b32 v101, v102, v103, s[56:57]
 v_cvt_pk_bf16_f32 v1, v2, v3
 v_cndmask_b32 v20, v20, v92, s[58:59]
 v_mfma_f32_16x16x32_bf16 v[112:115], a[32:35], a[184:187], v[112:115]
 v_cndmask_b32 v28, v28, v100, s[58:59]
 v_cvt_pk_bf16_f32 v107, v110, v111
 v_mfma_f32_16x16x32_bf16 v[116:119], a[36:39], a[184:187], v[116:119]
 v_cndmask_b32 v21, v21, v93, s[60:61]
 v_cndmask_b32 v29, v29, v101, s[60:61]
 v_cvt_pk_bf16_f32 v2, v76, v77
 v_mfma_f32_16x16x32_bf16 v[40:43], a[24:27], a[184:187], v[40:43]
 v_cvt_pk_bf16_f32 v92, v20, v21
 v_cvt_pk_bf16_f32 v32, v32, v33
 v_cvt_pk_bf16_f32 v100, v28, v29
 v_mfma_f32_16x16x32_bf16 v[44:47], a[28:31], a[184:187], v[44:47]
 v_lshlrev_b32 v20, 16, v92
 v_cvt_pk_bf16_f32 v3, v78, v79
 v_mfma_f32_16x16x32_bf16 v[160:163], a[184:187], a[40:43], v[160:163]
 v_cvt_pk_bf16_f32 v33, v34, v35
 v_lshlrev_b32 v28, 16, v100
 v_and_b32 v21, s68, v92
 v_mfma_f32_16x16x32_bf16 v[196:199], a[184:187], a[44:47], v[196:199]
 v_and_b32 v29, s68, v100
 v_cvt_pk_bf16_f32 v34, v36, v37
 v_mul_f32 v20, s69, v20
 v_mfma_f32_16x16x32_bf16 v[112:115], a[128:131], a[188:191], v[112:115]
 buffer_store_dwordx4 v[0:3], v232, s[20:23], s40 offen offset:0 sc1
 v_mul_f32 v28, s69, v28
 v_mfma_f32_16x16x32_bf16 v[116:119], a[132:135], a[188:191], v[116:119]
 v_mul_f32 v21, s69, v21
 v_cvt_pk_bf16_f32 v35, v38, v39
 v_mul_f32 v29, s69, v29
 v_mfma_f32_16x16x32_bf16 v[40:43], a[120:123], a[188:191], v[40:43]
 v_cvt_pk_bf16_f32 v92, v20, v21
 v_cvt_pk_bf16_f32 v8, v8, v9
 v_cvt_pk_bf16_f32 v146, v156, v157
 v_mfma_f32_16x16x32_bf16 v[44:47], a[124:127], a[188:191], v[44:47]
 v_cvt_pk_bf16_f32 v100, v28, v29
 v_lshlrev_b32 v20, 16, v92
 v_mfma_f32_16x16x32_bf16 v[160:163], a[188:191], a[136:139], v[160:163]
 v_lshlrev_b32 v28, 16, v100
 v_cvt_pk_bf16_f32 v9, v10, v11
 v_cvt_pk_bf16_f32 v147, v158, v159
 v_mfma_f32_16x16x32_bf16 v[196:199], a[188:191], a[140:143], v[196:199]
 v_and_b32 v21, s68, v92
 v_and_b32 v29, s68, v100
 v_max_f32 v92, v20, v21
 v_mfma_f32_16x16x32_bf16 v[112:115], a[152:155], a[192:195], v[112:115]
 v_cvt_pk_bf16_f32 v182, v192, v193
 v_max_f32 v100, v28, v29
 v_mfma_f32_16x16x32_bf16 v[116:119], a[156:159], a[192:195], v[116:119]
 v_cvt_pk_bf16_f32 v10, v84, v85
 v_permlane32_swap_b32 v92, v100
 v_cvt_pk_bf16_f32 v183, v194, v195
 v_mfma_f32_16x16x32_bf16 v[40:43], a[144:147], a[192:195], v[40:43]
 v_max_f32 v92, v92, v100
 v_mov_b32 v100, v92
    s_nop 1
 v_permlane16_swap_b32 v92, v100
 v_mfma_f32_16x16x32_bf16 v[44:47], a[148:151], a[192:195], v[44:47]
 v_cvt_pk_bf16_f32 v11, v86, v87
 v_mfma_f32_16x16x32_bf16 v[36:39], v[96:99], v[32:35], 0
 v_mfma_f32_16x16x32_bf16 v[160:163], a[192:195], a[160:163], v[160:163]
 v_max_f32 v92, v92, v100
 v_mul_f32 v92, s70, v92
 v_mfma_f32_16x16x32_bf16 v[108:111], v[104:107], v[32:35], 0
 v_mfma_f32_16x16x32_bf16 v[196:199], a[192:195], a[164:167], v[196:199]
 v_mov_b32 v100, v92
 buffer_store_dwordx4 v[8:11], v232, s[20:23], s40 offen offset:1024 sc1
 s_waitcnt lgkmcnt(0)
 v_mfma_f32_16x16x32_bf16 v[120:123], a[8:11], a[60:63], v[120:123]
 ds_read_b128 a[180:183], v227 offset:14336
 v_mfma_f32_16x16x32_bf16 v[124:127], a[12:15], a[60:63], v[124:127]
 ds_read_b128 a[184:187], v228 offset:14336
 v_permlane32_swap_b32 v92, v100
 v_fma_f32 v20, v20, s70, -v92
 v_cvt_pk_bf16_f32 v112, v112, v113
 v_mfma_f32_16x16x32_bf16 v[48:51], a[0:3], a[60:63], v[48:51]
 v_fma_f32 v21, v21, s70, -v92
 v_fma_f32 v28, v28, s70, -v100
 v_mfma_f32_16x16x32_bf16 v[52:55], a[4:7], a[60:63], v[52:55]
 ds_read_b128 a[188:191], v225 offset:14336
 v_fma_f32 v29, v29, s70, -v100
 v_cvt_pk_bf16_f32 v113, v114, v115
 v_mfma_f32_16x16x32_bf16 v[164:167], a[60:63], a[16:19], v[164:167]
 v_exp_f32 v20, v20
 v_exp_f32 v21, v21
 v_mfma_f32_16x16x32_bf16 v[200:203], a[60:63], a[20:23], v[200:203]
 ds_read_b128 a[192:195], v226 offset:14336
 v_cvt_pk_bf16_f32 v114, v116, v117
 v_exp_f32 v28, v28
 v_exp_f32 v29, v29
 v_mfma_f32_16x16x32_bf16 v[120:123], a[32:35], a[64:67], v[120:123]
 v_add_f32 v92, v20, v21
 v_cvt_pk_bf16_f32 v115, v118, v119
 v_mfma_f32_16x16x32_bf16 v[124:127], a[36:39], a[64:67], v[124:127]
 v_add_f32 v100, v28, v29
    s_nop 1
 v_permlane32_swap_b32 v92, v100
 v_mfma_f32_16x16x32_bf16 v[48:51], a[24:27], a[64:67], v[48:51]
 v_add_f32 v92, v92, v100
 v_cvt_pk_bf16_f32 v40, v40, v41
 v_mfma_f32_16x16x32_bf16 v[52:55], a[28:31], a[64:67], v[52:55]
 v_mov_b32 v100, v92
    s_nop 1
 v_permlane16_swap_b32 v92, v100
 v_mfma_f32_16x16x32_bf16 v[164:167], a[64:67], a[40:43], v[164:167]
 v_cvt_pk_bf16_f32 v41, v42, v43
 v_add_f32 v92, v92, v100
 v_rcp_f32 v92, v92
 v_mfma_f32_16x16x32_bf16 v[200:203], a[64:67], a[44:47], v[200:203]
 v_mov_b32 v100, v92
 v_cvt_pk_bf16_f32 v42, v44, v45
 v_mfma_f32_16x16x32_bf16 v[120:123], a[128:131], a[68:71], v[120:123]
 v_permlane32_swap_b32 v92, v100
 v_mul_f32 v20, v20, v92
 v_mfma_f32_16x16x32_bf16 v[124:127], a[132:135], a[68:71], v[124:127]
 v_mul_f32 v21, v21, v92
 v_cvt_pk_bf16_f32 v43, v46, v47
 v_mfma_f32_16x16x32_bf16 v[48:51], a[120:123], a[68:71], v[48:51]
 v_mul_f32 v28, v28, v100
 v_mul_f32 v29, v29, v100
 v_cvt_pk_bf16_f32 v148, v160, v161
 v_mfma_f32_16x16x32_bf16 v[52:55], a[124:127], a[68:71], v[52:55]
 v_cvt_pk_bf16_f32 v92, v20, v21
 v_cvt_pk_bf16_f32 v100, v28, v29
 v_mfma_f32_16x16x32_bf16 v[164:167], a[68:71], a[136:139], v[164:167]
 v_perm_b32 v20, v92, v92, v239
 v_cvt_pk_bf16_f32 v149, v162, v163
 v_mfma_f32_16x16x32_bf16 v[200:203], a[68:71], a[140:143], v[200:203]
 v_perm_b32 v28, v100, v100, v239
 v_perm_b32 v21, v92, v92, v240
 v_mfma_f32_16x16x32_bf16 v[120:123], a[152:155], a[72:75], v[120:123]
 v_perm_b32 v29, v100, v100, v240
 v_cvt_pk_bf16_f32 v184, v196, v197
 v_mfma_f32_16x16x32_bf16 v[124:127], a[156:159], a[72:75], v[124:127]
 v_perm_b32 v22, v92, v92, v241
 v_perm_b32 v30, v100, v100, v241
 v_cvt_pk_bf16_f32 v185, v198, v199
 v_mfma_f32_16x16x32_bf16 v[48:51], a[144:147], a[72:75], v[48:51]
 v_perm_b32 v23, v92, v92, v242
 v_perm_b32 v31, v100, v100, v242
 v_mfma_f32_16x16x32_bf16 v[52:55], a[148:151], a[72:75], v[52:55]
 v_mfma_f32_16x16x32_bf16 v[16:19], v[140:143], v[20:23], 0
 v_mfma_f32_16x16x32_bf16 v[44:47], v[104:107], v[40:43], 0
 v_mfma_f32_16x16x32_bf16 v[164:167], a[72:75], a[160:163], v[164:167]
 v_mfma_f32_16x16x32_bf16 v[92:95], v[176:179], v[20:23], 0
 v_mfma_f32_16x16x32_bf16 v[24:27], v[142:145], v[28:31], 0
 v_mfma_f32_16x16x32_bf16 v[200:203], a[72:75], a[164:167], v[200:203]
 v_mfma_f32_16x16x32_bf16 v[116:119], v[112:115], v[40:43], 0
 v_mfma_f32_16x16x32_bf16 v[100:103], v[178:181], v[28:31], 0
 s_waitcnt lgkmcnt(0)
 v_mfma_f32_16x16x32_bf16 v[128:131], a[8:11], a[180:183], v[128:131]
 v_mfma_f32_16x16x32_bf16 v[132:135], a[12:15], a[180:183], v[132:135]
 v_cndmask_b32 v36, v36, v37, s[56:57]
 v_cndmask_b32 v44, v44, v45, s[56:57]
 v_cvt_pk_bf16_f32 v120, v120, v121
 v_mfma_f32_16x16x32_bf16 v[56:59], a[0:3], a[180:183], v[56:59]
 v_cndmask_b32 v37, v38, v39, s[56:57]
 v_cndmask_b32 v45, v46, v47, s[56:57]
 v_cvt_pk_bf16_f32 v16, v16, v17
 v_mfma_f32_16x16x32_bf16 v[60:63], a[4:7], a[180:183], v[60:63]
 v_cndmask_b32 v108, v108, v109, s[56:57]
 v_cvt_pk_bf16_f32 v121, v122, v123
 v_cndmask_b32 v116, v116, v117, s[56:57]
 v_mfma_f32_16x16x32_bf16 v[168:171], a[180:183], a[16:19], v[168:171]
 v_cndmask_b32 v109, v110, v111, s[56:57]
 v_cvt_pk_bf16_f32 v17, v18, v19
 v_mfma_f32_16x16x32_bf16 v[204:207], a[180:183], a[20:23], v[204:207]
 v_cvt_pk_bf16_f32 v122, v124, v125
 v_cndmask_b32 v117, v118, v119, s[56:57]
 v_cndmask_b32 v36, v36, v108, s[58:59]
 v_mfma_f32_16x16x32_bf16 v[128:131], a[32:35], a[184:187], v[128:131]
 v_cndmask_b32 v44, v44, v116, s[58:59]
 v_cvt_pk_bf16_f32 v123, v126, v127
 v_cndmask_b32 v37, v37, v109, s[60:61]
 v_mfma_f32_16x16x32_bf16 v[132:135], a[36:39], a[184:187], v[132:135]
 v_cvt_pk_bf16_f32 v18, v92, v93
 v_cndmask_b32 v45, v45, v117, s[60:61]
 v_mfma_f32_16x16x32_bf16 v[56:59], a[24:27], a[184:187], v[56:59]
 v_cvt_pk_bf16_f32 v108, v36, v37
 v_cvt_pk_bf16_f32 v48, v48, v49
 v_cvt_pk_bf16_f32 v116, v44, v45
 v_mfma_f32_16x16x32_bf16 v[60:63], a[28:31], a[184:187], v[60:63]
 v_cvt_pk_bf16_f32 v19, v94, v95
 v_lshlrev_b32 v36, 16, v108
 v_cvt_pk_bf16_f32 v49, v50, v51
 v_mfma_f32_16x16x32_bf16 v[168:171], a[184:187], a[40:43], v[168:171]
 v_lshlrev_b32 v44, 16, v116
 v_and_b32 v37, s68, v108
 v_mfma_f32_16x16x32_bf16 v[204:207], a[184:187], a[44:47], v[204:207]
 buffer_store_dwordx4 v[16:19], v232, s[20:23], s40 offen offset:2048 sc1
 v_and_b32 v45, s68, v116
 v_cvt_pk_bf16_f32 v50, v52, v53
 v_mfma_f32_16x16x32_bf16 v[128:131], a[128:131], a[188:191], v[128:131]
 v_mul_f32 v36, s69, v36
 v_mul_f32 v44, s69, v44
 v_mul_f32 v37, s69, v37
 v_mfma_f32_16x16x32_bf16 v[132:135], a[132:135], a[188:191], v[132:135]
 v_cvt_pk_bf16_f32 v24, v24, v25
 v_cvt_pk_bf16_f32 v51, v54, v55
 v_mul_f32 v45, s69, v45
 v_mfma_f32_16x16x32_bf16 v[56:59], a[120:123], a[188:191], v[56:59]
 v_cvt_pk_bf16_f32 v108, v36, v37
 v_cvt_pk_bf16_f32 v150, v164, v165
 v_mfma_f32_16x16x32_bf16 v[60:63], a[124:127], a[188:191], v[60:63]
 v_cvt_pk_bf16_f32 v116, v44, v45
 v_cvt_pk_bf16_f32 v25, v26, v27
 v_lshlrev_b32 v36, 16, v108
 v_mfma_f32_16x16x32_bf16 v[168:171], a[188:191], a[136:139], v[168:171]
 v_lshlrev_b32 v44, 16, v116
 v_cvt_pk_bf16_f32 v151, v166, v167
 v_and_b32 v37, s68, v108
 v_mfma_f32_16x16x32_bf16 v[204:207], a[188:191], a[140:143], v[204:207]
 v_cvt_pk_bf16_f32 v26, v100, v101
 v_and_b32 v45, s68, v116
 v_mfma_f32_16x16x32_bf16 v[128:131], a[152:155], a[192:195], v[128:131]
 v_max_f32 v108, v36, v37
 v_cvt_pk_bf16_f32 v186, v200, v201
 v_max_f32 v116, v44, v45
 v_mfma_f32_16x16x32_bf16 v[132:135], a[156:159], a[192:195], v[132:135]
    s_nop 0
 v_permlane32_swap_b32 v108, v116
 v_cvt_pk_bf16_f32 v27, v102, v103
 v_cvt_pk_bf16_f32 v187, v202, v203
 v_mfma_f32_16x16x32_bf16 v[56:59], a[144:147], a[192:195], v[56:59]
 v_max_f32 v108, v108, v116
 v_mov_b32 v116, v108
 v_mfma_f32_16x16x32_bf16 v[60:63], a[148:151], a[192:195], v[60:63]
    s_nop 0
 v_permlane16_swap_b32 v108, v116
 buffer_store_dwordx4 v[24:27], v232, s[20:23], s40 offen offset:3072 sc1
 v_mfma_f32_16x16x32_bf16 v[52:55], v[112:115], v[48:51], 0
 v_mfma_f32_16x16x32_bf16 v[168:171], a[192:195], a[160:163], v[168:171]
 v_max_f32 v108, v108, v116
 v_mul_f32 v108, s70, v108
 v_mfma_f32_16x16x32_bf16 v[124:127], v[120:123], v[48:51], 0
 v_mfma_f32_16x16x32_bf16 v[204:207], a[192:195], a[164:167], v[204:207]
 v_mov_b32 v116, v108
 s_add_u32 s40, s40, 4096
    s_nop 0
 v_permlane32_swap_b32 v108, v116
 v_fma_f32 v36, v36, s70, -v108
 v_cvt_pk_bf16_f32 v128, v128, v129
 v_fma_f32 v37, v37, s70, -v108
 v_fma_f32 v44, v44, s70, -v116
 v_fma_f32 v45, v45, s70, -v116
 v_cvt_pk_bf16_f32 v129, v130, v131
 v_exp_f32 v36, v36
 v_exp_f32 v37, v37
 v_cvt_pk_bf16_f32 v130, v132, v133
 v_exp_f32 v44, v44
 v_exp_f32 v45, v45
 v_add_f32 v108, v36, v37
 v_cvt_pk_bf16_f32 v131, v134, v135
 v_add_f32 v116, v44, v45
    s_nop 1
 v_permlane32_swap_b32 v108, v116
 v_add_f32 v108, v108, v116
 v_cvt_pk_bf16_f32 v56, v56, v57
 v_mov_b32 v116, v108
    s_nop 1
 v_permlane16_swap_b32 v108, v116
 v_cvt_pk_bf16_f32 v57, v58, v59
 v_add_f32 v108, v108, v116
 v_rcp_f32 v108, v108
    s_nop 0
 v_mov_b32 v116, v108
 v_cvt_pk_bf16_f32 v58, v60, v61
    s_nop 0
 v_permlane32_swap_b32 v108, v116
 v_mul_f32 v36, v36, v108
 v_mul_f32 v37, v37, v108
 v_cvt_pk_bf16_f32 v59, v62, v63
 v_mul_f32 v44, v44, v116
 v_mul_f32 v45, v45, v116
 v_cvt_pk_bf16_f32 v152, v168, v169
 v_cvt_pk_bf16_f32 v108, v36, v37
 v_cvt_pk_bf16_f32 v116, v44, v45
 v_perm_b32 v36, v108, v108, v239
 v_cvt_pk_bf16_f32 v153, v170, v171
 v_perm_b32 v44, v116, v116, v239
 v_perm_b32 v37, v108, v108, v240
 v_perm_b32 v45, v116, v116, v240
 v_cvt_pk_bf16_f32 v188, v204, v205
 v_perm_b32 v38, v108, v108, v241
 v_perm_b32 v46, v116, v116, v241
 v_cvt_pk_bf16_f32 v189, v206, v207
 v_perm_b32 v39, v108, v108, v242
 v_perm_b32 v47, v116, v116, v242
    s_nop 0
 v_mfma_f32_16x16x32_bf16 v[32:35], v[144:147], v[36:39], 0
 v_mfma_f32_16x16x32_bf16 v[60:63], v[120:123], v[56:59], 0
 v_mfma_f32_16x16x32_bf16 v[108:111], v[180:183], v[36:39], 0
 v_mfma_f32_16x16x32_bf16 v[40:43], v[146:149], v[44:47], 0
 v_mfma_f32_16x16x32_bf16 v[132:135], v[128:131], v[56:59], 0
 v_mfma_f32_16x16x32_bf16 v[116:119], v[182:185], v[44:47], 0
 v_cndmask_b32 v52, v52, v53, s[56:57]
    s_nop 2
 v_cndmask_b32 v60, v60, v61, s[56:57]
 v_cndmask_b32 v53, v54, v55, s[56:57]
 v_cndmask_b32 v61, v62, v63, s[56:57]
 v_cndmask_b32 v124, v124, v125, s[56:57]
 v_cndmask_b32 v132, v132, v133, s[56:57]
 v_cndmask_b32 v125, v126, v127, s[56:57]
 v_cndmask_b32 v133, v134, v135, s[56:57]
 v_cvt_pk_bf16_f32 v32, v32, v33
 v_cndmask_b32 v52, v52, v124, s[58:59]
 v_cndmask_b32 v60, v60, v132, s[58:59]
 v_cndmask_b32 v53, v53, v125, s[60:61]
 v_cndmask_b32 v61, v61, v133, s[60:61]
 v_cvt_pk_bf16_f32 v124, v52, v53
 v_cvt_pk_bf16_f32 v132, v60, v61
 v_lshlrev_b32 v52, 16, v124
 v_cvt_pk_bf16_f32 v33, v34, v35
 v_lshlrev_b32 v60, 16, v132
 v_and_b32 v53, s68, v124
 v_and_b32 v61, s68, v132
 v_mul_f32 v52, s69, v52
 v_mul_f32 v60, s69, v60
 v_mul_f32 v53, s69, v53
 v_mul_f32 v61, s69, v61
 v_cvt_pk_bf16_f32 v124, v52, v53
 v_cvt_pk_bf16_f32 v34, v108, v109
 v_cvt_pk_bf16_f32 v132, v60, v61
 v_lshlrev_b32 v52, 16, v124
 v_lshlrev_b32 v60, 16, v132
 v_and_b32 v53, s68, v124
 v_and_b32 v61, s68, v132
 v_max_f32 v124, v52, v53
 v_max_f32 v132, v60, v61
 v_cvt_pk_bf16_f32 v35, v110, v111
    s_nop 0
 v_permlane32_swap_b32 v124, v132
 v_max_f32 v124, v124, v132
 v_mov_b32 v132, v124
    s_nop 1
 v_permlane16_swap_b32 v124, v132
 v_max_f32 v124, v124, v132
 v_mul_f32 v124, s70, v124
 v_mov_b32 v132, v124
 buffer_store_dwordx4 v[32:35], v232, s[20:23], s40 offen offset:0 sc1
    s_nop 0
 v_permlane32_swap_b32 v124, v132
 v_fma_f32 v52, v52, s70, -v124
 v_fma_f32 v53, v53, s70, -v124
 v_fma_f32 v60, v60, s70, -v132
 v_fma_f32 v61, v61, s70, -v132
 v_exp_f32 v52, v52
 v_exp_f32 v53, v53
 v_exp_f32 v60, v60
 v_cvt_pk_bf16_f32 v40, v40, v41
 v_exp_f32 v61, v61
 v_add_f32 v124, v52, v53
 v_add_f32 v132, v60, v61
    s_nop 1
 v_permlane32_swap_b32 v124, v132
 v_add_f32 v124, v124, v132
 v_mov_b32 v132, v124
    s_nop 1
 v_permlane16_swap_b32 v124, v132
 v_cvt_pk_bf16_f32 v41, v42, v43
 v_add_f32 v124, v124, v132
 v_rcp_f32 v124, v124
    s_nop 0
 v_mov_b32 v132, v124
    s_nop 1
 v_permlane32_swap_b32 v124, v132
 v_mul_f32 v52, v52, v124
 v_mul_f32 v53, v53, v124
 v_mul_f32 v60, v60, v132
 v_mul_f32 v61, v61, v132
 v_cvt_pk_bf16_f32 v42, v116, v117
 v_cvt_pk_bf16_f32 v124, v52, v53
 v_cvt_pk_bf16_f32 v132, v60, v61
 v_perm_b32 v52, v124, v124, v239
 v_perm_b32 v60, v132, v132, v239
 v_perm_b32 v53, v124, v124, v240
 v_perm_b32 v61, v132, v132, v240
 v_perm_b32 v54, v124, v124, v241
 v_cvt_pk_bf16_f32 v43, v118, v119
 v_perm_b32 v62, v132, v132, v241
 v_perm_b32 v55, v124, v124, v242
 v_perm_b32 v63, v132, v132, v242
    s_nop 0
 v_mfma_f32_16x16x32_bf16 v[48:51], v[148:151], v[52:55], 0
 v_mfma_f32_16x16x32_bf16 v[124:127], v[184:187], v[52:55], 0
 v_mfma_f32_16x16x32_bf16 v[56:59], v[150:153], v[60:63], 0
 v_mfma_f32_16x16x32_bf16 v[132:135], v[186:189], v[60:63], 0
 buffer_store_dwordx4 v[40:43], v232, s[20:23], s40 offen offset:1024 sc1
    s_nop 3
 v_cvt_pk_bf16_f32 v48, v48, v49
 v_cvt_pk_bf16_f32 v49, v50, v51
 v_cvt_pk_bf16_f32 v50, v124, v125
 v_cvt_pk_bf16_f32 v51, v126, v127
 buffer_store_dwordx4 v[48:51], v232, s[20:23], s40 offen offset:2048 sc1
 v_cvt_pk_bf16_f32 v56, v56, v57
 v_cvt_pk_bf16_f32 v57, v58, v59
 v_cvt_pk_bf16_f32 v58, v132, v133
 v_cvt_pk_bf16_f32 v59, v134, v135
 buffer_store_dwordx4 v[56:59], v232, s[20:23], s40 offen offset:3072 sc1
 s_branch L2_start
L1_h:
 s_cmp_lg_u32 s33, 3
 s_cbranch_scc1 L1h_dma
 s_waitcnt lgkmcnt(0)
 s_mov_b32 s12, s4
 s_mov_b32 s13, s5
 s_mov_b32 s16, s8
 s_mov_b32 s17, s9
 s_mov_b32 s18, 0x700000
 s_lshl_b32 s40, s2, 14
 v_lshrrev_b32 v232, 1, v224
 v_lshlrev_b32 v232, 11, v232
 v_and_b32 v233, 1, v224
 v_lshl_add_u32 v232, v233, 6, v232
 v_add_u32 v232, s40, v232
 v_mov_b32 v234, 0x80000000
 v_cmp_gt_u32 vcc, 16, v224
    s_nop 1
 v_cndmask_b32 v239, v234, v232, vcc
 s_lshl_b32 s40, s34, 4
 s_add_u32 s40, s40, s35
 s_mul_i32 s40, s40, 3584
 v_lshl_add_u32 v232, v224, 6, s40
 v_cmp_gt_u32 vcc, 56, v224
    s_nop 1
 v_cndmask_b32 v252, v234, v232, vcc
 s_mov_b32 s74, 0x200000
 s_mov_b32 s75, 0x20000
 s_mov_b32 s76, s10
 s_mov_b32 s77, s11
 s_mov_b32 s78, 0x700000
 s_mov_b32 s79, 0x20000
 s_lshl_b32 s40, s2, 10
 s_mul_i32 s41, s2, 3584
 v_lshlrev_b32 v232, 6, v224
 v_add_u32 v233, s40, v232
 v_cmp_gt_u32 vcc, 16, v224
    s_nop 1
 v_cndmask_b32 v253, v234, v233, vcc
 v_add_u32 v233, s41, v232
 v_cmp_gt_u32 vcc, 56, v224
    s_nop 1
 v_cndmask_b32 v254, v234, v233, vcc
 s_mov_b32 s54, 4294443008
 s_mov_b32 s55, 4293132288
 s_movk_i32 s50, 512
 s_mov_b32 s51, 1835008
 v_and_b32 v232, 15, v224
 v_lshrrev_b32 v233, 4, v224
 v_lshrrev_b32 v234, 1, v232
 v_xor_b32 v235, v233, v234
 v_xor_b32 v236, 4, v235
 v_lshlrev_b32 v235, 4, v235
 v_lshlrev_b32 v236, 4, v236
 s_lshl_b32 s40, s36, 14
 v_lshl_add_u32 v237, v232, 7, s40
 v_add_u32 v225, v237, v235
 v_add_u32 v226, v237, v236
 v_add_u32 v227, 61440, v225
 v_add_u32 v228, 61440, v226
 v_lshrrev_b32 v232, 4, v224
 v_bfe_u32 v233, v224, 2, 2
 v_and_b32 v234, 3, v224
 v_mul_u32_u24 v235, 3584, v232
 v_mul_u32_u24 v236, 448, v233
 v_add_u32 v235, v235, v236
 v_lshl_add_u32 v235, v234, 3, v235
 v_and_b32 v236, 1, v232
 s_lshl_b32 s40, s37, 3
 s_add_u32 s41, s40, 0
 v_xor_b32 v237, s41, v236
 v_lshl_add_u32 v229, v237, 5, v235
 s_add_u32 s41, s40, 1
 v_xor_b32 v237, s41, v236
 v_lshl_add_u32 v230, v237, 5, v235
 s_add_u32 s41, s37, 6
 v_xor_b32 v237, s41, v236
 v_lshl_add_u32 v231, v237, 5, v235
 s_mov_b32 s22, 0x10000000
 s_mov_b32 s23, 0x20000
 s_mov_b32 s26, 2048
 s_mov_b32 s27, 0x20000
 v_and_b32 v238, 15, v224
 v_lshlrev_b32 v238, 4, v238
 v_lshrrev_b32 v232, 4, v224
 v_lshl_add_u32 v255, v232, 11, v238
 s_mov_b32 s39, s29
 s_lshl_b32 s56, s29, 14
 s_add_u32 s58, s56, 8192
 s_mov_b32 s57, 0
 s_mov_b32 s64, s4
 s_mov_b32 s65, s5
 s_mov_b32 s66, 0x400000
 s_mov_b32 s67, 0x20000
 s_mov_b32 s68, 0xffff0000
 s_mov_b32 s69, 0x3f803f80
 v_mov_b32 v236, 0
 v_mov_b32 v237, 0
 s_lshl_b32 s40, s30, 1
 s_and_b32 s41, s31, 1
 s_add_u32 s40, s40, s41
 s_lshl_b32 s40, s40, 8
 s_lshr_b32 s41, s31, 1
 s_lshl_b32 s41, s41, 2
 s_add_u32 s40, s40, s41
 s_add_u32 s40, s40, 18939904
 s_lshr_b32 s41, s30, 1
 s_lshl_b32 s41, s41, 5
 s_add_u32 s41, s41, s31
 s_lshl_b32 s41, s41, 8
 s_add_u32 s41, s41, 18944000
 s_and_b32 s42, s30, 1
 s_cmp_eq_u32 s42, 1
 s_cselect_b32 s41, s41, s40
 v_mov_b32 v232, 0
 buffer_store_dword v232, off, s[20:23], s40 sc1
 buffer_store_dword v232, off, s[20:23], s40 offset:128 sc1
 buffer_store_dword v232, off, s[20:23], s41 sc1
 s_and_b32 s3, s3, 15
 s_mul_i32 s40, s3, s3
 s_lshl_b32 s40, s40, 16
 s_lshl_b32 s41, s3, 8
 s_add_u32 s40, s40, s41
 s_add_u32 s40, s40, 1
 v_mov_b32 v232, s40
 v_accvgpr_write_b32 a252, v232
 s_lshl_b32 s59, s30, 2
 s_mul_i32 s40, s31, 52429
 s_lshr_b32 s40, s40, 19
 s_mul_i32 s40, s40, 10
 s_sub_u32 s28, s31, s40
 s_barrier
 ds_read_b64_tr_b16 a[32:33], v229 offset:0
 ds_read_b64_tr_b16 a[34:35], v229 offset:1792
 ds_read_b128 a[0:3], v227 offset:0
 ds_read_b64_tr_b16 a[36:37], v230 offset:0
 ds_read_b64_tr_b16 a[38:39], v230 offset:1792
 ds_read_b128 a[4:7], v227 offset:2048
 ds_read_b64_tr_b16 a[40:41], v229 offset:64
 ds_read_b64_tr_b16 a[42:43], v229 offset:1856
 ds_read_b128 a[8:11], v227 offset:4096
 ds_read_b64_tr_b16 a[44:45], v230 offset:64
 ds_read_b64_tr_b16 a[46:47], v230 offset:1856
 ds_read_b128 a[12:15], v227 offset:6144
 ds_read_b64_tr_b16 a[48:49], v229 offset:128
 ds_read_b64_tr_b16 a[50:51], v229 offset:1920
 ds_read_b128 a[16:19], v227 offset:8192
 ds_read_b64_tr_b16 a[52:53], v230 offset:128
 ds_read_b64_tr_b16 a[54:55], v230 offset:1920
 ds_read_b128 a[20:23], v227 offset:10240
 ds_read_b64_tr_b16 a[56:57], v231 offset:0
 ds_read_b64_tr_b16 a[58:59], v231 offset:1792
 ds_read_b128 a[24:27], v227 offset:12288
 ds_read_b128 a[28:31], v227 offset:14336
 s_waitcnt lgkmcnt(0)
 s_barrier
 v_mfma_f32_16x16x32_bf16 v[0:3], a[32:35], a[0:3], 0
 ds_read_b64_tr_b16 a[92:93], v229 offset:15360
 v_mfma_f32_16x16x32_bf16 v[28:31], a[32:35], a[4:7], 0
 ds_read_b64_tr_b16 a[94:95], v229 offset:17152
 v_mfma_f32_16x16x32_bf16 v[32:35], a[36:39], a[4:7], 0
 ds_read_b128 a[60:63], v228 offset:0
 v_mfma_f32_16x16x32_bf16 v[4:7], a[36:39], a[0:3], 0
 v_mfma_f32_16x16x32_bf16 v[8:11], a[40:43], a[0:3], 0
 ds_read_b64_tr_b16 a[96:97], v230 offset:15360
 v_mfma_f32_16x16x32_bf16 v[36:39], a[40:43], a[4:7], 0
 buffer_load_dword a204, v252, s[16:19], s51 offen
 s_add_u32 s51, s51, 458752
 v_mfma_f32_16x16x32_bf16 v[40:43], a[44:47], a[4:7], 0
 ds_read_b64_tr_b16 a[98:99], v230 offset:17152
 v_mfma_f32_16x16x32_bf16 v[12:15], a[44:47], a[0:3], 0
 v_mfma_f32_16x16x32_bf16 v[16:19], a[48:51], a[0:3], 0
 ds_read_b128 a[64:67], v228 offset:2048
 v_mfma_f32_16x16x32_bf16 v[44:47], a[48:51], a[4:7], 0
 v_mfma_f32_16x16x32_bf16 v[48:51], a[52:55], a[4:7], 0
 ds_read_b64_tr_b16 a[100:101], v229 offset:15424
 v_mfma_f32_16x16x32_bf16 v[20:23], a[52:55], a[0:3], 0
 v_mfma_f32_16x16x32_bf16 v[24:27], a[56:59], a[0:3], 0
 ds_read_b64_tr_b16 a[102:103], v229 offset:17216
 v_mfma_f32_16x16x32_bf16 v[52:55], a[56:59], a[4:7], 0
 v_mfma_f32_16x16x32_bf16 v[80:83], a[56:59], a[8:11], 0
 ds_read_b128 a[68:71], v228 offset:4096
 v_mfma_f32_16x16x32_bf16 v[108:111], a[56:59], a[12:15], 0
 v_mfma_f32_16x16x32_bf16 v[104:107], a[52:55], a[12:15], 0
 ds_read_b64_tr_b16 a[104:105], v230 offset:15424
 v_mfma_f32_16x16x32_bf16 v[76:79], a[52:55], a[8:11], 0
 v_mfma_f32_16x16x32_bf16 v[72:75], a[48:51], a[8:11], 0
 ds_read_b64_tr_b16 a[106:107], v230 offset:17216
 v_mfma_f32_16x16x32_bf16 v[100:103], a[48:51], a[12:15], 0
 v_mfma_f32_16x16x32_bf16 v[96:99], a[44:47], a[12:15], 0
 ds_read_b128 a[72:75], v228 offset:6144
 v_mfma_f32_16x16x32_bf16 v[68:71], a[44:47], a[8:11], 0
 v_mfma_f32_16x16x32_bf16 v[64:67], a[40:43], a[8:11], 0
 ds_read_b64_tr_b16 a[108:109], v229 offset:15488
 v_mfma_f32_16x16x32_bf16 v[92:95], a[40:43], a[12:15], 0
 v_mfma_f32_16x16x32_bf16 v[88:91], a[36:39], a[12:15], 0
 ds_read_b64_tr_b16 a[110:111], v229 offset:17280
 v_mfma_f32_16x16x32_bf16 v[60:63], a[36:39], a[8:11], 0
 v_mfma_f32_16x16x32_bf16 v[56:59], a[32:35], a[8:11], 0
 ds_read_b128 a[76:79], v228 offset:8192
 v_mfma_f32_16x16x32_bf16 v[84:87], a[32:35], a[12:15], 0
 v_mfma_f32_16x16x32_bf16 v[112:115], a[32:35], a[16:19], 0
 ds_read_b64_tr_b16 a[112:113], v230 offset:15488
 s_cmp_lt_u32 s50, 2048
 s_cselect_b32 s14, 0x400000, 0
 v_mfma_f32_16x16x32_bf16 v[140:143], a[32:35], a[20:23], 0
 buffer_load_dword a205, v239, s[12:15], s50 offen
 s_add_u32 s50, s50, 128
 v_mfma_f32_16x16x32_bf16 v[144:147], a[36:39], a[20:23], 0
 ds_read_b64_tr_b16 a[114:115], v230 offset:17280
 v_mfma_f32_16x16x32_bf16 v[116:119], a[36:39], a[16:19], 0
 v_mfma_f32_16x16x32_bf16 v[120:123], a[40:43], a[16:19], 0
 ds_read_b128 a[80:83], v228 offset:10240
 v_mfma_f32_16x16x32_bf16 v[148:151], a[40:43], a[20:23], 0
 v_mfma_f32_16x16x32_bf16 v[152:155], a[44:47], a[20:23], 0
 ds_read_b64_tr_b16 a[116:117], v231 offset:15360
 v_mfma_f32_16x16x32_bf16 v[124:127], a[44:47], a[16:19], 0
 v_mfma_f32_16x16x32_bf16 v[128:131], a[48:51], a[16:19], 0
 ds_read_b64_tr_b16 a[118:119], v231 offset:17152
 v_mfma_f32_16x16x32_bf16 v[156:159], a[48:51], a[20:23], 0
 v_mfma_f32_16x16x32_bf16 v[160:163], a[52:55], a[20:23], 0
 ds_read_b128 a[84:87], v228 offset:12288
 v_mfma_f32_16x16x32_bf16 v[132:135], a[52:55], a[16:19], 0
 v_mfma_f32_16x16x32_bf16 v[136:139], a[56:59], a[16:19], 0
 ds_read_b128 a[88:91], v228 offset:14336
 v_mfma_f32_16x16x32_bf16 v[164:167], a[56:59], a[20:23], 0
 v_mfma_f32_16x16x32_bf16 v[192:195], a[56:59], a[24:27], 0
 v_mfma_f32_16x16x32_bf16 v[220:223], a[56:59], a[28:31], 0
 v_mfma_f32_16x16x32_bf16 v[216:219], a[52:55], a[28:31], 0
 v_mfma_f32_16x16x32_bf16 v[188:191], a[52:55], a[24:27], 0
 v_mfma_f32_16x16x32_bf16 v[184:187], a[48:51], a[24:27], 0
 v_mfma_f32_16x16x32_bf16 v[212:215], a[48:51], a[28:31], 0
 v_mfma_f32_16x16x32_bf16 v[208:211], a[44:47], a[28:31], 0
 v_mfma_f32_16x16x32_bf16 v[180:183], a[44:47], a[24:27], 0
 v_mfma_f32_16x16x32_bf16 v[176:179], a[40:43], a[24:27], 0
 v_mfma_f32_16x16x32_bf16 v[204:207], a[40:43], a[28:31], 0
 v_mfma_f32_16x16x32_bf16 v[200:203], a[36:39], a[28:31], 0
 v_mfma_f32_16x16x32_bf16 v[172:175], a[36:39], a[24:27], 0
 v_mfma_f32_16x16x32_bf16 v[168:171], a[32:35], a[24:27], 0
 v_mfma_f32_16x16x32_bf16 v[196:199], a[32:35], a[28:31], 0
 s_waitcnt lgkmcnt(0)
 s_barrier
 v_mfma_f32_16x16x32_bf16 v[0:3], a[92:95], a[60:63], v[0:3]
 v_add_u32 v227, 95232, v225
 v_add_u32 v228, 95232, v226
 ds_read_b64_tr_b16 a[32:33], v229 offset:30720
 v_mfma_f32_16x16x32_bf16 v[28:31], a[92:95], a[64:67], v[28:31]
 ds_read_b64_tr_b16 a[34:35], v229 offset:32512
 v_mfma_f32_16x16x32_bf16 v[32:35], a[96:99], a[64:67], v[32:35]
 ds_read_b128 a[0:3], v227 offset:0
 v_mfma_f32_16x16x32_bf16 v[4:7], a[96:99], a[60:63], v[4:7]
 v_mfma_f32_16x16x32_bf16 v[8:11], a[100:103], a[60:63], v[8:11]
 ds_read_b64_tr_b16 a[36:37], v230 offset:30720
 v_mfma_f32_16x16x32_bf16 v[36:39], a[100:103], a[64:67], v[36:39]
 buffer_load_dword a204, v252, s[16:19], s51 offen
 s_add_u32 s51, s51, 458752
 v_mfma_f32_16x16x32_bf16 v[40:43], a[104:107], a[64:67], v[40:43]
 ds_read_b64_tr_b16 a[38:39], v230 offset:32512
 v_mfma_f32_16x16x32_bf16 v[12:15], a[104:107], a[60:63], v[12:15]
 v_mfma_f32_16x16x32_bf16 v[16:19], a[108:111], a[60:63], v[16:19]
 ds_read_b128 a[4:7], v227 offset:2048
 v_mfma_f32_16x16x32_bf16 v[44:47], a[108:111], a[64:67], v[44:47]
 v_mfma_f32_16x16x32_bf16 v[48:51], a[112:115], a[64:67], v[48:51]
 ds_read_b64_tr_b16 a[40:41], v229 offset:30784
 v_mfma_f32_16x16x32_bf16 v[20:23], a[112:115], a[60:63], v[20:23]
 v_mfma_f32_16x16x32_bf16 v[24:27], a[116:119], a[60:63], v[24:27]
 ds_read_b64_tr_b16 a[42:43], v229 offset:32576
 v_mfma_f32_16x16x32_bf16 v[52:55], a[116:119], a[64:67], v[52:55]
 v_mfma_f32_16x16x32_bf16 v[80:83], a[116:119], a[68:71], v[80:83]
 ds_read_b128 a[8:11], v227 offset:4096
 v_mfma_f32_16x16x32_bf16 v[108:111], a[116:119], a[72:75], v[108:111]
 v_mfma_f32_16x16x32_bf16 v[104:107], a[112:115], a[72:75], v[104:107]
 ds_read_b64_tr_b16 a[44:45], v230 offset:30784
 v_mfma_f32_16x16x32_bf16 v[76:79], a[112:115], a[68:71], v[76:79]
 v_mfma_f32_16x16x32_bf16 v[72:75], a[108:111], a[68:71], v[72:75]
 ds_read_b64_tr_b16 a[46:47], v230 offset:32576
 v_mfma_f32_16x16x32_bf16 v[100:103], a[108:111], a[72:75], v[100:103]
 v_mfma_f32_16x16x32_bf16 v[96:99], a[104:107], a[72:75], v[96:99]
 ds_read_b128 a[12:15], v227 offset:6144
 v_mfma_f32_16x16x32_bf16 v[68:71], a[104:107], a[68:71], v[68:71]
 v_mfma_f32_16x16x32_bf16 v[64:67], a[100:103], a[68:71], v[64:67]
 ds_read_b64_tr_b16 a[48:49], v229 offset:30848
 v_mfma_f32_16x16x32_bf16 v[92:95], a[100:103], a[72:75], v[92:95]
 v_mfma_f32_16x16x32_bf16 v[88:91], a[96:99], a[72:75], v[88:91]
 ds_read_b64_tr_b16 a[50:51], v229 offset:32640
 v_mfma_f32_16x16x32_bf16 v[60:63], a[96:99], a[68:71], v[60:63]
 v_mfma_f32_16x16x32_bf16 v[56:59], a[92:95], a[68:71], v[56:59]
 ds_read_b128 a[16:19], v227 offset:8192
 v_mfma_f32_16x16x32_bf16 v[84:87], a[92:95], a[72:75], v[84:87]
 v_mfma_f32_16x16x32_bf16 v[112:115], a[92:95], a[76:79], v[112:115]
 ds_read_b64_tr_b16 a[52:53], v230 offset:30848
 s_cmp_lt_u32 s50, 2048
 s_cselect_b32 s14, 0x400000, 0
 v_mfma_f32_16x16x32_bf16 v[140:143], a[92:95], a[80:83], v[140:143]
 buffer_load_dword a205, v239, s[12:15], s50 offen
 s_add_u32 s50, s50, 128
 v_mfma_f32_16x16x32_bf16 v[144:147], a[96:99], a[80:83], v[144:147]
 ds_read_b64_tr_b16 a[54:55], v230 offset:32640
 v_mfma_f32_16x16x32_bf16 v[116:119], a[96:99], a[76:79], v[116:119]
 v_mfma_f32_16x16x32_bf16 v[120:123], a[100:103], a[76:79], v[120:123]
 ds_read_b128 a[20:23], v227 offset:10240
 v_mfma_f32_16x16x32_bf16 v[148:151], a[100:103], a[80:83], v[148:151]
 v_mfma_f32_16x16x32_bf16 v[152:155], a[104:107], a[80:83], v[152:155]
 ds_read_b64_tr_b16 a[56:57], v231 offset:30720
 v_mfma_f32_16x16x32_bf16 v[124:127], a[104:107], a[76:79], v[124:127]
 v_mfma_f32_16x16x32_bf16 v[128:131], a[108:111], a[76:79], v[128:131]
 ds_read_b64_tr_b16 a[58:59], v231 offset:32512
 v_mfma_f32_16x16x32_bf16 v[156:159], a[108:111], a[80:83], v[156:159]
 v_mfma_f32_16x16x32_bf16 v[160:163], a[112:115], a[80:83], v[160:163]
 ds_read_b128 a[24:27], v227 offset:12288
 v_mfma_f32_16x16x32_bf16 v[132:135], a[112:115], a[76:79], v[132:135]
 v_mfma_f32_16x16x32_bf16 v[136:139], a[116:119], a[76:79], v[136:139]
 ds_read_b128 a[28:31], v227 offset:14336
 v_mfma_f32_16x16x32_bf16 v[164:167], a[116:119], a[80:83], v[164:167]
 v_mfma_f32_16x16x32_bf16 v[192:195], a[116:119], a[84:87], v[192:195]
 v_mfma_f32_16x16x32_bf16 v[220:223], a[116:119], a[88:91], v[220:223]
 v_mfma_f32_16x16x32_bf16 v[216:219], a[112:115], a[88:91], v[216:219]
 v_mfma_f32_16x16x32_bf16 v[188:191], a[112:115], a[84:87], v[188:191]
 v_mfma_f32_16x16x32_bf16 v[184:187], a[108:111], a[84:87], v[184:187]
 v_mfma_f32_16x16x32_bf16 v[212:215], a[108:111], a[88:91], v[212:215]
 v_mfma_f32_16x16x32_bf16 v[208:211], a[104:107], a[88:91], v[208:211]
 v_mfma_f32_16x16x32_bf16 v[180:183], a[104:107], a[84:87], v[180:183]
 v_mfma_f32_16x16x32_bf16 v[176:179], a[100:103], a[84:87], v[176:179]
 v_mfma_f32_16x16x32_bf16 v[204:207], a[100:103], a[88:91], v[204:207]
 v_mfma_f32_16x16x32_bf16 v[200:203], a[96:99], a[88:91], v[200:203]
 v_mfma_f32_16x16x32_bf16 v[172:175], a[96:99], a[84:87], v[172:175]
 v_mfma_f32_16x16x32_bf16 v[168:171], a[92:95], a[84:87], v[168:171]
 v_mfma_f32_16x16x32_bf16 v[196:199], a[92:95], a[88:91], v[196:199]
 s_waitcnt lgkmcnt(0)
 s_barrier
 v_mfma_f32_16x16x32_bf16 v[0:3], a[32:35], a[0:3], v[0:3]
 ds_read_b64_tr_b16 a[92:93], v229 offset:46080
 v_mfma_f32_16x16x32_bf16 v[28:31], a[32:35], a[4:7], v[28:31]
 ds_read_b64_tr_b16 a[94:95], v229 offset:47872
 v_mfma_f32_16x16x32_bf16 v[32:35], a[36:39], a[4:7], v[32:35]
 ds_read_b128 a[60:63], v228 offset:0
 v_mfma_f32_16x16x32_bf16 v[4:7], a[36:39], a[0:3], v[4:7]
 v_mfma_f32_16x16x32_bf16 v[8:11], a[40:43], a[0:3], v[8:11]
 ds_read_b64_tr_b16 a[96:97], v230 offset:46080
 v_mfma_f32_16x16x32_bf16 v[36:39], a[40:43], a[4:7], v[36:39]
 buffer_load_dword a204, v252, s[16:19], s51 offen
 s_add_u32 s51, s51, 458752
 v_mfma_f32_16x16x32_bf16 v[40:43], a[44:47], a[4:7], v[40:43]
 ds_read_b64_tr_b16 a[98:99], v230 offset:47872
 v_mfma_f32_16x16x32_bf16 v[12:15], a[44:47], a[0:3], v[12:15]
 v_mfma_f32_16x16x32_bf16 v[16:19], a[48:51], a[0:3], v[16:19]
 ds_read_b128 a[64:67], v228 offset:2048
 v_mfma_f32_16x16x32_bf16 v[44:47], a[48:51], a[4:7], v[44:47]
 v_mfma_f32_16x16x32_bf16 v[48:51], a[52:55], a[4:7], v[48:51]
 ds_read_b64_tr_b16 a[100:101], v229 offset:46144
 v_mfma_f32_16x16x32_bf16 v[20:23], a[52:55], a[0:3], v[20:23]
 v_mfma_f32_16x16x32_bf16 v[24:27], a[56:59], a[0:3], v[24:27]
 ds_read_b64_tr_b16 a[102:103], v229 offset:47936
 v_mfma_f32_16x16x32_bf16 v[52:55], a[56:59], a[4:7], v[52:55]
 v_mfma_f32_16x16x32_bf16 v[80:83], a[56:59], a[8:11], v[80:83]
 ds_read_b128 a[68:71], v228 offset:4096
 v_mfma_f32_16x16x32_bf16 v[108:111], a[56:59], a[12:15], v[108:111]
 v_mfma_f32_16x16x32_bf16 v[104:107], a[52:55], a[12:15], v[104:107]
 ds_read_b64_tr_b16 a[104:105], v230 offset:46144
 v_mfma_f32_16x16x32_bf16 v[76:79], a[52:55], a[8:11], v[76:79]
 v_mfma_f32_16x16x32_bf16 v[72:75], a[48:51], a[8:11], v[72:75]
 ds_read_b64_tr_b16 a[106:107], v230 offset:47936
 v_mfma_f32_16x16x32_bf16 v[100:103], a[48:51], a[12:15], v[100:103]
 v_mfma_f32_16x16x32_bf16 v[96:99], a[44:47], a[12:15], v[96:99]
 ds_read_b128 a[72:75], v228 offset:6144
 v_mfma_f32_16x16x32_bf16 v[68:71], a[44:47], a[8:11], v[68:71]
 v_mfma_f32_16x16x32_bf16 v[64:67], a[40:43], a[8:11], v[64:67]
 ds_read_b64_tr_b16 a[108:109], v229 offset:46208
 v_mfma_f32_16x16x32_bf16 v[92:95], a[40:43], a[12:15], v[92:95]
 v_mfma_f32_16x16x32_bf16 v[88:91], a[36:39], a[12:15], v[88:91]
 ds_read_b64_tr_b16 a[110:111], v229 offset:48000
 v_mfma_f32_16x16x32_bf16 v[60:63], a[36:39], a[8:11], v[60:63]
 v_mfma_f32_16x16x32_bf16 v[56:59], a[32:35], a[8:11], v[56:59]
 ds_read_b128 a[76:79], v228 offset:8192
 v_mfma_f32_16x16x32_bf16 v[84:87], a[32:35], a[12:15], v[84:87]
 v_mfma_f32_16x16x32_bf16 v[112:115], a[32:35], a[16:19], v[112:115]
 ds_read_b64_tr_b16 a[112:113], v230 offset:46208
 s_cmp_lt_u32 s50, 2048
 s_cselect_b32 s14, 0x400000, 0
 v_mfma_f32_16x16x32_bf16 v[140:143], a[32:35], a[20:23], v[140:143]
 buffer_load_dword a205, v239, s[12:15], s50 offen
 s_add_u32 s50, s50, 128
 v_mfma_f32_16x16x32_bf16 v[144:147], a[36:39], a[20:23], v[144:147]
 ds_read_b64_tr_b16 a[114:115], v230 offset:48000
 v_mfma_f32_16x16x32_bf16 v[116:119], a[36:39], a[16:19], v[116:119]
 v_mfma_f32_16x16x32_bf16 v[120:123], a[40:43], a[16:19], v[120:123]
 ds_read_b128 a[80:83], v228 offset:10240
 v_mfma_f32_16x16x32_bf16 v[148:151], a[40:43], a[20:23], v[148:151]
 v_mfma_f32_16x16x32_bf16 v[152:155], a[44:47], a[20:23], v[152:155]
 ds_read_b64_tr_b16 a[116:117], v231 offset:46080
 v_mfma_f32_16x16x32_bf16 v[124:127], a[44:47], a[16:19], v[124:127]
 v_mfma_f32_16x16x32_bf16 v[128:131], a[48:51], a[16:19], v[128:131]
 ds_read_b64_tr_b16 a[118:119], v231 offset:47872
 v_mfma_f32_16x16x32_bf16 v[156:159], a[48:51], a[20:23], v[156:159]
 v_mfma_f32_16x16x32_bf16 v[160:163], a[52:55], a[20:23], v[160:163]
 ds_read_b128 a[84:87], v228 offset:12288
 v_mfma_f32_16x16x32_bf16 v[132:135], a[52:55], a[16:19], v[132:135]
 v_mfma_f32_16x16x32_bf16 v[136:139], a[56:59], a[16:19], v[136:139]
 ds_read_b128 a[88:91], v228 offset:14336
 v_mfma_f32_16x16x32_bf16 v[164:167], a[56:59], a[20:23], v[164:167]
 v_mfma_f32_16x16x32_bf16 v[192:195], a[56:59], a[24:27], v[192:195]
 v_mfma_f32_16x16x32_bf16 v[220:223], a[56:59], a[28:31], v[220:223]
 v_mfma_f32_16x16x32_bf16 v[216:219], a[52:55], a[28:31], v[216:219]
 v_mfma_f32_16x16x32_bf16 v[188:191], a[52:55], a[24:27], v[188:191]
 v_mfma_f32_16x16x32_bf16 v[184:187], a[48:51], a[24:27], v[184:187]
 v_mfma_f32_16x16x32_bf16 v[212:215], a[48:51], a[28:31], v[212:215]
 v_mfma_f32_16x16x32_bf16 v[208:211], a[44:47], a[28:31], v[208:211]
 v_mfma_f32_16x16x32_bf16 v[180:183], a[44:47], a[24:27], v[180:183]
 v_mfma_f32_16x16x32_bf16 v[176:179], a[40:43], a[24:27], v[176:179]
 v_mfma_f32_16x16x32_bf16 v[204:207], a[40:43], a[28:31], v[204:207]
 v_mfma_f32_16x16x32_bf16 v[200:203], a[36:39], a[28:31], v[200:203]
 v_mfma_f32_16x16x32_bf16 v[172:175], a[36:39], a[24:27], v[172:175]
 v_mfma_f32_16x16x32_bf16 v[168:171], a[32:35], a[24:27], v[168:171]
 v_mfma_f32_16x16x32_bf16 v[196:199], a[32:35], a[28:31], v[196:199]
 s_waitcnt lgkmcnt(0)
 s_barrier
 v_mfma_f32_16x16x32_bf16 v[0:3], a[92:95], a[60:63], v[0:3]
 v_add_u32 v227, 129024, v225
 v_add_u32 v228, 129024, v226
 s_mov_b32 s46, 129024
 ds_read_b64_tr_b16 a[32:33], v229 offset:0
 v_mfma_f32_16x16x32_bf16 v[28:31], a[92:95], a[64:67], v[28:31]
 s_mov_b32 s47, 61440
 s_mov_b32 s48, 95232
 s_mov_b32 s52, 5
 ds_read_b64_tr_b16 a[34:35], v229 offset:1792
 v_mfma_f32_16x16x32_bf16 v[32:35], a[96:99], a[64:67], v[32:35]
 ds_read_b128 a[0:3], v227 offset:0
 v_mfma_f32_16x16x32_bf16 v[4:7], a[96:99], a[60:63], v[4:7]
 v_mfma_f32_16x16x32_bf16 v[8:11], a[100:103], a[60:63], v[8:11]
 ds_read_b64_tr_b16 a[36:37], v230 offset:0
 v_mfma_f32_16x16x32_bf16 v[36:39], a[100:103], a[64:67], v[36:39]
 buffer_load_dword a204, v252, s[16:19], s51 offen
 s_add_u32 s51, s51, 458752
 v_mfma_f32_16x16x32_bf16 v[40:43], a[104:107], a[64:67], v[40:43]
 ds_read_b64_tr_b16 a[38:39], v230 offset:1792
 v_mfma_f32_16x16x32_bf16 v[12:15], a[104:107], a[60:63], v[12:15]
 v_mfma_f32_16x16x32_bf16 v[16:19], a[108:111], a[60:63], v[16:19]
 ds_read_b128 a[4:7], v227 offset:2048
 v_mfma_f32_16x16x32_bf16 v[44:47], a[108:111], a[64:67], v[44:47]
 v_mfma_f32_16x16x32_bf16 v[48:51], a[112:115], a[64:67], v[48:51]
 ds_read_b64_tr_b16 a[40:41], v229 offset:64
 v_mfma_f32_16x16x32_bf16 v[20:23], a[112:115], a[60:63], v[20:23]
 v_mfma_f32_16x16x32_bf16 v[24:27], a[116:119], a[60:63], v[24:27]
 ds_read_b64_tr_b16 a[42:43], v229 offset:1856
 v_mfma_f32_16x16x32_bf16 v[52:55], a[116:119], a[64:67], v[52:55]
 v_mfma_f32_16x16x32_bf16 v[80:83], a[116:119], a[68:71], v[80:83]
 ds_read_b128 a[8:11], v227 offset:4096
 v_mfma_f32_16x16x32_bf16 v[108:111], a[116:119], a[72:75], v[108:111]
 v_mfma_f32_16x16x32_bf16 v[104:107], a[112:115], a[72:75], v[104:107]
 ds_read_b64_tr_b16 a[44:45], v230 offset:64
 v_mfma_f32_16x16x32_bf16 v[76:79], a[112:115], a[68:71], v[76:79]
 v_mfma_f32_16x16x32_bf16 v[72:75], a[108:111], a[68:71], v[72:75]
 ds_read_b64_tr_b16 a[46:47], v230 offset:1856
 v_mfma_f32_16x16x32_bf16 v[100:103], a[108:111], a[72:75], v[100:103]
 v_mfma_f32_16x16x32_bf16 v[96:99], a[104:107], a[72:75], v[96:99]
 ds_read_b128 a[12:15], v227 offset:6144
 v_mfma_f32_16x16x32_bf16 v[68:71], a[104:107], a[68:71], v[68:71]
 v_mfma_f32_16x16x32_bf16 v[64:67], a[100:103], a[68:71], v[64:67]
 ds_read_b64_tr_b16 a[48:49], v229 offset:128
 v_mfma_f32_16x16x32_bf16 v[92:95], a[100:103], a[72:75], v[92:95]
 v_mfma_f32_16x16x32_bf16 v[88:91], a[96:99], a[72:75], v[88:91]
 ds_read_b64_tr_b16 a[50:51], v229 offset:1920
 v_mfma_f32_16x16x32_bf16 v[60:63], a[96:99], a[68:71], v[60:63]
 v_mfma_f32_16x16x32_bf16 v[56:59], a[92:95], a[68:71], v[56:59]
 ds_read_b128 a[16:19], v227 offset:8192
 v_mfma_f32_16x16x32_bf16 v[84:87], a[92:95], a[72:75], v[84:87]
 v_mfma_f32_16x16x32_bf16 v[112:115], a[92:95], a[76:79], v[112:115]
 ds_read_b64_tr_b16 a[52:53], v230 offset:128
 s_cmp_lt_u32 s50, 2048
 s_cselect_b32 s14, 0x400000, 0
 v_mfma_f32_16x16x32_bf16 v[140:143], a[92:95], a[80:83], v[140:143]
 buffer_load_dword a205, v239, s[12:15], s50 offen
 s_add_u32 s50, s50, 128
 v_mfma_f32_16x16x32_bf16 v[144:147], a[96:99], a[80:83], v[144:147]
 ds_read_b64_tr_b16 a[54:55], v230 offset:1920
 v_mfma_f32_16x16x32_bf16 v[116:119], a[96:99], a[76:79], v[116:119]
 v_mfma_f32_16x16x32_bf16 v[120:123], a[100:103], a[76:79], v[120:123]
 ds_read_b128 a[20:23], v227 offset:10240
 v_mfma_f32_16x16x32_bf16 v[148:151], a[100:103], a[80:83], v[148:151]
 v_mfma_f32_16x16x32_bf16 v[152:155], a[104:107], a[80:83], v[152:155]
 ds_read_b64_tr_b16 a[56:57], v231 offset:0
 v_mfma_f32_16x16x32_bf16 v[124:127], a[104:107], a[76:79], v[124:127]
 v_mfma_f32_16x16x32_bf16 v[128:131], a[108:111], a[76:79], v[128:131]
 ds_read_b64_tr_b16 a[58:59], v231 offset:1792
 v_mfma_f32_16x16x32_bf16 v[156:159], a[108:111], a[80:83], v[156:159]
 v_mfma_f32_16x16x32_bf16 v[160:163], a[112:115], a[80:83], v[160:163]
 ds_read_b128 a[24:27], v227 offset:12288
 v_mfma_f32_16x16x32_bf16 v[132:135], a[112:115], a[76:79], v[132:135]
 v_mfma_f32_16x16x32_bf16 v[136:139], a[116:119], a[76:79], v[136:139]
 ds_read_b128 a[28:31], v227 offset:14336
 v_mfma_f32_16x16x32_bf16 v[164:167], a[116:119], a[80:83], v[164:167]
 v_mfma_f32_16x16x32_bf16 v[192:195], a[116:119], a[84:87], v[192:195]
 v_mfma_f32_16x16x32_bf16 v[220:223], a[116:119], a[88:91], v[220:223]
 v_mfma_f32_16x16x32_bf16 v[216:219], a[112:115], a[88:91], v[216:219]
 v_mfma_f32_16x16x32_bf16 v[188:191], a[112:115], a[84:87], v[188:191]
 v_mfma_f32_16x16x32_bf16 v[184:187], a[108:111], a[84:87], v[184:187]
 v_mfma_f32_16x16x32_bf16 v[212:215], a[108:111], a[88:91], v[212:215]
 v_mfma_f32_16x16x32_bf16 v[208:211], a[104:107], a[88:91], v[208:211]
 v_mfma_f32_16x16x32_bf16 v[180:183], a[104:107], a[84:87], v[180:183]
 v_mfma_f32_16x16x32_bf16 v[176:179], a[100:103], a[84:87], v[176:179]
 v_mfma_f32_16x16x32_bf16 v[204:207], a[100:103], a[88:91], v[204:207]
 v_mfma_f32_16x16x32_bf16 v[200:203], a[96:99], a[88:91], v[200:203]
 v_mfma_f32_16x16x32_bf16 v[172:175], a[96:99], a[84:87], v[172:175]
 v_mfma_f32_16x16x32_bf16 v[168:171], a[92:95], a[84:87], v[168:171]
 v_mfma_f32_16x16x32_bf16 v[196:199], a[92:95], a[88:91], v[196:199]
.p2align 6
L1hP_loop:
 s_waitcnt lgkmcnt(0)
 s_barrier
 v_mfma_f32_16x16x32_bf16 v[0:3], a[32:35], a[0:3], v[0:3]
 ds_read_b64_tr_b16 a[92:93], v229 offset:15360
 v_mfma_f32_16x16x32_bf16 v[28:31], a[32:35], a[4:7], v[28:31]
 ds_read_b64_tr_b16 a[94:95], v229 offset:17152
 v_mfma_f32_16x16x32_bf16 v[32:35], a[36:39], a[4:7], v[32:35]
 ds_read_b128 a[60:63], v228 offset:0
 v_mfma_f32_16x16x32_bf16 v[4:7], a[36:39], a[0:3], v[4:7]
 v_mfma_f32_16x16x32_bf16 v[8:11], a[40:43], a[0:3], v[8:11]
 ds_read_b64_tr_b16 a[96:97], v230 offset:15360
 v_mfma_f32_16x16x32_bf16 v[36:39], a[40:43], a[4:7], v[36:39]
 buffer_load_dword a206, v253, s[72:75], s54 offen
 s_add_u32 s54, s54, 262144
 v_mfma_f32_16x16x32_bf16 v[40:43], a[44:47], a[4:7], v[40:43]
 ds_read_b64_tr_b16 a[98:99], v230 offset:17152
 v_mfma_f32_16x16x32_bf16 v[12:15], a[44:47], a[0:3], v[12:15]
 v_mfma_f32_16x16x32_bf16 v[16:19], a[48:51], a[0:3], v[16:19]
 ds_read_b128 a[64:67], v228 offset:2048
 v_mfma_f32_16x16x32_bf16 v[44:47], a[48:51], a[4:7], v[44:47]
 v_mfma_f32_16x16x32_bf16 v[48:51], a[52:55], a[4:7], v[48:51]
 ds_read_b64_tr_b16 a[100:101], v229 offset:15424
 v_mfma_f32_16x16x32_bf16 v[20:23], a[52:55], a[0:3], v[20:23]
 v_mfma_f32_16x16x32_bf16 v[24:27], a[56:59], a[0:3], v[24:27]
 ds_read_b64_tr_b16 a[102:103], v229 offset:17216
 v_mfma_f32_16x16x32_bf16 v[52:55], a[56:59], a[4:7], v[52:55]
 v_mfma_f32_16x16x32_bf16 v[80:83], a[56:59], a[8:11], v[80:83]
 ds_read_b128 a[68:71], v228 offset:4096
 v_mfma_f32_16x16x32_bf16 v[108:111], a[56:59], a[12:15], v[108:111]
 v_mfma_f32_16x16x32_bf16 v[104:107], a[52:55], a[12:15], v[104:107]
 ds_read_b64_tr_b16 a[104:105], v230 offset:15424
 v_mfma_f32_16x16x32_bf16 v[76:79], a[52:55], a[8:11], v[76:79]
 v_mfma_f32_16x16x32_bf16 v[72:75], a[48:51], a[8:11], v[72:75]
 ds_read_b64_tr_b16 a[106:107], v230 offset:17216
 v_mfma_f32_16x16x32_bf16 v[100:103], a[48:51], a[12:15], v[100:103]
 v_mfma_f32_16x16x32_bf16 v[96:99], a[44:47], a[12:15], v[96:99]
 ds_read_b128 a[72:75], v228 offset:6144
 v_mfma_f32_16x16x32_bf16 v[68:71], a[44:47], a[8:11], v[68:71]
 v_mfma_f32_16x16x32_bf16 v[64:67], a[40:43], a[8:11], v[64:67]
 ds_read_b64_tr_b16 a[108:109], v229 offset:15488
 v_mfma_f32_16x16x32_bf16 v[92:95], a[40:43], a[12:15], v[92:95]
 v_mfma_f32_16x16x32_bf16 v[88:91], a[36:39], a[12:15], v[88:91]
 ds_read_b64_tr_b16 a[110:111], v229 offset:17280
 v_mfma_f32_16x16x32_bf16 v[60:63], a[36:39], a[8:11], v[60:63]
 v_mfma_f32_16x16x32_bf16 v[56:59], a[32:35], a[8:11], v[56:59]
 ds_read_b128 a[76:79], v228 offset:8192
 v_mfma_f32_16x16x32_bf16 v[84:87], a[32:35], a[12:15], v[84:87]
 v_mfma_f32_16x16x32_bf16 v[112:115], a[32:35], a[16:19], v[112:115]
 ds_read_b64_tr_b16 a[112:113], v230 offset:15488
 v_mfma_f32_16x16x32_bf16 v[140:143], a[32:35], a[20:23], v[140:143]
 buffer_load_dword a207, v254, s[76:79], s55 offen
 s_add_u32 s55, s55, 917504
 v_mfma_f32_16x16x32_bf16 v[144:147], a[36:39], a[20:23], v[144:147]
 ds_read_b64_tr_b16 a[114:115], v230 offset:17280
 v_mfma_f32_16x16x32_bf16 v[116:119], a[36:39], a[16:19], v[116:119]
 v_mfma_f32_16x16x32_bf16 v[120:123], a[40:43], a[16:19], v[120:123]
 ds_read_b128 a[80:83], v228 offset:10240
 v_mfma_f32_16x16x32_bf16 v[148:151], a[40:43], a[20:23], v[148:151]
 v_mfma_f32_16x16x32_bf16 v[152:155], a[44:47], a[20:23], v[152:155]
 ds_read_b64_tr_b16 a[116:117], v231 offset:15360
 v_mfma_f32_16x16x32_bf16 v[124:127], a[44:47], a[16:19], v[124:127]
 v_mfma_f32_16x16x32_bf16 v[128:131], a[48:51], a[16:19], v[128:131]
 ds_read_b64_tr_b16 a[118:119], v231 offset:17152
 v_mfma_f32_16x16x32_bf16 v[156:159], a[48:51], a[20:23], v[156:159]
 v_mfma_f32_16x16x32_bf16 v[160:163], a[52:55], a[20:23], v[160:163]
 ds_read_b128 a[84:87], v228 offset:12288
 v_mfma_f32_16x16x32_bf16 v[132:135], a[52:55], a[16:19], v[132:135]
 v_mfma_f32_16x16x32_bf16 v[136:139], a[56:59], a[16:19], v[136:139]
 ds_read_b128 a[88:91], v228 offset:14336
 v_mfma_f32_16x16x32_bf16 v[164:167], a[56:59], a[20:23], v[164:167]
 v_mfma_f32_16x16x32_bf16 v[192:195], a[56:59], a[24:27], v[192:195]
 v_mfma_f32_16x16x32_bf16 v[220:223], a[56:59], a[28:31], v[220:223]
 v_mfma_f32_16x16x32_bf16 v[216:219], a[52:55], a[28:31], v[216:219]
 v_mfma_f32_16x16x32_bf16 v[188:191], a[52:55], a[24:27], v[188:191]
 v_mfma_f32_16x16x32_bf16 v[184:187], a[48:51], a[24:27], v[184:187]
 v_mfma_f32_16x16x32_bf16 v[212:215], a[48:51], a[28:31], v[212:215]
 v_mfma_f32_16x16x32_bf16 v[208:211], a[44:47], a[28:31], v[208:211]
 v_mfma_f32_16x16x32_bf16 v[180:183], a[44:47], a[24:27], v[180:183]
 v_mfma_f32_16x16x32_bf16 v[176:179], a[40:43], a[24:27], v[176:179]
 v_mfma_f32_16x16x32_bf16 v[204:207], a[40:43], a[28:31], v[204:207]
 v_mfma_f32_16x16x32_bf16 v[200:203], a[36:39], a[28:31], v[200:203]
 v_mfma_f32_16x16x32_bf16 v[172:175], a[36:39], a[24:27], v[172:175]
 v_mfma_f32_16x16x32_bf16 v[168:171], a[32:35], a[24:27], v[168:171]
 v_mfma_f32_16x16x32_bf16 v[196:199], a[32:35], a[28:31], v[196:199]
 s_waitcnt lgkmcnt(0)
 s_barrier
 v_mfma_f32_16x16x32_bf16 v[0:3], a[92:95], a[60:63], v[0:3]
 v_add_u32 v227, s47, v225
 v_add_u32 v228, s47, v226
 s_mov_b32 s53, s46
 ds_read_b64_tr_b16 a[32:33], v229 offset:30720
 v_mfma_f32_16x16x32_bf16 v[28:31], a[92:95], a[64:67], v[28:31]
 s_mov_b32 s46, s47
 s_mov_b32 s47, s48
 s_mov_b32 s48, s53
 ds_read_b64_tr_b16 a[34:35], v229 offset:32512
 v_mfma_f32_16x16x32_bf16 v[32:35], a[96:99], a[64:67], v[32:35]
 ds_read_b128 a[0:3], v227 offset:0
 v_mfma_f32_16x16x32_bf16 v[4:7], a[96:99], a[60:63], v[4:7]
 v_mfma_f32_16x16x32_bf16 v[8:11], a[100:103], a[60:63], v[8:11]
 ds_read_b64_tr_b16 a[36:37], v230 offset:30720
 s_cmp_eq_u32 s28, 0
 s_cselect_b32 s29, s59, 0x1000
 s_mov_b64 exec, 1
 buffer_atomic_add a252, off, s[60:63], s29 sc1
 s_mov_b64 exec, -1
 s_sub_u32 s28, s28, 1
 v_mfma_f32_16x16x32_bf16 v[36:39], a[100:103], a[64:67], v[36:39]
 buffer_load_dword a204, v252, s[16:19], s51 offen
 s_add_u32 s51, s51, 458752
 v_mfma_f32_16x16x32_bf16 v[40:43], a[104:107], a[64:67], v[40:43]
 ds_read_b64_tr_b16 a[38:39], v230 offset:32512
 v_mfma_f32_16x16x32_bf16 v[12:15], a[104:107], a[60:63], v[12:15]
 v_mfma_f32_16x16x32_bf16 v[16:19], a[108:111], a[60:63], v[16:19]
 ds_read_b128 a[4:7], v227 offset:2048
 v_mfma_f32_16x16x32_bf16 v[44:47], a[108:111], a[64:67], v[44:47]
 v_mfma_f32_16x16x32_bf16 v[48:51], a[112:115], a[64:67], v[48:51]
 ds_read_b64_tr_b16 a[40:41], v229 offset:30784
 v_mfma_f32_16x16x32_bf16 v[20:23], a[112:115], a[60:63], v[20:23]
 v_mfma_f32_16x16x32_bf16 v[24:27], a[116:119], a[60:63], v[24:27]
 ds_read_b64_tr_b16 a[42:43], v229 offset:32576
 v_mfma_f32_16x16x32_bf16 v[52:55], a[116:119], a[64:67], v[52:55]
 v_mfma_f32_16x16x32_bf16 v[80:83], a[116:119], a[68:71], v[80:83]
 ds_read_b128 a[8:11], v227 offset:4096
 v_mfma_f32_16x16x32_bf16 v[108:111], a[116:119], a[72:75], v[108:111]
 v_mfma_f32_16x16x32_bf16 v[104:107], a[112:115], a[72:75], v[104:107]
 ds_read_b64_tr_b16 a[44:45], v230 offset:30784
 v_mfma_f32_16x16x32_bf16 v[76:79], a[112:115], a[68:71], v[76:79]
 v_mfma_f32_16x16x32_bf16 v[72:75], a[108:111], a[68:71], v[72:75]
 ds_read_b64_tr_b16 a[46:47], v230 offset:32576
 v_mfma_f32_16x16x32_bf16 v[100:103], a[108:111], a[72:75], v[100:103]
 v_mfma_f32_16x16x32_bf16 v[96:99], a[104:107], a[72:75], v[96:99]
 ds_read_b128 a[12:15], v227 offset:6144
 v_mfma_f32_16x16x32_bf16 v[68:71], a[104:107], a[68:71], v[68:71]
 v_mfma_f32_16x16x32_bf16 v[64:67], a[100:103], a[68:71], v[64:67]
 ds_read_b64_tr_b16 a[48:49], v229 offset:30848
 v_mfma_f32_16x16x32_bf16 v[92:95], a[100:103], a[72:75], v[92:95]
 v_mfma_f32_16x16x32_bf16 v[88:91], a[96:99], a[72:75], v[88:91]
 ds_read_b64_tr_b16 a[50:51], v229 offset:32640
 v_mfma_f32_16x16x32_bf16 v[60:63], a[96:99], a[68:71], v[60:63]
 v_mfma_f32_16x16x32_bf16 v[56:59], a[92:95], a[68:71], v[56:59]
 ds_read_b128 a[16:19], v227 offset:8192
 v_mfma_f32_16x16x32_bf16 v[84:87], a[92:95], a[72:75], v[84:87]
 v_mfma_f32_16x16x32_bf16 v[112:115], a[92:95], a[76:79], v[112:115]
 ds_read_b64_tr_b16 a[52:53], v230 offset:30848
 s_cmp_lt_u32 s50, 2048
 s_cselect_b32 s14, 0x400000, 0
 v_mfma_f32_16x16x32_bf16 v[140:143], a[92:95], a[80:83], v[140:143]
 buffer_load_dword a205, v239, s[12:15], s50 offen
 s_add_u32 s50, s50, 128
 v_mfma_f32_16x16x32_bf16 v[144:147], a[96:99], a[80:83], v[144:147]
 ds_read_b64_tr_b16 a[54:55], v230 offset:32640
 v_mfma_f32_16x16x32_bf16 v[116:119], a[96:99], a[76:79], v[116:119]
 v_mfma_f32_16x16x32_bf16 v[120:123], a[100:103], a[76:79], v[120:123]
 ds_read_b128 a[20:23], v227 offset:10240
 v_mfma_f32_16x16x32_bf16 v[148:151], a[100:103], a[80:83], v[148:151]
 v_mfma_f32_16x16x32_bf16 v[152:155], a[104:107], a[80:83], v[152:155]
 ds_read_b64_tr_b16 a[56:57], v231 offset:30720
 v_mfma_f32_16x16x32_bf16 v[124:127], a[104:107], a[76:79], v[124:127]
 v_mfma_f32_16x16x32_bf16 v[128:131], a[108:111], a[76:79], v[128:131]
 ds_read_b64_tr_b16 a[58:59], v231 offset:32512
 v_mfma_f32_16x16x32_bf16 v[156:159], a[108:111], a[80:83], v[156:159]
 v_mfma_f32_16x16x32_bf16 v[160:163], a[112:115], a[80:83], v[160:163]
 ds_read_b128 a[24:27], v227 offset:12288
 v_mfma_f32_16x16x32_bf16 v[132:135], a[112:115], a[76:79], v[132:135]
 v_mfma_f32_16x16x32_bf16 v[136:139], a[116:119], a[76:79], v[136:139]
 ds_read_b128 a[28:31], v227 offset:14336
 v_mfma_f32_16x16x32_bf16 v[164:167], a[116:119], a[80:83], v[164:167]
 v_mfma_f32_16x16x32_bf16 v[192:195], a[116:119], a[84:87], v[192:195]
 v_mfma_f32_16x16x32_bf16 v[220:223], a[116:119], a[88:91], v[220:223]
 v_mfma_f32_16x16x32_bf16 v[216:219], a[112:115], a[88:91], v[216:219]
 v_mfma_f32_16x16x32_bf16 v[188:191], a[112:115], a[84:87], v[188:191]
 v_mfma_f32_16x16x32_bf16 v[184:187], a[108:111], a[84:87], v[184:187]
 v_mfma_f32_16x16x32_bf16 v[212:215], a[108:111], a[88:91], v[212:215]
 v_mfma_f32_16x16x32_bf16 v[208:211], a[104:107], a[88:91], v[208:211]
 v_mfma_f32_16x16x32_bf16 v[180:183], a[104:107], a[84:87], v[180:183]
 v_mfma_f32_16x16x32_bf16 v[176:179], a[100:103], a[84:87], v[176:179]
 v_mfma_f32_16x16x32_bf16 v[204:207], a[100:103], a[88:91], v[204:207]
 v_mfma_f32_16x16x32_bf16 v[200:203], a[96:99], a[88:91], v[200:203]
 v_mfma_f32_16x16x32_bf16 v[172:175], a[96:99], a[84:87], v[172:175]
 v_mfma_f32_16x16x32_bf16 v[168:171], a[92:95], a[84:87], v[168:171]
 v_mfma_f32_16x16x32_bf16 v[196:199], a[92:95], a[88:91], v[196:199]
 s_waitcnt lgkmcnt(0)
 s_barrier
 v_mfma_f32_16x16x32_bf16 v[0:3], a[32:35], a[0:3], v[0:3]
 s_sub_u32 s52, s52, 1
 ds_read_b64_tr_b16 a[92:93], v229 offset:46080
 v_mfma_f32_16x16x32_bf16 v[28:31], a[32:35], a[4:7], v[28:31]
 ds_read_b64_tr_b16 a[94:95], v229 offset:47872
 v_mfma_f32_16x16x32_bf16 v[32:35], a[36:39], a[4:7], v[32:35]
 ds_read_b128 a[60:63], v228 offset:0
 v_mfma_f32_16x16x32_bf16 v[4:7], a[36:39], a[0:3], v[4:7]
 v_mfma_f32_16x16x32_bf16 v[8:11], a[40:43], a[0:3], v[8:11]
 ds_read_b64_tr_b16 a[96:97], v230 offset:46080
 v_mfma_f32_16x16x32_bf16 v[36:39], a[40:43], a[4:7], v[36:39]
 buffer_load_dword a206, v253, s[72:75], s54 offen
 s_add_u32 s54, s54, 262144
 v_mfma_f32_16x16x32_bf16 v[40:43], a[44:47], a[4:7], v[40:43]
 ds_read_b64_tr_b16 a[98:99], v230 offset:47872
 v_mfma_f32_16x16x32_bf16 v[12:15], a[44:47], a[0:3], v[12:15]
 v_mfma_f32_16x16x32_bf16 v[16:19], a[48:51], a[0:3], v[16:19]
 ds_read_b128 a[64:67], v228 offset:2048
 v_mfma_f32_16x16x32_bf16 v[44:47], a[48:51], a[4:7], v[44:47]
 v_mfma_f32_16x16x32_bf16 v[48:51], a[52:55], a[4:7], v[48:51]
 ds_read_b64_tr_b16 a[100:101], v229 offset:46144
 v_mfma_f32_16x16x32_bf16 v[20:23], a[52:55], a[0:3], v[20:23]
 v_mfma_f32_16x16x32_bf16 v[24:27], a[56:59], a[0:3], v[24:27]
 ds_read_b64_tr_b16 a[102:103], v229 offset:47936
 v_mfma_f32_16x16x32_bf16 v[52:55], a[56:59], a[4:7], v[52:55]
 v_mfma_f32_16x16x32_bf16 v[80:83], a[56:59], a[8:11], v[80:83]
 ds_read_b128 a[68:71], v228 offset:4096
 v_mfma_f32_16x16x32_bf16 v[108:111], a[56:59], a[12:15], v[108:111]
 v_mfma_f32_16x16x32_bf16 v[104:107], a[52:55], a[12:15], v[104:107]
 ds_read_b64_tr_b16 a[104:105], v230 offset:46144
 v_mfma_f32_16x16x32_bf16 v[76:79], a[52:55], a[8:11], v[76:79]
 v_mfma_f32_16x16x32_bf16 v[72:75], a[48:51], a[8:11], v[72:75]
 ds_read_b64_tr_b16 a[106:107], v230 offset:47936
 v_mfma_f32_16x16x32_bf16 v[100:103], a[48:51], a[12:15], v[100:103]
 v_mfma_f32_16x16x32_bf16 v[96:99], a[44:47], a[12:15], v[96:99]
 ds_read_b128 a[72:75], v228 offset:6144
 v_mfma_f32_16x16x32_bf16 v[68:71], a[44:47], a[8:11], v[68:71]
 v_mfma_f32_16x16x32_bf16 v[64:67], a[40:43], a[8:11], v[64:67]
 ds_read_b64_tr_b16 a[108:109], v229 offset:46208
 v_mfma_f32_16x16x32_bf16 v[92:95], a[40:43], a[12:15], v[92:95]
 v_mfma_f32_16x16x32_bf16 v[88:91], a[36:39], a[12:15], v[88:91]
 ds_read_b64_tr_b16 a[110:111], v229 offset:48000
 v_mfma_f32_16x16x32_bf16 v[60:63], a[36:39], a[8:11], v[60:63]
 v_mfma_f32_16x16x32_bf16 v[56:59], a[32:35], a[8:11], v[56:59]
 ds_read_b128 a[76:79], v228 offset:8192
 v_mfma_f32_16x16x32_bf16 v[84:87], a[32:35], a[12:15], v[84:87]
 v_mfma_f32_16x16x32_bf16 v[112:115], a[32:35], a[16:19], v[112:115]
 ds_read_b64_tr_b16 a[112:113], v230 offset:46208
 v_mfma_f32_16x16x32_bf16 v[140:143], a[32:35], a[20:23], v[140:143]
 buffer_load_dword a207, v254, s[76:79], s55 offen
 s_add_u32 s55, s55, 917504
 v_mfma_f32_16x16x32_bf16 v[144:147], a[36:39], a[20:23], v[144:147]
 ds_read_b64_tr_b16 a[114:115], v230 offset:48000
 v_mfma_f32_16x16x32_bf16 v[116:119], a[36:39], a[16:19], v[116:119]
 v_mfma_f32_16x16x32_bf16 v[120:123], a[40:43], a[16:19], v[120:123]
 ds_read_b128 a[80:83], v228 offset:10240
 v_mfma_f32_16x16x32_bf16 v[148:151], a[40:43], a[20:23], v[148:151]
 v_mfma_f32_16x16x32_bf16 v[152:155], a[44:47], a[20:23], v[152:155]
 ds_read_b64_tr_b16 a[116:117], v231 offset:46080
 v_mfma_f32_16x16x32_bf16 v[124:127], a[44:47], a[16:19], v[124:127]
 v_mfma_f32_16x16x32_bf16 v[128:131], a[48:51], a[16:19], v[128:131]
 ds_read_b64_tr_b16 a[118:119], v231 offset:47872
 v_mfma_f32_16x16x32_bf16 v[156:159], a[48:51], a[20:23], v[156:159]
 v_mfma_f32_16x16x32_bf16 v[160:163], a[52:55], a[20:23], v[160:163]
 ds_read_b128 a[84:87], v228 offset:12288
 v_mfma_f32_16x16x32_bf16 v[132:135], a[52:55], a[16:19], v[132:135]
 v_mfma_f32_16x16x32_bf16 v[136:139], a[56:59], a[16:19], v[136:139]
 ds_read_b128 a[88:91], v228 offset:14336
 v_mfma_f32_16x16x32_bf16 v[164:167], a[56:59], a[20:23], v[164:167]
 v_mfma_f32_16x16x32_bf16 v[192:195], a[56:59], a[24:27], v[192:195]
 v_mfma_f32_16x16x32_bf16 v[220:223], a[56:59], a[28:31], v[220:223]
 v_mfma_f32_16x16x32_bf16 v[216:219], a[52:55], a[28:31], v[216:219]
 v_mfma_f32_16x16x32_bf16 v[188:191], a[52:55], a[24:27], v[188:191]
 v_mfma_f32_16x16x32_bf16 v[184:187], a[48:51], a[24:27], v[184:187]
 v_mfma_f32_16x16x32_bf16 v[212:215], a[48:51], a[28:31], v[212:215]
 v_mfma_f32_16x16x32_bf16 v[208:211], a[44:47], a[28:31], v[208:211]
 v_mfma_f32_16x16x32_bf16 v[180:183], a[44:47], a[24:27], v[180:183]
 v_mfma_f32_16x16x32_bf16 v[176:179], a[40:43], a[24:27], v[176:179]
 v_mfma_f32_16x16x32_bf16 v[204:207], a[40:43], a[28:31], v[204:207]
 v_mfma_f32_16x16x32_bf16 v[200:203], a[36:39], a[28:31], v[200:203]
 v_mfma_f32_16x16x32_bf16 v[172:175], a[36:39], a[24:27], v[172:175]
 v_mfma_f32_16x16x32_bf16 v[168:171], a[32:35], a[24:27], v[168:171]
 v_mfma_f32_16x16x32_bf16 v[196:199], a[32:35], a[28:31], v[196:199]
 s_waitcnt lgkmcnt(0)
 s_barrier
 v_mfma_f32_16x16x32_bf16 v[0:3], a[92:95], a[60:63], v[0:3]
 v_add_u32 v227, s47, v225
 v_add_u32 v228, s47, v226
 s_mov_b32 s53, s46
 ds_read_b64_tr_b16 a[32:33], v229 offset:0
 v_mfma_f32_16x16x32_bf16 v[28:31], a[92:95], a[64:67], v[28:31]
 s_mov_b32 s46, s47
 s_mov_b32 s47, s48
 s_mov_b32 s48, s53
 ds_read_b64_tr_b16 a[34:35], v229 offset:1792
 v_mfma_f32_16x16x32_bf16 v[32:35], a[96:99], a[64:67], v[32:35]
 ds_read_b128 a[0:3], v227 offset:0
 v_mfma_f32_16x16x32_bf16 v[4:7], a[96:99], a[60:63], v[4:7]
 v_mfma_f32_16x16x32_bf16 v[8:11], a[100:103], a[60:63], v[8:11]
 ds_read_b64_tr_b16 a[36:37], v230 offset:0
 s_cmp_eq_u32 s28, 0
 s_cselect_b32 s29, s59, 0x1000
 s_mov_b64 exec, 1
 buffer_atomic_add a252, off, s[60:63], s29 sc1
 s_mov_b64 exec, -1
 s_sub_u32 s28, s28, 1
 v_mfma_f32_16x16x32_bf16 v[36:39], a[100:103], a[64:67], v[36:39]
 buffer_load_dword a204, v252, s[16:19], s51 offen
 s_add_u32 s51, s51, 458752
 v_mfma_f32_16x16x32_bf16 v[40:43], a[104:107], a[64:67], v[40:43]
 ds_read_b64_tr_b16 a[38:39], v230 offset:1792
 v_mfma_f32_16x16x32_bf16 v[12:15], a[104:107], a[60:63], v[12:15]
 v_mfma_f32_16x16x32_bf16 v[16:19], a[108:111], a[60:63], v[16:19]
 ds_read_b128 a[4:7], v227 offset:2048
 v_mfma_f32_16x16x32_bf16 v[44:47], a[108:111], a[64:67], v[44:47]
 v_mfma_f32_16x16x32_bf16 v[48:51], a[112:115], a[64:67], v[48:51]
 ds_read_b64_tr_b16 a[40:41], v229 offset:64
 v_mfma_f32_16x16x32_bf16 v[20:23], a[112:115], a[60:63], v[20:23]
 v_mfma_f32_16x16x32_bf16 v[24:27], a[116:119], a[60:63], v[24:27]
 ds_read_b64_tr_b16 a[42:43], v229 offset:1856
 v_mfma_f32_16x16x32_bf16 v[52:55], a[116:119], a[64:67], v[52:55]
 v_mfma_f32_16x16x32_bf16 v[80:83], a[116:119], a[68:71], v[80:83]
 ds_read_b128 a[8:11], v227 offset:4096
 v_mfma_f32_16x16x32_bf16 v[108:111], a[116:119], a[72:75], v[108:111]
 v_mfma_f32_16x16x32_bf16 v[104:107], a[112:115], a[72:75], v[104:107]
 ds_read_b64_tr_b16 a[44:45], v230 offset:64
 v_mfma_f32_16x16x32_bf16 v[76:79], a[112:115], a[68:71], v[76:79]
 v_mfma_f32_16x16x32_bf16 v[72:75], a[108:111], a[68:71], v[72:75]
 ds_read_b64_tr_b16 a[46:47], v230 offset:1856
 v_mfma_f32_16x16x32_bf16 v[100:103], a[108:111], a[72:75], v[100:103]
 v_mfma_f32_16x16x32_bf16 v[96:99], a[104:107], a[72:75], v[96:99]
 ds_read_b128 a[12:15], v227 offset:6144
 v_mfma_f32_16x16x32_bf16 v[68:71], a[104:107], a[68:71], v[68:71]
 v_mfma_f32_16x16x32_bf16 v[64:67], a[100:103], a[68:71], v[64:67]
 ds_read_b64_tr_b16 a[48:49], v229 offset:128
 v_mfma_f32_16x16x32_bf16 v[92:95], a[100:103], a[72:75], v[92:95]
 v_mfma_f32_16x16x32_bf16 v[88:91], a[96:99], a[72:75], v[88:91]
 ds_read_b64_tr_b16 a[50:51], v229 offset:1920
 v_mfma_f32_16x16x32_bf16 v[60:63], a[96:99], a[68:71], v[60:63]
 v_mfma_f32_16x16x32_bf16 v[56:59], a[92:95], a[68:71], v[56:59]
 ds_read_b128 a[16:19], v227 offset:8192
 v_mfma_f32_16x16x32_bf16 v[84:87], a[92:95], a[72:75], v[84:87]
 v_mfma_f32_16x16x32_bf16 v[112:115], a[92:95], a[76:79], v[112:115]
 ds_read_b64_tr_b16 a[52:53], v230 offset:128
 s_cmp_lt_u32 s50, 2048
 s_cselect_b32 s14, 0x400000, 0
 v_mfma_f32_16x16x32_bf16 v[140:143], a[92:95], a[80:83], v[140:143]
 buffer_load_dword a205, v239, s[12:15], s50 offen
 s_add_u32 s50, s50, 128
 v_mfma_f32_16x16x32_bf16 v[144:147], a[96:99], a[80:83], v[144:147]
 ds_read_b64_tr_b16 a[54:55], v230 offset:1920
 v_mfma_f32_16x16x32_bf16 v[116:119], a[96:99], a[76:79], v[116:119]
 v_mfma_f32_16x16x32_bf16 v[120:123], a[100:103], a[76:79], v[120:123]
 ds_read_b128 a[20:23], v227 offset:10240
 v_mfma_f32_16x16x32_bf16 v[148:151], a[100:103], a[80:83], v[148:151]
 v_mfma_f32_16x16x32_bf16 v[152:155], a[104:107], a[80:83], v[152:155]
 ds_read_b64_tr_b16 a[56:57], v231 offset:0
 v_mfma_f32_16x16x32_bf16 v[124:127], a[104:107], a[76:79], v[124:127]
 v_mfma_f32_16x16x32_bf16 v[128:131], a[108:111], a[76:79], v[128:131]
 ds_read_b64_tr_b16 a[58:59], v231 offset:1792
 v_mfma_f32_16x16x32_bf16 v[156:159], a[108:111], a[80:83], v[156:159]
 v_mfma_f32_16x16x32_bf16 v[160:163], a[112:115], a[80:83], v[160:163]
 ds_read_b128 a[24:27], v227 offset:12288
 v_mfma_f32_16x16x32_bf16 v[132:135], a[112:115], a[76:79], v[132:135]
 v_mfma_f32_16x16x32_bf16 v[136:139], a[116:119], a[76:79], v[136:139]
 ds_read_b128 a[28:31], v227 offset:14336
 v_mfma_f32_16x16x32_bf16 v[164:167], a[116:119], a[80:83], v[164:167]
 v_mfma_f32_16x16x32_bf16 v[192:195], a[116:119], a[84:87], v[192:195]
 v_mfma_f32_16x16x32_bf16 v[220:223], a[116:119], a[88:91], v[220:223]
 v_mfma_f32_16x16x32_bf16 v[216:219], a[112:115], a[88:91], v[216:219]
 v_mfma_f32_16x16x32_bf16 v[188:191], a[112:115], a[84:87], v[188:191]
 v_mfma_f32_16x16x32_bf16 v[184:187], a[108:111], a[84:87], v[184:187]
 v_mfma_f32_16x16x32_bf16 v[212:215], a[108:111], a[88:91], v[212:215]
 v_mfma_f32_16x16x32_bf16 v[208:211], a[104:107], a[88:91], v[208:211]
 v_mfma_f32_16x16x32_bf16 v[180:183], a[104:107], a[84:87], v[180:183]
 v_mfma_f32_16x16x32_bf16 v[176:179], a[100:103], a[84:87], v[176:179]
 v_mfma_f32_16x16x32_bf16 v[204:207], a[100:103], a[88:91], v[204:207]
 v_mfma_f32_16x16x32_bf16 v[200:203], a[96:99], a[88:91], v[200:203]
 v_mfma_f32_16x16x32_bf16 v[172:175], a[96:99], a[84:87], v[172:175]
 v_mfma_f32_16x16x32_bf16 v[168:171], a[92:95], a[84:87], v[168:171]
 v_mfma_f32_16x16x32_bf16 v[196:199], a[92:95], a[88:91], v[196:199]
 s_cmp_lg_u32 s52, 0
 s_cbranch_scc1 L1hP_loop
 s_waitcnt lgkmcnt(0)
 s_barrier
 v_mfma_f32_16x16x32_bf16 v[0:3], a[32:35], a[0:3], v[0:3]
 ds_read_b64_tr_b16 a[92:93], v229 offset:15360
 v_mfma_f32_16x16x32_bf16 v[28:31], a[32:35], a[4:7], v[28:31]
 ds_read_b64_tr_b16 a[94:95], v229 offset:17152
 v_mfma_f32_16x16x32_bf16 v[32:35], a[36:39], a[4:7], v[32:35]
 ds_read_b128 a[60:63], v228 offset:0
 v_mfma_f32_16x16x32_bf16 v[4:7], a[36:39], a[0:3], v[4:7]
 v_mfma_f32_16x16x32_bf16 v[8:11], a[40:43], a[0:3], v[8:11]
 ds_read_b64_tr_b16 a[96:97], v230 offset:15360
 v_lshlrev_b32 v235, 6, v224
 v_mfma_f32_16x16x32_bf16 v[36:39], a[40:43], a[4:7], v[36:39]
 buffer_load_dword a204, v235, s[92:95], s91 offen
 v_mfma_f32_16x16x32_bf16 v[40:43], a[44:47], a[4:7], v[40:43]
 ds_read_b64_tr_b16 a[98:99], v230 offset:17152
 v_mfma_f32_16x16x32_bf16 v[12:15], a[44:47], a[0:3], v[12:15]
 v_mfma_f32_16x16x32_bf16 v[16:19], a[48:51], a[0:3], v[16:19]
 ds_read_b128 a[64:67], v228 offset:2048
 v_mfma_f32_16x16x32_bf16 v[44:47], a[48:51], a[4:7], v[44:47]
 v_mfma_f32_16x16x32_bf16 v[48:51], a[52:55], a[4:7], v[48:51]
 ds_read_b64_tr_b16 a[100:101], v229 offset:15424
 v_mfma_f32_16x16x32_bf16 v[20:23], a[52:55], a[0:3], v[20:23]
 v_mfma_f32_16x16x32_bf16 v[24:27], a[56:59], a[0:3], v[24:27]
 ds_read_b64_tr_b16 a[102:103], v229 offset:17216
 v_mfma_f32_16x16x32_bf16 v[52:55], a[56:59], a[4:7], v[52:55]
 v_mfma_f32_16x16x32_bf16 v[80:83], a[56:59], a[8:11], v[80:83]
 ds_read_b128 a[68:71], v228 offset:4096
 v_mfma_f32_16x16x32_bf16 v[108:111], a[56:59], a[12:15], v[108:111]
 v_mfma_f32_16x16x32_bf16 v[104:107], a[52:55], a[12:15], v[104:107]
 ds_read_b64_tr_b16 a[104:105], v230 offset:15424
 v_mfma_f32_16x16x32_bf16 v[76:79], a[52:55], a[8:11], v[76:79]
 v_mfma_f32_16x16x32_bf16 v[72:75], a[48:51], a[8:11], v[72:75]
 ds_read_b64_tr_b16 a[106:107], v230 offset:17216
 v_mfma_f32_16x16x32_bf16 v[100:103], a[48:51], a[12:15], v[100:103]
 v_mfma_f32_16x16x32_bf16 v[96:99], a[44:47], a[12:15], v[96:99]
 ds_read_b128 a[72:75], v228 offset:6144
 v_mfma_f32_16x16x32_bf16 v[68:71], a[44:47], a[8:11], v[68:71]
 buffer_load_dword a206, v253, s[72:75], s54 offen
 s_add_u32 s54, s54, 262144
 v_mfma_f32_16x16x32_bf16 v[64:67], a[40:43], a[8:11], v[64:67]
 ds_read_b64_tr_b16 a[108:109], v229 offset:15488
 v_mfma_f32_16x16x32_bf16 v[92:95], a[40:43], a[12:15], v[92:95]
 v_mfma_f32_16x16x32_bf16 v[88:91], a[36:39], a[12:15], v[88:91]
 ds_read_b64_tr_b16 a[110:111], v229 offset:17280
 v_mfma_f32_16x16x32_bf16 v[60:63], a[36:39], a[8:11], v[60:63]
 v_mfma_f32_16x16x32_bf16 v[56:59], a[32:35], a[8:11], v[56:59]
 ds_read_b128 a[76:79], v228 offset:8192
 v_mfma_f32_16x16x32_bf16 v[84:87], a[32:35], a[12:15], v[84:87]
 v_mfma_f32_16x16x32_bf16 v[112:115], a[32:35], a[16:19], v[112:115]
 ds_read_b64_tr_b16 a[112:113], v230 offset:15488
 v_mfma_f32_16x16x32_bf16 v[140:143], a[32:35], a[20:23], v[140:143]
 v_mfma_f32_16x16x32_bf16 v[144:147], a[36:39], a[20:23], v[144:147]
 ds_read_b64_tr_b16 a[114:115], v230 offset:17280
 v_mfma_f32_16x16x32_bf16 v[116:119], a[36:39], a[16:19], v[116:119]
 v_mfma_f32_16x16x32_bf16 v[120:123], a[40:43], a[16:19], v[120:123]
 ds_read_b128 a[80:83], v228 offset:10240
 v_mfma_f32_16x16x32_bf16 v[148:151], a[40:43], a[20:23], v[148:151]
 v_mfma_f32_16x16x32_bf16 v[152:155], a[44:47], a[20:23], v[152:155]
 ds_read_b64_tr_b16 a[116:117], v231 offset:15360
 v_mfma_f32_16x16x32_bf16 v[124:127], a[44:47], a[16:19], v[124:127]
 v_mfma_f32_16x16x32_bf16 v[128:131], a[48:51], a[16:19], v[128:131]
 ds_read_b64_tr_b16 a[118:119], v231 offset:17152
 v_mfma_f32_16x16x32_bf16 v[156:159], a[48:51], a[20:23], v[156:159]
 buffer_load_dword a207, v254, s[76:79], s55 offen
 s_add_u32 s55, s55, 917504
 v_mfma_f32_16x16x32_bf16 v[160:163], a[52:55], a[20:23], v[160:163]
 ds_read_b128 a[84:87], v228 offset:12288
 v_mfma_f32_16x16x32_bf16 v[132:135], a[52:55], a[16:19], v[132:135]
 v_mfma_f32_16x16x32_bf16 v[136:139], a[56:59], a[16:19], v[136:139]
 ds_read_b128 a[88:91], v228 offset:14336
 v_mfma_f32_16x16x32_bf16 v[164:167], a[56:59], a[20:23], v[164:167]
 v_mfma_f32_16x16x32_bf16 v[192:195], a[56:59], a[24:27], v[192:195]
 v_mfma_f32_16x16x32_bf16 v[220:223], a[56:59], a[28:31], v[220:223]
 v_mfma_f32_16x16x32_bf16 v[216:219], a[52:55], a[28:31], v[216:219]
 v_mfma_f32_16x16x32_bf16 v[188:191], a[52:55], a[24:27], v[188:191]
 v_mfma_f32_16x16x32_bf16 v[184:187], a[48:51], a[24:27], v[184:187]
 v_mfma_f32_16x16x32_bf16 v[212:215], a[48:51], a[28:31], v[212:215]
 v_mfma_f32_16x16x32_bf16 v[208:211], a[44:47], a[28:31], v[208:211]
 v_mfma_f32_16x16x32_bf16 v[180:183], a[44:47], a[24:27], v[180:183]
 v_mfma_f32_16x16x32_bf16 v[176:179], a[40:43], a[24:27], v[176:179]
 v_mfma_f32_16x16x32_bf16 v[204:207], a[40:43], a[28:31], v[204:207]
 v_mfma_f32_16x16x32_bf16 v[200:203], a[36:39], a[28:31], v[200:203]
 v_mfma_f32_16x16x32_bf16 v[172:175], a[36:39], a[24:27], v[172:175]
 v_mfma_f32_16x16x32_bf16 v[168:171], a[32:35], a[24:27], v[168:171]
 v_mfma_f32_16x16x32_bf16 v[196:199], a[32:35], a[28:31], v[196:199]
 s_waitcnt lgkmcnt(0)
 s_barrier
 v_mfma_f32_16x16x32_bf16 v[0:3], a[92:95], a[60:63], v[0:3]
 v_add_u32 v227, s47, v225
 v_add_u32 v228, s47, v226
 s_mov_b32 s53, s46
 ds_read_b64_tr_b16 a[32:33], v229 offset:30720
 v_mfma_f32_16x16x32_bf16 v[28:31], a[92:95], a[64:67], v[28:31]
 s_mov_b32 s46, s47
 s_mov_b32 s47, s48
 s_mov_b32 s48, s53
 ds_read_b64_tr_b16 a[34:35], v229 offset:32512
 v_mfma_f32_16x16x32_bf16 v[32:35], a[96:99], a[64:67], v[32:35]
 ds_read_b128 a[0:3], v227 offset:0
 v_mfma_f32_16x16x32_bf16 v[4:7], a[96:99], a[60:63], v[4:7]
 v_mfma_f32_16x16x32_bf16 v[8:11], a[100:103], a[60:63], v[8:11]
 ds_read_b64_tr_b16 a[36:37], v230 offset:30720
 v_mfma_f32_16x16x32_bf16 v[36:39], a[100:103], a[64:67], v[36:39]
 buffer_load_dword a204, v252, s[16:19], s51 offen
 s_add_u32 s51, s51, 458752
 v_mfma_f32_16x16x32_bf16 v[40:43], a[104:107], a[64:67], v[40:43]
 ds_read_b64_tr_b16 a[38:39], v230 offset:32512
 v_mfma_f32_16x16x32_bf16 v[12:15], a[104:107], a[60:63], v[12:15]
 v_mfma_f32_16x16x32_bf16 v[16:19], a[108:111], a[60:63], v[16:19]
 ds_read_b128 a[4:7], v227 offset:2048
 v_mfma_f32_16x16x32_bf16 v[44:47], a[108:111], a[64:67], v[44:47]
 v_mfma_f32_16x16x32_bf16 v[48:51], a[112:115], a[64:67], v[48:51]
 ds_read_b64_tr_b16 a[40:41], v229 offset:30784
 v_mfma_f32_16x16x32_bf16 v[20:23], a[112:115], a[60:63], v[20:23]
 v_mfma_f32_16x16x32_bf16 v[24:27], a[116:119], a[60:63], v[24:27]
 ds_read_b64_tr_b16 a[42:43], v229 offset:32576
 v_mfma_f32_16x16x32_bf16 v[52:55], a[116:119], a[64:67], v[52:55]
 v_mfma_f32_16x16x32_bf16 v[80:83], a[116:119], a[68:71], v[80:83]
 ds_read_b128 a[8:11], v227 offset:4096
 v_mfma_f32_16x16x32_bf16 v[108:111], a[116:119], a[72:75], v[108:111]
 v_mfma_f32_16x16x32_bf16 v[104:107], a[112:115], a[72:75], v[104:107]
 ds_read_b64_tr_b16 a[44:45], v230 offset:30784
 v_mfma_f32_16x16x32_bf16 v[76:79], a[112:115], a[68:71], v[76:79]
 v_mfma_f32_16x16x32_bf16 v[72:75], a[108:111], a[68:71], v[72:75]
 ds_read_b64_tr_b16 a[46:47], v230 offset:32576
 v_mfma_f32_16x16x32_bf16 v[100:103], a[108:111], a[72:75], v[100:103]
 v_mfma_f32_16x16x32_bf16 v[96:99], a[104:107], a[72:75], v[96:99]
 ds_read_b128 a[12:15], v227 offset:6144
 v_mfma_f32_16x16x32_bf16 v[68:71], a[104:107], a[68:71], v[68:71]
 v_mfma_f32_16x16x32_bf16 v[64:67], a[100:103], a[68:71], v[64:67]
 ds_read_b64_tr_b16 a[48:49], v229 offset:30848
 v_mfma_f32_16x16x32_bf16 v[92:95], a[100:103], a[72:75], v[92:95]
 v_mfma_f32_16x16x32_bf16 v[88:91], a[96:99], a[72:75], v[88:91]
 ds_read_b64_tr_b16 a[50:51], v229 offset:32640
 v_mfma_f32_16x16x32_bf16 v[60:63], a[96:99], a[68:71], v[60:63]
 v_mfma_f32_16x16x32_bf16 v[56:59], a[92:95], a[68:71], v[56:59]
 ds_read_b128 a[16:19], v227 offset:8192
 v_mfma_f32_16x16x32_bf16 v[84:87], a[92:95], a[72:75], v[84:87]
 v_mfma_f32_16x16x32_bf16 v[112:115], a[92:95], a[76:79], v[112:115]
 ds_read_b64_tr_b16 a[52:53], v230 offset:30848
 s_cmp_lt_u32 s50, 2048
 s_cselect_b32 s14, 0x400000, 0
 v_mfma_f32_16x16x32_bf16 v[140:143], a[92:95], a[80:83], v[140:143]
 buffer_load_dword a205, v239, s[12:15], s50 offen
 s_add_u32 s50, s50, 128
 v_mfma_f32_16x16x32_bf16 v[144:147], a[96:99], a[80:83], v[144:147]
 ds_read_b64_tr_b16 a[54:55], v230 offset:32640
 v_mfma_f32_16x16x32_bf16 v[116:119], a[96:99], a[76:79], v[116:119]
 v_mfma_f32_16x16x32_bf16 v[120:123], a[100:103], a[76:79], v[120:123]
 ds_read_b128 a[20:23], v227 offset:10240
 v_mfma_f32_16x16x32_bf16 v[148:151], a[100:103], a[80:83], v[148:151]
 v_mfma_f32_16x16x32_bf16 v[152:155], a[104:107], a[80:83], v[152:155]
 ds_read_b64_tr_b16 a[56:57], v231 offset:30720
 v_mfma_f32_16x16x32_bf16 v[124:127], a[104:107], a[76:79], v[124:127]
 v_mfma_f32_16x16x32_bf16 v[128:131], a[108:111], a[76:79], v[128:131]
 ds_read_b64_tr_b16 a[58:59], v231 offset:32512
 v_mfma_f32_16x16x32_bf16 v[156:159], a[108:111], a[80:83], v[156:159]
 v_mfma_f32_16x16x32_bf16 v[160:163], a[112:115], a[80:83], v[160:163]
 ds_read_b128 a[24:27], v227 offset:12288
 v_mfma_f32_16x16x32_bf16 v[132:135], a[112:115], a[76:79], v[132:135]
 v_mfma_f32_16x16x32_bf16 v[136:139], a[116:119], a[76:79], v[136:139]
 ds_read_b128 a[28:31], v227 offset:14336
 v_mfma_f32_16x16x32_bf16 v[164:167], a[116:119], a[80:83], v[164:167]
 v_mfma_f32_16x16x32_bf16 v[192:195], a[116:119], a[84:87], v[192:195]
 v_mfma_f32_16x16x32_bf16 v[220:223], a[116:119], a[88:91], v[220:223]
 v_mfma_f32_16x16x32_bf16 v[216:219], a[112:115], a[88:91], v[216:219]
 v_mfma_f32_16x16x32_bf16 v[188:191], a[112:115], a[84:87], v[188:191]
 v_mfma_f32_16x16x32_bf16 v[184:187], a[108:111], a[84:87], v[184:187]
 v_mfma_f32_16x16x32_bf16 v[212:215], a[108:111], a[88:91], v[212:215]
 v_mfma_f32_16x16x32_bf16 v[208:211], a[104:107], a[88:91], v[208:211]
 v_mfma_f32_16x16x32_bf16 v[180:183], a[104:107], a[84:87], v[180:183]
 v_mfma_f32_16x16x32_bf16 v[176:179], a[100:103], a[84:87], v[176:179]
 v_mfma_f32_16x16x32_bf16 v[204:207], a[100:103], a[88:91], v[204:207]
 v_mfma_f32_16x16x32_bf16 v[200:203], a[96:99], a[88:91], v[200:203]
 v_mfma_f32_16x16x32_bf16 v[172:175], a[96:99], a[84:87], v[172:175]
 v_mfma_f32_16x16x32_bf16 v[168:171], a[92:95], a[84:87], v[168:171]
 v_mfma_f32_16x16x32_bf16 v[196:199], a[92:95], a[88:91], v[196:199]
 s_waitcnt lgkmcnt(0)
 s_barrier
 v_mfma_f32_16x16x32_bf16 v[0:3], a[32:35], a[0:3], v[0:3]
 ds_read_b64_tr_b16 a[92:93], v229 offset:46080
 v_mfma_f32_16x16x32_bf16 v[28:31], a[32:35], a[4:7], v[28:31]
 ds_read_b64_tr_b16 a[94:95], v229 offset:47872
 v_mfma_f32_16x16x32_bf16 v[32:35], a[36:39], a[4:7], v[32:35]
 ds_read_b128 a[60:63], v228 offset:0
 v_mfma_f32_16x16x32_bf16 v[4:7], a[36:39], a[0:3], v[4:7]
 v_mfma_f32_16x16x32_bf16 v[8:11], a[40:43], a[0:3], v[8:11]
 ds_read_b64_tr_b16 a[96:97], v230 offset:46080
 v_mfma_f32_16x16x32_bf16 v[36:39], a[40:43], a[4:7], v[36:39]
 s_and_b32 s43, s30, 6
 s_lshl_b32 s43, s43, 2
 buffer_load_dwordx2 a[250:251], off, s[60:63], s43 sc1
 v_mfma_f32_16x16x32_bf16 v[40:43], a[44:47], a[4:7], v[40:43]
 ds_read_b64_tr_b16 a[98:99], v230 offset:47872
 v_mfma_f32_16x16x32_bf16 v[12:15], a[44:47], a[0:3], v[12:15]
 v_mfma_f32_16x16x32_bf16 v[16:19], a[48:51], a[0:3], v[16:19]
 ds_read_b128 a[64:67], v228 offset:2048
 v_mfma_f32_16x16x32_bf16 v[44:47], a[48:51], a[4:7], v[44:47]
 v_mfma_f32_16x16x32_bf16 v[48:51], a[52:55], a[4:7], v[48:51]
 ds_read_b64_tr_b16 a[100:101], v229 offset:46144
 v_mfma_f32_16x16x32_bf16 v[20:23], a[52:55], a[0:3], v[20:23]
 v_mfma_f32_16x16x32_bf16 v[24:27], a[56:59], a[0:3], v[24:27]
 ds_read_b64_tr_b16 a[102:103], v229 offset:47936
 v_mfma_f32_16x16x32_bf16 v[52:55], a[56:59], a[4:7], v[52:55]
 v_mfma_f32_16x16x32_bf16 v[80:83], a[56:59], a[8:11], v[80:83]
 ds_read_b128 a[68:71], v228 offset:4096
 v_mfma_f32_16x16x32_bf16 v[108:111], a[56:59], a[12:15], v[108:111]
 v_mfma_f32_16x16x32_bf16 v[104:107], a[52:55], a[12:15], v[104:107]
 ds_read_b64_tr_b16 a[104:105], v230 offset:46144
 v_mfma_f32_16x16x32_bf16 v[76:79], a[52:55], a[8:11], v[76:79]
 v_mfma_f32_16x16x32_bf16 v[72:75], a[48:51], a[8:11], v[72:75]
 ds_read_b64_tr_b16 a[106:107], v230 offset:47936
 v_mfma_f32_16x16x32_bf16 v[100:103], a[48:51], a[12:15], v[100:103]
 v_mfma_f32_16x16x32_bf16 v[96:99], a[44:47], a[12:15], v[96:99]
 ds_read_b128 a[72:75], v228 offset:6144
 v_mfma_f32_16x16x32_bf16 v[68:71], a[44:47], a[8:11], v[68:71]
 buffer_load_dword a206, v253, s[72:75], s54 offen
 s_add_u32 s54, s54, 262144
 v_mfma_f32_16x16x32_bf16 v[64:67], a[40:43], a[8:11], v[64:67]
 ds_read_b64_tr_b16 a[108:109], v229 offset:46208
 v_mfma_f32_16x16x32_bf16 v[92:95], a[40:43], a[12:15], v[92:95]
 v_mfma_f32_16x16x32_bf16 v[88:91], a[36:39], a[12:15], v[88:91]
 ds_read_b64_tr_b16 a[110:111], v229 offset:48000
 v_mfma_f32_16x16x32_bf16 v[60:63], a[36:39], a[8:11], v[60:63]
 v_mfma_f32_16x16x32_bf16 v[56:59], a[32:35], a[8:11], v[56:59]
 ds_read_b128 a[76:79], v228 offset:8192
 v_mfma_f32_16x16x32_bf16 v[84:87], a[32:35], a[12:15], v[84:87]
 v_mfma_f32_16x16x32_bf16 v[112:115], a[32:35], a[16:19], v[112:115]
 ds_read_b64_tr_b16 a[112:113], v230 offset:46208
 v_mfma_f32_16x16x32_bf16 v[140:143], a[32:35], a[20:23], v[140:143]
 v_mfma_f32_16x16x32_bf16 v[144:147], a[36:39], a[20:23], v[144:147]
 ds_read_b64_tr_b16 a[114:115], v230 offset:48000
 v_mfma_f32_16x16x32_bf16 v[116:119], a[36:39], a[16:19], v[116:119]
 v_mfma_f32_16x16x32_bf16 v[120:123], a[40:43], a[16:19], v[120:123]
 ds_read_b128 a[80:83], v228 offset:10240
 v_mfma_f32_16x16x32_bf16 v[148:151], a[40:43], a[20:23], v[148:151]
 v_mfma_f32_16x16x32_bf16 v[152:155], a[44:47], a[20:23], v[152:155]
 ds_read_b64_tr_b16 a[116:117], v231 offset:46080
 v_mfma_f32_16x16x32_bf16 v[124:127], a[44:47], a[16:19], v[124:127]
 v_mfma_f32_16x16x32_bf16 v[128:131], a[48:51], a[16:19], v[128:131]
 ds_read_b64_tr_b16 a[118:119], v231 offset:47872
 v_mfma_f32_16x16x32_bf16 v[156:159], a[48:51], a[20:23], v[156:159]
 buffer_load_dword a207, v254, s[76:79], s55 offen
 s_add_u32 s55, s55, 917504
 v_mfma_f32_16x16x32_bf16 v[160:163], a[52:55], a[20:23], v[160:163]
 ds_read_b128 a[84:87], v228 offset:12288
 v_mfma_f32_16x16x32_bf16 v[132:135], a[52:55], a[16:19], v[132:135]
 v_mfma_f32_16x16x32_bf16 v[136:139], a[56:59], a[16:19], v[136:139]
 ds_read_b128 a[88:91], v228 offset:14336
 v_mfma_f32_16x16x32_bf16 v[164:167], a[56:59], a[20:23], v[164:167]
 v_mfma_f32_16x16x32_bf16 v[192:195], a[56:59], a[24:27], v[192:195]
 v_mfma_f32_16x16x32_bf16 v[220:223], a[56:59], a[28:31], v[220:223]
 v_mfma_f32_16x16x32_bf16 v[216:219], a[52:55], a[28:31], v[216:219]
 v_mfma_f32_16x16x32_bf16 v[188:191], a[52:55], a[24:27], v[188:191]
 v_mfma_f32_16x16x32_bf16 v[184:187], a[48:51], a[24:27], v[184:187]
 v_mfma_f32_16x16x32_bf16 v[212:215], a[48:51], a[28:31], v[212:215]
 v_mfma_f32_16x16x32_bf16 v[208:211], a[44:47], a[28:31], v[208:211]
 v_mfma_f32_16x16x32_bf16 v[180:183], a[44:47], a[24:27], v[180:183]
 v_mfma_f32_16x16x32_bf16 v[176:179], a[40:43], a[24:27], v[176:179]
 v_mfma_f32_16x16x32_bf16 v[204:207], a[40:43], a[28:31], v[204:207]
 v_mfma_f32_16x16x32_bf16 v[200:203], a[36:39], a[28:31], v[200:203]
 v_mfma_f32_16x16x32_bf16 v[172:175], a[36:39], a[24:27], v[172:175]
 v_mfma_f32_16x16x32_bf16 v[168:171], a[32:35], a[24:27], v[168:171]
 v_mfma_f32_16x16x32_bf16 v[196:199], a[32:35], a[28:31], v[196:199]
 s_waitcnt lgkmcnt(0)
 s_barrier
 v_mfma_f32_16x16x32_bf16 v[0:3], a[92:95], a[60:63], v[0:3]
 v_add_u32 v227, s47, v225
 v_add_u32 v228, s47, v226
 v_add_u32 v225, 61440, v225
 ds_read_b64_tr_b16 a[0:1], v229 offset:0
 v_mfma_f32_16x16x32_bf16 v[28:31], a[92:95], a[64:67], v[28:31]
 v_add_u32 v226, 61440, v226
 ds_read_b64_tr_b16 a[2:3], v229 offset:1792
 v_mfma_f32_16x16x32_bf16 v[32:35], a[96:99], a[64:67], v[32:35]
 ds_read_b64_tr_b16 a[4:5], v230 offset:0
 v_mfma_f32_16x16x32_bf16 v[4:7], a[96:99], a[60:63], v[4:7]
 ds_read_b64_tr_b16 a[6:7], v230 offset:1792
 v_mfma_f32_16x16x32_bf16 v[8:11], a[100:103], a[60:63], v[8:11]
 v_mfma_f32_16x16x32_bf16 v[36:39], a[100:103], a[64:67], v[36:39]
 ds_read_b64_tr_b16 a[8:9], v229 offset:64
 v_mfma_f32_16x16x32_bf16 v[40:43], a[104:107], a[64:67], v[40:43]
 v_mfma_f32_16x16x32_bf16 v[12:15], a[104:107], a[60:63], v[12:15]
 ds_read_b64_tr_b16 a[10:11], v229 offset:1856
 v_mfma_f32_16x16x32_bf16 v[16:19], a[108:111], a[60:63], v[16:19]
 v_mfma_f32_16x16x32_bf16 v[44:47], a[108:111], a[64:67], v[44:47]
 ds_read_b64_tr_b16 a[12:13], v230 offset:64
 v_mfma_f32_16x16x32_bf16 v[48:51], a[112:115], a[64:67], v[48:51]
 ds_read_b64_tr_b16 a[14:15], v230 offset:1856
 v_mfma_f32_16x16x32_bf16 v[20:23], a[112:115], a[60:63], v[20:23]
 v_mfma_f32_16x16x32_bf16 v[24:27], a[116:119], a[60:63], v[24:27]
 ds_read_b64_tr_b16 a[16:17], v229 offset:128
 v_mfma_f32_16x16x32_bf16 v[52:55], a[116:119], a[64:67], v[52:55]
 v_mfma_f32_16x16x32_bf16 v[80:83], a[116:119], a[68:71], v[80:83]
 ds_read_b64_tr_b16 a[18:19], v229 offset:1920
 v_mfma_f32_16x16x32_bf16 v[108:111], a[116:119], a[72:75], v[108:111]
 v_mfma_f32_16x16x32_bf16 v[104:107], a[112:115], a[72:75], v[104:107]
 ds_read_b64_tr_b16 a[20:21], v230 offset:128
 v_mfma_f32_16x16x32_bf16 v[76:79], a[112:115], a[68:71], v[76:79]
 ds_read_b64_tr_b16 a[22:23], v230 offset:1920
 v_mfma_f32_16x16x32_bf16 v[72:75], a[108:111], a[68:71], v[72:75]
 v_mfma_f32_16x16x32_bf16 v[100:103], a[108:111], a[72:75], v[100:103]
 ds_read_b64_tr_b16 a[24:25], v231 offset:0
 v_mfma_f32_16x16x32_bf16 v[96:99], a[104:107], a[72:75], v[96:99]
 v_mfma_f32_16x16x32_bf16 v[68:71], a[104:107], a[68:71], v[68:71]
 ds_read_b64_tr_b16 a[26:27], v231 offset:1792
 v_mfma_f32_16x16x32_bf16 v[64:67], a[100:103], a[68:71], v[64:67]
 v_mfma_f32_16x16x32_bf16 v[92:95], a[100:103], a[72:75], v[92:95]
 ds_read_b64_tr_b16 a[28:29], v229 offset:15360
 v_mfma_f32_16x16x32_bf16 v[88:91], a[96:99], a[72:75], v[88:91]
 ds_read_b64_tr_b16 a[30:31], v229 offset:17152
 v_mfma_f32_16x16x32_bf16 v[60:63], a[96:99], a[68:71], v[60:63]
 v_mfma_f32_16x16x32_bf16 v[56:59], a[92:95], a[68:71], v[56:59]
 ds_read_b64_tr_b16 a[32:33], v230 offset:15360
 v_mfma_f32_16x16x32_bf16 v[84:87], a[92:95], a[72:75], v[84:87]
 v_mfma_f32_16x16x32_bf16 v[112:115], a[92:95], a[76:79], v[112:115]
 ds_read_b64_tr_b16 a[34:35], v230 offset:17152
 v_mfma_f32_16x16x32_bf16 v[140:143], a[92:95], a[80:83], v[140:143]
 v_mfma_f32_16x16x32_bf16 v[144:147], a[96:99], a[80:83], v[144:147]
 ds_read_b64_tr_b16 a[36:37], v229 offset:15424
 v_mfma_f32_16x16x32_bf16 v[116:119], a[96:99], a[76:79], v[116:119]
 ds_read_b64_tr_b16 a[38:39], v229 offset:17216
 v_mfma_f32_16x16x32_bf16 v[120:123], a[100:103], a[76:79], v[120:123]
 v_mfma_f32_16x16x32_bf16 v[148:151], a[100:103], a[80:83], v[148:151]
 ds_read_b64_tr_b16 a[40:41], v230 offset:15424
 v_mfma_f32_16x16x32_bf16 v[152:155], a[104:107], a[80:83], v[152:155]
 v_mfma_f32_16x16x32_bf16 v[124:127], a[104:107], a[76:79], v[124:127]
 ds_read_b64_tr_b16 a[42:43], v230 offset:17216
 v_mfma_f32_16x16x32_bf16 v[128:131], a[108:111], a[76:79], v[128:131]
 v_mfma_f32_16x16x32_bf16 v[156:159], a[108:111], a[80:83], v[156:159]
 ds_read_b64_tr_b16 a[44:45], v229 offset:15488
 v_mfma_f32_16x16x32_bf16 v[160:163], a[112:115], a[80:83], v[160:163]
 ds_read_b64_tr_b16 a[46:47], v229 offset:17280
 v_mfma_f32_16x16x32_bf16 v[132:135], a[112:115], a[76:79], v[132:135]
 v_mfma_f32_16x16x32_bf16 v[136:139], a[116:119], a[76:79], v[136:139]
 ds_read_b64_tr_b16 a[48:49], v230 offset:15488
 v_mfma_f32_16x16x32_bf16 v[164:167], a[116:119], a[80:83], v[164:167]
 v_mfma_f32_16x16x32_bf16 v[192:195], a[116:119], a[84:87], v[192:195]
 ds_read_b64_tr_b16 a[50:51], v230 offset:17280
 v_mfma_f32_16x16x32_bf16 v[220:223], a[116:119], a[88:91], v[220:223]
 v_mfma_f32_16x16x32_bf16 v[216:219], a[112:115], a[88:91], v[216:219]
 ds_read_b64_tr_b16 a[52:53], v231 offset:15360
 v_mfma_f32_16x16x32_bf16 v[188:191], a[112:115], a[84:87], v[188:191]
 ds_read_b64_tr_b16 a[54:55], v231 offset:17152
 v_mfma_f32_16x16x32_bf16 v[184:187], a[108:111], a[84:87], v[184:187]
 v_mfma_f32_16x16x32_bf16 v[212:215], a[108:111], a[88:91], v[212:215]
 ds_read_b128 a[180:183], v227 offset:0
 v_mfma_f32_16x16x32_bf16 v[208:211], a[104:107], a[88:91], v[208:211]
 v_mfma_f32_16x16x32_bf16 v[180:183], a[104:107], a[84:87], v[180:183]
 ds_read_b128 a[184:187], v228 offset:0
 v_mfma_f32_16x16x32_bf16 v[176:179], a[100:103], a[84:87], v[176:179]
 v_mfma_f32_16x16x32_bf16 v[204:207], a[100:103], a[88:91], v[204:207]
 v_mfma_f32_16x16x32_bf16 v[200:203], a[96:99], a[88:91], v[200:203]
 v_mfma_f32_16x16x32_bf16 v[172:175], a[96:99], a[84:87], v[172:175]
 v_mfma_f32_16x16x32_bf16 v[168:171], a[92:95], a[84:87], v[168:171]
 v_mfma_f32_16x16x32_bf16 v[196:199], a[92:95], a[88:91], v[196:199]
 s_branch L1h_tail
L1h_dma:
 s_lshl_b32 s40, s37, 6
 v_xor_b32 v235, s40, v235
 v_xor_b32 v236, 64, v235
 s_mul_i32 s39, s33, 180224
 s_add_u32 s39, s39, s38
 s_mul_i32 s45, s33, 11264
 s_add_u32 s40, s39, 0
 v_add_u32 v239, s40, v235
 s_add_u32 s40, s39, 15360
 v_add_u32 v240, s40, v236
 s_add_u32 s40, s39, 30720
 v_add_u32 v241, s40, v235
 s_add_u32 s40, s39, 46080
 v_add_u32 v242, s40, v236
 s_add_u32 s40, s39, 65536
 v_add_u32 v243, s40, v235
 s_add_u32 s40, s39, 80896
 v_add_u32 v244, s40, v236
 s_add_u32 s40, s39, 98304
 v_add_u32 v245, s40, v235
 s_add_u32 s40, s39, 113664
 v_add_u32 v246, s40, v236
 s_add_u32 s40, s39, 129024
 v_add_u32 v247, s40, v235
 s_add_u32 s40, s39, 144384
 v_add_u32 v248, s40, v236
 s_add_u32 s40, s39, 163840
 s_mov_b32 s41, 0x80000000
 s_cmp_eq_u32 s33, 2
 s_cselect_b32 s40, s41, s40
 v_add_u32 v249, s40, v235
 s_waitcnt lgkmcnt(0)
 s_mov_b32 s12, s4
 s_mov_b32 s13, s5
 s_add_u32 m0, s45, 61440
 s_add_u32 s50, s71, 0
 s_and_b32 s50, s50, 2047
 s_mov_b32 s16, s8
 buffer_load_dwordx4 v239, s[12:15], s50 offen offset:0  lds
 s_mov_b32 s17, s9
 s_mov_b32 s18, 0x700000
 s_mul_i32 s40, s33, 320
 s_mul_i32 s41, s35, 448
 s_mov_b32 s42, 7168
 s_mul_i32 s44, s33, 5120
 s_mul_i32 s51, s71, 3584
 buffer_load_dwordx4 v240, s[12:15], s50 offen offset:1024  lds
 v_add_u32 v237, s40, v224
 v_add_u32 v232, 0, v237
 v_mul_u32_u24 v233, 2341, v232
 v_lshrrev_b32 v233, 16, v233
 v_mul_u32_u24 v234, 28, v233
 v_sub_u32 v234, v232, v234
 v_lshrrev_b32 v235, 2, v233
 buffer_load_dwordx4 v241, s[12:15], s50 offen offset:2048  lds
 v_and_b32 v235, 2, v235
 v_xor_b32 v234, v234, v235
 v_lshlrev_b32 v234, 4, v234
 v_mul_lo_u32 v233, v233, s42
 s_sub_u32 s43, s41, 0
 v_add3_u32 v251, v233, v234, s43
 v_add_u32 v232, 64, v237
 buffer_load_dwordx4 v242, s[12:15], s50 offen offset:3072  lds
 v_mul_u32_u24 v233, 2341, v232
 v_lshrrev_b32 v233, 16, v233
 v_mul_u32_u24 v234, 28, v233
 v_sub_u32 v234, v232, v234
 v_lshrrev_b32 v235, 2, v233
 v_and_b32 v235, 2, v235
 s_add_u32 m0, s45, 65536
 v_xor_b32 v234, v234, v235
 buffer_load_dwordx4 v243, s[12:15], s50 offen offset:0  lds
 v_lshlrev_b32 v234, 4, v234
 v_mul_lo_u32 v233, v233, s42
 s_sub_u32 s43, s41, 1024
 v_add3_u32 v252, v233, v234, s43
 v_add_u32 v232, 128, v237
 v_mul_u32_u24 v233, 2341, v232
 v_lshrrev_b32 v233, 16, v233
 buffer_load_dwordx4 v244, s[12:15], s50 offen offset:1024  lds
 v_mul_u32_u24 v234, 28, v233
 v_sub_u32 v234, v232, v234
 v_lshrrev_b32 v235, 2, v233
 v_and_b32 v235, 2, v235
 v_xor_b32 v234, v234, v235
 v_lshlrev_b32 v234, 4, v234
 s_add_u32 m0, s45, 67584
 s_add_u32 s50, s71, 0
 s_and_b32 s50, s50, 2047
 v_mul_lo_u32 v233, v233, s42
 buffer_load_dwordx4 v245, s[12:15], s50 offen offset:0  lds
 s_sub_u32 s43, s41, 2048
 v_add3_u32 v253, v233, v234, s43
 v_add_u32 v232, 192, v237
 v_mul_u32_u24 v233, 2341, v232
 v_lshrrev_b32 v233, 16, v233
 v_mul_u32_u24 v234, 28, v233
 v_sub_u32 v234, v232, v234
 buffer_load_dwordx4 v246, s[12:15], s50 offen offset:1024  lds
 v_lshrrev_b32 v235, 2, v233
 v_and_b32 v235, 2, v235
 v_xor_b32 v234, v234, v235
 v_lshlrev_b32 v234, 4, v234
 v_mul_lo_u32 v233, v233, s42
 s_sub_u32 s43, s41, 3072
 v_add3_u32 v254, v233, v234, s43
 buffer_load_dwordx4 v247, s[12:15], s50 offen offset:2048  lds
 v_add_u32 v232, 256, v237
 v_mul_u32_u24 v233, 2341, v232
 v_lshrrev_b32 v233, 16, v233
 v_mul_u32_u24 v234, 28, v233
 v_sub_u32 v234, v232, v234
 v_lshrrev_b32 v235, 2, v233
 v_and_b32 v235, 2, v235
 buffer_load_dwordx4 v248, s[12:15], s50 offen offset:3072  lds
 v_xor_b32 v234, v234, v235
 v_lshlrev_b32 v234, 4, v234
 v_mul_lo_u32 v233, v233, s42
 s_sub_u32 s43, s41, 0
 v_add3_u32 v233, v233, v234, s43
 v_mov_b32 v234, 0x80000000
 s_add_u32 m0, s45, 71680
 v_cmp_gt_u32 vcc, 896, v232
 buffer_load_dwordx4 v249, s[12:15], s50 offen offset:0  lds
    s_nop 0
 v_cndmask_b32 v255, v234, v233, vcc
 s_add_u32 m0, s44, 0
 v_and_b32 v232, 15, v224
 buffer_load_dwordx4 v251, s[16:19], s51 offen offset:0  lds
 v_lshrrev_b32 v233, 4, v224
 v_lshrrev_b32 v234, 1, v232
 v_xor_b32 v235, v233, v234
 v_xor_b32 v236, 4, v235
 buffer_load_dwordx4 v252, s[16:19], s51 offen offset:1024  lds
 v_lshlrev_b32 v235, 4, v235
 v_lshlrev_b32 v236, 4, v236
 s_lshl_b32 s40, s36, 14
 v_lshl_add_u32 v237, v232, 7, s40
 buffer_load_dwordx4 v253, s[16:19], s51 offen offset:2048  lds
 v_add_u32 v225, v237, v235
 v_add_u32 v226, v237, v236
 v_add_u32 v227, 61440, v225
 v_add_u32 v228, 61440, v226
 buffer_load_dwordx4 v254, s[16:19], s51 offen offset:3072  lds
 v_lshrrev_b32 v232, 4, v224
 v_bfe_u32 v233, v224, 2, 2
 v_and_b32 v234, 3, v224
 s_add_u32 m0, s44, 4096
 v_mul_u32_u24 v235, 3584, v232
 buffer_load_dwordx4 v255, s[16:19], s51 offen offset:0  lds
 s_add_u32 s51, s51, 229376
 s_cmp_eq_u32 s51, 7340032
 s_cselect_b32 s51, 0, s51
 s_add_u32 m0, s44, 15360
 v_mul_u32_u24 v236, 448, v233
 buffer_load_dwordx4 v251, s[16:19], s51 offen offset:0  lds
 v_add_u32 v235, v235, v236
 v_lshl_add_u32 v235, v234, 3, v235
 v_and_b32 v236, 1, v232
 s_lshl_b32 s40, s37, 3
 buffer_load_dwordx4 v252, s[16:19], s51 offen offset:1024  lds
 s_add_u32 s41, s40, 0
 v_xor_b32 v237, s41, v236
 v_lshl_add_u32 v229, v237, 5, v235
 s_add_u32 s41, s40, 1
 buffer_load_dwordx4 v253, s[16:19], s51 offen offset:2048  lds
 v_xor_b32 v237, s41, v236
 v_lshl_add_u32 v230, v237, 5, v235
 s_add_u32 s41, s37, 6
 v_xor_b32 v237, s41, v236
 buffer_load_dwordx4 v254, s[16:19], s51 offen offset:3072  lds
 v_lshl_add_u32 v231, v237, 5, v235
 s_mov_b32 s22, 0x10000000
 s_mov_b32 s23, 0x20000
 s_add_u32 m0, s44, 19456
 s_mov_b32 s26, 2048
 buffer_load_dwordx4 v255, s[16:19], s51 offen offset:0  lds
 s_add_u32 s51, s51, 229376
 s_cmp_eq_u32 s51, 7340032
 s_cselect_b32 s51, 0, s51
 s_mov_b32 s27, 0x20000
 s_add_u32 m0, s45, 95232
 s_add_u32 s50, s71, 128
 s_and_b32 s50, s50, 2047
 buffer_load_dwordx4 v239, s[12:15], s50 offen offset:0  lds
 buffer_load_dwordx4 v240, s[12:15], s50 offen offset:1024  lds
 buffer_load_dwordx4 v241, s[12:15], s50 offen offset:2048  lds
 buffer_load_dwordx4 v242, s[12:15], s50 offen offset:3072  lds
 s_add_u32 m0, s45, 99328
    s_nop 0
 buffer_load_dwordx4 v243, s[12:15], s50 offen offset:0  lds
 buffer_load_dwordx4 v244, s[12:15], s50 offen offset:1024  lds
 s_add_u32 m0, s45, 101376
 s_add_u32 s50, s71, 128
 s_and_b32 s50, s50, 2047
 buffer_load_dwordx4 v245, s[12:15], s50 offen offset:0  lds
 buffer_load_dwordx4 v246, s[12:15], s50 offen offset:1024  lds
 buffer_load_dwordx4 v247, s[12:15], s50 offen offset:2048  lds
 buffer_load_dwordx4 v248, s[12:15], s50 offen offset:3072  lds
 s_add_u32 m0, s45, 105472
    s_nop 0
 buffer_load_dwordx4 v249, s[12:15], s50 offen offset:0  lds
 s_add_u32 m0, s44, 30720
    s_nop 0
 buffer_load_dwordx4 v251, s[16:19], s51 offen offset:0  lds
 buffer_load_dwordx4 v252, s[16:19], s51 offen offset:1024  lds
 buffer_load_dwordx4 v253, s[16:19], s51 offen offset:2048  lds
 buffer_load_dwordx4 v254, s[16:19], s51 offen offset:3072  lds
 s_add_u32 m0, s44, 34816
    s_nop 0
 buffer_load_dwordx4 v255, s[16:19], s51 offen offset:0  lds
 s_add_u32 s51, s51, 229376
 s_cmp_eq_u32 s51, 7340032
 s_cselect_b32 s51, 0, s51
 s_waitcnt vmcnt(21)
 s_barrier
 ds_read_b64_tr_b16 a[32:33], v229 offset:0
 ds_read_b64_tr_b16 a[34:35], v229 offset:1792
 ds_read_b128 a[0:3], v227 offset:0
 ds_read_b64_tr_b16 a[36:37], v230 offset:0
 ds_read_b64_tr_b16 a[38:39], v230 offset:1792
 ds_read_b128 a[4:7], v227 offset:2048
 ds_read_b64_tr_b16 a[40:41], v229 offset:64
 ds_read_b64_tr_b16 a[42:43], v229 offset:1856
 ds_read_b128 a[8:11], v227 offset:4096
 ds_read_b64_tr_b16 a[44:45], v230 offset:64
 ds_read_b64_tr_b16 a[46:47], v230 offset:1856
 ds_read_b128 a[12:15], v227 offset:6144
 ds_read_b64_tr_b16 a[48:49], v229 offset:128
 ds_read_b64_tr_b16 a[50:51], v229 offset:1920
 ds_read_b128 a[16:19], v227 offset:8192
 ds_read_b64_tr_b16 a[52:53], v230 offset:128
 ds_read_b64_tr_b16 a[54:55], v230 offset:1920
 ds_read_b128 a[20:23], v227 offset:10240
 ds_read_b64_tr_b16 a[56:57], v231 offset:0
 ds_read_b64_tr_b16 a[58:59], v231 offset:1792
 ds_read_b128 a[24:27], v227 offset:12288
 ds_read_b128 a[28:31], v227 offset:14336
 s_waitcnt lgkmcnt(0)
 s_waitcnt vmcnt(16)
 s_barrier
 v_mfma_f32_16x16x32_bf16 v[0:3], a[32:35], a[0:3], 0
 ds_read_b64_tr_b16 a[92:93], v229 offset:15360
 v_mfma_f32_16x16x32_bf16 v[28:31], a[32:35], a[4:7], 0
 ds_read_b64_tr_b16 a[94:95], v229 offset:17152
 v_mfma_f32_16x16x32_bf16 v[32:35], a[36:39], a[4:7], 0
 ds_read_b128 a[60:63], v228 offset:0
 v_mfma_f32_16x16x32_bf16 v[4:7], a[36:39], a[0:3], 0
 v_mfma_f32_16x16x32_bf16 v[8:11], a[40:43], a[0:3], 0
 ds_read_b64_tr_b16 a[96:97], v230 offset:15360
 s_add_u32 m0, s44, 46080
 v_mfma_f32_16x16x32_bf16 v[36:39], a[40:43], a[4:7], 0
 buffer_load_dwordx4 v251, s[16:19], s51 offen offset:0  lds
 v_mfma_f32_16x16x32_bf16 v[40:43], a[44:47], a[4:7], 0
 ds_read_b64_tr_b16 a[98:99], v230 offset:17152
 v_mfma_f32_16x16x32_bf16 v[12:15], a[44:47], a[0:3], 0
 v_mfma_f32_16x16x32_bf16 v[16:19], a[48:51], a[0:3], 0
 ds_read_b128 a[64:67], v228 offset:2048
 v_mfma_f32_16x16x32_bf16 v[44:47], a[48:51], a[4:7], 0
 buffer_load_dwordx4 v252, s[16:19], s51 offen offset:1024  lds
 v_mfma_f32_16x16x32_bf16 v[48:51], a[52:55], a[4:7], 0
 ds_read_b64_tr_b16 a[100:101], v229 offset:15424
 v_mfma_f32_16x16x32_bf16 v[20:23], a[52:55], a[0:3], 0
 v_mfma_f32_16x16x32_bf16 v[24:27], a[56:59], a[0:3], 0
 ds_read_b64_tr_b16 a[102:103], v229 offset:17216
 v_mfma_f32_16x16x32_bf16 v[52:55], a[56:59], a[4:7], 0
 buffer_load_dwordx4 v253, s[16:19], s51 offen offset:2048  lds
 v_mfma_f32_16x16x32_bf16 v[80:83], a[56:59], a[8:11], 0
 ds_read_b128 a[68:71], v228 offset:4096
 v_mfma_f32_16x16x32_bf16 v[108:111], a[56:59], a[12:15], 0
 v_mfma_f32_16x16x32_bf16 v[104:107], a[52:55], a[12:15], 0
 ds_read_b64_tr_b16 a[104:105], v230 offset:15424
 v_mfma_f32_16x16x32_bf16 v[76:79], a[52:55], a[8:11], 0
 v_mfma_f32_16x16x32_bf16 v[72:75], a[48:51], a[8:11], 0
 ds_read_b64_tr_b16 a[106:107], v230 offset:17216
 buffer_load_dwordx4 v254, s[16:19], s51 offen offset:3072  lds
 v_mfma_f32_16x16x32_bf16 v[100:103], a[48:51], a[12:15], 0
 v_mfma_f32_16x16x32_bf16 v[96:99], a[44:47], a[12:15], 0
 ds_read_b128 a[72:75], v228 offset:6144
 v_mfma_f32_16x16x32_bf16 v[68:71], a[44:47], a[8:11], 0
 s_add_u32 m0, s44, 50176
 v_mfma_f32_16x16x32_bf16 v[64:67], a[40:43], a[8:11], 0
 ds_read_b64_tr_b16 a[108:109], v229 offset:15488
 buffer_load_dwordx4 v255, s[16:19], s51 offen offset:0  lds
 s_add_u32 s51, s51, 229376
 s_cmp_eq_u32 s51, 7340032
 s_cselect_b32 s51, 0, s51
 v_mfma_f32_16x16x32_bf16 v[92:95], a[40:43], a[12:15], 0
 v_mfma_f32_16x16x32_bf16 v[88:91], a[36:39], a[12:15], 0
 ds_read_b64_tr_b16 a[110:111], v229 offset:17280
 v_mfma_f32_16x16x32_bf16 v[60:63], a[36:39], a[8:11], 0
 v_mfma_f32_16x16x32_bf16 v[56:59], a[32:35], a[8:11], 0
 ds_read_b128 a[76:79], v228 offset:8192
 s_add_u32 m0, s45, 129024
 s_add_u32 s50, s71, 256
 s_and_b32 s50, s50, 2047
 v_mfma_f32_16x16x32_bf16 v[84:87], a[32:35], a[12:15], 0
 buffer_load_dwordx4 v239, s[12:15], s50 offen offset:0  lds
 v_mfma_f32_16x16x32_bf16 v[112:115], a[32:35], a[16:19], 0
 ds_read_b64_tr_b16 a[112:113], v230 offset:15488
 v_mfma_f32_16x16x32_bf16 v[140:143], a[32:35], a[20:23], 0
 v_mfma_f32_16x16x32_bf16 v[144:147], a[36:39], a[20:23], 0
 ds_read_b64_tr_b16 a[114:115], v230 offset:17280
 v_mfma_f32_16x16x32_bf16 v[116:119], a[36:39], a[16:19], 0
 buffer_load_dwordx4 v240, s[12:15], s50 offen offset:1024  lds
 v_mfma_f32_16x16x32_bf16 v[120:123], a[40:43], a[16:19], 0
 ds_read_b128 a[80:83], v228 offset:10240
 v_mfma_f32_16x16x32_bf16 v[148:151], a[40:43], a[20:23], 0
 v_mfma_f32_16x16x32_bf16 v[152:155], a[44:47], a[20:23], 0
 ds_read_b64_tr_b16 a[116:117], v231 offset:15360
 v_mfma_f32_16x16x32_bf16 v[124:127], a[44:47], a[16:19], 0
 v_mfma_f32_16x16x32_bf16 v[128:131], a[48:51], a[16:19], 0
 ds_read_b64_tr_b16 a[118:119], v231 offset:17152
 buffer_load_dwordx4 v241, s[12:15], s50 offen offset:2048  lds
 v_mfma_f32_16x16x32_bf16 v[156:159], a[48:51], a[20:23], 0
 v_mfma_f32_16x16x32_bf16 v[160:163], a[52:55], a[20:23], 0
 ds_read_b128 a[84:87], v228 offset:12288
 v_mfma_f32_16x16x32_bf16 v[132:135], a[52:55], a[16:19], 0
 v_mfma_f32_16x16x32_bf16 v[136:139], a[56:59], a[16:19], 0
 ds_read_b128 a[88:91], v228 offset:14336
 buffer_load_dwordx4 v242, s[12:15], s50 offen offset:3072  lds
 v_mfma_f32_16x16x32_bf16 v[164:167], a[56:59], a[20:23], 0
 v_mfma_f32_16x16x32_bf16 v[192:195], a[56:59], a[24:27], 0
 v_mfma_f32_16x16x32_bf16 v[220:223], a[56:59], a[28:31], 0
 v_mfma_f32_16x16x32_bf16 v[216:219], a[52:55], a[28:31], 0
 s_add_u32 m0, s45, 133120
 v_mfma_f32_16x16x32_bf16 v[188:191], a[52:55], a[24:27], 0
 buffer_load_dwordx4 v243, s[12:15], s50 offen offset:0  lds
 v_mfma_f32_16x16x32_bf16 v[184:187], a[48:51], a[24:27], 0
 v_mfma_f32_16x16x32_bf16 v[212:215], a[48:51], a[28:31], 0
 v_mfma_f32_16x16x32_bf16 v[208:211], a[44:47], a[28:31], 0
 v_mfma_f32_16x16x32_bf16 v[180:183], a[44:47], a[24:27], 0
 buffer_load_dwordx4 v244, s[12:15], s50 offen offset:1024  lds
 v_mfma_f32_16x16x32_bf16 v[176:179], a[40:43], a[24:27], 0
 v_mfma_f32_16x16x32_bf16 v[204:207], a[40:43], a[28:31], 0
 v_mfma_f32_16x16x32_bf16 v[200:203], a[36:39], a[28:31], 0
 v_mfma_f32_16x16x32_bf16 v[172:175], a[36:39], a[24:27], 0
 v_mfma_f32_16x16x32_bf16 v[168:171], a[32:35], a[24:27], 0
 v_mfma_f32_16x16x32_bf16 v[196:199], a[32:35], a[28:31], 0
 s_waitcnt lgkmcnt(0)
 s_waitcnt vmcnt(11)
 s_barrier
 v_mfma_f32_16x16x32_bf16 v[0:3], a[92:95], a[60:63], v[0:3]
 v_add_u32 v227, 95232, v225
 v_add_u32 v228, 95232, v226
 ds_read_b64_tr_b16 a[32:33], v229 offset:30720
 v_mfma_f32_16x16x32_bf16 v[28:31], a[92:95], a[64:67], v[28:31]
 ds_read_b64_tr_b16 a[34:35], v229 offset:32512
 v_mfma_f32_16x16x32_bf16 v[32:35], a[96:99], a[64:67], v[32:35]
 ds_read_b128 a[0:3], v227 offset:0
 v_mfma_f32_16x16x32_bf16 v[4:7], a[96:99], a[60:63], v[4:7]
 v_mfma_f32_16x16x32_bf16 v[8:11], a[100:103], a[60:63], v[8:11]
 ds_read_b64_tr_b16 a[36:37], v230 offset:30720
 s_add_u32 m0, s44, 0
 v_mfma_f32_16x16x32_bf16 v[36:39], a[100:103], a[64:67], v[36:39]
 buffer_load_dwordx4 v251, s[16:19], s51 offen offset:0  lds
 v_mfma_f32_16x16x32_bf16 v[40:43], a[104:107], a[64:67], v[40:43]
 ds_read_b64_tr_b16 a[38:39], v230 offset:32512
 v_mfma_f32_16x16x32_bf16 v[12:15], a[104:107], a[60:63], v[12:15]
 v_mfma_f32_16x16x32_bf16 v[16:19], a[108:111], a[60:63], v[16:19]
 ds_read_b128 a[4:7], v227 offset:2048
 buffer_load_dwordx4 v252, s[16:19], s51 offen offset:1024  lds
 v_mfma_f32_16x16x32_bf16 v[44:47], a[108:111], a[64:67], v[44:47]
 v_mfma_f32_16x16x32_bf16 v[48:51], a[112:115], a[64:67], v[48:51]
 ds_read_b64_tr_b16 a[40:41], v229 offset:30784
 v_mfma_f32_16x16x32_bf16 v[20:23], a[112:115], a[60:63], v[20:23]
 buffer_load_dwordx4 v253, s[16:19], s51 offen offset:2048  lds
 v_mfma_f32_16x16x32_bf16 v[24:27], a[116:119], a[60:63], v[24:27]
 ds_read_b64_tr_b16 a[42:43], v229 offset:32576
 v_mfma_f32_16x16x32_bf16 v[52:55], a[116:119], a[64:67], v[52:55]
 v_mfma_f32_16x16x32_bf16 v[80:83], a[116:119], a[68:71], v[80:83]
 ds_read_b128 a[8:11], v227 offset:4096
 buffer_load_dwordx4 v254, s[16:19], s51 offen offset:3072  lds
 v_mfma_f32_16x16x32_bf16 v[108:111], a[116:119], a[72:75], v[108:111]
 v_mfma_f32_16x16x32_bf16 v[104:107], a[112:115], a[72:75], v[104:107]
 ds_read_b64_tr_b16 a[44:45], v230 offset:30784
 v_mfma_f32_16x16x32_bf16 v[76:79], a[112:115], a[68:71], v[76:79]
 s_add_u32 m0, s44, 4096
 v_mfma_f32_16x16x32_bf16 v[72:75], a[108:111], a[68:71], v[72:75]
 ds_read_b64_tr_b16 a[46:47], v230 offset:32576
 buffer_load_dwordx4 v255, s[16:19], s51 offen offset:0  lds
 s_add_u32 s51, s51, 229376
 s_cmp_eq_u32 s51, 7340032
 s_cselect_b32 s51, 0, s51
 v_mfma_f32_16x16x32_bf16 v[100:103], a[108:111], a[72:75], v[100:103]
 v_mfma_f32_16x16x32_bf16 v[96:99], a[104:107], a[72:75], v[96:99]
 ds_read_b128 a[12:15], v227 offset:6144
 s_add_u32 m0, s45, 135168
 s_add_u32 s50, s71, 256
 s_and_b32 s50, s50, 2047
 v_mfma_f32_16x16x32_bf16 v[68:71], a[104:107], a[68:71], v[68:71]
 buffer_load_dwordx4 v245, s[12:15], s50 offen offset:0  lds
 v_mfma_f32_16x16x32_bf16 v[64:67], a[100:103], a[68:71], v[64:67]
 ds_read_b64_tr_b16 a[48:49], v229 offset:30848
 v_mfma_f32_16x16x32_bf16 v[92:95], a[100:103], a[72:75], v[92:95]
 v_mfma_f32_16x16x32_bf16 v[88:91], a[96:99], a[72:75], v[88:91]
 ds_read_b64_tr_b16 a[50:51], v229 offset:32640
 buffer_load_dwordx4 v246, s[12:15], s50 offen offset:1024  lds
 v_mfma_f32_16x16x32_bf16 v[60:63], a[96:99], a[68:71], v[60:63]
 v_mfma_f32_16x16x32_bf16 v[56:59], a[92:95], a[68:71], v[56:59]
 ds_read_b128 a[16:19], v227 offset:8192
 v_mfma_f32_16x16x32_bf16 v[84:87], a[92:95], a[72:75], v[84:87]
 buffer_load_dwordx4 v247, s[12:15], s50 offen offset:2048  lds
 v_mfma_f32_16x16x32_bf16 v[112:115], a[92:95], a[76:79], v[112:115]
 ds_read_b64_tr_b16 a[52:53], v230 offset:30848
 v_mfma_f32_16x16x32_bf16 v[140:143], a[92:95], a[80:83], v[140:143]
 v_mfma_f32_16x16x32_bf16 v[144:147], a[96:99], a[80:83], v[144:147]
 ds_read_b64_tr_b16 a[54:55], v230 offset:32640
 v_mfma_f32_16x16x32_bf16 v[116:119], a[96:99], a[76:79], v[116:119]
 buffer_load_dwordx4 v248, s[12:15], s50 offen offset:3072  lds
 v_mfma_f32_16x16x32_bf16 v[120:123], a[100:103], a[76:79], v[120:123]
 ds_read_b128 a[20:23], v227 offset:10240
 v_mfma_f32_16x16x32_bf16 v[148:151], a[100:103], a[80:83], v[148:151]
 s_add_u32 m0, s45, 139264
 v_mfma_f32_16x16x32_bf16 v[152:155], a[104:107], a[80:83], v[152:155]
 ds_read_b64_tr_b16 a[56:57], v231 offset:30720
 buffer_load_dwordx4 v249, s[12:15], s50 offen offset:0  lds
 v_mfma_f32_16x16x32_bf16 v[124:127], a[104:107], a[76:79], v[124:127]
 v_mfma_f32_16x16x32_bf16 v[128:131], a[108:111], a[76:79], v[128:131]
 ds_read_b64_tr_b16 a[58:59], v231 offset:32512
 s_add_u32 m0, s44, 15360
 v_mfma_f32_16x16x32_bf16 v[156:159], a[108:111], a[80:83], v[156:159]
 buffer_load_dwordx4 v251, s[16:19], s51 offen offset:0  lds
 v_mfma_f32_16x16x32_bf16 v[160:163], a[112:115], a[80:83], v[160:163]
 ds_read_b128 a[24:27], v227 offset:12288
 v_mfma_f32_16x16x32_bf16 v[132:135], a[112:115], a[76:79], v[132:135]
 v_mfma_f32_16x16x32_bf16 v[136:139], a[116:119], a[76:79], v[136:139]
 ds_read_b128 a[28:31], v227 offset:14336
 buffer_load_dwordx4 v252, s[16:19], s51 offen offset:1024  lds
 v_mfma_f32_16x16x32_bf16 v[164:167], a[116:119], a[80:83], v[164:167]
 v_mfma_f32_16x16x32_bf16 v[192:195], a[116:119], a[84:87], v[192:195]
 v_mfma_f32_16x16x32_bf16 v[220:223], a[116:119], a[88:91], v[220:223]
 v_mfma_f32_16x16x32_bf16 v[216:219], a[112:115], a[88:91], v[216:219]
 buffer_load_dwordx4 v253, s[16:19], s51 offen offset:2048  lds
 v_mfma_f32_16x16x32_bf16 v[188:191], a[112:115], a[84:87], v[188:191]
 v_mfma_f32_16x16x32_bf16 v[184:187], a[108:111], a[84:87], v[184:187]
 v_mfma_f32_16x16x32_bf16 v[212:215], a[108:111], a[88:91], v[212:215]
 buffer_load_dwordx4 v254, s[16:19], s51 offen offset:3072  lds
 v_mfma_f32_16x16x32_bf16 v[208:211], a[104:107], a[88:91], v[208:211]
 v_mfma_f32_16x16x32_bf16 v[180:183], a[104:107], a[84:87], v[180:183]
 s_add_u32 m0, s44, 19456
 v_mfma_f32_16x16x32_bf16 v[176:179], a[100:103], a[84:87], v[176:179]
 buffer_load_dwordx4 v255, s[16:19], s51 offen offset:0  lds
 s_add_u32 s51, s51, 229376
 s_cmp_eq_u32 s51, 7340032
 s_cselect_b32 s51, 0, s51
 v_mfma_f32_16x16x32_bf16 v[204:207], a[100:103], a[88:91], v[204:207]
 v_mfma_f32_16x16x32_bf16 v[200:203], a[96:99], a[88:91], v[200:203]
 v_mfma_f32_16x16x32_bf16 v[172:175], a[96:99], a[84:87], v[172:175]
 v_mfma_f32_16x16x32_bf16 v[168:171], a[92:95], a[84:87], v[168:171]
 v_mfma_f32_16x16x32_bf16 v[196:199], a[92:95], a[88:91], v[196:199]
 s_waitcnt lgkmcnt(0)
 s_waitcnt vmcnt(21)
 s_barrier
 v_mfma_f32_16x16x32_bf16 v[0:3], a[32:35], a[0:3], v[0:3]
 ds_read_b64_tr_b16 a[92:93], v229 offset:46080
 v_mfma_f32_16x16x32_bf16 v[28:31], a[32:35], a[4:7], v[28:31]
 ds_read_b64_tr_b16 a[94:95], v229 offset:47872
 v_mfma_f32_16x16x32_bf16 v[32:35], a[36:39], a[4:7], v[32:35]
 ds_read_b128 a[60:63], v228 offset:0
 v_mfma_f32_16x16x32_bf16 v[4:7], a[36:39], a[0:3], v[4:7]
 v_mfma_f32_16x16x32_bf16 v[8:11], a[40:43], a[0:3], v[8:11]
 ds_read_b64_tr_b16 a[96:97], v230 offset:46080
 s_add_u32 m0, s45, 61440
 s_add_u32 s50, s71, 384
 s_and_b32 s50, s50, 2047
 v_mfma_f32_16x16x32_bf16 v[36:39], a[40:43], a[4:7], v[36:39]
 buffer_load_dwordx4 v239, s[12:15], s50 offen offset:0  lds
 v_mfma_f32_16x16x32_bf16 v[40:43], a[44:47], a[4:7], v[40:43]
 ds_read_b64_tr_b16 a[98:99], v230 offset:47872
 v_mfma_f32_16x16x32_bf16 v[12:15], a[44:47], a[0:3], v[12:15]
 v_mfma_f32_16x16x32_bf16 v[16:19], a[48:51], a[0:3], v[16:19]
 ds_read_b128 a[64:67], v228 offset:2048
 buffer_load_dwordx4 v240, s[12:15], s50 offen offset:1024  lds
 v_mfma_f32_16x16x32_bf16 v[44:47], a[48:51], a[4:7], v[44:47]
 v_mfma_f32_16x16x32_bf16 v[48:51], a[52:55], a[4:7], v[48:51]
 ds_read_b64_tr_b16 a[100:101], v229 offset:46144
 v_mfma_f32_16x16x32_bf16 v[20:23], a[52:55], a[0:3], v[20:23]
 buffer_load_dwordx4 v241, s[12:15], s50 offen offset:2048  lds
 v_mfma_f32_16x16x32_bf16 v[24:27], a[56:59], a[0:3], v[24:27]
 ds_read_b64_tr_b16 a[102:103], v229 offset:47936
 v_mfma_f32_16x16x32_bf16 v[52:55], a[56:59], a[4:7], v[52:55]
 v_mfma_f32_16x16x32_bf16 v[80:83], a[56:59], a[8:11], v[80:83]
 ds_read_b128 a[68:71], v228 offset:4096
 buffer_load_dwordx4 v242, s[12:15], s50 offen offset:3072  lds
 v_mfma_f32_16x16x32_bf16 v[108:111], a[56:59], a[12:15], v[108:111]
 v_mfma_f32_16x16x32_bf16 v[104:107], a[52:55], a[12:15], v[104:107]
 ds_read_b64_tr_b16 a[104:105], v230 offset:46144
 s_add_u32 m0, s45, 65536
 v_mfma_f32_16x16x32_bf16 v[76:79], a[52:55], a[8:11], v[76:79]
 buffer_load_dwordx4 v243, s[12:15], s50 offen offset:0  lds
 v_mfma_f32_16x16x32_bf16 v[72:75], a[48:51], a[8:11], v[72:75]
 ds_read_b64_tr_b16 a[106:107], v230 offset:47936
 v_mfma_f32_16x16x32_bf16 v[100:103], a[48:51], a[12:15], v[100:103]
 v_mfma_f32_16x16x32_bf16 v[96:99], a[44:47], a[12:15], v[96:99]
 ds_read_b128 a[72:75], v228 offset:6144
 buffer_load_dwordx4 v244, s[12:15], s50 offen offset:1024  lds
 v_mfma_f32_16x16x32_bf16 v[68:71], a[44:47], a[8:11], v[68:71]
 v_mfma_f32_16x16x32_bf16 v[64:67], a[40:43], a[8:11], v[64:67]
 ds_read_b64_tr_b16 a[108:109], v229 offset:46208
 s_add_u32 m0, s44, 30720
 v_mfma_f32_16x16x32_bf16 v[92:95], a[40:43], a[12:15], v[92:95]
 buffer_load_dwordx4 v251, s[16:19], s51 offen offset:0  lds
 v_mfma_f32_16x16x32_bf16 v[88:91], a[36:39], a[12:15], v[88:91]
 ds_read_b64_tr_b16 a[110:111], v229 offset:48000
 v_mfma_f32_16x16x32_bf16 v[60:63], a[36:39], a[8:11], v[60:63]
 v_mfma_f32_16x16x32_bf16 v[56:59], a[32:35], a[8:11], v[56:59]
 ds_read_b128 a[76:79], v228 offset:8192
 buffer_load_dwordx4 v252, s[16:19], s51 offen offset:1024  lds
 v_mfma_f32_16x16x32_bf16 v[84:87], a[32:35], a[12:15], v[84:87]
 v_mfma_f32_16x16x32_bf16 v[112:115], a[32:35], a[16:19], v[112:115]
 ds_read_b64_tr_b16 a[112:113], v230 offset:46208
 v_mfma_f32_16x16x32_bf16 v[140:143], a[32:35], a[20:23], v[140:143]
 buffer_load_dwordx4 v253, s[16:19], s51 offen offset:2048  lds
 v_mfma_f32_16x16x32_bf16 v[144:147], a[36:39], a[20:23], v[144:147]
 ds_read_b64_tr_b16 a[114:115], v230 offset:48000
 v_mfma_f32_16x16x32_bf16 v[116:119], a[36:39], a[16:19], v[116:119]
 v_mfma_f32_16x16x32_bf16 v[120:123], a[40:43], a[16:19], v[120:123]
 ds_read_b128 a[80:83], v228 offset:10240
 buffer_load_dwordx4 v254, s[16:19], s51 offen offset:3072  lds
 v_mfma_f32_16x16x32_bf16 v[148:151], a[40:43], a[20:23], v[148:151]
 v_mfma_f32_16x16x32_bf16 v[152:155], a[44:47], a[20:23], v[152:155]
 ds_read_b64_tr_b16 a[116:117], v231 offset:46080
 s_add_u32 m0, s44, 34816
 v_mfma_f32_16x16x32_bf16 v[124:127], a[44:47], a[16:19], v[124:127]
 buffer_load_dwordx4 v255, s[16:19], s51 offen offset:0  lds
 s_add_u32 s51, s51, 229376
 s_cmp_eq_u32 s51, 7340032
 s_cselect_b32 s51, 0, s51
 v_mfma_f32_16x16x32_bf16 v[128:131], a[48:51], a[16:19], v[128:131]
 ds_read_b64_tr_b16 a[118:119], v231 offset:47872
 v_mfma_f32_16x16x32_bf16 v[156:159], a[48:51], a[20:23], v[156:159]
 s_add_u32 m0, s45, 67584
 s_add_u32 s50, s71, 384
 s_and_b32 s50, s50, 2047
 v_mfma_f32_16x16x32_bf16 v[160:163], a[52:55], a[20:23], v[160:163]
 ds_read_b128 a[84:87], v228 offset:12288
 buffer_load_dwordx4 v245, s[12:15], s50 offen offset:0  lds
 v_mfma_f32_16x16x32_bf16 v[132:135], a[52:55], a[16:19], v[132:135]
 v_mfma_f32_16x16x32_bf16 v[136:139], a[56:59], a[16:19], v[136:139]
 ds_read_b128 a[88:91], v228 offset:14336
 v_mfma_f32_16x16x32_bf16 v[164:167], a[56:59], a[20:23], v[164:167]
 buffer_load_dwordx4 v246, s[12:15], s50 offen offset:1024  lds
 v_mfma_f32_16x16x32_bf16 v[192:195], a[56:59], a[24:27], v[192:195]
 v_mfma_f32_16x16x32_bf16 v[220:223], a[56:59], a[28:31], v[220:223]
 v_mfma_f32_16x16x32_bf16 v[216:219], a[52:55], a[28:31], v[216:219]
 buffer_load_dwordx4 v247, s[12:15], s50 offen offset:2048  lds
 v_mfma_f32_16x16x32_bf16 v[188:191], a[52:55], a[24:27], v[188:191]
 v_mfma_f32_16x16x32_bf16 v[184:187], a[48:51], a[24:27], v[184:187]
 v_mfma_f32_16x16x32_bf16 v[212:215], a[48:51], a[28:31], v[212:215]
 buffer_load_dwordx4 v248, s[12:15], s50 offen offset:3072  lds
 v_mfma_f32_16x16x32_bf16 v[208:211], a[44:47], a[28:31], v[208:211]
 v_mfma_f32_16x16x32_bf16 v[180:183], a[44:47], a[24:27], v[180:183]
 s_add_u32 m0, s45, 71680
 v_mfma_f32_16x16x32_bf16 v[176:179], a[40:43], a[24:27], v[176:179]
 buffer_load_dwordx4 v249, s[12:15], s50 offen offset:0  lds
 v_mfma_f32_16x16x32_bf16 v[204:207], a[40:43], a[28:31], v[204:207]
 v_mfma_f32_16x16x32_bf16 v[200:203], a[36:39], a[28:31], v[200:203]
 v_mfma_f32_16x16x32_bf16 v[172:175], a[36:39], a[24:27], v[172:175]
 v_mfma_f32_16x16x32_bf16 v[168:171], a[32:35], a[24:27], v[168:171]
 v_mfma_f32_16x16x32_bf16 v[196:199], a[32:35], a[28:31], v[196:199]
 s_waitcnt lgkmcnt(0)
 s_waitcnt vmcnt(21)
 s_barrier
 v_mfma_f32_16x16x32_bf16 v[0:3], a[92:95], a[60:63], v[0:3]
 v_add_u32 v227, 129024, v225
 v_add_u32 v228, 129024, v226
 s_mov_b32 s46, 129024
 ds_read_b64_tr_b16 a[32:33], v229 offset:0
 v_mfma_f32_16x16x32_bf16 v[28:31], a[92:95], a[64:67], v[28:31]
 s_mov_b32 s47, 61440
 s_mov_b32 s48, 95232
 s_mov_b32 s52, 5
 ds_read_b64_tr_b16 a[34:35], v229 offset:1792
 v_mfma_f32_16x16x32_bf16 v[32:35], a[96:99], a[64:67], v[32:35]
 s_add_u32 s49, s45, 95232
 ds_read_b128 a[0:3], v227 offset:0
 v_mfma_f32_16x16x32_bf16 v[4:7], a[96:99], a[60:63], v[4:7]
 v_mfma_f32_16x16x32_bf16 v[8:11], a[100:103], a[60:63], v[8:11]
 ds_read_b64_tr_b16 a[36:37], v230 offset:0
 s_add_u32 m0, s45, 95232
 s_add_u32 s50, s71, 512
 s_and_b32 s50, s50, 2047
 v_mfma_f32_16x16x32_bf16 v[36:39], a[100:103], a[64:67], v[36:39]
 buffer_load_dwordx4 v239, s[12:15], s50 offen offset:0  lds
 v_mfma_f32_16x16x32_bf16 v[40:43], a[104:107], a[64:67], v[40:43]
 ds_read_b64_tr_b16 a[38:39], v230 offset:1792
 v_mfma_f32_16x16x32_bf16 v[12:15], a[104:107], a[60:63], v[12:15]
 v_mfma_f32_16x16x32_bf16 v[16:19], a[108:111], a[60:63], v[16:19]
 ds_read_b128 a[4:7], v227 offset:2048
 v_mfma_f32_16x16x32_bf16 v[44:47], a[108:111], a[64:67], v[44:47]
 buffer_load_dwordx4 v240, s[12:15], s50 offen offset:1024  lds
 v_mfma_f32_16x16x32_bf16 v[48:51], a[112:115], a[64:67], v[48:51]
 ds_read_b64_tr_b16 a[40:41], v229 offset:64
 v_mfma_f32_16x16x32_bf16 v[20:23], a[112:115], a[60:63], v[20:23]
 v_mfma_f32_16x16x32_bf16 v[24:27], a[116:119], a[60:63], v[24:27]
 ds_read_b64_tr_b16 a[42:43], v229 offset:1856
 v_mfma_f32_16x16x32_bf16 v[52:55], a[116:119], a[64:67], v[52:55]
 buffer_load_dwordx4 v241, s[12:15], s50 offen offset:2048  lds
 v_mfma_f32_16x16x32_bf16 v[80:83], a[116:119], a[68:71], v[80:83]
 ds_read_b128 a[8:11], v227 offset:4096
 v_mfma_f32_16x16x32_bf16 v[108:111], a[116:119], a[72:75], v[108:111]
 v_mfma_f32_16x16x32_bf16 v[104:107], a[112:115], a[72:75], v[104:107]
 ds_read_b64_tr_b16 a[44:45], v230 offset:64
 v_mfma_f32_16x16x32_bf16 v[76:79], a[112:115], a[68:71], v[76:79]
 v_mfma_f32_16x16x32_bf16 v[72:75], a[108:111], a[68:71], v[72:75]
 ds_read_b64_tr_b16 a[46:47], v230 offset:1856
 buffer_load_dwordx4 v242, s[12:15], s50 offen offset:3072  lds
 v_mfma_f32_16x16x32_bf16 v[100:103], a[108:111], a[72:75], v[100:103]
 v_mfma_f32_16x16x32_bf16 v[96:99], a[104:107], a[72:75], v[96:99]
 ds_read_b128 a[12:15], v227 offset:6144
 v_mfma_f32_16x16x32_bf16 v[68:71], a[104:107], a[68:71], v[68:71]
 s_add_u32 m0, s45, 99328
 v_mfma_f32_16x16x32_bf16 v[64:67], a[100:103], a[68:71], v[64:67]
 ds_read_b64_tr_b16 a[48:49], v229 offset:128
 buffer_load_dwordx4 v243, s[12:15], s50 offen offset:0  lds
 v_mfma_f32_16x16x32_bf16 v[92:95], a[100:103], a[72:75], v[92:95]
 v_mfma_f32_16x16x32_bf16 v[88:91], a[96:99], a[72:75], v[88:91]
 ds_read_b64_tr_b16 a[50:51], v229 offset:1920
 v_mfma_f32_16x16x32_bf16 v[60:63], a[96:99], a[68:71], v[60:63]
 v_mfma_f32_16x16x32_bf16 v[56:59], a[92:95], a[68:71], v[56:59]
 ds_read_b128 a[16:19], v227 offset:8192
 v_mfma_f32_16x16x32_bf16 v[84:87], a[92:95], a[72:75], v[84:87]
 buffer_load_dwordx4 v244, s[12:15], s50 offen offset:1024  lds
 v_mfma_f32_16x16x32_bf16 v[112:115], a[92:95], a[76:79], v[112:115]
 ds_read_b64_tr_b16 a[52:53], v230 offset:128
 v_mfma_f32_16x16x32_bf16 v[140:143], a[92:95], a[80:83], v[140:143]
 v_mfma_f32_16x16x32_bf16 v[144:147], a[96:99], a[80:83], v[144:147]
 ds_read_b64_tr_b16 a[54:55], v230 offset:1920
 s_add_u32 m0, s44, 46080
 v_mfma_f32_16x16x32_bf16 v[116:119], a[96:99], a[76:79], v[116:119]
 buffer_load_dwordx4 v251, s[16:19], s51 offen offset:0  lds
 v_mfma_f32_16x16x32_bf16 v[120:123], a[100:103], a[76:79], v[120:123]
 ds_read_b128 a[20:23], v227 offset:10240
 v_mfma_f32_16x16x32_bf16 v[148:151], a[100:103], a[80:83], v[148:151]
 v_mfma_f32_16x16x32_bf16 v[152:155], a[104:107], a[80:83], v[152:155]
 ds_read_b64_tr_b16 a[56:57], v231 offset:0
 v_mfma_f32_16x16x32_bf16 v[124:127], a[104:107], a[76:79], v[124:127]
 v_mfma_f32_16x16x32_bf16 v[128:131], a[108:111], a[76:79], v[128:131]
 ds_read_b64_tr_b16 a[58:59], v231 offset:1792
 buffer_load_dwordx4 v252, s[16:19], s51 offen offset:1024  lds
 v_mfma_f32_16x16x32_bf16 v[156:159], a[108:111], a[80:83], v[156:159]
 v_mfma_f32_16x16x32_bf16 v[160:163], a[112:115], a[80:83], v[160:163]
 ds_read_b128 a[24:27], v227 offset:12288
 v_mfma_f32_16x16x32_bf16 v[132:135], a[112:115], a[76:79], v[132:135]
 v_mfma_f32_16x16x32_bf16 v[136:139], a[116:119], a[76:79], v[136:139]
 ds_read_b128 a[28:31], v227 offset:14336
 buffer_load_dwordx4 v253, s[16:19], s51 offen offset:2048  lds
 v_mfma_f32_16x16x32_bf16 v[164:167], a[116:119], a[80:83], v[164:167]
 v_mfma_f32_16x16x32_bf16 v[192:195], a[116:119], a[84:87], v[192:195]
 v_mfma_f32_16x16x32_bf16 v[220:223], a[116:119], a[88:91], v[220:223]
 v_mfma_f32_16x16x32_bf16 v[216:219], a[112:115], a[88:91], v[216:219]
 v_mfma_f32_16x16x32_bf16 v[188:191], a[112:115], a[84:87], v[188:191]
 buffer_load_dwordx4 v254, s[16:19], s51 offen offset:3072  lds
 v_mfma_f32_16x16x32_bf16 v[184:187], a[108:111], a[84:87], v[184:187]
 v_mfma_f32_16x16x32_bf16 v[212:215], a[108:111], a[88:91], v[212:215]
 v_mfma_f32_16x16x32_bf16 v[208:211], a[104:107], a[88:91], v[208:211]
 s_add_u32 m0, s44, 50176
 v_mfma_f32_16x16x32_bf16 v[180:183], a[104:107], a[84:87], v[180:183]
 buffer_load_dwordx4 v255, s[16:19], s51 offen offset:0  lds
 s_add_u32 s51, s51, 229376
 s_cmp_eq_u32 s51, 7340032
 s_cselect_b32 s51, 0, s51
 v_mfma_f32_16x16x32_bf16 v[176:179], a[100:103], a[84:87], v[176:179]
 v_mfma_f32_16x16x32_bf16 v[204:207], a[100:103], a[88:91], v[204:207]
 v_mfma_f32_16x16x32_bf16 v[200:203], a[96:99], a[88:91], v[200:203]
 v_mfma_f32_16x16x32_bf16 v[172:175], a[96:99], a[84:87], v[172:175]
 v_mfma_f32_16x16x32_bf16 v[168:171], a[92:95], a[84:87], v[168:171]
 v_mfma_f32_16x16x32_bf16 v[196:199], a[92:95], a[88:91], v[196:199]
.p2align 6
L1hD_loop:
 s_waitcnt lgkmcnt(0)
 s_waitcnt vmcnt(27)
 s_barrier
 v_mfma_f32_16x16x32_bf16 v[0:3], a[32:35], a[0:3], v[0:3]
 ds_read_b64_tr_b16 a[92:93], v229 offset:15360
 v_mfma_f32_16x16x32_bf16 v[28:31], a[32:35], a[4:7], v[28:31]
 ds_read_b64_tr_b16 a[94:95], v229 offset:17152
 v_mfma_f32_16x16x32_bf16 v[32:35], a[36:39], a[4:7], v[32:35]
 ds_read_b128 a[60:63], v228 offset:0
 v_mfma_f32_16x16x32_bf16 v[4:7], a[36:39], a[0:3], v[4:7]
 v_mfma_f32_16x16x32_bf16 v[8:11], a[40:43], a[0:3], v[8:11]
 ds_read_b64_tr_b16 a[96:97], v230 offset:15360
 s_add_u32 m0, s44, 0
 v_mfma_f32_16x16x32_bf16 v[36:39], a[40:43], a[4:7], v[36:39]
 buffer_load_dwordx4 v251, s[16:19], s51 offen offset:0  lds
 v_mfma_f32_16x16x32_bf16 v[40:43], a[44:47], a[4:7], v[40:43]
 ds_read_b64_tr_b16 a[98:99], v230 offset:17152
 v_mfma_f32_16x16x32_bf16 v[12:15], a[44:47], a[0:3], v[12:15]
 v_mfma_f32_16x16x32_bf16 v[16:19], a[48:51], a[0:3], v[16:19]
 ds_read_b128 a[64:67], v228 offset:2048
 v_mfma_f32_16x16x32_bf16 v[44:47], a[48:51], a[4:7], v[44:47]
 buffer_load_dwordx4 v252, s[16:19], s51 offen offset:1024  lds
 v_mfma_f32_16x16x32_bf16 v[48:51], a[52:55], a[4:7], v[48:51]
 ds_read_b64_tr_b16 a[100:101], v229 offset:15424
 v_mfma_f32_16x16x32_bf16 v[20:23], a[52:55], a[0:3], v[20:23]
 v_mfma_f32_16x16x32_bf16 v[24:27], a[56:59], a[0:3], v[24:27]
 ds_read_b64_tr_b16 a[102:103], v229 offset:17216
 v_mfma_f32_16x16x32_bf16 v[52:55], a[56:59], a[4:7], v[52:55]
 v_mfma_f32_16x16x32_bf16 v[80:83], a[56:59], a[8:11], v[80:83]
 ds_read_b128 a[68:71], v228 offset:4096
 buffer_load_dwordx4 v253, s[16:19], s51 offen offset:2048  lds
 v_mfma_f32_16x16x32_bf16 v[108:111], a[56:59], a[12:15], v[108:111]
 v_mfma_f32_16x16x32_bf16 v[104:107], a[52:55], a[12:15], v[104:107]
 ds_read_b64_tr_b16 a[104:105], v230 offset:15424
 v_mfma_f32_16x16x32_bf16 v[76:79], a[52:55], a[8:11], v[76:79]
 v_mfma_f32_16x16x32_bf16 v[72:75], a[48:51], a[8:11], v[72:75]
 ds_read_b64_tr_b16 a[106:107], v230 offset:17216
 v_mfma_f32_16x16x32_bf16 v[100:103], a[48:51], a[12:15], v[100:103]
 buffer_load_dwordx4 v254, s[16:19], s51 offen offset:3072  lds
 v_mfma_f32_16x16x32_bf16 v[96:99], a[44:47], a[12:15], v[96:99]
 ds_read_b128 a[72:75], v228 offset:6144
 v_mfma_f32_16x16x32_bf16 v[68:71], a[44:47], a[8:11], v[68:71]
 v_mfma_f32_16x16x32_bf16 v[64:67], a[40:43], a[8:11], v[64:67]
 ds_read_b64_tr_b16 a[108:109], v229 offset:15488
 v_mfma_f32_16x16x32_bf16 v[92:95], a[40:43], a[12:15], v[92:95]
 s_add_u32 m0, s44, 4096
 v_mfma_f32_16x16x32_bf16 v[88:91], a[36:39], a[12:15], v[88:91]
 ds_read_b64_tr_b16 a[110:111], v229 offset:17280
 buffer_load_dwordx4 v255, s[16:19], s51 offen offset:0  lds
 s_add_u32 s51, s51, 229376
 s_cmp_eq_u32 s51, 7340032
 s_cselect_b32 s51, 0, s51
 v_mfma_f32_16x16x32_bf16 v[60:63], a[36:39], a[8:11], v[60:63]
 v_mfma_f32_16x16x32_bf16 v[56:59], a[32:35], a[8:11], v[56:59]
 ds_read_b128 a[76:79], v228 offset:8192
 v_mfma_f32_16x16x32_bf16 v[84:87], a[32:35], a[12:15], v[84:87]
 v_mfma_f32_16x16x32_bf16 v[112:115], a[32:35], a[16:19], v[112:115]
 ds_read_b64_tr_b16 a[112:113], v230 offset:15488
 s_add_u32 m0, s49, 6144
 v_mfma_f32_16x16x32_bf16 v[140:143], a[32:35], a[20:23], v[140:143]
 buffer_load_dwordx4 v245, s[12:15], s50 offen offset:0  lds
 v_mfma_f32_16x16x32_bf16 v[144:147], a[36:39], a[20:23], v[144:147]
 ds_read_b64_tr_b16 a[114:115], v230 offset:17280
 v_mfma_f32_16x16x32_bf16 v[116:119], a[36:39], a[16:19], v[116:119]
 v_mfma_f32_16x16x32_bf16 v[120:123], a[40:43], a[16:19], v[120:123]
 ds_read_b128 a[80:83], v228 offset:10240
 v_mfma_f32_16x16x32_bf16 v[148:151], a[40:43], a[20:23], v[148:151]
 v_mfma_f32_16x16x32_bf16 v[152:155], a[44:47], a[20:23], v[152:155]
 ds_read_b64_tr_b16 a[116:117], v231 offset:15360
 buffer_load_dwordx4 v246, s[12:15], s50 offen offset:1024  lds
 v_mfma_f32_16x16x32_bf16 v[124:127], a[44:47], a[16:19], v[124:127]
 v_mfma_f32_16x16x32_bf16 v[128:131], a[48:51], a[16:19], v[128:131]
 ds_read_b64_tr_b16 a[118:119], v231 offset:17152
 v_mfma_f32_16x16x32_bf16 v[156:159], a[48:51], a[20:23], v[156:159]
 v_mfma_f32_16x16x32_bf16 v[160:163], a[52:55], a[20:23], v[160:163]
 ds_read_b128 a[84:87], v228 offset:12288
 v_mfma_f32_16x16x32_bf16 v[132:135], a[52:55], a[16:19], v[132:135]
 buffer_load_dwordx4 v247, s[12:15], s50 offen offset:2048  lds
 v_mfma_f32_16x16x32_bf16 v[136:139], a[56:59], a[16:19], v[136:139]
 ds_read_b128 a[88:91], v228 offset:14336
 v_mfma_f32_16x16x32_bf16 v[164:167], a[56:59], a[20:23], v[164:167]
 v_mfma_f32_16x16x32_bf16 v[192:195], a[56:59], a[24:27], v[192:195]
 v_mfma_f32_16x16x32_bf16 v[220:223], a[56:59], a[28:31], v[220:223]
 v_mfma_f32_16x16x32_bf16 v[216:219], a[52:55], a[28:31], v[216:219]
 buffer_load_dwordx4 v248, s[12:15], s50 offen offset:3072  lds
 v_mfma_f32_16x16x32_bf16 v[188:191], a[52:55], a[24:27], v[188:191]
 v_mfma_f32_16x16x32_bf16 v[184:187], a[48:51], a[24:27], v[184:187]
 v_mfma_f32_16x16x32_bf16 v[212:215], a[48:51], a[28:31], v[212:215]
 v_mfma_f32_16x16x32_bf16 v[208:211], a[44:47], a[28:31], v[208:211]
 s_add_u32 m0, s49, 10240
 v_mfma_f32_16x16x32_bf16 v[180:183], a[44:47], a[24:27], v[180:183]
 buffer_load_dwordx4 v249, s[12:15], s50 offen offset:0  lds
 v_mfma_f32_16x16x32_bf16 v[176:179], a[40:43], a[24:27], v[176:179]
 v_mfma_f32_16x16x32_bf16 v[204:207], a[40:43], a[28:31], v[204:207]
 v_mfma_f32_16x16x32_bf16 v[200:203], a[36:39], a[28:31], v[200:203]
 v_mfma_f32_16x16x32_bf16 v[172:175], a[36:39], a[24:27], v[172:175]
 v_mfma_f32_16x16x32_bf16 v[168:171], a[32:35], a[24:27], v[168:171]
 v_mfma_f32_16x16x32_bf16 v[196:199], a[32:35], a[28:31], v[196:199]
 s_waitcnt lgkmcnt(0)
 s_waitcnt vmcnt(21)
 s_barrier
 v_mfma_f32_16x16x32_bf16 v[0:3], a[92:95], a[60:63], v[0:3]
 v_add_u32 v227, s47, v225
 v_add_u32 v228, s47, v226
 s_add_u32 s49, s46, s45
 ds_read_b64_tr_b16 a[32:33], v229 offset:30720
 v_mfma_f32_16x16x32_bf16 v[28:31], a[92:95], a[64:67], v[28:31]
 s_add_u32 s50, s50, 128
 s_and_b32 s50, s50, 2047
 s_mov_b32 s53, s46
 ds_read_b64_tr_b16 a[34:35], v229 offset:32512
 v_mfma_f32_16x16x32_bf16 v[32:35], a[96:99], a[64:67], v[32:35]
 s_mov_b32 s46, s47
 s_mov_b32 s47, s48
 s_mov_b32 s48, s53
 ds_read_b128 a[0:3], v227 offset:0
 v_mfma_f32_16x16x32_bf16 v[4:7], a[96:99], a[60:63], v[4:7]
 v_mfma_f32_16x16x32_bf16 v[8:11], a[100:103], a[60:63], v[8:11]
 ds_read_b64_tr_b16 a[36:37], v230 offset:30720
 s_add_u32 m0, s44, 15360
 v_mfma_f32_16x16x32_bf16 v[36:39], a[100:103], a[64:67], v[36:39]
 buffer_load_dwordx4 v251, s[16:19], s51 offen offset:0  lds
 v_mfma_f32_16x16x32_bf16 v[40:43], a[104:107], a[64:67], v[40:43]
 ds_read_b64_tr_b16 a[38:39], v230 offset:32512
 v_mfma_f32_16x16x32_bf16 v[12:15], a[104:107], a[60:63], v[12:15]
 v_mfma_f32_16x16x32_bf16 v[16:19], a[108:111], a[60:63], v[16:19]
 ds_read_b128 a[4:7], v227 offset:2048
 v_mfma_f32_16x16x32_bf16 v[44:47], a[108:111], a[64:67], v[44:47]
 buffer_load_dwordx4 v252, s[16:19], s51 offen offset:1024  lds
 v_mfma_f32_16x16x32_bf16 v[48:51], a[112:115], a[64:67], v[48:51]
 ds_read_b64_tr_b16 a[40:41], v229 offset:30784
 v_mfma_f32_16x16x32_bf16 v[20:23], a[112:115], a[60:63], v[20:23]
 v_mfma_f32_16x16x32_bf16 v[24:27], a[116:119], a[60:63], v[24:27]
 ds_read_b64_tr_b16 a[42:43], v229 offset:32576
 v_mfma_f32_16x16x32_bf16 v[52:55], a[116:119], a[64:67], v[52:55]
 buffer_load_dwordx4 v253, s[16:19], s51 offen offset:2048  lds
 v_mfma_f32_16x16x32_bf16 v[80:83], a[116:119], a[68:71], v[80:83]
 ds_read_b128 a[8:11], v227 offset:4096
 v_mfma_f32_16x16x32_bf16 v[108:111], a[116:119], a[72:75], v[108:111]
 v_mfma_f32_16x16x32_bf16 v[104:107], a[112:115], a[72:75], v[104:107]
 ds_read_b64_tr_b16 a[44:45], v230 offset:30784
 v_mfma_f32_16x16x32_bf16 v[76:79], a[112:115], a[68:71], v[76:79]
 v_mfma_f32_16x16x32_bf16 v[72:75], a[108:111], a[68:71], v[72:75]
 ds_read_b64_tr_b16 a[46:47], v230 offset:32576
 buffer_load_dwordx4 v254, s[16:19], s51 offen offset:3072  lds
 v_mfma_f32_16x16x32_bf16 v[100:103], a[108:111], a[72:75], v[100:103]
 v_mfma_f32_16x16x32_bf16 v[96:99], a[104:107], a[72:75], v[96:99]
 ds_read_b128 a[12:15], v227 offset:6144
 v_mfma_f32_16x16x32_bf16 v[68:71], a[104:107], a[68:71], v[68:71]
 s_add_u32 m0, s44, 19456
 v_mfma_f32_16x16x32_bf16 v[64:67], a[100:103], a[68:71], v[64:67]
 ds_read_b64_tr_b16 a[48:49], v229 offset:30848
 buffer_load_dwordx4 v255, s[16:19], s51 offen offset:0  lds
 s_add_u32 s51, s51, 229376
 s_cmp_eq_u32 s51, 7340032
 s_cselect_b32 s51, 0, s51
 v_mfma_f32_16x16x32_bf16 v[92:95], a[100:103], a[72:75], v[92:95]
 v_mfma_f32_16x16x32_bf16 v[88:91], a[96:99], a[72:75], v[88:91]
 ds_read_b64_tr_b16 a[50:51], v229 offset:32640
 v_mfma_f32_16x16x32_bf16 v[60:63], a[96:99], a[68:71], v[60:63]
 v_mfma_f32_16x16x32_bf16 v[56:59], a[92:95], a[68:71], v[56:59]
 ds_read_b128 a[16:19], v227 offset:8192
 s_add_u32 m0, s49, 0
 v_mfma_f32_16x16x32_bf16 v[84:87], a[92:95], a[72:75], v[84:87]
 buffer_load_dwordx4 v239, s[12:15], s50 offen offset:0  lds
 v_mfma_f32_16x16x32_bf16 v[112:115], a[92:95], a[76:79], v[112:115]
 ds_read_b64_tr_b16 a[52:53], v230 offset:30848
 v_mfma_f32_16x16x32_bf16 v[140:143], a[92:95], a[80:83], v[140:143]
 v_mfma_f32_16x16x32_bf16 v[144:147], a[96:99], a[80:83], v[144:147]
 ds_read_b64_tr_b16 a[54:55], v230 offset:32640
 v_mfma_f32_16x16x32_bf16 v[116:119], a[96:99], a[76:79], v[116:119]
 buffer_load_dwordx4 v240, s[12:15], s50 offen offset:1024  lds
 v_mfma_f32_16x16x32_bf16 v[120:123], a[100:103], a[76:79], v[120:123]
 ds_read_b128 a[20:23], v227 offset:10240
 v_mfma_f32_16x16x32_bf16 v[148:151], a[100:103], a[80:83], v[148:151]
 v_mfma_f32_16x16x32_bf16 v[152:155], a[104:107], a[80:83], v[152:155]
 ds_read_b64_tr_b16 a[56:57], v231 offset:30720
 v_mfma_f32_16x16x32_bf16 v[124:127], a[104:107], a[76:79], v[124:127]
 v_mfma_f32_16x16x32_bf16 v[128:131], a[108:111], a[76:79], v[128:131]
 ds_read_b64_tr_b16 a[58:59], v231 offset:32512
 buffer_load_dwordx4 v241, s[12:15], s50 offen offset:2048  lds
 v_mfma_f32_16x16x32_bf16 v[156:159], a[108:111], a[80:83], v[156:159]
 v_mfma_f32_16x16x32_bf16 v[160:163], a[112:115], a[80:83], v[160:163]
 ds_read_b128 a[24:27], v227 offset:12288
 v_mfma_f32_16x16x32_bf16 v[132:135], a[112:115], a[76:79], v[132:135]
 v_mfma_f32_16x16x32_bf16 v[136:139], a[116:119], a[76:79], v[136:139]
 ds_read_b128 a[28:31], v227 offset:14336
 buffer_load_dwordx4 v242, s[12:15], s50 offen offset:3072  lds
 v_mfma_f32_16x16x32_bf16 v[164:167], a[116:119], a[80:83], v[164:167]
 v_mfma_f32_16x16x32_bf16 v[192:195], a[116:119], a[84:87], v[192:195]
 v_mfma_f32_16x16x32_bf16 v[220:223], a[116:119], a[88:91], v[220:223]
 v_mfma_f32_16x16x32_bf16 v[216:219], a[112:115], a[88:91], v[216:219]
 s_add_u32 m0, s49, 4096
 v_mfma_f32_16x16x32_bf16 v[188:191], a[112:115], a[84:87], v[188:191]
 buffer_load_dwordx4 v243, s[12:15], s50 offen offset:0  lds
 v_mfma_f32_16x16x32_bf16 v[184:187], a[108:111], a[84:87], v[184:187]
 v_mfma_f32_16x16x32_bf16 v[212:215], a[108:111], a[88:91], v[212:215]
 v_mfma_f32_16x16x32_bf16 v[208:211], a[104:107], a[88:91], v[208:211]
 v_mfma_f32_16x16x32_bf16 v[180:183], a[104:107], a[84:87], v[180:183]
 buffer_load_dwordx4 v244, s[12:15], s50 offen offset:1024  lds
 v_mfma_f32_16x16x32_bf16 v[176:179], a[100:103], a[84:87], v[176:179]
 v_mfma_f32_16x16x32_bf16 v[204:207], a[100:103], a[88:91], v[204:207]
 v_mfma_f32_16x16x32_bf16 v[200:203], a[96:99], a[88:91], v[200:203]
 v_mfma_f32_16x16x32_bf16 v[172:175], a[96:99], a[84:87], v[172:175]
 v_mfma_f32_16x16x32_bf16 v[168:171], a[92:95], a[84:87], v[168:171]
 v_mfma_f32_16x16x32_bf16 v[196:199], a[92:95], a[88:91], v[196:199]
 s_waitcnt lgkmcnt(0)
 s_waitcnt vmcnt(21)
 s_barrier
 v_mfma_f32_16x16x32_bf16 v[0:3], a[32:35], a[0:3], v[0:3]
 s_sub_u32 s52, s52, 1
 ds_read_b64_tr_b16 a[92:93], v229 offset:46080
 v_mfma_f32_16x16x32_bf16 v[28:31], a[32:35], a[4:7], v[28:31]
 ds_read_b64_tr_b16 a[94:95], v229 offset:47872
 v_mfma_f32_16x16x32_bf16 v[32:35], a[36:39], a[4:7], v[32:35]
 ds_read_b128 a[60:63], v228 offset:0
 v_mfma_f32_16x16x32_bf16 v[4:7], a[36:39], a[0:3], v[4:7]
 v_mfma_f32_16x16x32_bf16 v[8:11], a[40:43], a[0:3], v[8:11]
 ds_read_b64_tr_b16 a[96:97], v230 offset:46080
 s_add_u32 m0, s44, 30720
 v_mfma_f32_16x16x32_bf16 v[36:39], a[40:43], a[4:7], v[36:39]
 buffer_load_dwordx4 v251, s[16:19], s51 offen offset:0  lds
 v_mfma_f32_16x16x32_bf16 v[40:43], a[44:47], a[4:7], v[40:43]
 ds_read_b64_tr_b16 a[98:99], v230 offset:47872
 v_mfma_f32_16x16x32_bf16 v[12:15], a[44:47], a[0:3], v[12:15]
 v_mfma_f32_16x16x32_bf16 v[16:19], a[48:51], a[0:3], v[16:19]
 ds_read_b128 a[64:67], v228 offset:2048
 v_mfma_f32_16x16x32_bf16 v[44:47], a[48:51], a[4:7], v[44:47]
 buffer_load_dwordx4 v252, s[16:19], s51 offen offset:1024  lds
 v_mfma_f32_16x16x32_bf16 v[48:51], a[52:55], a[4:7], v[48:51]
 ds_read_b64_tr_b16 a[100:101], v229 offset:46144
 v_mfma_f32_16x16x32_bf16 v[20:23], a[52:55], a[0:3], v[20:23]
 v_mfma_f32_16x16x32_bf16 v[24:27], a[56:59], a[0:3], v[24:27]
 ds_read_b64_tr_b16 a[102:103], v229 offset:47936
 v_mfma_f32_16x16x32_bf16 v[52:55], a[56:59], a[4:7], v[52:55]
 v_mfma_f32_16x16x32_bf16 v[80:83], a[56:59], a[8:11], v[80:83]
 ds_read_b128 a[68:71], v228 offset:4096
 buffer_load_dwordx4 v253, s[16:19], s51 offen offset:2048  lds
 v_mfma_f32_16x16x32_bf16 v[108:111], a[56:59], a[12:15], v[108:111]
 v_mfma_f32_16x16x32_bf16 v[104:107], a[52:55], a[12:15], v[104:107]
 ds_read_b64_tr_b16 a[104:105], v230 offset:46144
 v_mfma_f32_16x16x32_bf16 v[76:79], a[52:55], a[8:11], v[76:79]
 v_mfma_f32_16x16x32_bf16 v[72:75], a[48:51], a[8:11], v[72:75]
 ds_read_b64_tr_b16 a[106:107], v230 offset:47936
 v_mfma_f32_16x16x32_bf16 v[100:103], a[48:51], a[12:15], v[100:103]
 buffer_load_dwordx4 v254, s[16:19], s51 offen offset:3072  lds
 v_mfma_f32_16x16x32_bf16 v[96:99], a[44:47], a[12:15], v[96:99]
 ds_read_b128 a[72:75], v228 offset:6144
 v_mfma_f32_16x16x32_bf16 v[68:71], a[44:47], a[8:11], v[68:71]
 v_mfma_f32_16x16x32_bf16 v[64:67], a[40:43], a[8:11], v[64:67]
 ds_read_b64_tr_b16 a[108:109], v229 offset:46208
 v_mfma_f32_16x16x32_bf16 v[92:95], a[40:43], a[12:15], v[92:95]
 s_add_u32 m0, s44, 34816
 v_mfma_f32_16x16x32_bf16 v[88:91], a[36:39], a[12:15], v[88:91]
 ds_read_b64_tr_b16 a[110:111], v229 offset:48000
 buffer_load_dwordx4 v255, s[16:19], s51 offen offset:0  lds
 s_add_u32 s51, s51, 229376
 s_cmp_eq_u32 s51, 7340032
 s_cselect_b32 s51, 0, s51
 v_mfma_f32_16x16x32_bf16 v[60:63], a[36:39], a[8:11], v[60:63]
 v_mfma_f32_16x16x32_bf16 v[56:59], a[32:35], a[8:11], v[56:59]
 ds_read_b128 a[76:79], v228 offset:8192
 v_mfma_f32_16x16x32_bf16 v[84:87], a[32:35], a[12:15], v[84:87]
 v_mfma_f32_16x16x32_bf16 v[112:115], a[32:35], a[16:19], v[112:115]
 ds_read_b64_tr_b16 a[112:113], v230 offset:46208
 s_add_u32 m0, s49, 6144
 v_mfma_f32_16x16x32_bf16 v[140:143], a[32:35], a[20:23], v[140:143]
 buffer_load_dwordx4 v245, s[12:15], s50 offen offset:0  lds
 v_mfma_f32_16x16x32_bf16 v[144:147], a[36:39], a[20:23], v[144:147]
 ds_read_b64_tr_b16 a[114:115], v230 offset:48000
 v_mfma_f32_16x16x32_bf16 v[116:119], a[36:39], a[16:19], v[116:119]
 v_mfma_f32_16x16x32_bf16 v[120:123], a[40:43], a[16:19], v[120:123]
 ds_read_b128 a[80:83], v228 offset:10240
 v_mfma_f32_16x16x32_bf16 v[148:151], a[40:43], a[20:23], v[148:151]
 v_mfma_f32_16x16x32_bf16 v[152:155], a[44:47], a[20:23], v[152:155]
 ds_read_b64_tr_b16 a[116:117], v231 offset:46080
 buffer_load_dwordx4 v246, s[12:15], s50 offen offset:1024  lds
 v_mfma_f32_16x16x32_bf16 v[124:127], a[44:47], a[16:19], v[124:127]
 v_mfma_f32_16x16x32_bf16 v[128:131], a[48:51], a[16:19], v[128:131]
 ds_read_b64_tr_b16 a[118:119], v231 offset:47872
 v_mfma_f32_16x16x32_bf16 v[156:159], a[48:51], a[20:23], v[156:159]
 v_mfma_f32_16x16x32_bf16 v[160:163], a[52:55], a[20:23], v[160:163]
 ds_read_b128 a[84:87], v228 offset:12288
 v_mfma_f32_16x16x32_bf16 v[132:135], a[52:55], a[16:19], v[132:135]
 buffer_load_dwordx4 v247, s[12:15], s50 offen offset:2048  lds
 v_mfma_f32_16x16x32_bf16 v[136:139], a[56:59], a[16:19], v[136:139]
 ds_read_b128 a[88:91], v228 offset:14336
 v_mfma_f32_16x16x32_bf16 v[164:167], a[56:59], a[20:23], v[164:167]
 v_mfma_f32_16x16x32_bf16 v[192:195], a[56:59], a[24:27], v[192:195]
 v_mfma_f32_16x16x32_bf16 v[220:223], a[56:59], a[28:31], v[220:223]
 v_mfma_f32_16x16x32_bf16 v[216:219], a[52:55], a[28:31], v[216:219]
 buffer_load_dwordx4 v248, s[12:15], s50 offen offset:3072  lds
 v_mfma_f32_16x16x32_bf16 v[188:191], a[52:55], a[24:27], v[188:191]
 v_mfma_f32_16x16x32_bf16 v[184:187], a[48:51], a[24:27], v[184:187]
 v_mfma_f32_16x16x32_bf16 v[212:215], a[48:51], a[28:31], v[212:215]
 v_mfma_f32_16x16x32_bf16 v[208:211], a[44:47], a[28:31], v[208:211]
 s_add_u32 m0, s49, 10240
 v_mfma_f32_16x16x32_bf16 v[180:183], a[44:47], a[24:27], v[180:183]
 buffer_load_dwordx4 v249, s[12:15], s50 offen offset:0  lds
 v_mfma_f32_16x16x32_bf16 v[176:179], a[40:43], a[24:27], v[176:179]
 v_mfma_f32_16x16x32_bf16 v[204:207], a[40:43], a[28:31], v[204:207]
 v_mfma_f32_16x16x32_bf16 v[200:203], a[36:39], a[28:31], v[200:203]
 v_mfma_f32_16x16x32_bf16 v[172:175], a[36:39], a[24:27], v[172:175]
 v_mfma_f32_16x16x32_bf16 v[168:171], a[32:35], a[24:27], v[168:171]
 v_mfma_f32_16x16x32_bf16 v[196:199], a[32:35], a[28:31], v[196:199]
 s_waitcnt lgkmcnt(0)
 s_waitcnt vmcnt(21)
 s_barrier
 v_mfma_f32_16x16x32_bf16 v[0:3], a[92:95], a[60:63], v[0:3]
 v_add_u32 v227, s47, v225
 v_add_u32 v228, s47, v226
 s_add_u32 s49, s46, s45
 ds_read_b64_tr_b16 a[32:33], v229 offset:0
 v_mfma_f32_16x16x32_bf16 v[28:31], a[92:95], a[64:67], v[28:31]
 s_add_u32 s50, s50, 128
 s_and_b32 s50, s50, 2047
 s_mov_b32 s53, s46
 ds_read_b64_tr_b16 a[34:35], v229 offset:1792
 v_mfma_f32_16x16x32_bf16 v[32:35], a[96:99], a[64:67], v[32:35]
 s_mov_b32 s46, s47
 s_mov_b32 s47, s48
 s_mov_b32 s48, s53
 ds_read_b128 a[0:3], v227 offset:0
 v_mfma_f32_16x16x32_bf16 v[4:7], a[96:99], a[60:63], v[4:7]
 v_mfma_f32_16x16x32_bf16 v[8:11], a[100:103], a[60:63], v[8:11]
 ds_read_b64_tr_b16 a[36:37], v230 offset:0
 s_add_u32 m0, s44, 46080
 v_mfma_f32_16x16x32_bf16 v[36:39], a[100:103], a[64:67], v[36:39]
 buffer_load_dwordx4 v251, s[16:19], s51 offen offset:0  lds
 v_mfma_f32_16x16x32_bf16 v[40:43], a[104:107], a[64:67], v[40:43]
 ds_read_b64_tr_b16 a[38:39], v230 offset:1792
 v_mfma_f32_16x16x32_bf16 v[12:15], a[104:107], a[60:63], v[12:15]
 v_mfma_f32_16x16x32_bf16 v[16:19], a[108:111], a[60:63], v[16:19]
 ds_read_b128 a[4:7], v227 offset:2048
 v_mfma_f32_16x16x32_bf16 v[44:47], a[108:111], a[64:67], v[44:47]
 buffer_load_dwordx4 v252, s[16:19], s51 offen offset:1024  lds
 v_mfma_f32_16x16x32_bf16 v[48:51], a[112:115], a[64:67], v[48:51]
 ds_read_b64_tr_b16 a[40:41], v229 offset:64
 v_mfma_f32_16x16x32_bf16 v[20:23], a[112:115], a[60:63], v[20:23]
 v_mfma_f32_16x16x32_bf16 v[24:27], a[116:119], a[60:63], v[24:27]
 ds_read_b64_tr_b16 a[42:43], v229 offset:1856
 v_mfma_f32_16x16x32_bf16 v[52:55], a[116:119], a[64:67], v[52:55]
 buffer_load_dwordx4 v253, s[16:19], s51 offen offset:2048  lds
 v_mfma_f32_16x16x32_bf16 v[80:83], a[116:119], a[68:71], v[80:83]
 ds_read_b128 a[8:11], v227 offset:4096
 v_mfma_f32_16x16x32_bf16 v[108:111], a[116:119], a[72:75], v[108:111]
 v_mfma_f32_16x16x32_bf16 v[104:107], a[112:115], a[72:75], v[104:107]
 ds_read_b64_tr_b16 a[44:45], v230 offset:64
 v_mfma_f32_16x16x32_bf16 v[76:79], a[112:115], a[68:71], v[76:79]
 v_mfma_f32_16x16x32_bf16 v[72:75], a[108:111], a[68:71], v[72:75]
 ds_read_b64_tr_b16 a[46:47], v230 offset:1856
 buffer_load_dwordx4 v254, s[16:19], s51 offen offset:3072  lds
 v_mfma_f32_16x16x32_bf16 v[100:103], a[108:111], a[72:75], v[100:103]
 v_mfma_f32_16x16x32_bf16 v[96:99], a[104:107], a[72:75], v[96:99]
 ds_read_b128 a[12:15], v227 offset:6144
 v_mfma_f32_16x16x32_bf16 v[68:71], a[104:107], a[68:71], v[68:71]
 s_add_u32 m0, s44, 50176
 v_mfma_f32_16x16x32_bf16 v[64:67], a[100:103], a[68:71], v[64:67]
 ds_read_b64_tr_b16 a[48:49], v229 offset:128
 buffer_load_dwordx4 v255, s[16:19], s51 offen offset:0  lds
 s_add_u32 s51, s51, 229376
 s_cmp_eq_u32 s51, 7340032
 s_cselect_b32 s51, 0, s51
 v_mfma_f32_16x16x32_bf16 v[92:95], a[100:103], a[72:75], v[92:95]
 v_mfma_f32_16x16x32_bf16 v[88:91], a[96:99], a[72:75], v[88:91]
 ds_read_b64_tr_b16 a[50:51], v229 offset:1920
 v_mfma_f32_16x16x32_bf16 v[60:63], a[96:99], a[68:71], v[60:63]
 v_mfma_f32_16x16x32_bf16 v[56:59], a[92:95], a[68:71], v[56:59]
 ds_read_b128 a[16:19], v227 offset:8192
 s_add_u32 m0, s49, 0
 v_mfma_f32_16x16x32_bf16 v[84:87], a[92:95], a[72:75], v[84:87]
 buffer_load_dwordx4 v239, s[12:15], s50 offen offset:0  lds
 v_mfma_f32_16x16x32_bf16 v[112:115], a[92:95], a[76:79], v[112:115]
 ds_read_b64_tr_b16 a[52:53], v230 offset:128
 v_mfma_f32_16x16x32_bf16 v[140:143], a[92:95], a[80:83], v[140:143]
 v_mfma_f32_16x16x32_bf16 v[144:147], a[96:99], a[80:83], v[144:147]
 ds_read_b64_tr_b16 a[54:55], v230 offset:1920
 v_mfma_f32_16x16x32_bf16 v[116:119], a[96:99], a[76:79], v[116:119]
 buffer_load_dwordx4 v240, s[12:15], s50 offen offset:1024  lds
 v_mfma_f32_16x16x32_bf16 v[120:123], a[100:103], a[76:79], v[120:123]
 ds_read_b128 a[20:23], v227 offset:10240
 v_mfma_f32_16x16x32_bf16 v[148:151], a[100:103], a[80:83], v[148:151]
 v_mfma_f32_16x16x32_bf16 v[152:155], a[104:107], a[80:83], v[152:155]
 ds_read_b64_tr_b16 a[56:57], v231 offset:0
 v_mfma_f32_16x16x32_bf16 v[124:127], a[104:107], a[76:79], v[124:127]
 v_mfma_f32_16x16x32_bf16 v[128:131], a[108:111], a[76:79], v[128:131]
 ds_read_b64_tr_b16 a[58:59], v231 offset:1792
 buffer_load_dwordx4 v241, s[12:15], s50 offen offset:2048  lds
 v_mfma_f32_16x16x32_bf16 v[156:159], a[108:111], a[80:83], v[156:159]
 v_mfma_f32_16x16x32_bf16 v[160:163], a[112:115], a[80:83], v[160:163]
 ds_read_b128 a[24:27], v227 offset:12288
 v_mfma_f32_16x16x32_bf16 v[132:135], a[112:115], a[76:79], v[132:135]
 v_mfma_f32_16x16x32_bf16 v[136:139], a[116:119], a[76:79], v[136:139]
 ds_read_b128 a[28:31], v227 offset:14336
 buffer_load_dwordx4 v242, s[12:15], s50 offen offset:3072  lds
 v_mfma_f32_16x16x32_bf16 v[164:167], a[116:119], a[80:83], v[164:167]
 v_mfma_f32_16x16x32_bf16 v[192:195], a[116:119], a[84:87], v[192:195]
 v_mfma_f32_16x16x32_bf16 v[220:223], a[116:119], a[88:91], v[220:223]
 v_mfma_f32_16x16x32_bf16 v[216:219], a[112:115], a[88:91], v[216:219]
 s_add_u32 m0, s49, 4096
 v_mfma_f32_16x16x32_bf16 v[188:191], a[112:115], a[84:87], v[188:191]
 buffer_load_dwordx4 v243, s[12:15], s50 offen offset:0  lds
 v_mfma_f32_16x16x32_bf16 v[184:187], a[108:111], a[84:87], v[184:187]
 v_mfma_f32_16x16x32_bf16 v[212:215], a[108:111], a[88:91], v[212:215]
 v_mfma_f32_16x16x32_bf16 v[208:211], a[104:107], a[88:91], v[208:211]
 v_mfma_f32_16x16x32_bf16 v[180:183], a[104:107], a[84:87], v[180:183]
 buffer_load_dwordx4 v244, s[12:15], s50 offen offset:1024  lds
 v_mfma_f32_16x16x32_bf16 v[176:179], a[100:103], a[84:87], v[176:179]
 v_mfma_f32_16x16x32_bf16 v[204:207], a[100:103], a[88:91], v[204:207]
 v_mfma_f32_16x16x32_bf16 v[200:203], a[96:99], a[88:91], v[200:203]
 v_mfma_f32_16x16x32_bf16 v[172:175], a[96:99], a[84:87], v[172:175]
 v_mfma_f32_16x16x32_bf16 v[168:171], a[92:95], a[84:87], v[168:171]
 v_mfma_f32_16x16x32_bf16 v[196:199], a[92:95], a[88:91], v[196:199]
 s_cmp_lg_u32 s52, 0
 s_cbranch_scc1 L1hD_loop
 s_waitcnt lgkmcnt(0)
 s_waitcnt vmcnt(27)
 s_barrier
 v_mfma_f32_16x16x32_bf16 v[0:3], a[32:35], a[0:3], v[0:3]
 ds_read_b64_tr_b16 a[92:93], v229 offset:15360
 v_mfma_f32_16x16x32_bf16 v[28:31], a[32:35], a[4:7], v[28:31]
 ds_read_b64_tr_b16 a[94:95], v229 offset:17152
 v_mfma_f32_16x16x32_bf16 v[32:35], a[36:39], a[4:7], v[32:35]
 ds_read_b128 a[60:63], v228 offset:0
 v_mfma_f32_16x16x32_bf16 v[4:7], a[36:39], a[0:3], v[4:7]
 v_mfma_f32_16x16x32_bf16 v[8:11], a[40:43], a[0:3], v[8:11]
 ds_read_b64_tr_b16 a[96:97], v230 offset:15360
 s_add_u32 m0, s44, 0
 v_mfma_f32_16x16x32_bf16 v[36:39], a[40:43], a[4:7], v[36:39]
 buffer_load_dwordx4 v251, s[16:19], s51 offen offset:0  lds
 v_mfma_f32_16x16x32_bf16 v[40:43], a[44:47], a[4:7], v[40:43]
 ds_read_b64_tr_b16 a[98:99], v230 offset:17152
 v_mfma_f32_16x16x32_bf16 v[12:15], a[44:47], a[0:3], v[12:15]
 v_mfma_f32_16x16x32_bf16 v[16:19], a[48:51], a[0:3], v[16:19]
 ds_read_b128 a[64:67], v228 offset:2048
 v_mfma_f32_16x16x32_bf16 v[44:47], a[48:51], a[4:7], v[44:47]
 buffer_load_dwordx4 v252, s[16:19], s51 offen offset:1024  lds
 v_mfma_f32_16x16x32_bf16 v[48:51], a[52:55], a[4:7], v[48:51]
 ds_read_b64_tr_b16 a[100:101], v229 offset:15424
 v_mfma_f32_16x16x32_bf16 v[20:23], a[52:55], a[0:3], v[20:23]
 v_mfma_f32_16x16x32_bf16 v[24:27], a[56:59], a[0:3], v[24:27]
 ds_read_b64_tr_b16 a[102:103], v229 offset:17216
 v_mfma_f32_16x16x32_bf16 v[52:55], a[56:59], a[4:7], v[52:55]
 v_mfma_f32_16x16x32_bf16 v[80:83], a[56:59], a[8:11], v[80:83]
 ds_read_b128 a[68:71], v228 offset:4096
 buffer_load_dwordx4 v253, s[16:19], s51 offen offset:2048  lds
 v_mfma_f32_16x16x32_bf16 v[108:111], a[56:59], a[12:15], v[108:111]
 v_mfma_f32_16x16x32_bf16 v[104:107], a[52:55], a[12:15], v[104:107]
 ds_read_b64_tr_b16 a[104:105], v230 offset:15424
 v_mfma_f32_16x16x32_bf16 v[76:79], a[52:55], a[8:11], v[76:79]
 v_mfma_f32_16x16x32_bf16 v[72:75], a[48:51], a[8:11], v[72:75]
 ds_read_b64_tr_b16 a[106:107], v230 offset:17216
 v_mfma_f32_16x16x32_bf16 v[100:103], a[48:51], a[12:15], v[100:103]
 buffer_load_dwordx4 v254, s[16:19], s51 offen offset:3072  lds
 v_mfma_f32_16x16x32_bf16 v[96:99], a[44:47], a[12:15], v[96:99]
 ds_read_b128 a[72:75], v228 offset:6144
 v_mfma_f32_16x16x32_bf16 v[68:71], a[44:47], a[8:11], v[68:71]
 v_mfma_f32_16x16x32_bf16 v[64:67], a[40:43], a[8:11], v[64:67]
 ds_read_b64_tr_b16 a[108:109], v229 offset:15488
 v_mfma_f32_16x16x32_bf16 v[92:95], a[40:43], a[12:15], v[92:95]
 s_add_u32 m0, s44, 4096
 v_mfma_f32_16x16x32_bf16 v[88:91], a[36:39], a[12:15], v[88:91]
 ds_read_b64_tr_b16 a[110:111], v229 offset:17280
 buffer_load_dwordx4 v255, s[16:19], s51 offen offset:0  lds
 s_add_u32 s51, s51, 229376
 s_cmp_eq_u32 s51, 7340032
 s_cselect_b32 s51, 0, s51
 v_mfma_f32_16x16x32_bf16 v[60:63], a[36:39], a[8:11], v[60:63]
 v_mfma_f32_16x16x32_bf16 v[56:59], a[32:35], a[8:11], v[56:59]
 ds_read_b128 a[76:79], v228 offset:8192
 v_mfma_f32_16x16x32_bf16 v[84:87], a[32:35], a[12:15], v[84:87]
 v_mfma_f32_16x16x32_bf16 v[112:115], a[32:35], a[16:19], v[112:115]
 ds_read_b64_tr_b16 a[112:113], v230 offset:15488
 s_add_u32 m0, s49, 6144
 v_mfma_f32_16x16x32_bf16 v[140:143], a[32:35], a[20:23], v[140:143]
 buffer_load_dwordx4 v245, s[12:15], s50 offen offset:0  lds
 v_mfma_f32_16x16x32_bf16 v[144:147], a[36:39], a[20:23], v[144:147]
 ds_read_b64_tr_b16 a[114:115], v230 offset:17280
 v_mfma_f32_16x16x32_bf16 v[116:119], a[36:39], a[16:19], v[116:119]
 v_mfma_f32_16x16x32_bf16 v[120:123], a[40:43], a[16:19], v[120:123]
 ds_read_b128 a[80:83], v228 offset:10240
 v_mfma_f32_16x16x32_bf16 v[148:151], a[40:43], a[20:23], v[148:151]
 v_mfma_f32_16x16x32_bf16 v[152:155], a[44:47], a[20:23], v[152:155]
 ds_read_b64_tr_b16 a[116:117], v231 offset:15360
 buffer_load_dwordx4 v246, s[12:15], s50 offen offset:1024  lds
 v_mfma_f32_16x16x32_bf16 v[124:127], a[44:47], a[16:19], v[124:127]
 v_mfma_f32_16x16x32_bf16 v[128:131], a[48:51], a[16:19], v[128:131]
 ds_read_b64_tr_b16 a[118:119], v231 offset:17152
 v_mfma_f32_16x16x32_bf16 v[156:159], a[48:51], a[20:23], v[156:159]
 v_mfma_f32_16x16x32_bf16 v[160:163], a[52:55], a[20:23], v[160:163]
 ds_read_b128 a[84:87], v228 offset:12288
 v_mfma_f32_16x16x32_bf16 v[132:135], a[52:55], a[16:19], v[132:135]
 buffer_load_dwordx4 v247, s[12:15], s50 offen offset:2048  lds
 v_mfma_f32_16x16x32_bf16 v[136:139], a[56:59], a[16:19], v[136:139]
 ds_read_b128 a[88:91], v228 offset:14336
 v_mfma_f32_16x16x32_bf16 v[164:167], a[56:59], a[20:23], v[164:167]
 v_mfma_f32_16x16x32_bf16 v[192:195], a[56:59], a[24:27], v[192:195]
 v_mfma_f32_16x16x32_bf16 v[220:223], a[56:59], a[28:31], v[220:223]
 v_mfma_f32_16x16x32_bf16 v[216:219], a[52:55], a[28:31], v[216:219]
 buffer_load_dwordx4 v248, s[12:15], s50 offen offset:3072  lds
 v_mfma_f32_16x16x32_bf16 v[188:191], a[52:55], a[24:27], v[188:191]
 v_mfma_f32_16x16x32_bf16 v[184:187], a[48:51], a[24:27], v[184:187]
 v_mfma_f32_16x16x32_bf16 v[212:215], a[48:51], a[28:31], v[212:215]
 v_mfma_f32_16x16x32_bf16 v[208:211], a[44:47], a[28:31], v[208:211]
 s_add_u32 m0, s49, 10240
 v_mfma_f32_16x16x32_bf16 v[180:183], a[44:47], a[24:27], v[180:183]
 buffer_load_dwordx4 v249, s[12:15], s50 offen offset:0  lds
 v_mfma_f32_16x16x32_bf16 v[176:179], a[40:43], a[24:27], v[176:179]
 v_mfma_f32_16x16x32_bf16 v[204:207], a[40:43], a[28:31], v[204:207]
 v_mfma_f32_16x16x32_bf16 v[200:203], a[36:39], a[28:31], v[200:203]
 v_mfma_f32_16x16x32_bf16 v[172:175], a[36:39], a[24:27], v[172:175]
 v_mfma_f32_16x16x32_bf16 v[168:171], a[32:35], a[24:27], v[168:171]
 v_mfma_f32_16x16x32_bf16 v[196:199], a[32:35], a[28:31], v[196:199]
 s_waitcnt lgkmcnt(0)
 s_waitcnt vmcnt(21)
 s_barrier
 v_mfma_f32_16x16x32_bf16 v[0:3], a[92:95], a[60:63], v[0:3]
 v_add_u32 v227, s47, v225
 v_add_u32 v228, s47, v226
 s_add_u32 s49, s46, s45
 ds_read_b64_tr_b16 a[32:33], v229 offset:30720
 v_mfma_f32_16x16x32_bf16 v[28:31], a[92:95], a[64:67], v[28:31]
 s_add_u32 s50, s50, 128
 s_and_b32 s50, s50, 2047
 s_mov_b32 s53, s46
 ds_read_b64_tr_b16 a[34:35], v229 offset:32512
 v_mfma_f32_16x16x32_bf16 v[32:35], a[96:99], a[64:67], v[32:35]
 s_mov_b32 s46, s47
 s_mov_b32 s47, s48
 s_mov_b32 s48, s53
 ds_read_b128 a[0:3], v227 offset:0
 v_mfma_f32_16x16x32_bf16 v[4:7], a[96:99], a[60:63], v[4:7]
 v_mfma_f32_16x16x32_bf16 v[8:11], a[100:103], a[60:63], v[8:11]
 ds_read_b64_tr_b16 a[36:37], v230 offset:30720
 s_add_u32 m0, s44, 15360
 v_mfma_f32_16x16x32_bf16 v[36:39], a[100:103], a[64:67], v[36:39]
 buffer_load_dwordx4 v251, s[16:19], s51 offen offset:0  lds
 v_mfma_f32_16x16x32_bf16 v[40:43], a[104:107], a[64:67], v[40:43]
 ds_read_b64_tr_b16 a[38:39], v230 offset:32512
 v_mfma_f32_16x16x32_bf16 v[12:15], a[104:107], a[60:63], v[12:15]
 v_mfma_f32_16x16x32_bf16 v[16:19], a[108:111], a[60:63], v[16:19]
 ds_read_b128 a[4:7], v227 offset:2048
 v_mfma_f32_16x16x32_bf16 v[44:47], a[108:111], a[64:67], v[44:47]
 buffer_load_dwordx4 v252, s[16:19], s51 offen offset:1024  lds
 v_mfma_f32_16x16x32_bf16 v[48:51], a[112:115], a[64:67], v[48:51]
 ds_read_b64_tr_b16 a[40:41], v229 offset:30784
 v_mfma_f32_16x16x32_bf16 v[20:23], a[112:115], a[60:63], v[20:23]
 v_mfma_f32_16x16x32_bf16 v[24:27], a[116:119], a[60:63], v[24:27]
 ds_read_b64_tr_b16 a[42:43], v229 offset:32576
 v_mfma_f32_16x16x32_bf16 v[52:55], a[116:119], a[64:67], v[52:55]
 buffer_load_dwordx4 v253, s[16:19], s51 offen offset:2048  lds
 v_mfma_f32_16x16x32_bf16 v[80:83], a[116:119], a[68:71], v[80:83]
 ds_read_b128 a[8:11], v227 offset:4096
 v_mfma_f32_16x16x32_bf16 v[108:111], a[116:119], a[72:75], v[108:111]
 v_mfma_f32_16x16x32_bf16 v[104:107], a[112:115], a[72:75], v[104:107]
 ds_read_b64_tr_b16 a[44:45], v230 offset:30784
 v_mfma_f32_16x16x32_bf16 v[76:79], a[112:115], a[68:71], v[76:79]
 v_mfma_f32_16x16x32_bf16 v[72:75], a[108:111], a[68:71], v[72:75]
 ds_read_b64_tr_b16 a[46:47], v230 offset:32576
 buffer_load_dwordx4 v254, s[16:19], s51 offen offset:3072  lds
 v_mfma_f32_16x16x32_bf16 v[100:103], a[108:111], a[72:75], v[100:103]
 v_mfma_f32_16x16x32_bf16 v[96:99], a[104:107], a[72:75], v[96:99]
 ds_read_b128 a[12:15], v227 offset:6144
 v_mfma_f32_16x16x32_bf16 v[68:71], a[104:107], a[68:71], v[68:71]
 s_add_u32 m0, s44, 19456
 v_mfma_f32_16x16x32_bf16 v[64:67], a[100:103], a[68:71], v[64:67]
 ds_read_b64_tr_b16 a[48:49], v229 offset:30848
 buffer_load_dwordx4 v255, s[16:19], s51 offen offset:0  lds
 s_add_u32 s51, s51, 229376
 s_cmp_eq_u32 s51, 7340032
 s_cselect_b32 s51, 0, s51
 v_mfma_f32_16x16x32_bf16 v[92:95], a[100:103], a[72:75], v[92:95]
 v_mfma_f32_16x16x32_bf16 v[88:91], a[96:99], a[72:75], v[88:91]
 ds_read_b64_tr_b16 a[50:51], v229 offset:32640
 v_mfma_f32_16x16x32_bf16 v[60:63], a[96:99], a[68:71], v[60:63]
 v_mfma_f32_16x16x32_bf16 v[56:59], a[92:95], a[68:71], v[56:59]
 ds_read_b128 a[16:19], v227 offset:8192
 s_add_u32 m0, s49, 0
 v_mfma_f32_16x16x32_bf16 v[84:87], a[92:95], a[72:75], v[84:87]
 buffer_load_dwordx4 v239, s[12:15], s50 offen offset:0  lds
 v_mfma_f32_16x16x32_bf16 v[112:115], a[92:95], a[76:79], v[112:115]
 ds_read_b64_tr_b16 a[52:53], v230 offset:30848
 v_mfma_f32_16x16x32_bf16 v[140:143], a[92:95], a[80:83], v[140:143]
 v_mfma_f32_16x16x32_bf16 v[144:147], a[96:99], a[80:83], v[144:147]
 ds_read_b64_tr_b16 a[54:55], v230 offset:32640
 v_mfma_f32_16x16x32_bf16 v[116:119], a[96:99], a[76:79], v[116:119]
 buffer_load_dwordx4 v240, s[12:15], s50 offen offset:1024  lds
 v_mfma_f32_16x16x32_bf16 v[120:123], a[100:103], a[76:79], v[120:123]
 ds_read_b128 a[20:23], v227 offset:10240
 v_mfma_f32_16x16x32_bf16 v[148:151], a[100:103], a[80:83], v[148:151]
 v_mfma_f32_16x16x32_bf16 v[152:155], a[104:107], a[80:83], v[152:155]
 ds_read_b64_tr_b16 a[56:57], v231 offset:30720
 v_mfma_f32_16x16x32_bf16 v[124:127], a[104:107], a[76:79], v[124:127]
 v_mfma_f32_16x16x32_bf16 v[128:131], a[108:111], a[76:79], v[128:131]
 ds_read_b64_tr_b16 a[58:59], v231 offset:32512
 buffer_load_dwordx4 v241, s[12:15], s50 offen offset:2048  lds
 v_mfma_f32_16x16x32_bf16 v[156:159], a[108:111], a[80:83], v[156:159]
 v_mfma_f32_16x16x32_bf16 v[160:163], a[112:115], a[80:83], v[160:163]
 ds_read_b128 a[24:27], v227 offset:12288
 v_mfma_f32_16x16x32_bf16 v[132:135], a[112:115], a[76:79], v[132:135]
 v_mfma_f32_16x16x32_bf16 v[136:139], a[116:119], a[76:79], v[136:139]
 ds_read_b128 a[28:31], v227 offset:14336
 buffer_load_dwordx4 v242, s[12:15], s50 offen offset:3072  lds
 v_mfma_f32_16x16x32_bf16 v[164:167], a[116:119], a[80:83], v[164:167]
 v_mfma_f32_16x16x32_bf16 v[192:195], a[116:119], a[84:87], v[192:195]
 v_mfma_f32_16x16x32_bf16 v[220:223], a[116:119], a[88:91], v[220:223]
 v_mfma_f32_16x16x32_bf16 v[216:219], a[112:115], a[88:91], v[216:219]
 s_add_u32 m0, s49, 4096
 v_mfma_f32_16x16x32_bf16 v[188:191], a[112:115], a[84:87], v[188:191]
 buffer_load_dwordx4 v243, s[12:15], s50 offen offset:0  lds
 v_mfma_f32_16x16x32_bf16 v[184:187], a[108:111], a[84:87], v[184:187]
 v_mfma_f32_16x16x32_bf16 v[212:215], a[108:111], a[88:91], v[212:215]
 v_mfma_f32_16x16x32_bf16 v[208:211], a[104:107], a[88:91], v[208:211]
 v_mfma_f32_16x16x32_bf16 v[180:183], a[104:107], a[84:87], v[180:183]
 buffer_load_dwordx4 v244, s[12:15], s50 offen offset:1024  lds
 v_mfma_f32_16x16x32_bf16 v[176:179], a[100:103], a[84:87], v[176:179]
 v_mfma_f32_16x16x32_bf16 v[204:207], a[100:103], a[88:91], v[204:207]
 v_mfma_f32_16x16x32_bf16 v[200:203], a[96:99], a[88:91], v[200:203]
 v_mfma_f32_16x16x32_bf16 v[172:175], a[96:99], a[84:87], v[172:175]
 v_mfma_f32_16x16x32_bf16 v[168:171], a[92:95], a[84:87], v[168:171]
 v_mfma_f32_16x16x32_bf16 v[196:199], a[92:95], a[88:91], v[196:199]
 s_waitcnt lgkmcnt(0)
 s_waitcnt vmcnt(27)
 s_barrier
 v_mfma_f32_16x16x32_bf16 v[0:3], a[32:35], a[0:3], v[0:3]
 ds_read_b64_tr_b16 a[92:93], v229 offset:46080
 v_mfma_f32_16x16x32_bf16 v[28:31], a[32:35], a[4:7], v[28:31]
 ds_read_b64_tr_b16 a[94:95], v229 offset:47872
 v_mfma_f32_16x16x32_bf16 v[32:35], a[36:39], a[4:7], v[32:35]
 ds_read_b128 a[60:63], v228 offset:0
 v_mfma_f32_16x16x32_bf16 v[4:7], a[36:39], a[0:3], v[4:7]
 v_mfma_f32_16x16x32_bf16 v[8:11], a[40:43], a[0:3], v[8:11]
 ds_read_b64_tr_b16 a[96:97], v230 offset:46080
 v_mfma_f32_16x16x32_bf16 v[36:39], a[40:43], a[4:7], v[36:39]
 s_and_b32 s43, s30, 6
 s_lshl_b32 s43, s43, 2
 buffer_load_dwordx2 a[250:251], off, s[60:63], s43 sc1
 v_mfma_f32_16x16x32_bf16 v[40:43], a[44:47], a[4:7], v[40:43]
 ds_read_b64_tr_b16 a[98:99], v230 offset:47872
 v_mfma_f32_16x16x32_bf16 v[12:15], a[44:47], a[0:3], v[12:15]
 v_mfma_f32_16x16x32_bf16 v[16:19], a[48:51], a[0:3], v[16:19]
 ds_read_b128 a[64:67], v228 offset:2048
 s_add_u32 m0, s44, 30720
 v_mfma_f32_16x16x32_bf16 v[44:47], a[48:51], a[4:7], v[44:47]
 buffer_load_dwordx4 v251, s[16:19], s51 offen offset:0  lds
 v_mfma_f32_16x16x32_bf16 v[48:51], a[52:55], a[4:7], v[48:51]
 ds_read_b64_tr_b16 a[100:101], v229 offset:46144
 v_mfma_f32_16x16x32_bf16 v[20:23], a[52:55], a[0:3], v[20:23]
 v_mfma_f32_16x16x32_bf16 v[24:27], a[56:59], a[0:3], v[24:27]
 ds_read_b64_tr_b16 a[102:103], v229 offset:47936
 v_mfma_f32_16x16x32_bf16 v[52:55], a[56:59], a[4:7], v[52:55]
 buffer_load_dwordx4 v252, s[16:19], s51 offen offset:1024  lds
 v_mfma_f32_16x16x32_bf16 v[80:83], a[56:59], a[8:11], v[80:83]
 ds_read_b128 a[68:71], v228 offset:4096
 v_mfma_f32_16x16x32_bf16 v[108:111], a[56:59], a[12:15], v[108:111]
 v_mfma_f32_16x16x32_bf16 v[104:107], a[52:55], a[12:15], v[104:107]
 ds_read_b64_tr_b16 a[104:105], v230 offset:46144
 v_mfma_f32_16x16x32_bf16 v[76:79], a[52:55], a[8:11], v[76:79]
 v_mfma_f32_16x16x32_bf16 v[72:75], a[48:51], a[8:11], v[72:75]
 ds_read_b64_tr_b16 a[106:107], v230 offset:47936
 buffer_load_dwordx4 v253, s[16:19], s51 offen offset:2048  lds
 v_mfma_f32_16x16x32_bf16 v[100:103], a[48:51], a[12:15], v[100:103]
 v_mfma_f32_16x16x32_bf16 v[96:99], a[44:47], a[12:15], v[96:99]
 ds_read_b128 a[72:75], v228 offset:6144
 v_mfma_f32_16x16x32_bf16 v[68:71], a[44:47], a[8:11], v[68:71]
 v_mfma_f32_16x16x32_bf16 v[64:67], a[40:43], a[8:11], v[64:67]
 ds_read_b64_tr_b16 a[108:109], v229 offset:46208
 buffer_load_dwordx4 v254, s[16:19], s51 offen offset:3072  lds
 v_mfma_f32_16x16x32_bf16 v[92:95], a[40:43], a[12:15], v[92:95]
 v_mfma_f32_16x16x32_bf16 v[88:91], a[36:39], a[12:15], v[88:91]
 ds_read_b64_tr_b16 a[110:111], v229 offset:48000
 v_mfma_f32_16x16x32_bf16 v[60:63], a[36:39], a[8:11], v[60:63]
 v_mfma_f32_16x16x32_bf16 v[56:59], a[32:35], a[8:11], v[56:59]
 ds_read_b128 a[76:79], v228 offset:8192
 s_add_u32 m0, s44, 34816
 v_mfma_f32_16x16x32_bf16 v[84:87], a[32:35], a[12:15], v[84:87]
 buffer_load_dwordx4 v255, s[16:19], s51 offen offset:0  lds
 s_add_u32 s51, s51, 229376
 s_cmp_eq_u32 s51, 7340032
 s_cselect_b32 s51, 0, s51
 v_mfma_f32_16x16x32_bf16 v[112:115], a[32:35], a[16:19], v[112:115]
 ds_read_b64_tr_b16 a[112:113], v230 offset:46208
 v_mfma_f32_16x16x32_bf16 v[140:143], a[32:35], a[20:23], v[140:143]
 v_mfma_f32_16x16x32_bf16 v[144:147], a[36:39], a[20:23], v[144:147]
 ds_read_b64_tr_b16 a[114:115], v230 offset:48000
 s_add_u32 m0, s49, 6144
 v_mfma_f32_16x16x32_bf16 v[116:119], a[36:39], a[16:19], v[116:119]
 buffer_load_dwordx4 v245, s[12:15], s50 offen offset:0  lds
 v_mfma_f32_16x16x32_bf16 v[120:123], a[40:43], a[16:19], v[120:123]
 ds_read_b128 a[80:83], v228 offset:10240
 v_mfma_f32_16x16x32_bf16 v[148:151], a[40:43], a[20:23], v[148:151]
 v_mfma_f32_16x16x32_bf16 v[152:155], a[44:47], a[20:23], v[152:155]
 ds_read_b64_tr_b16 a[116:117], v231 offset:46080
 v_mfma_f32_16x16x32_bf16 v[124:127], a[44:47], a[16:19], v[124:127]
 v_mfma_f32_16x16x32_bf16 v[128:131], a[48:51], a[16:19], v[128:131]
 ds_read_b64_tr_b16 a[118:119], v231 offset:47872
 buffer_load_dwordx4 v246, s[12:15], s50 offen offset:1024  lds
 v_mfma_f32_16x16x32_bf16 v[156:159], a[48:51], a[20:23], v[156:159]
 v_mfma_f32_16x16x32_bf16 v[160:163], a[52:55], a[20:23], v[160:163]
 ds_read_b128 a[84:87], v228 offset:12288
 v_mfma_f32_16x16x32_bf16 v[132:135], a[52:55], a[16:19], v[132:135]
 v_mfma_f32_16x16x32_bf16 v[136:139], a[56:59], a[16:19], v[136:139]
 ds_read_b128 a[88:91], v228 offset:14336
 buffer_load_dwordx4 v247, s[12:15], s50 offen offset:2048  lds
 v_mfma_f32_16x16x32_bf16 v[164:167], a[56:59], a[20:23], v[164:167]
 v_mfma_f32_16x16x32_bf16 v[192:195], a[56:59], a[24:27], v[192:195]
 v_mfma_f32_16x16x32_bf16 v[220:223], a[56:59], a[28:31], v[220:223]
 v_mfma_f32_16x16x32_bf16 v[216:219], a[52:55], a[28:31], v[216:219]
 v_mfma_f32_16x16x32_bf16 v[188:191], a[52:55], a[24:27], v[188:191]
 buffer_load_dwordx4 v248, s[12:15], s50 offen offset:3072  lds
 v_mfma_f32_16x16x32_bf16 v[184:187], a[48:51], a[24:27], v[184:187]
 v_mfma_f32_16x16x32_bf16 v[212:215], a[48:51], a[28:31], v[212:215]
 v_mfma_f32_16x16x32_bf16 v[208:211], a[44:47], a[28:31], v[208:211]
 s_add_u32 m0, s49, 10240
 v_mfma_f32_16x16x32_bf16 v[180:183], a[44:47], a[24:27], v[180:183]
 buffer_load_dwordx4 v249, s[12:15], s50 offen offset:0  lds
 v_mfma_f32_16x16x32_bf16 v[176:179], a[40:43], a[24:27], v[176:179]
 v_mfma_f32_16x16x32_bf16 v[204:207], a[40:43], a[28:31], v[204:207]
 v_mfma_f32_16x16x32_bf16 v[200:203], a[36:39], a[28:31], v[200:203]
 v_mfma_f32_16x16x32_bf16 v[172:175], a[36:39], a[24:27], v[172:175]
 v_mfma_f32_16x16x32_bf16 v[168:171], a[32:35], a[24:27], v[168:171]
 v_mfma_f32_16x16x32_bf16 v[196:199], a[32:35], a[28:31], v[196:199]
 s_waitcnt lgkmcnt(0)
 s_waitcnt vmcnt(17)
 s_barrier
 v_mfma_f32_16x16x32_bf16 v[0:3], a[92:95], a[60:63], v[0:3]
 v_add_u32 v227, s47, v225
 v_add_u32 v228, s47, v226
 v_add_u32 v225, 61440, v225
 ds_read_b64_tr_b16 a[0:1], v229 offset:0
 v_mfma_f32_16x16x32_bf16 v[28:31], a[92:95], a[64:67], v[28:31]
 v_add_u32 v226, 61440, v226
 ds_read_b64_tr_b16 a[2:3], v229 offset:1792
 v_mfma_f32_16x16x32_bf16 v[32:35], a[96:99], a[64:67], v[32:35]
 ds_read_b64_tr_b16 a[4:5], v230 offset:0
 v_mfma_f32_16x16x32_bf16 v[4:7], a[96:99], a[60:63], v[4:7]
 ds_read_b64_tr_b16 a[6:7], v230 offset:1792
 v_mfma_f32_16x16x32_bf16 v[8:11], a[100:103], a[60:63], v[8:11]
 s_add_u32 m0, s44, 46080
 v_mfma_f32_16x16x32_bf16 v[36:39], a[100:103], a[64:67], v[36:39]
 ds_read_b64_tr_b16 a[8:9], v229 offset:64
 buffer_load_dwordx4 v251, s[16:19], s51 offen offset:0  lds
 v_mfma_f32_16x16x32_bf16 v[40:43], a[104:107], a[64:67], v[40:43]
 v_mfma_f32_16x16x32_bf16 v[12:15], a[104:107], a[60:63], v[12:15]
 ds_read_b64_tr_b16 a[10:11], v229 offset:1856
 v_mfma_f32_16x16x32_bf16 v[16:19], a[108:111], a[60:63], v[16:19]
 v_mfma_f32_16x16x32_bf16 v[44:47], a[108:111], a[64:67], v[44:47]
 ds_read_b64_tr_b16 a[12:13], v230 offset:64
 v_mfma_f32_16x16x32_bf16 v[48:51], a[112:115], a[64:67], v[48:51]
 ds_read_b64_tr_b16 a[14:15], v230 offset:1856
 v_mfma_f32_16x16x32_bf16 v[20:23], a[112:115], a[60:63], v[20:23]
 v_mfma_f32_16x16x32_bf16 v[24:27], a[116:119], a[60:63], v[24:27]
 ds_read_b64_tr_b16 a[16:17], v229 offset:128
 v_mfma_f32_16x16x32_bf16 v[52:55], a[116:119], a[64:67], v[52:55]
 v_mfma_f32_16x16x32_bf16 v[80:83], a[116:119], a[68:71], v[80:83]
 ds_read_b64_tr_b16 a[18:19], v229 offset:1920
 buffer_load_dwordx4 v252, s[16:19], s51 offen offset:1024  lds
 v_mfma_f32_16x16x32_bf16 v[108:111], a[116:119], a[72:75], v[108:111]
 v_mfma_f32_16x16x32_bf16 v[104:107], a[112:115], a[72:75], v[104:107]
 ds_read_b64_tr_b16 a[20:21], v230 offset:128
 v_mfma_f32_16x16x32_bf16 v[76:79], a[112:115], a[68:71], v[76:79]
 ds_read_b64_tr_b16 a[22:23], v230 offset:1920
 v_mfma_f32_16x16x32_bf16 v[72:75], a[108:111], a[68:71], v[72:75]
 v_mfma_f32_16x16x32_bf16 v[100:103], a[108:111], a[72:75], v[100:103]
 ds_read_b64_tr_b16 a[24:25], v231 offset:0
 v_mfma_f32_16x16x32_bf16 v[96:99], a[104:107], a[72:75], v[96:99]
 v_mfma_f32_16x16x32_bf16 v[68:71], a[104:107], a[68:71], v[68:71]
 ds_read_b64_tr_b16 a[26:27], v231 offset:1792
 v_mfma_f32_16x16x32_bf16 v[64:67], a[100:103], a[68:71], v[64:67]
 v_mfma_f32_16x16x32_bf16 v[92:95], a[100:103], a[72:75], v[92:95]
 ds_read_b64_tr_b16 a[28:29], v229 offset:15360
 v_mfma_f32_16x16x32_bf16 v[88:91], a[96:99], a[72:75], v[88:91]
 ds_read_b64_tr_b16 a[30:31], v229 offset:17152
 buffer_load_dwordx4 v253, s[16:19], s51 offen offset:2048  lds
 v_mfma_f32_16x16x32_bf16 v[60:63], a[96:99], a[68:71], v[60:63]
 v_mfma_f32_16x16x32_bf16 v[56:59], a[92:95], a[68:71], v[56:59]
 ds_read_b64_tr_b16 a[32:33], v230 offset:15360
 v_mfma_f32_16x16x32_bf16 v[84:87], a[92:95], a[72:75], v[84:87]
 v_mfma_f32_16x16x32_bf16 v[112:115], a[92:95], a[76:79], v[112:115]
 ds_read_b64_tr_b16 a[34:35], v230 offset:17152
 v_mfma_f32_16x16x32_bf16 v[140:143], a[92:95], a[80:83], v[140:143]
 v_mfma_f32_16x16x32_bf16 v[144:147], a[96:99], a[80:83], v[144:147]
 ds_read_b64_tr_b16 a[36:37], v229 offset:15424
 v_mfma_f32_16x16x32_bf16 v[116:119], a[96:99], a[76:79], v[116:119]
 ds_read_b64_tr_b16 a[38:39], v229 offset:17216
 v_mfma_f32_16x16x32_bf16 v[120:123], a[100:103], a[76:79], v[120:123]
 v_mfma_f32_16x16x32_bf16 v[148:151], a[100:103], a[80:83], v[148:151]
 ds_read_b64_tr_b16 a[40:41], v230 offset:15424
 v_mfma_f32_16x16x32_bf16 v[152:155], a[104:107], a[80:83], v[152:155]
 buffer_load_dwordx4 v254, s[16:19], s51 offen offset:3072  lds
 v_mfma_f32_16x16x32_bf16 v[124:127], a[104:107], a[76:79], v[124:127]
 ds_read_b64_tr_b16 a[42:43], v230 offset:17216
 v_mfma_f32_16x16x32_bf16 v[128:131], a[108:111], a[76:79], v[128:131]
 v_mfma_f32_16x16x32_bf16 v[156:159], a[108:111], a[80:83], v[156:159]
 ds_read_b64_tr_b16 a[44:45], v229 offset:15488
 v_mfma_f32_16x16x32_bf16 v[160:163], a[112:115], a[80:83], v[160:163]
 ds_read_b64_tr_b16 a[46:47], v229 offset:17280
 v_mfma_f32_16x16x32_bf16 v[132:135], a[112:115], a[76:79], v[132:135]
 v_mfma_f32_16x16x32_bf16 v[136:139], a[116:119], a[76:79], v[136:139]
 ds_read_b64_tr_b16 a[48:49], v230 offset:15488
 v_mfma_f32_16x16x32_bf16 v[164:167], a[116:119], a[80:83], v[164:167]
 v_mfma_f32_16x16x32_bf16 v[192:195], a[116:119], a[84:87], v[192:195]
 ds_read_b64_tr_b16 a[50:51], v230 offset:17280
 v_mfma_f32_16x16x32_bf16 v[220:223], a[116:119], a[88:91], v[220:223]
 s_add_u32 m0, s44, 50176
 v_mfma_f32_16x16x32_bf16 v[216:219], a[112:115], a[88:91], v[216:219]
 ds_read_b64_tr_b16 a[52:53], v231 offset:15360
 buffer_load_dwordx4 v255, s[16:19], s51 offen offset:0  lds
 s_add_u32 s51, s51, 229376
 s_cmp_eq_u32 s51, 7340032
 s_cselect_b32 s51, 0, s51
 v_mfma_f32_16x16x32_bf16 v[188:191], a[112:115], a[84:87], v[188:191]
 ds_read_b64_tr_b16 a[54:55], v231 offset:17152
 v_mfma_f32_16x16x32_bf16 v[184:187], a[108:111], a[84:87], v[184:187]
 v_mfma_f32_16x16x32_bf16 v[212:215], a[108:111], a[88:91], v[212:215]
 ds_read_b128 a[180:183], v227 offset:0
 v_mfma_f32_16x16x32_bf16 v[208:211], a[104:107], a[88:91], v[208:211]
 v_mfma_f32_16x16x32_bf16 v[180:183], a[104:107], a[84:87], v[180:183]
 ds_read_b128 a[184:187], v228 offset:0
 v_mfma_f32_16x16x32_bf16 v[176:179], a[100:103], a[84:87], v[176:179]
 v_mfma_f32_16x16x32_bf16 v[204:207], a[100:103], a[88:91], v[204:207]
 v_mfma_f32_16x16x32_bf16 v[200:203], a[96:99], a[88:91], v[200:203]
 v_mfma_f32_16x16x32_bf16 v[172:175], a[96:99], a[84:87], v[172:175]
 v_mfma_f32_16x16x32_bf16 v[168:171], a[92:95], a[84:87], v[168:171]
 v_mfma_f32_16x16x32_bf16 v[196:199], a[92:95], a[88:91], v[196:199]
 s_waitcnt vmcnt(0)
L1h_tail:
 s_waitcnt lgkmcnt(0)
 s_barrier
 v_mfma_f32_16x16x32_bf16 v[0:3], a[0:3], a[180:183], v[0:3]
 ds_read_b128 a[188:191], v225 offset:0
 ds_read_b128 a[192:195], v226 offset:0
 ds_read_b64_tr_b16 a[120:121], v229 offset:30720
 v_mfma_f32_16x16x32_bf16 v[4:7], a[4:7], a[180:183], v[4:7]
 ds_read_b64_tr_b16 a[122:123], v229 offset:32512
 ds_read_b64_tr_b16 a[124:125], v230 offset:30720
 ds_read_b64_tr_b16 a[126:127], v230 offset:32512
 v_lshlrev_b32 v232, 4, v224
 s_lshl_b32 s40, s34, 1
 v_mfma_f32_16x16x32_bf16 v[8:11], a[8:11], a[180:183], v[8:11]
 ds_read_b64_tr_b16 a[128:129], v229 offset:30784
 ds_read_b64_tr_b16 a[130:131], v229 offset:32576
 ds_read_b64_tr_b16 a[132:133], v230 offset:30784
 s_add_u32 s40, s40, s36
 s_mul_i32 s40, s40, 1179648
 v_mfma_f32_16x16x32_bf16 v[12:15], a[12:15], a[180:183], v[12:15]
 ds_read_b64_tr_b16 a[134:135], v230 offset:32576
 ds_read_b64_tr_b16 a[136:137], v229 offset:30848
 s_mul_i32 s41, s35, 57344
 v_mfma_f32_16x16x32_bf16 v[16:19], a[16:19], a[180:183], v[16:19]
 ds_read_b64_tr_b16 a[138:139], v229 offset:32640
 ds_read_b64_tr_b16 a[140:141], v230 offset:30848
 ds_read_b64_tr_b16 a[142:143], v230 offset:32640
 s_add_u32 s40, s40, s41
 s_add_u32 s40, s40, 262144
 v_mfma_f32_16x16x32_bf16 v[20:23], a[20:23], a[180:183], v[20:23]
 ds_read_b64_tr_b16 a[144:145], v231 offset:30720
 ds_read_b64_tr_b16 a[146:147], v231 offset:32512
 ds_read_b64_tr_b16 a[148:149], v229 offset:46080
 s_add_u32 s59, s40, 24576
 v_mfma_f32_16x16x32_bf16 v[24:27], a[24:27], a[180:183], v[24:27]
 ds_read_b64_tr_b16 a[150:151], v229 offset:47872
 ds_read_b64_tr_b16 a[152:153], v230 offset:46080
 ds_read_b64_tr_b16 a[154:155], v230 offset:47872
 s_lshl_b32 s41, s37, 3
 s_add_u32 s59, s59, s41
 v_mfma_f32_16x16x32_bf16 v[0:3], a[28:31], a[184:187], v[0:3]
 ds_read_b64_tr_b16 a[156:157], v229 offset:46144
 ds_read_b64_tr_b16 a[158:159], v229 offset:47936
 s_lshl_b32 s41, s37, 15
 v_mfma_f32_16x16x32_bf16 v[4:7], a[32:35], a[184:187], v[4:7]
 ds_read_b64_tr_b16 a[160:161], v230 offset:46144
 ds_read_b64_tr_b16 a[162:163], v230 offset:47936
 ds_read_b64_tr_b16 a[164:165], v229 offset:46208
 s_add_u32 s56, s40, s41
 s_add_u32 s57, s56, 8192
 v_mfma_f32_16x16x32_bf16 v[8:11], a[36:39], a[184:187], v[8:11]
 ds_read_b64_tr_b16 a[166:167], v229 offset:48000
 ds_read_b64_tr_b16 a[168:169], v230 offset:46208
 ds_read_b64_tr_b16 a[170:171], v230 offset:48000
 s_add_u32 s58, s56, 16384
 v_mfma_f32_16x16x32_bf16 v[12:15], a[40:43], a[184:187], v[12:15]
 ds_read_b64_tr_b16 a[172:173], v231 offset:46080
 ds_read_b64_tr_b16 a[174:175], v231 offset:47872
 s_and_b32 s41, s30, 1
 s_mul_i32 s41, s41, 7
 v_mfma_f32_16x16x32_bf16 v[16:19], a[44:47], a[184:187], v[16:19]
 s_add_u32 s41, s41, 6
 v_mfma_f32_16x16x32_bf16 v[20:23], a[48:51], a[184:187], v[20:23]
 s_cmp_ge_u32 s35, s41
 s_cselect_b32 s60, 1, 0
 s_and_b32 s74, s30, 1
 v_mfma_f32_16x16x32_bf16 v[24:27], a[52:55], a[184:187], v[24:27]
 s_waitcnt lgkmcnt(0)
 s_and_b32 s75, s31, 7
 v_mfma_f32_16x16x32_bf16 v[0:3], a[120:123], a[188:191], v[0:3]
 ds_read_b128 a[60:63], v227 offset:2048
 s_lshl_b32 s44, s33, 12
 s_mul_i32 s46, s74, 917504
 v_mfma_f32_16x16x32_bf16 v[4:7], a[124:127], a[188:191], v[4:7]
 ds_read_b128 a[64:67], v228 offset:2048
 s_sub_u32 s16, s72, 4096
 s_subb_u32 s17, s73, 0
 v_mfma_f32_16x16x32_bf16 v[8:11], a[128:131], a[188:191], v[8:11]
 ds_read_b128 a[68:71], v225 offset:2048
 s_mov_b32 s18, 2101248
 v_lshrrev_b32 v254, 4, v224
 v_mfma_f32_16x16x32_bf16 v[12:15], a[132:135], a[188:191], v[12:15]
 ds_read_b128 a[72:75], v226 offset:2048
 v_and_b32 v255, 15, v224
 v_mfma_f32_16x16x32_bf16 v[16:19], a[136:139], a[188:191], v[16:19]
 s_lshl_b32 s76, s33, 14
 s_lshl_b32 s77, s75, 8
 v_mfma_f32_16x16x32_bf16 v[20:23], a[140:143], a[188:191], v[20:23]
 s_add_u32 s76, s76, s77
 v_mfma_f32_16x16x32_bf16 v[24:27], a[144:147], a[188:191], v[24:27]
 v_lshl_add_u32 v252, v254, 1, 0
 v_xor_b32 v252, v252, v255
 v_mfma_f32_16x16x32_bf16 v[0:3], a[148:151], a[192:195], v[0:3]
 v_lshlrev_b32 v252, 4, v252
 v_mfma_f32_16x16x32_bf16 v[4:7], a[152:155], a[192:195], v[4:7]
 v_lshl_add_u32 v252, v254, 11, v252
 s_add_u32 s77, s76, 2048
 v_mfma_f32_16x16x32_bf16 v[8:11], a[156:159], a[192:195], v[8:11]
 v_add_u32 v252, s77, v252
 v_mfma_f32_16x16x32_bf16 v[12:15], a[160:163], a[192:195], v[12:15]
 v_lshl_add_u32 v253, v254, 1, 8
 v_xor_b32 v253, v253, v255
 v_mfma_f32_16x16x32_bf16 v[16:19], a[164:167], a[192:195], v[16:19]
 v_lshlrev_b32 v253, 4, v253
 v_mfma_f32_16x16x32_bf16 v[20:23], a[168:171], a[192:195], v[20:23]
 v_lshl_add_u32 v253, v254, 11, v253
 s_add_u32 s77, s76, 9216
 v_mfma_f32_16x16x32_bf16 v[24:27], a[172:175], a[192:195], v[24:27]
 v_add_u32 v253, s77, v253
 s_waitcnt lgkmcnt(0)
 s_barrier
 v_mfma_f32_16x16x32_bf16 v[28:31], a[0:3], a[60:63], v[28:31]
 ds_read_b128 a[180:183], v227 offset:4096
 v_mfma_f32_16x16x32_bf16 v[32:35], a[4:7], a[60:63], v[32:35]
 ds_read_b128 a[184:187], v228 offset:4096
 v_cvt_pk_bf16_f32 v0, v0, v1
 v_cvt_pk_bf16_f32 v1, v2, v3
 v_mfma_f32_16x16x32_bf16 v[36:39], a[8:11], a[60:63], v[36:39]
 v_cvt_pk_bf16_f32 v2, v4, v5
 v_mfma_f32_16x16x32_bf16 v[40:43], a[12:15], a[60:63], v[40:43]
 ds_read_b128 a[188:191], v225 offset:4096
 v_cvt_pk_bf16_f32 v3, v6, v7
 v_mfma_f32_16x16x32_bf16 v[44:47], a[16:19], a[60:63], v[44:47]
 v_pk_max_i16 v0, v0, 0
 v_mfma_f32_16x16x32_bf16 v[48:51], a[20:23], a[60:63], v[48:51]
 ds_read_b128 a[192:195], v226 offset:4096
 v_pk_max_i16 v1, v1, 0
 v_mfma_f32_16x16x32_bf16 v[52:55], a[24:27], a[60:63], v[52:55]
 v_pk_max_i16 v2, v2, 0
 v_pk_max_i16 v3, v3, 0
 v_mfma_f32_16x16x32_bf16 v[28:31], a[28:31], a[64:67], v[28:31]
 s_cmp_eq_u32 s60, 0
 s_cbranch_scc1 L1h_st0_0
 buffer_store_dwordx4 v[0:3], v232, s[20:23], s56 offen offset:0
 s_branch L1h_st0_0x
L1h_st0_0:
 buffer_store_dwordx4 v[0:3], v232, s[20:23], s56 offen offset:0 sc1
L1h_st0_0x:
 v_mfma_f32_16x16x32_bf16 v[32:35], a[32:35], a[64:67], v[32:35]
 v_cvt_pk_bf16_f32 v8, v8, v9
 v_mfma_f32_16x16x32_bf16 v[36:39], a[36:39], a[64:67], v[36:39]
 v_cvt_pk_bf16_f32 v9, v10, v11
 v_mfma_f32_16x16x32_bf16 v[40:43], a[40:43], a[64:67], v[40:43]
 v_cvt_pk_bf16_f32 v10, v12, v13
 v_mfma_f32_16x16x32_bf16 v[44:47], a[44:47], a[64:67], v[44:47]
 v_cvt_pk_bf16_f32 v11, v14, v15
 v_pk_max_i16 v8, v8, 0
 v_mfma_f32_16x16x32_bf16 v[48:51], a[48:51], a[64:67], v[48:51]
 v_pk_max_i16 v9, v9, 0
 v_mfma_f32_16x16x32_bf16 v[52:55], a[52:55], a[64:67], v[52:55]
 v_pk_max_i16 v10, v10, 0
 v_mfma_f32_16x16x32_bf16 v[28:31], a[120:123], a[68:71], v[28:31]
 v_pk_max_i16 v11, v11, 0
 v_mfma_f32_16x16x32_bf16 v[32:35], a[124:127], a[68:71], v[32:35]
 s_cmp_eq_u32 s60, 0
 s_cbranch_scc1 L1h_st0_1
 buffer_store_dwordx4 v[8:11], v232, s[20:23], s57 offen offset:0
 s_branch L1h_st0_1x
L1h_st0_1:
 buffer_store_dwordx4 v[8:11], v232, s[20:23], s57 offen offset:0 sc1
L1h_st0_1x:
 v_mfma_f32_16x16x32_bf16 v[36:39], a[128:131], a[68:71], v[36:39]
 v_cvt_pk_bf16_f32 v16, v16, v17
 v_mfma_f32_16x16x32_bf16 v[40:43], a[132:135], a[68:71], v[40:43]
 v_cvt_pk_bf16_f32 v17, v18, v19
 v_cvt_pk_bf16_f32 v18, v20, v21
 v_mfma_f32_16x16x32_bf16 v[44:47], a[136:139], a[68:71], v[44:47]
 v_cvt_pk_bf16_f32 v19, v22, v23
 v_mfma_f32_16x16x32_bf16 v[48:51], a[140:143], a[68:71], v[48:51]
 v_pk_max_i16 v16, v16, 0
 v_mfma_f32_16x16x32_bf16 v[52:55], a[144:147], a[68:71], v[52:55]
 v_pk_max_i16 v17, v17, 0
 v_mfma_f32_16x16x32_bf16 v[28:31], a[148:151], a[72:75], v[28:31]
 v_pk_max_i16 v18, v18, 0
 v_mfma_f32_16x16x32_bf16 v[32:35], a[152:155], a[72:75], v[32:35]
 v_pk_max_i16 v19, v19, 0
 s_cmp_eq_u32 s60, 0
 s_cbranch_scc1 L1h_st0_2
 buffer_store_dwordx4 v[16:19], v232, s[20:23], s58 offen offset:0
 s_branch L1h_st0_2x
L1h_st0_2:
 buffer_store_dwordx4 v[16:19], v232, s[20:23], s58 offen offset:0 sc1
L1h_st0_2x:
 v_mfma_f32_16x16x32_bf16 v[36:39], a[156:159], a[72:75], v[36:39]
 v_cvt_pk_bf16_f32 v24, v24, v25
 v_mfma_f32_16x16x32_bf16 v[40:43], a[160:163], a[72:75], v[40:43]
 v_cvt_pk_bf16_f32 v25, v26, v27
 v_mfma_f32_16x16x32_bf16 v[44:47], a[164:167], a[72:75], v[44:47]
 v_pk_max_i16 v24, v24, 0
 v_mfma_f32_16x16x32_bf16 v[48:51], a[168:171], a[72:75], v[48:51]
 v_pk_max_i16 v25, v25, 0
 v_mfma_f32_16x16x32_bf16 v[52:55], a[172:175], a[72:75], v[52:55]
 buffer_store_dwordx2 v[24:25], v232, s[20:23], s59 offen offset:0
 s_waitcnt lgkmcnt(0)
 v_mfma_f32_16x16x32_bf16 v[56:59], a[0:3], a[180:183], v[56:59]
 ds_read_b128 a[60:63], v227 offset:6144
 v_mfma_f32_16x16x32_bf16 v[60:63], a[4:7], a[180:183], v[60:63]
 ds_read_b128 a[64:67], v228 offset:6144
 v_cvt_pk_bf16_f32 v28, v28, v29
 v_cvt_pk_bf16_f32 v29, v30, v31
 v_mfma_f32_16x16x32_bf16 v[64:67], a[8:11], a[180:183], v[64:67]
 v_cvt_pk_bf16_f32 v30, v32, v33
 v_mfma_f32_16x16x32_bf16 v[68:71], a[12:15], a[180:183], v[68:71]
 ds_read_b128 a[68:71], v225 offset:6144
 v_cvt_pk_bf16_f32 v31, v34, v35
 v_mfma_f32_16x16x32_bf16 v[72:75], a[16:19], a[180:183], v[72:75]
 v_pk_max_i16 v28, v28, 0
 v_pk_max_i16 v29, v29, 0
 v_mfma_f32_16x16x32_bf16 v[76:79], a[20:23], a[180:183], v[76:79]
 ds_read_b128 a[72:75], v226 offset:6144
 v_pk_max_i16 v30, v30, 0
 v_mfma_f32_16x16x32_bf16 v[80:83], a[24:27], a[180:183], v[80:83]
 v_pk_max_i16 v31, v31, 0
 v_mfma_f32_16x16x32_bf16 v[56:59], a[28:31], a[184:187], v[56:59]
 s_cmp_eq_u32 s60, 0
 s_cbranch_scc1 L1h_st1_0
 buffer_store_dwordx4 v[28:31], v232, s[20:23], s56 offen offset:1024
 s_branch L1h_st1_0x
L1h_st1_0:
 buffer_store_dwordx4 v[28:31], v232, s[20:23], s56 offen offset:1024 sc1
L1h_st1_0x:
 v_mfma_f32_16x16x32_bf16 v[60:63], a[32:35], a[184:187], v[60:63]
 v_cvt_pk_bf16_f32 v36, v36, v37
 s_add_u32 m0, s44, 0
 s_add_u32 s78, s46, 0
 buffer_load_dwordx4 v252, s[16:19], s78 offen offset:2048  lds
 v_mfma_f32_16x16x32_bf16 v[64:67], a[36:39], a[184:187], v[64:67]
 v_cvt_pk_bf16_f32 v37, v38, v39
 v_mfma_f32_16x16x32_bf16 v[68:71], a[40:43], a[184:187], v[68:71]
 v_cvt_pk_bf16_f32 v38, v40, v41
 v_mfma_f32_16x16x32_bf16 v[72:75], a[44:47], a[184:187], v[72:75]
 v_cvt_pk_bf16_f32 v39, v42, v43
 v_mfma_f32_16x16x32_bf16 v[76:79], a[48:51], a[184:187], v[76:79]
 v_pk_max_i16 v36, v36, 0
 v_pk_max_i16 v37, v37, 0
 v_mfma_f32_16x16x32_bf16 v[80:83], a[52:55], a[184:187], v[80:83]
 v_pk_max_i16 v38, v38, 0
 v_mfma_f32_16x16x32_bf16 v[56:59], a[120:123], a[188:191], v[56:59]
 v_pk_max_i16 v39, v39, 0
 v_mfma_f32_16x16x32_bf16 v[60:63], a[124:127], a[188:191], v[60:63]
 s_cmp_eq_u32 s60, 0
 s_cbranch_scc1 L1h_st1_1
 buffer_store_dwordx4 v[36:39], v232, s[20:23], s57 offen offset:1024
 s_branch L1h_st1_1x
L1h_st1_1:
 buffer_store_dwordx4 v[36:39], v232, s[20:23], s57 offen offset:1024 sc1
L1h_st1_1x:
 v_mfma_f32_16x16x32_bf16 v[64:67], a[128:131], a[188:191], v[64:67]
 v_cvt_pk_bf16_f32 v44, v44, v45
 v_cvt_pk_bf16_f32 v45, v46, v47
 v_mfma_f32_16x16x32_bf16 v[68:71], a[132:135], a[188:191], v[68:71]
 v_cvt_pk_bf16_f32 v46, v48, v49
 v_mfma_f32_16x16x32_bf16 v[72:75], a[136:139], a[188:191], v[72:75]
 buffer_load_dwordx4 v253, s[16:19], s78 offen offset:3072  lds
 v_mfma_f32_16x16x32_bf16 v[76:79], a[140:143], a[188:191], v[76:79]
 v_cvt_pk_bf16_f32 v47, v50, v51
 v_mfma_f32_16x16x32_bf16 v[80:83], a[144:147], a[188:191], v[80:83]
 v_pk_max_i16 v44, v44, 0
 v_pk_max_i16 v45, v45, 0
 v_mfma_f32_16x16x32_bf16 v[56:59], a[148:151], a[192:195], v[56:59]
 v_pk_max_i16 v46, v46, 0
 v_mfma_f32_16x16x32_bf16 v[60:63], a[152:155], a[192:195], v[60:63]
 v_pk_max_i16 v47, v47, 0
 v_mfma_f32_16x16x32_bf16 v[64:67], a[156:159], a[192:195], v[64:67]
 s_cmp_eq_u32 s60, 0
 s_cbranch_scc1 L1h_st1_2
 buffer_store_dwordx4 v[44:47], v232, s[20:23], s58 offen offset:1024
 s_branch L1h_st1_2x
L1h_st1_2:
 buffer_store_dwordx4 v[44:47], v232, s[20:23], s58 offen offset:1024 sc1
L1h_st1_2x:
 v_mfma_f32_16x16x32_bf16 v[68:71], a[160:163], a[192:195], v[68:71]
 v_cvt_pk_bf16_f32 v52, v52, v53
 v_cvt_pk_bf16_f32 v53, v54, v55
 v_mfma_f32_16x16x32_bf16 v[72:75], a[164:167], a[192:195], v[72:75]
 v_pk_max_i16 v52, v52, 0
 v_mfma_f32_16x16x32_bf16 v[76:79], a[168:171], a[192:195], v[76:79]
 v_pk_max_i16 v53, v53, 0
 v_mfma_f32_16x16x32_bf16 v[80:83], a[172:175], a[192:195], v[80:83]
 buffer_store_dwordx2 v[52:53], v232, s[20:23], s59 offen offset:1024
 s_waitcnt lgkmcnt(0)
 v_mfma_f32_16x16x32_bf16 v[84:87], a[0:3], a[60:63], v[84:87]
 ds_read_b128 a[180:183], v227 offset:8192
 v_mfma_f32_16x16x32_bf16 v[88:91], a[4:7], a[60:63], v[88:91]
 ds_read_b128 a[184:187], v228 offset:8192
 v_cvt_pk_bf16_f32 v56, v56, v57
 v_cvt_pk_bf16_f32 v57, v58, v59
 v_mfma_f32_16x16x32_bf16 v[92:95], a[8:11], a[60:63], v[92:95]
 v_cvt_pk_bf16_f32 v58, v60, v61
 v_mfma_f32_16x16x32_bf16 v[96:99], a[12:15], a[60:63], v[96:99]
 ds_read_b128 a[188:191], v225 offset:8192
 v_cvt_pk_bf16_f32 v59, v62, v63
 v_mfma_f32_16x16x32_bf16 v[100:103], a[16:19], a[60:63], v[100:103]
 v_pk_max_i16 v56, v56, 0
 v_pk_max_i16 v57, v57, 0
 v_mfma_f32_16x16x32_bf16 v[104:107], a[20:23], a[60:63], v[104:107]
 ds_read_b128 a[192:195], v226 offset:8192
 v_pk_max_i16 v58, v58, 0
 v_mfma_f32_16x16x32_bf16 v[108:111], a[24:27], a[60:63], v[108:111]
 v_pk_max_i16 v59, v59, 0
 v_mfma_f32_16x16x32_bf16 v[84:87], a[28:31], a[64:67], v[84:87]
 s_cmp_eq_u32 s60, 0
 s_cbranch_scc1 L1h_st2_0
 buffer_store_dwordx4 v[56:59], v232, s[20:23], s56 offen offset:2048
 s_branch L1h_st2_0x
L1h_st2_0:
 buffer_store_dwordx4 v[56:59], v232, s[20:23], s56 offen offset:2048 sc1
L1h_st2_0x:
 v_mfma_f32_16x16x32_bf16 v[88:91], a[32:35], a[64:67], v[88:91]
 v_cvt_pk_bf16_f32 v64, v64, v65
 s_add_u32 m0, s44, 16384
 s_add_u32 s78, s46, 65536
 buffer_load_dwordx4 v252, s[16:19], s78 offen offset:2048  lds
 v_mfma_f32_16x16x32_bf16 v[92:95], a[36:39], a[64:67], v[92:95]
 v_cvt_pk_bf16_f32 v65, v66, v67
 v_mfma_f32_16x16x32_bf16 v[96:99], a[40:43], a[64:67], v[96:99]
 v_cvt_pk_bf16_f32 v66, v68, v69
 v_mfma_f32_16x16x32_bf16 v[100:103], a[44:47], a[64:67], v[100:103]
 v_cvt_pk_bf16_f32 v67, v70, v71
 v_mfma_f32_16x16x32_bf16 v[104:107], a[48:51], a[64:67], v[104:107]
 v_pk_max_i16 v64, v64, 0
 v_pk_max_i16 v65, v65, 0
 v_mfma_f32_16x16x32_bf16 v[108:111], a[52:55], a[64:67], v[108:111]
 v_pk_max_i16 v66, v66, 0
 v_mfma_f32_16x16x32_bf16 v[84:87], a[120:123], a[68:71], v[84:87]
 v_pk_max_i16 v67, v67, 0
 v_mfma_f32_16x16x32_bf16 v[88:91], a[124:127], a[68:71], v[88:91]
 s_cmp_eq_u32 s60, 0
 s_cbranch_scc1 L1h_st2_1
 buffer_store_dwordx4 v[64:67], v232, s[20:23], s57 offen offset:2048
 s_branch L1h_st2_1x
L1h_st2_1:
 buffer_store_dwordx4 v[64:67], v232, s[20:23], s57 offen offset:2048 sc1
L1h_st2_1x:
 v_mfma_f32_16x16x32_bf16 v[92:95], a[128:131], a[68:71], v[92:95]
 v_cvt_pk_bf16_f32 v72, v72, v73
 v_cvt_pk_bf16_f32 v73, v74, v75
 v_mfma_f32_16x16x32_bf16 v[96:99], a[132:135], a[68:71], v[96:99]
 v_cvt_pk_bf16_f32 v74, v76, v77
 v_mfma_f32_16x16x32_bf16 v[100:103], a[136:139], a[68:71], v[100:103]
 buffer_load_dwordx4 v253, s[16:19], s78 offen offset:3072  lds
 v_mfma_f32_16x16x32_bf16 v[104:107], a[140:143], a[68:71], v[104:107]
 v_cvt_pk_bf16_f32 v75, v78, v79
 v_mfma_f32_16x16x32_bf16 v[108:111], a[144:147], a[68:71], v[108:111]
 v_pk_max_i16 v72, v72, 0
 v_pk_max_i16 v73, v73, 0
 v_mfma_f32_16x16x32_bf16 v[84:87], a[148:151], a[72:75], v[84:87]
 v_pk_max_i16 v74, v74, 0
 v_mfma_f32_16x16x32_bf16 v[88:91], a[152:155], a[72:75], v[88:91]
 v_pk_max_i16 v75, v75, 0
 v_mfma_f32_16x16x32_bf16 v[92:95], a[156:159], a[72:75], v[92:95]
 s_cmp_eq_u32 s60, 0
 s_cbranch_scc1 L1h_st2_2
 buffer_store_dwordx4 v[72:75], v232, s[20:23], s58 offen offset:2048
 s_branch L1h_st2_2x
L1h_st2_2:
 buffer_store_dwordx4 v[72:75], v232, s[20:23], s58 offen offset:2048 sc1
L1h_st2_2x:
 v_mfma_f32_16x16x32_bf16 v[96:99], a[160:163], a[72:75], v[96:99]
 v_cvt_pk_bf16_f32 v80, v80, v81
 v_cvt_pk_bf16_f32 v81, v82, v83
 v_mfma_f32_16x16x32_bf16 v[100:103], a[164:167], a[72:75], v[100:103]
 v_pk_max_i16 v80, v80, 0
 v_mfma_f32_16x16x32_bf16 v[104:107], a[168:171], a[72:75], v[104:107]
 v_pk_max_i16 v81, v81, 0
 v_mfma_f32_16x16x32_bf16 v[108:111], a[172:175], a[72:75], v[108:111]
 buffer_store_dwordx2 v[80:81], v232, s[20:23], s59 offen offset:2048
 s_waitcnt lgkmcnt(0)
 v_mfma_f32_16x16x32_bf16 v[112:115], a[0:3], a[180:183], v[112:115]
 ds_read_b128 a[60:63], v227 offset:10240
 v_mfma_f32_16x16x32_bf16 v[116:119], a[4:7], a[180:183], v[116:119]
 ds_read_b128 a[64:67], v228 offset:10240
 v_cvt_pk_bf16_f32 v84, v84, v85
 v_cvt_pk_bf16_f32 v85, v86, v87
 v_mfma_f32_16x16x32_bf16 v[120:123], a[8:11], a[180:183], v[120:123]
 v_cvt_pk_bf16_f32 v86, v88, v89
 v_mfma_f32_16x16x32_bf16 v[124:127], a[12:15], a[180:183], v[124:127]
 ds_read_b128 a[68:71], v225 offset:10240
 v_cvt_pk_bf16_f32 v87, v90, v91
 v_pk_max_i16 v84, v84, 0
 v_mfma_f32_16x16x32_bf16 v[128:131], a[16:19], a[180:183], v[128:131]
 v_pk_max_i16 v85, v85, 0
 v_mfma_f32_16x16x32_bf16 v[132:135], a[20:23], a[180:183], v[132:135]
 ds_read_b128 a[72:75], v226 offset:10240
 v_pk_max_i16 v86, v86, 0
 v_pk_max_i16 v87, v87, 0
 v_mfma_f32_16x16x32_bf16 v[136:139], a[24:27], a[180:183], v[136:139]
 s_cmp_eq_u32 s60, 0
 s_cbranch_scc1 L1h_st3_0
 buffer_store_dwordx4 v[84:87], v232, s[20:23], s56 offen offset:3072
 s_branch L1h_st3_0x
L1h_st3_0:
 buffer_store_dwordx4 v[84:87], v232, s[20:23], s56 offen offset:3072 sc1
L1h_st3_0x:
 v_mfma_f32_16x16x32_bf16 v[112:115], a[28:31], a[184:187], v[112:115]
 v_cvt_pk_bf16_f32 v92, v92, v93
 v_mfma_f32_16x16x32_bf16 v[116:119], a[32:35], a[184:187], v[116:119]
 v_cvt_pk_bf16_f32 v93, v94, v95
 v_cvt_pk_bf16_f32 v94, v96, v97
 v_mfma_f32_16x16x32_bf16 v[120:123], a[36:39], a[184:187], v[120:123]
 s_add_u32 m0, s44, 32768
 s_add_u32 s78, s46, 131072
 buffer_load_dwordx4 v252, s[16:19], s78 offen offset:2048  lds
 v_mfma_f32_16x16x32_bf16 v[124:127], a[40:43], a[184:187], v[124:127]
 v_cvt_pk_bf16_f32 v95, v98, v99
 v_pk_max_i16 v92, v92, 0
 v_mfma_f32_16x16x32_bf16 v[128:131], a[44:47], a[184:187], v[128:131]
 v_pk_max_i16 v93, v93, 0
 v_mfma_f32_16x16x32_bf16 v[132:135], a[48:51], a[184:187], v[132:135]
 v_pk_max_i16 v94, v94, 0
 v_mfma_f32_16x16x32_bf16 v[136:139], a[52:55], a[184:187], v[136:139]
 v_pk_max_i16 v95, v95, 0
 s_cmp_eq_u32 s60, 0
 s_cbranch_scc1 L1h_st3_1
 buffer_store_dwordx4 v[92:95], v232, s[20:23], s57 offen offset:3072
 s_branch L1h_st3_1x
L1h_st3_1:
 buffer_store_dwordx4 v[92:95], v232, s[20:23], s57 offen offset:3072 sc1
L1h_st3_1x:
 v_mfma_f32_16x16x32_bf16 v[112:115], a[120:123], a[188:191], v[112:115]
 v_cvt_pk_bf16_f32 v100, v100, v101
 v_mfma_f32_16x16x32_bf16 v[116:119], a[124:127], a[188:191], v[116:119]
 v_cvt_pk_bf16_f32 v101, v102, v103
 v_cvt_pk_bf16_f32 v102, v104, v105
 v_mfma_f32_16x16x32_bf16 v[120:123], a[128:131], a[188:191], v[120:123]
 v_cvt_pk_bf16_f32 v103, v106, v107
 v_mfma_f32_16x16x32_bf16 v[124:127], a[132:135], a[188:191], v[124:127]
 v_pk_max_i16 v100, v100, 0
 v_mfma_f32_16x16x32_bf16 v[128:131], a[136:139], a[188:191], v[128:131]
 buffer_load_dwordx4 v253, s[16:19], s78 offen offset:3072  lds
 v_pk_max_i16 v101, v101, 0
 v_mfma_f32_16x16x32_bf16 v[132:135], a[140:143], a[188:191], v[132:135]
 v_pk_max_i16 v102, v102, 0
 v_mfma_f32_16x16x32_bf16 v[136:139], a[144:147], a[188:191], v[136:139]
 v_pk_max_i16 v103, v103, 0
 s_cmp_eq_u32 s60, 0
 s_cbranch_scc1 L1h_st3_2
 buffer_store_dwordx4 v[100:103], v232, s[20:23], s58 offen offset:3072
 s_branch L1h_st3_2x
L1h_st3_2:
 buffer_store_dwordx4 v[100:103], v232, s[20:23], s58 offen offset:3072 sc1
L1h_st3_2x:
 v_mfma_f32_16x16x32_bf16 v[112:115], a[148:151], a[192:195], v[112:115]
 v_cvt_pk_bf16_f32 v108, v108, v109
 v_mfma_f32_16x16x32_bf16 v[116:119], a[152:155], a[192:195], v[116:119]
 v_cvt_pk_bf16_f32 v109, v110, v111
 v_mfma_f32_16x16x32_bf16 v[120:123], a[156:159], a[192:195], v[120:123]
 v_pk_max_i16 v108, v108, 0
 v_pk_max_i16 v109, v109, 0
 v_mfma_f32_16x16x32_bf16 v[124:127], a[160:163], a[192:195], v[124:127]
 buffer_store_dwordx2 v[108:109], v232, s[20:23], s59 offen offset:3072
 v_mfma_f32_16x16x32_bf16 v[128:131], a[164:167], a[192:195], v[128:131]
 s_add_u32 s56, s56, 4096
 s_add_u32 s57, s57, 4096
 v_mfma_f32_16x16x32_bf16 v[132:135], a[168:171], a[192:195], v[132:135]
 s_add_u32 s58, s58, 4096
 v_mfma_f32_16x16x32_bf16 v[136:139], a[172:175], a[192:195], v[136:139]
 s_add_u32 s59, s59, 4096
 s_waitcnt lgkmcnt(0)
 v_mfma_f32_16x16x32_bf16 v[140:143], a[0:3], a[60:63], v[140:143]
 ds_read_b128 a[180:183], v227 offset:12288
 v_mfma_f32_16x16x32_bf16 v[144:147], a[4:7], a[60:63], v[144:147]
 ds_read_b128 a[184:187], v228 offset:12288
 v_cvt_pk_bf16_f32 v112, v112, v113
 v_cvt_pk_bf16_f32 v113, v114, v115
 v_mfma_f32_16x16x32_bf16 v[148:151], a[8:11], a[60:63], v[148:151]
 v_cvt_pk_bf16_f32 v114, v116, v117
 v_mfma_f32_16x16x32_bf16 v[152:155], a[12:15], a[60:63], v[152:155]
 ds_read_b128 a[188:191], v225 offset:12288
 v_cvt_pk_bf16_f32 v115, v118, v119
 v_mfma_f32_16x16x32_bf16 v[156:159], a[16:19], a[60:63], v[156:159]
 v_pk_max_i16 v112, v112, 0
 v_pk_max_i16 v113, v113, 0
 v_mfma_f32_16x16x32_bf16 v[160:163], a[20:23], a[60:63], v[160:163]
 ds_read_b128 a[192:195], v226 offset:12288
 v_pk_max_i16 v114, v114, 0
 v_mfma_f32_16x16x32_bf16 v[164:167], a[24:27], a[60:63], v[164:167]
 v_pk_max_i16 v115, v115, 0
 v_mfma_f32_16x16x32_bf16 v[140:143], a[28:31], a[64:67], v[140:143]
 s_cmp_eq_u32 s60, 0
 s_cbranch_scc1 L1h_st4_0
 buffer_store_dwordx4 v[112:115], v232, s[20:23], s56 offen offset:0
 s_branch L1h_st4_0x
L1h_st4_0:
 buffer_store_dwordx4 v[112:115], v232, s[20:23], s56 offen offset:0 sc1
L1h_st4_0x:
 v_mfma_f32_16x16x32_bf16 v[144:147], a[32:35], a[64:67], v[144:147]
 v_cvt_pk_bf16_f32 v120, v120, v121
 s_add_u32 m0, s44, 98304
 s_add_u32 s78, s46, 393216
 buffer_load_dwordx4 v252, s[16:19], s78 offen offset:2048  lds
 v_mfma_f32_16x16x32_bf16 v[148:151], a[36:39], a[64:67], v[148:151]
 v_cvt_pk_bf16_f32 v121, v122, v123
 v_mfma_f32_16x16x32_bf16 v[152:155], a[40:43], a[64:67], v[152:155]
 v_cvt_pk_bf16_f32 v122, v124, v125
 v_mfma_f32_16x16x32_bf16 v[156:159], a[44:47], a[64:67], v[156:159]
 v_cvt_pk_bf16_f32 v123, v126, v127
 v_mfma_f32_16x16x32_bf16 v[160:163], a[48:51], a[64:67], v[160:163]
 v_pk_max_i16 v120, v120, 0
 v_pk_max_i16 v121, v121, 0
 v_mfma_f32_16x16x32_bf16 v[164:167], a[52:55], a[64:67], v[164:167]
 v_pk_max_i16 v122, v122, 0
 v_mfma_f32_16x16x32_bf16 v[140:143], a[120:123], a[68:71], v[140:143]
 v_pk_max_i16 v123, v123, 0
 v_mfma_f32_16x16x32_bf16 v[144:147], a[124:127], a[68:71], v[144:147]
 s_cmp_eq_u32 s60, 0
 s_cbranch_scc1 L1h_st4_1
 buffer_store_dwordx4 v[120:123], v232, s[20:23], s57 offen offset:0
 s_branch L1h_st4_1x
L1h_st4_1:
 buffer_store_dwordx4 v[120:123], v232, s[20:23], s57 offen offset:0 sc1
L1h_st4_1x:
 v_mfma_f32_16x16x32_bf16 v[148:151], a[128:131], a[68:71], v[148:151]
 v_cvt_pk_bf16_f32 v128, v128, v129
 v_cvt_pk_bf16_f32 v129, v130, v131
 v_mfma_f32_16x16x32_bf16 v[152:155], a[132:135], a[68:71], v[152:155]
 v_cvt_pk_bf16_f32 v130, v132, v133
 v_mfma_f32_16x16x32_bf16 v[156:159], a[136:139], a[68:71], v[156:159]
 buffer_load_dwordx4 v253, s[16:19], s78 offen offset:3072  lds
 v_mfma_f32_16x16x32_bf16 v[160:163], a[140:143], a[68:71], v[160:163]
 v_cvt_pk_bf16_f32 v131, v134, v135
 v_mfma_f32_16x16x32_bf16 v[164:167], a[144:147], a[68:71], v[164:167]
 v_pk_max_i16 v128, v128, 0
 v_pk_max_i16 v129, v129, 0
 v_mfma_f32_16x16x32_bf16 v[140:143], a[148:151], a[72:75], v[140:143]
 v_pk_max_i16 v130, v130, 0
 v_mfma_f32_16x16x32_bf16 v[144:147], a[152:155], a[72:75], v[144:147]
 v_pk_max_i16 v131, v131, 0
 v_mfma_f32_16x16x32_bf16 v[148:151], a[156:159], a[72:75], v[148:151]
 s_cmp_eq_u32 s60, 0
 s_cbranch_scc1 L1h_st4_2
 buffer_store_dwordx4 v[128:131], v232, s[20:23], s58 offen offset:0
 s_branch L1h_st4_2x
L1h_st4_2:
 buffer_store_dwordx4 v[128:131], v232, s[20:23], s58 offen offset:0 sc1
L1h_st4_2x:
 v_mfma_f32_16x16x32_bf16 v[152:155], a[160:163], a[72:75], v[152:155]
 v_cvt_pk_bf16_f32 v136, v136, v137
 v_cvt_pk_bf16_f32 v137, v138, v139
 v_mfma_f32_16x16x32_bf16 v[156:159], a[164:167], a[72:75], v[156:159]
 v_pk_max_i16 v136, v136, 0
 v_mfma_f32_16x16x32_bf16 v[160:163], a[168:171], a[72:75], v[160:163]
 v_pk_max_i16 v137, v137, 0
 v_mfma_f32_16x16x32_bf16 v[164:167], a[172:175], a[72:75], v[164:167]
 buffer_store_dwordx2 v[136:137], v232, s[20:23], s59 offen offset:0
 s_waitcnt lgkmcnt(0)
 v_mfma_f32_16x16x32_bf16 v[168:171], a[0:3], a[180:183], v[168:171]
 ds_read_b128 a[60:63], v227 offset:14336
 v_mfma_f32_16x16x32_bf16 v[172:175], a[4:7], a[180:183], v[172:175]
 ds_read_b128 a[64:67], v228 offset:14336
 v_cvt_pk_bf16_f32 v140, v140, v141
 v_cvt_pk_bf16_f32 v141, v142, v143
 v_mfma_f32_16x16x32_bf16 v[176:179], a[8:11], a[180:183], v[176:179]
 v_cvt_pk_bf16_f32 v142, v144, v145
 v_mfma_f32_16x16x32_bf16 v[180:183], a[12:15], a[180:183], v[180:183]
 ds_read_b128 a[68:71], v225 offset:14336
 v_cvt_pk_bf16_f32 v143, v146, v147
 v_mfma_f32_16x16x32_bf16 v[184:187], a[16:19], a[180:183], v[184:187]
 v_pk_max_i16 v140, v140, 0
 v_mfma_f32_16x16x32_bf16 v[188:191], a[20:23], a[180:183], v[188:191]
 ds_read_b128 a[72:75], v226 offset:14336
 v_pk_max_i16 v141, v141, 0
 v_mfma_f32_16x16x32_bf16 v[192:195], a[24:27], a[180:183], v[192:195]
 v_pk_max_i16 v142, v142, 0
 v_pk_max_i16 v143, v143, 0
 v_mfma_f32_16x16x32_bf16 v[168:171], a[28:31], a[184:187], v[168:171]
 s_cmp_eq_u32 s60, 0
 s_cbranch_scc1 L1h_st5_0
 buffer_store_dwordx4 v[140:143], v232, s[20:23], s56 offen offset:1024
 s_branch L1h_st5_0x
L1h_st5_0:
 buffer_store_dwordx4 v[140:143], v232, s[20:23], s56 offen offset:1024 sc1
L1h_st5_0x:
 v_mfma_f32_16x16x32_bf16 v[172:175], a[32:35], a[184:187], v[172:175]
 v_cvt_pk_bf16_f32 v148, v148, v149
 v_mfma_f32_16x16x32_bf16 v[176:179], a[36:39], a[184:187], v[176:179]
 v_cvt_pk_bf16_f32 v149, v150, v151
 v_mfma_f32_16x16x32_bf16 v[180:183], a[40:43], a[184:187], v[180:183]
 v_cvt_pk_bf16_f32 v150, v152, v153
 v_mfma_f32_16x16x32_bf16 v[184:187], a[44:47], a[184:187], v[184:187]
 v_cvt_pk_bf16_f32 v151, v154, v155
 v_pk_max_i16 v148, v148, 0
 v_mfma_f32_16x16x32_bf16 v[188:191], a[48:51], a[184:187], v[188:191]
 v_pk_max_i16 v149, v149, 0
 v_mfma_f32_16x16x32_bf16 v[192:195], a[52:55], a[184:187], v[192:195]
 v_pk_max_i16 v150, v150, 0
 v_mfma_f32_16x16x32_bf16 v[168:171], a[120:123], a[188:191], v[168:171]
 v_pk_max_i16 v151, v151, 0
 v_mfma_f32_16x16x32_bf16 v[172:175], a[124:127], a[188:191], v[172:175]
 s_cmp_eq_u32 s60, 0
 s_cbranch_scc1 L1h_st5_1
 buffer_store_dwordx4 v[148:151], v232, s[20:23], s57 offen offset:1024
 s_branch L1h_st5_1x
L1h_st5_1:
 buffer_store_dwordx4 v[148:151], v232, s[20:23], s57 offen offset:1024 sc1
L1h_st5_1x:
 v_mfma_f32_16x16x32_bf16 v[176:179], a[128:131], a[188:191], v[176:179]
 v_cvt_pk_bf16_f32 v156, v156, v157
 v_mfma_f32_16x16x32_bf16 v[180:183], a[132:135], a[188:191], v[180:183]
 v_cvt_pk_bf16_f32 v157, v158, v159
 v_cvt_pk_bf16_f32 v158, v160, v161
 v_mfma_f32_16x16x32_bf16 v[184:187], a[136:139], a[188:191], v[184:187]
 v_cvt_pk_bf16_f32 v159, v162, v163
 v_mfma_f32_16x16x32_bf16 v[188:191], a[140:143], a[188:191], v[188:191]
 v_pk_max_i16 v156, v156, 0
 v_mfma_f32_16x16x32_bf16 v[192:195], a[144:147], a[188:191], v[192:195]
 v_pk_max_i16 v157, v157, 0
 v_mfma_f32_16x16x32_bf16 v[168:171], a[148:151], a[192:195], v[168:171]
 v_pk_max_i16 v158, v158, 0
 v_mfma_f32_16x16x32_bf16 v[172:175], a[152:155], a[192:195], v[172:175]
 v_pk_max_i16 v159, v159, 0
 s_cmp_eq_u32 s60, 0
 s_cbranch_scc1 L1h_st5_2
 buffer_store_dwordx4 v[156:159], v232, s[20:23], s58 offen offset:1024
 s_branch L1h_st5_2x
L1h_st5_2:
 buffer_store_dwordx4 v[156:159], v232, s[20:23], s58 offen offset:1024 sc1
L1h_st5_2x:
 v_mfma_f32_16x16x32_bf16 v[176:179], a[156:159], a[192:195], v[176:179]
 v_cvt_pk_bf16_f32 v164, v164, v165
 v_mfma_f32_16x16x32_bf16 v[180:183], a[160:163], a[192:195], v[180:183]
 v_cvt_pk_bf16_f32 v165, v166, v167
 v_mfma_f32_16x16x32_bf16 v[184:187], a[164:167], a[192:195], v[184:187]
 v_pk_max_i16 v164, v164, 0
 v_mfma_f32_16x16x32_bf16 v[188:191], a[168:171], a[192:195], v[188:191]
 v_pk_max_i16 v165, v165, 0
 v_mfma_f32_16x16x32_bf16 v[192:195], a[172:175], a[192:195], v[192:195]
 buffer_store_dwordx2 v[164:165], v232, s[20:23], s59 offen offset:1024
 s_waitcnt lgkmcnt(0)
 v_mfma_f32_16x16x32_bf16 v[196:199], a[0:3], a[60:63], v[196:199]
 v_mfma_f32_16x16x32_bf16 v[200:203], a[4:7], a[60:63], v[200:203]
 v_cvt_pk_bf16_f32 v168, v168, v169
 v_cvt_pk_bf16_f32 v169, v170, v171
 v_mfma_f32_16x16x32_bf16 v[204:207], a[8:11], a[60:63], v[204:207]
 v_cvt_pk_bf16_f32 v170, v172, v173
 v_mfma_f32_16x16x32_bf16 v[208:211], a[12:15], a[60:63], v[208:211]
 v_cvt_pk_bf16_f32 v171, v174, v175
 v_mfma_f32_16x16x32_bf16 v[212:215], a[16:19], a[60:63], v[212:215]
 v_pk_max_i16 v168, v168, 0
 v_mfma_f32_16x16x32_bf16 v[216:219], a[20:23], a[60:63], v[216:219]
 v_pk_max_i16 v169, v169, 0
 v_mfma_f32_16x16x32_bf16 v[220:223], a[24:27], a[60:63], v[220:223]
 v_pk_max_i16 v170, v170, 0
 v_pk_max_i16 v171, v171, 0
 v_mfma_f32_16x16x32_bf16 v[196:199], a[28:31], a[64:67], v[196:199]
 s_cmp_eq_u32 s60, 0
 s_cbranch_scc1 L1h_st6_0
 buffer_store_dwordx4 v[168:171], v232, s[20:23], s56 offen offset:2048
 s_branch L1h_st6_0x
L1h_st6_0:
 buffer_store_dwordx4 v[168:171], v232, s[20:23], s56 offen offset:2048 sc1
L1h_st6_0x:
 v_mfma_f32_16x16x32_bf16 v[200:203], a[32:35], a[64:67], v[200:203]
 v_cvt_pk_bf16_f32 v176, v176, v177
 v_mfma_f32_16x16x32_bf16 v[204:207], a[36:39], a[64:67], v[204:207]
 v_cvt_pk_bf16_f32 v177, v178, v179
 v_mfma_f32_16x16x32_bf16 v[208:211], a[40:43], a[64:67], v[208:211]
 v_cvt_pk_bf16_f32 v178, v180, v181
 v_mfma_f32_16x16x32_bf16 v[212:215], a[44:47], a[64:67], v[212:215]
 v_cvt_pk_bf16_f32 v179, v182, v183
 v_pk_max_i16 v176, v176, 0
 v_mfma_f32_16x16x32_bf16 v[216:219], a[48:51], a[64:67], v[216:219]
 v_pk_max_i16 v177, v177, 0
 v_mfma_f32_16x16x32_bf16 v[220:223], a[52:55], a[64:67], v[220:223]
 v_pk_max_i16 v178, v178, 0
 v_mfma_f32_16x16x32_bf16 v[196:199], a[120:123], a[68:71], v[196:199]
 v_pk_max_i16 v179, v179, 0
 v_mfma_f32_16x16x32_bf16 v[200:203], a[124:127], a[68:71], v[200:203]
 s_cmp_eq_u32 s60, 0
 s_cbranch_scc1 L1h_st6_1
 buffer_store_dwordx4 v[176:179], v232, s[20:23], s57 offen offset:2048
 s_branch L1h_st6_1x
L1h_st6_1:
 buffer_store_dwordx4 v[176:179], v232, s[20:23], s57 offen offset:2048 sc1
L1h_st6_1x:
 v_mfma_f32_16x16x32_bf16 v[204:207], a[128:131], a[68:71], v[204:207]
 v_cvt_pk_bf16_f32 v184, v184, v185
 v_mfma_f32_16x16x32_bf16 v[208:211], a[132:135], a[68:71], v[208:211]
 v_cvt_pk_bf16_f32 v185, v186, v187
 v_cvt_pk_bf16_f32 v186, v188, v189
 v_mfma_f32_16x16x32_bf16 v[212:215], a[136:139], a[68:71], v[212:215]
 v_cvt_pk_bf16_f32 v187, v190, v191
 v_mfma_f32_16x16x32_bf16 v[216:219], a[140:143], a[68:71], v[216:219]
 v_pk_max_i16 v184, v184, 0
 v_mfma_f32_16x16x32_bf16 v[220:223], a[144:147], a[68:71], v[220:223]
 v_pk_max_i16 v185, v185, 0
 v_mfma_f32_16x16x32_bf16 v[196:199], a[148:151], a[72:75], v[196:199]
 v_pk_max_i16 v186, v186, 0
 v_mfma_f32_16x16x32_bf16 v[200:203], a[152:155], a[72:75], v[200:203]
 v_pk_max_i16 v187, v187, 0
 s_cmp_eq_u32 s60, 0
 s_cbranch_scc1 L1h_st6_2
 buffer_store_dwordx4 v[184:187], v232, s[20:23], s58 offen offset:2048
 s_branch L1h_st6_2x
L1h_st6_2:
 buffer_store_dwordx4 v[184:187], v232, s[20:23], s58 offen offset:2048 sc1
L1h_st6_2x:
 v_mfma_f32_16x16x32_bf16 v[204:207], a[156:159], a[72:75], v[204:207]
 v_cvt_pk_bf16_f32 v192, v192, v193
 v_mfma_f32_16x16x32_bf16 v[208:211], a[160:163], a[72:75], v[208:211]
 v_cvt_pk_bf16_f32 v193, v194, v195
 v_mfma_f32_16x16x32_bf16 v[212:215], a[164:167], a[72:75], v[212:215]
 v_pk_max_i16 v192, v192, 0
 v_mfma_f32_16x16x32_bf16 v[216:219], a[168:171], a[72:75], v[216:219]
 v_pk_max_i16 v193, v193, 0
 v_mfma_f32_16x16x32_bf16 v[220:223], a[172:175], a[72:75], v[220:223]
 buffer_store_dwordx2 v[192:193], v232, s[20:23], s59 offen offset:2048
 v_cvt_pk_bf16_f32 v196, v196, v197
 v_cvt_pk_bf16_f32 v197, v198, v199
 v_cvt_pk_bf16_f32 v198, v200, v201
 v_cvt_pk_bf16_f32 v199, v202, v203
 v_pk_max_i16 v196, v196, 0
 v_pk_max_i16 v197, v197, 0
 v_pk_max_i16 v198, v198, 0
 v_pk_max_i16 v199, v199, 0
 s_cmp_eq_u32 s60, 0
 s_cbranch_scc1 L1h_st7_0
 buffer_store_dwordx4 v[196:199], v232, s[20:23], s56 offen offset:3072
 s_branch L1h_st7_0x
L1h_st7_0:
 buffer_store_dwordx4 v[196:199], v232, s[20:23], s56 offen offset:3072 sc1
L1h_st7_0x:
 v_cvt_pk_bf16_f32 v204, v204, v205
 v_cvt_pk_bf16_f32 v205, v206, v207
 v_cvt_pk_bf16_f32 v206, v208, v209
 v_cvt_pk_bf16_f32 v207, v210, v211
 v_pk_max_i16 v204, v204, 0
 v_pk_max_i16 v205, v205, 0
 v_pk_max_i16 v206, v206, 0
 v_pk_max_i16 v207, v207, 0
 s_cmp_eq_u32 s60, 0
 s_cbranch_scc1 L1h_st7_1
 buffer_store_dwordx4 v[204:207], v232, s[20:23], s57 offen offset:3072
 s_branch L1h_st7_1x
L1h_st7_1:
 buffer_store_dwordx4 v[204:207], v232, s[20:23], s57 offen offset:3072 sc1
L1h_st7_1x:
 v_cvt_pk_bf16_f32 v212, v212, v213
 v_cvt_pk_bf16_f32 v213, v214, v215
 v_cvt_pk_bf16_f32 v214, v216, v217
 v_cvt_pk_bf16_f32 v215, v218, v219
 v_pk_max_i16 v212, v212, 0
 v_pk_max_i16 v213, v213, 0
 v_pk_max_i16 v214, v214, 0
 v_pk_max_i16 v215, v215, 0
 s_cmp_eq_u32 s60, 0
 s_cbranch_scc1 L1h_st7_2
 buffer_store_dwordx4 v[212:215], v232, s[20:23], s58 offen offset:3072
 s_branch L1h_st7_2x
L1h_st7_2:
 buffer_store_dwordx4 v[212:215], v232, s[20:23], s58 offen offset:3072 sc1
L1h_st7_2x:
 v_cvt_pk_bf16_f32 v220, v220, v221
 v_cvt_pk_bf16_f32 v221, v222, v223
 v_pk_max_i16 v220, v220, 0
 v_pk_max_i16 v221, v221, 0
 buffer_store_dwordx2 v[220:221], v232, s[20:23], s59 offen offset:3072
L2_start:
 s_load_dwordx2 s[24:25], s[0:1], 56
 s_load_dwordx2 s[60:61], s[0:1], 64
 s_and_b32 s32, s30, 1
 s_lshr_b32 s34, s30, 1
 s_lshl_b32 s34, s34, 2
 s_lshr_b32 s35, s31, 3
 s_add_u32 s34, s34, s35
 s_and_b32 s35, s31, 7
 s_mov_b32 s74, 0xffff
 s_mov_b32 s75, 0xffff
 s_lshl_b32 s40, s30, 1
 s_and_b32 s41, s31, 1
 s_add_u32 s41, s41, s40
 s_lshl_b32 s41, s41, 8
 s_lshr_b32 s42, s31, 1
 s_lshl_b32 s42, s42, 2
 s_add_u32 s41, s41, s42
 s_add_u32 s56, s41, 18939904
 s_lshr_b32 s41, s31, 4
 s_add_u32 s41, s41, s40
 s_lshl_b32 s57, s41, 8
 s_add_u32 s57, s57, 18939904
 s_xor_b32 s58, s57, 512
 v_mov_b32 v213, 0
 v_mov_b32 v216, 1
 s_and_b32 s3, s3, 15
 s_mul_i32 s40, s3, s3
 s_lshl_b32 s40, s40, 21
 s_lshl_b32 s41, s3, 13
 s_add_u32 s40, s40, s41
 s_add_u32 s59, s40, 32
 s_mov_b32 s62, 256
 s_mov_b32 s63, 0x20000
 s_mov_b32 s43, 0
 s_waitcnt vmcnt(0) lgkmcnt(0)
L2_regchk:
 v_accvgpr_read_b32 v217, a250
 v_accvgpr_read_b32 v218, a251
 v_readfirstlane_b32 s40, v217
 v_readfirstlane_b32 s41, v218
    s_nop 1
 s_or_b32 s42, s40, s41
 s_and_b32 s42, s42, 31
 s_min_u32 s64, s40, s41
 s_cmp_eq_u32 s64, 0
 s_cselect_b32 s42, 1, s42
 s_cmp_eq_u32 s42, 0
 s_cbranch_scc1 L2_regok
 s_sleep 2
 s_and_b32 s42, s30, 6
 s_lshl_b32 s42, s42, 2
 buffer_load_dwordx2 a[250:251], off, s[60:63], s42 sc1
 s_waitcnt vmcnt(0)
 s_add_u32 s43, s43, 1
 s_cmp_lt_u32 s43, 50000
 s_cbranch_scc1 L2_regchk
L2_regok:
 s_barrier
 s_cmp_eq_u32 s32, 0
 s_cselect_b32 s40, s40, s41
 s_cmp_eq_u32 s40, s59
 s_cselect_b32 s40, 128, 0
 s_add_u32 s57, s57, s40
 s_cmp_lg_u32 s33, 0
 s_cbranch_scc1 L2_flagged
 s_cmp_eq_u32 s40, 128
 s_cbranch_scc1 L2_fast
 buffer_wbl2 sc1
 s_waitcnt vmcnt(0)
 s_branch L2_slow
L2_fast:
 s_mov_b64 exec, 1
 buffer_store_dword v216, off, s[20:23], s56 offset:128
L2_slow:
 s_mov_b64 exec, 1
 buffer_store_dword v216, off, s[20:23], s56 sc1
 s_mov_b64 exec, -1
L2_flagged:
 s_add_u32 m0, s44, 49152
 s_add_u32 s78, s46, 196608
 buffer_load_dwordx4 v252, s[16:19], s78 offen offset:2048  lds
 buffer_load_dwordx4 v253, s[16:19], s78 offen offset:3072  lds
 s_add_u32 m0, s44, 65536
 s_add_u32 s78, s46, 262144
 buffer_load_dwordx4 v252, s[16:19], s78 offen offset:2048  lds
 buffer_load_dwordx4 v253, s[16:19], s78 offen offset:3072  lds
 s_add_u32 m0, s44, 81920
 s_add_u32 s78, s46, 327680
 buffer_load_dwordx4 v252, s[16:19], s78 offen offset:2048  lds
 buffer_load_dwordx4 v253, s[16:19], s78 offen offset:3072  lds
 s_add_u32 s46, s46, 458752
 s_mov_b32 s12, s20
 s_mov_b32 s13, s21
 s_mov_b32 s15, 0x20000
 s_mul_i32 s45, s34, 1179648
 s_add_u32 s14, s45, 1179648
 s_mul_i32 s40, s32, 114688
 s_add_u32 s48, s45, 262144
 s_add_u32 s45, s45, s40
 s_mul_i32 s40, s32, 516096
 s_add_u32 s48, s48, s40
 s_mul_i32 s49, s32, 4128768
 s_lshr_b32 s36, s33, 1
 s_and_b32 s37, s33, 1
 s_lshl_b32 s40, s33, 11
 v_lshl_add_u32 v210, v224, 4, s40
 v_lshrrev_b32 v216, 4, v224
 v_and_b32 v217, 15, v224
 v_lshlrev_b32 v218, 2, v224
 v_mov_b32 v219, 0x80000000
 v_cmp_gt_u32 vcc, 16, v224
    s_nop 1
 v_cndmask_b32 v215, v219, v218, vcc
 s_cmp_lg_u32 s33, 0
 s_cbranch_scc1 L2_nold
 buffer_load_dword v214, v215, s[20:23], s57 offen sc1
L2_nold:
 s_mov_b32 s26, 0x400000
 s_mov_b32 s27, 0x20000
 s_lshl_b32 s40, s36, 13
 v_lshl_add_u32 v200, v224, 4, s40
 v_add_u32 v201, 0x10000, v200
 v_bfe_u32 v218, v224, 2, 2
 v_and_b32 v219, 3, v224
 v_and_b32 v220, 1, v216
 v_lshrrev_b32 v221, 1, v216
 v_lshlrev_b32 v222, 12, v221
 v_lshl_add_u32 v222, v220, 10, v222
 v_lshl_add_u32 v222, v218, 8, v222
 v_lshl_add_u32 v222, v219, 3, v222
 v_add_u32 v222, 2048, v222
 v_lshl_add_u32 v219, v220, 2, v218
 s_lshl_b32 s40, s37, 2
 s_add_u32 s41, s40, 0
 v_xor_b32 v223, s41, v219
 v_lshl_add_u32 v202, v223, 5, v222
 v_add_u32 v206, 0x10000, v202
 s_add_u32 s41, s40, 1
 v_xor_b32 v223, s41, v219
 v_lshl_add_u32 v203, v223, 5, v222
 v_add_u32 v207, 0x10000, v203
 s_add_u32 s41, s40, 2
 v_xor_b32 v223, s41, v219
 v_lshl_add_u32 v204, v223, 5, v222
 v_add_u32 v208, 0x10000, v204
 s_add_u32 s41, s40, 3
 v_xor_b32 v223, s41, v219
 v_lshl_add_u32 v205, v223, 5, v222
 v_add_u32 v209, 0x10000, v205
 v_lshlrev_b32 v212, 11, v217
 v_lshl_add_u32 v212, v220, 5, v212
 v_lshl_add_u32 v212, v221, 4, v212
 s_lshl_b32 s52, s34, 18
 s_lshl_b32 s43, s36, 17
 s_add_u32 s52, s52, s43
 s_lshl_b32 s43, s35, 8
 s_add_u32 s52, s52, s43
 s_lshl_b32 s43, s37, 7
 s_add_u32 s52, s52, s43
 s_lshl_b32 s50, s34, 3
 s_add_u32 s50, s50, s35
 s_lshl_b32 s51, s50, 8
 s_add_u32 s51, s51, 18944000
 s_lshl_b32 s50, s50, 16
 s_lshl_b32 s42, s33, 14
 s_add_u32 s50, s50, s42
 s_add_u32 s50, s50, 20971520
 v_lshlrev_b32 v211, 4, v224
 v_lshlrev_b32 v223, 3, v217
 s_lshl_b32 s53, s34, 10
 s_lshl_b32 s41, s36, 9
 s_add_u32 s53, s53, s41
 s_add_u32 s53, s53, 18874368
 s_sub_u32 s76, s10, 4096
 s_subb_u32 s77, s11, 0
 s_mov_b32 s43, 0
 s_cmp_lg_u32 s33, 0
 s_cbranch_scc1 L2_pg_ok
L2_pg:
 s_waitcnt vmcnt(0)
 v_cmp_eq_u32 vcc, 1, v214
    s_nop 1
 s_and_b32 s40, vcc_lo, s74
 s_cmp_eq_u32 s40, s74
 s_cbranch_scc1 L2_pg_ok
 s_sleep 4
 buffer_load_dword v214, v215, s[20:23], s57 offen sc1
 s_add_u32 s43, s43, 1
 s_cmp_lt_u32 s43, 50000
 s_cbranch_scc1 L2_pg
L2_pg_ok:
 s_barrier
 s_add_u32 m0, s44, 0
 s_nop 0
 buffer_load_dwordx4 v210, s[12:15], s45 offen  lds
 buffer_load_dwordx4 v210, s[12:15], s45 offen offset:1024  lds
 s_add_u32 s45, s45, 8192
 s_add_u32 m0, s44, 16384
 s_nop 0
 buffer_load_dwordx4 v210, s[12:15], s45 offen  lds
 buffer_load_dwordx4 v210, s[12:15], s45 offen offset:1024  lds
 s_add_u32 s45, s45, 8192
 s_add_u32 m0, s44, 32768
 s_nop 0
 buffer_load_dwordx4 v210, s[12:15], s45 offen  lds
 buffer_load_dwordx4 v210, s[12:15], s45 offen offset:1024  lds
 s_add_u32 s45, s45, 8192
 s_add_u32 m0, s44, 49152
 s_nop 0
 buffer_load_dwordx4 v210, s[12:15], s45 offen  lds
 buffer_load_dwordx4 v210, s[12:15], s45 offen offset:1024  lds
 s_add_u32 s45, s45, 8192
 s_add_u32 m0, s44, 65536
 s_nop 0
 buffer_load_dwordx4 v210, s[12:15], s45 offen  lds
 buffer_load_dwordx4 v210, s[12:15], s45 offen offset:1024  lds
 s_add_u32 s45, s45, 8192
 s_add_u32 m0, s44, 81920
 s_nop 0
 buffer_load_dwordx4 v210, s[12:15], s45 offen  lds
 buffer_load_dwordx4 v210, s[12:15], s45 offen offset:1024  lds
 s_add_u32 s45, s45, 8192
 s_add_u32 m0, s44, 98304
 s_nop 0
 buffer_load_dwordx4 v210, s[12:15], s45 offen  lds
 buffer_load_dwordx4 v210, s[12:15], s45 offen offset:1024  lds
 s_add_u32 s45, s45, 8192
 s_waitcnt vmcnt(12)
 s_barrier
 ds_read_b64_tr_b16 a[16:17], v202 offset:0
 ds_read_b64_tr_b16 a[18:19], v202 offset:8192
 ds_read_b128 a[0:3], v200 offset:0
 ds_read_b64_tr_b16 a[20:21], v203 offset:0
 ds_read_b64_tr_b16 a[22:23], v203 offset:8192
 ds_read_b128 a[4:7], v200 offset:1024
 ds_read_b64_tr_b16 a[24:25], v204 offset:0
 ds_read_b64_tr_b16 a[26:27], v204 offset:8192
 ds_read_b128 a[8:11], v200 offset:4096
 ds_read_b64_tr_b16 a[28:29], v205 offset:0
 ds_read_b64_tr_b16 a[30:31], v205 offset:8192
 ds_read_b128 a[12:15], v200 offset:5120
 s_cmp_lg_u32 s32, 0
 s_cbranch_scc1 L2_P
 s_waitcnt lgkmcnt(0)
 s_waitcnt vmcnt(8)
 s_barrier
 v_mfma_f32_16x16x32_bf16 v[0:3], a[16:19], a[0:3], 0
 ds_read_b64_tr_b16 a[48:49], v202 offset:16384
 v_mfma_f32_16x16x32_bf16 v[16:19], a[16:19], a[4:7], 0
 ds_read_b64_tr_b16 a[50:51], v202 offset:24576
 s_add_u32 m0, s44, 114688
 v_mfma_f32_16x16x32_bf16 v[20:23], a[20:23], a[4:7], 0
 ds_read_b128 a[32:35], v200 offset:16384
 buffer_load_dwordx4 v210, s[12:15], s45 offen  lds
 v_mfma_f32_16x16x32_bf16 v[4:7], a[20:23], a[0:3], 0
 ds_read_b64_tr_b16 a[52:53], v203 offset:16384
 v_mfma_f32_16x16x32_bf16 v[8:11], a[24:27], a[0:3], 0
 ds_read_b64_tr_b16 a[54:55], v203 offset:24576
 v_mfma_f32_16x16x32_bf16 v[24:27], a[24:27], a[4:7], 0
 ds_read_b128 a[36:39], v200 offset:17408
 buffer_load_dwordx4 v210, s[12:15], s45 offen offset:1024  lds
 v_mfma_f32_16x16x32_bf16 v[28:31], a[28:31], a[4:7], 0
 ds_read_b64_tr_b16 a[56:57], v204 offset:16384
 v_mfma_f32_16x16x32_bf16 v[12:15], a[28:31], a[0:3], 0
 ds_read_b64_tr_b16 a[58:59], v204 offset:24576
 v_mfma_f32_16x16x32_bf16 v[44:47], a[28:31], a[8:11], 0
 ds_read_b128 a[40:43], v200 offset:20480
 buffer_load_dwordx4 v252, s[16:19], s46 offen offset:2048  lds
 v_mfma_f32_16x16x32_bf16 v[60:63], a[28:31], a[12:15], 0
 ds_read_b64_tr_b16 a[60:61], v205 offset:16384
 v_mfma_f32_16x16x32_bf16 v[56:59], a[24:27], a[12:15], 0
 ds_read_b64_tr_b16 a[62:63], v205 offset:24576
 v_mfma_f32_16x16x32_bf16 v[40:43], a[24:27], a[8:11], 0
 ds_read_b128 a[44:47], v200 offset:21504
 buffer_load_dwordx4 v253, s[16:19], s46 offen offset:3072  lds
 s_add_u32 s45, s45, 8192
 s_add_u32 s46, s46, 65536
 v_mfma_f32_16x16x32_bf16 v[36:39], a[20:23], a[8:11], 0
 v_mfma_f32_16x16x32_bf16 v[52:55], a[20:23], a[12:15], 0
 v_mfma_f32_16x16x32_bf16 v[48:51], a[16:19], a[12:15], 0
 v_mfma_f32_16x16x32_bf16 v[32:35], a[16:19], a[8:11], 0
 s_waitcnt lgkmcnt(0)
 v_mfma_f32_16x16x32_bf16 v[0:3], a[48:51], a[32:35], v[0:3]
 ds_read_b64_tr_b16 a[16:17], v202 offset:32768
 v_mfma_f32_16x16x32_bf16 v[16:19], a[48:51], a[36:39], v[16:19]
 ds_read_b64_tr_b16 a[18:19], v202 offset:40960
 s_add_u32 m0, s44, 0
 v_mfma_f32_16x16x32_bf16 v[20:23], a[52:55], a[36:39], v[20:23]
 ds_read_b128 a[0:3], v200 offset:32768
 buffer_load_dwordx4 v210, s[12:15], s45 offen  lds
 v_mfma_f32_16x16x32_bf16 v[4:7], a[52:55], a[32:35], v[4:7]
 ds_read_b64_tr_b16 a[20:21], v203 offset:32768
 v_mfma_f32_16x16x32_bf16 v[8:11], a[56:59], a[32:35], v[8:11]
 ds_read_b64_tr_b16 a[22:23], v203 offset:40960
 v_mfma_f32_16x16x32_bf16 v[24:27], a[56:59], a[36:39], v[24:27]
 ds_read_b128 a[4:7], v200 offset:33792
 buffer_load_dwordx4 v210, s[12:15], s45 offen offset:1024  lds
 v_mfma_f32_16x16x32_bf16 v[28:31], a[60:63], a[36:39], v[28:31]
 ds_read_b64_tr_b16 a[24:25], v204 offset:32768
 v_mfma_f32_16x16x32_bf16 v[12:15], a[60:63], a[32:35], v[12:15]
 ds_read_b64_tr_b16 a[26:27], v204 offset:40960
 v_mfma_f32_16x16x32_bf16 v[44:47], a[60:63], a[40:43], v[44:47]
 ds_read_b128 a[8:11], v200 offset:36864
 buffer_load_dwordx4 v252, s[16:19], s46 offen offset:2048  lds
 v_mfma_f32_16x16x32_bf16 v[60:63], a[60:63], a[44:47], v[60:63]
 ds_read_b64_tr_b16 a[28:29], v205 offset:32768
 v_mfma_f32_16x16x32_bf16 v[56:59], a[56:59], a[44:47], v[56:59]
 ds_read_b64_tr_b16 a[30:31], v205 offset:40960
 v_mfma_f32_16x16x32_bf16 v[40:43], a[56:59], a[40:43], v[40:43]
 ds_read_b128 a[12:15], v200 offset:37888
 buffer_load_dwordx4 v253, s[16:19], s46 offen offset:3072  lds
 s_add_u32 s45, s45, 8192
 s_add_u32 s46, s46, 65536
 v_mfma_f32_16x16x32_bf16 v[36:39], a[52:55], a[40:43], v[36:39]
 v_mfma_f32_16x16x32_bf16 v[52:55], a[52:55], a[44:47], v[52:55]
 v_mfma_f32_16x16x32_bf16 v[48:51], a[48:51], a[44:47], v[48:51]
 v_mfma_f32_16x16x32_bf16 v[32:35], a[48:51], a[40:43], v[32:35]
 s_waitcnt lgkmcnt(0)
 s_waitcnt vmcnt(12)
 s_barrier
 v_mfma_f32_16x16x32_bf16 v[0:3], a[16:19], a[0:3], v[0:3]
 ds_read_b64_tr_b16 a[48:49], v202 offset:49152
 v_mfma_f32_16x16x32_bf16 v[16:19], a[16:19], a[4:7], v[16:19]
 ds_read_b64_tr_b16 a[50:51], v202 offset:57344
 s_add_u32 m0, s44, 16384
 v_mfma_f32_16x16x32_bf16 v[20:23], a[20:23], a[4:7], v[20:23]
 ds_read_b128 a[32:35], v200 offset:49152
 buffer_load_dwordx4 v210, s[12:15], s45 offen  lds
 v_mfma_f32_16x16x32_bf16 v[4:7], a[20:23], a[0:3], v[4:7]
 ds_read_b64_tr_b16 a[52:53], v203 offset:49152
 v_mfma_f32_16x16x32_bf16 v[8:11], a[24:27], a[0:3], v[8:11]
 ds_read_b64_tr_b16 a[54:55], v203 offset:57344
 v_mfma_f32_16x16x32_bf16 v[24:27], a[24:27], a[4:7], v[24:27]
 ds_read_b128 a[36:39], v200 offset:50176
 buffer_load_dwordx4 v210, s[12:15], s45 offen offset:1024  lds
 v_mfma_f32_16x16x32_bf16 v[28:31], a[28:31], a[4:7], v[28:31]
 ds_read_b64_tr_b16 a[56:57], v204 offset:49152
 v_mfma_f32_16x16x32_bf16 v[12:15], a[28:31], a[0:3], v[12:15]
 ds_read_b64_tr_b16 a[58:59], v204 offset:57344
 v_mfma_f32_16x16x32_bf16 v[44:47], a[28:31], a[8:11], v[44:47]
 ds_read_b128 a[40:43], v200 offset:53248
 buffer_load_dwordx4 v252, s[16:19], s46 offen offset:2048  lds
 v_mfma_f32_16x16x32_bf16 v[60:63], a[28:31], a[12:15], v[60:63]
 ds_read_b64_tr_b16 a[60:61], v205 offset:49152
 v_mfma_f32_16x16x32_bf16 v[56:59], a[24:27], a[12:15], v[56:59]
 ds_read_b64_tr_b16 a[62:63], v205 offset:57344
 v_mfma_f32_16x16x32_bf16 v[40:43], a[24:27], a[8:11], v[40:43]
 ds_read_b128 a[44:47], v200 offset:54272
 buffer_load_dwordx4 v253, s[16:19], s46 offen offset:3072  lds
 s_add_u32 s45, s45, 8192
 s_add_u32 s46, s46, 65536
 v_mfma_f32_16x16x32_bf16 v[36:39], a[20:23], a[8:11], v[36:39]
 v_mfma_f32_16x16x32_bf16 v[52:55], a[20:23], a[12:15], v[52:55]
 v_mfma_f32_16x16x32_bf16 v[48:51], a[16:19], a[12:15], v[48:51]
 v_mfma_f32_16x16x32_bf16 v[32:35], a[16:19], a[8:11], v[32:35]
 s_waitcnt lgkmcnt(0)
 v_mfma_f32_16x16x32_bf16 v[0:3], a[48:51], a[32:35], v[0:3]
 ds_read_b64_tr_b16 a[16:17], v206 offset:0
 v_mfma_f32_16x16x32_bf16 v[16:19], a[48:51], a[36:39], v[16:19]
 ds_read_b64_tr_b16 a[18:19], v206 offset:8192
 s_add_u32 m0, s44, 32768
 v_mfma_f32_16x16x32_bf16 v[20:23], a[52:55], a[36:39], v[20:23]
 ds_read_b128 a[0:3], v201 offset:0
 buffer_load_dwordx4 v210, s[12:15], s45 offen  lds
 v_mfma_f32_16x16x32_bf16 v[4:7], a[52:55], a[32:35], v[4:7]
 ds_read_b64_tr_b16 a[20:21], v207 offset:0
 v_mfma_f32_16x16x32_bf16 v[8:11], a[56:59], a[32:35], v[8:11]
 ds_read_b64_tr_b16 a[22:23], v207 offset:8192
 v_mfma_f32_16x16x32_bf16 v[24:27], a[56:59], a[36:39], v[24:27]
 ds_read_b128 a[4:7], v201 offset:1024
 buffer_load_dwordx4 v210, s[12:15], s45 offen offset:1024  lds
 v_mfma_f32_16x16x32_bf16 v[28:31], a[60:63], a[36:39], v[28:31]
 ds_read_b64_tr_b16 a[24:25], v208 offset:0
 v_mfma_f32_16x16x32_bf16 v[12:15], a[60:63], a[32:35], v[12:15]
 ds_read_b64_tr_b16 a[26:27], v208 offset:8192
 v_mfma_f32_16x16x32_bf16 v[44:47], a[60:63], a[40:43], v[44:47]
 ds_read_b128 a[8:11], v201 offset:4096
 buffer_load_dwordx4 v252, s[16:19], s46 offen offset:2048  lds
 v_mfma_f32_16x16x32_bf16 v[60:63], a[60:63], a[44:47], v[60:63]
 ds_read_b64_tr_b16 a[28:29], v209 offset:0
 v_mfma_f32_16x16x32_bf16 v[56:59], a[56:59], a[44:47], v[56:59]
 ds_read_b64_tr_b16 a[30:31], v209 offset:8192
 v_mfma_f32_16x16x32_bf16 v[40:43], a[56:59], a[40:43], v[40:43]
 ds_read_b128 a[12:15], v201 offset:5120
 buffer_load_dwordx4 v253, s[16:19], s46 offen offset:3072  lds
 s_add_u32 s45, s45, 8192
 s_add_u32 s46, s46, 65536
 v_mfma_f32_16x16x32_bf16 v[36:39], a[52:55], a[40:43], v[36:39]
 v_mfma_f32_16x16x32_bf16 v[52:55], a[52:55], a[44:47], v[52:55]
 v_mfma_f32_16x16x32_bf16 v[48:51], a[48:51], a[44:47], v[48:51]
 v_mfma_f32_16x16x32_bf16 v[32:35], a[48:51], a[40:43], v[32:35]
 s_waitcnt lgkmcnt(0)
 s_waitcnt vmcnt(16)
 s_barrier
 v_mfma_f32_16x16x32_bf16 v[0:3], a[16:19], a[0:3], v[0:3]
 ds_read_b64_tr_b16 a[48:49], v206 offset:16384
 v_mfma_f32_16x16x32_bf16 v[16:19], a[16:19], a[4:7], v[16:19]
 ds_read_b64_tr_b16 a[50:51], v206 offset:24576
 s_add_u32 m0, s44, 49152
 v_mfma_f32_16x16x32_bf16 v[20:23], a[20:23], a[4:7], v[20:23]
 ds_read_b128 a[32:35], v201 offset:16384
 buffer_load_dwordx4 v210, s[12:15], s45 offen  lds
 v_mfma_f32_16x16x32_bf16 v[4:7], a[20:23], a[0:3], v[4:7]
 ds_read_b64_tr_b16 a[52:53], v207 offset:16384
 v_mfma_f32_16x16x32_bf16 v[8:11], a[24:27], a[0:3], v[8:11]
 ds_read_b64_tr_b16 a[54:55], v207 offset:24576
 v_mfma_f32_16x16x32_bf16 v[24:27], a[24:27], a[4:7], v[24:27]
 ds_read_b128 a[36:39], v201 offset:17408
 buffer_load_dwordx4 v210, s[12:15], s45 offen offset:1024  lds
 v_mfma_f32_16x16x32_bf16 v[28:31], a[28:31], a[4:7], v[28:31]
 ds_read_b64_tr_b16 a[56:57], v208 offset:16384
 v_mfma_f32_16x16x32_bf16 v[12:15], a[28:31], a[0:3], v[12:15]
 ds_read_b64_tr_b16 a[58:59], v208 offset:24576
 v_mfma_f32_16x16x32_bf16 v[44:47], a[28:31], a[8:11], v[44:47]
 ds_read_b128 a[40:43], v201 offset:20480
 buffer_load_dwordx4 v252, s[16:19], s46 offen offset:2048  lds
 v_mfma_f32_16x16x32_bf16 v[60:63], a[28:31], a[12:15], v[60:63]
 ds_read_b64_tr_b16 a[60:61], v209 offset:16384
 v_mfma_f32_16x16x32_bf16 v[56:59], a[24:27], a[12:15], v[56:59]
 ds_read_b64_tr_b16 a[62:63], v209 offset:24576
 v_mfma_f32_16x16x32_bf16 v[40:43], a[24:27], a[8:11], v[40:43]
 ds_read_b128 a[44:47], v201 offset:21504
 buffer_load_dwordx4 v253, s[16:19], s46 offen offset:3072  lds
 s_add_u32 s45, s45, 8192
 s_add_u32 s46, s46, 65536
 v_mfma_f32_16x16x32_bf16 v[36:39], a[20:23], a[8:11], v[36:39]
 v_mfma_f32_16x16x32_bf16 v[52:55], a[20:23], a[12:15], v[52:55]
 v_mfma_f32_16x16x32_bf16 v[48:51], a[16:19], a[12:15], v[48:51]
 v_mfma_f32_16x16x32_bf16 v[32:35], a[16:19], a[8:11], v[32:35]
 s_waitcnt lgkmcnt(0)
 v_mfma_f32_16x16x32_bf16 v[0:3], a[48:51], a[32:35], v[0:3]
 ds_read_b64_tr_b16 a[16:17], v206 offset:32768
 v_mfma_f32_16x16x32_bf16 v[16:19], a[48:51], a[36:39], v[16:19]
 ds_read_b64_tr_b16 a[18:19], v206 offset:40960
 s_add_u32 m0, s44, 65536
 v_mfma_f32_16x16x32_bf16 v[20:23], a[52:55], a[36:39], v[20:23]
 ds_read_b128 a[0:3], v201 offset:32768
 buffer_load_dwordx4 v210, s[12:15], s45 offen  lds
 v_mfma_f32_16x16x32_bf16 v[4:7], a[52:55], a[32:35], v[4:7]
 ds_read_b64_tr_b16 a[20:21], v207 offset:32768
 v_mfma_f32_16x16x32_bf16 v[8:11], a[56:59], a[32:35], v[8:11]
 ds_read_b64_tr_b16 a[22:23], v207 offset:40960
 v_mfma_f32_16x16x32_bf16 v[24:27], a[56:59], a[36:39], v[24:27]
 ds_read_b128 a[4:7], v201 offset:33792
 buffer_load_dwordx4 v210, s[12:15], s45 offen offset:1024  lds
 v_mfma_f32_16x16x32_bf16 v[28:31], a[60:63], a[36:39], v[28:31]
 ds_read_b64_tr_b16 a[24:25], v208 offset:32768
 v_mfma_f32_16x16x32_bf16 v[12:15], a[60:63], a[32:35], v[12:15]
 ds_read_b64_tr_b16 a[26:27], v208 offset:40960
 v_mfma_f32_16x16x32_bf16 v[44:47], a[60:63], a[40:43], v[44:47]
 ds_read_b128 a[8:11], v201 offset:36864
 buffer_load_dwordx4 v252, s[16:19], s46 offen offset:2048  lds
 v_mfma_f32_16x16x32_bf16 v[60:63], a[60:63], a[44:47], v[60:63]
 ds_read_b64_tr_b16 a[28:29], v209 offset:32768
 v_mfma_f32_16x16x32_bf16 v[56:59], a[56:59], a[44:47], v[56:59]
 ds_read_b64_tr_b16 a[30:31], v209 offset:40960
 v_mfma_f32_16x16x32_bf16 v[40:43], a[56:59], a[40:43], v[40:43]
 ds_read_b128 a[12:15], v201 offset:37888
 buffer_load_dwordx4 v253, s[16:19], s46 offen offset:3072  lds
 s_add_u32 s45, s45, 8192
 s_add_u32 s46, s46, 65536
 v_mfma_f32_16x16x32_bf16 v[36:39], a[52:55], a[40:43], v[36:39]
 v_mfma_f32_16x16x32_bf16 v[52:55], a[52:55], a[44:47], v[52:55]
 v_mfma_f32_16x16x32_bf16 v[48:51], a[48:51], a[44:47], v[48:51]
 v_mfma_f32_16x16x32_bf16 v[32:35], a[48:51], a[40:43], v[32:35]
 s_waitcnt lgkmcnt(0)
 s_waitcnt vmcnt(16)
 s_barrier
 v_mfma_f32_16x16x32_bf16 v[0:3], a[16:19], a[0:3], v[0:3]
 ds_read_b64_tr_b16 a[48:49], v206 offset:49152
 v_mfma_f32_16x16x32_bf16 v[16:19], a[16:19], a[4:7], v[16:19]
 ds_read_b64_tr_b16 a[50:51], v206 offset:57344
 s_add_u32 m0, s44, 81920
 v_mfma_f32_16x16x32_bf16 v[20:23], a[20:23], a[4:7], v[20:23]
 ds_read_b128 a[32:35], v201 offset:49152
 buffer_load_dwordx4 v210, s[12:15], s45 offen  lds
 v_mfma_f32_16x16x32_bf16 v[4:7], a[20:23], a[0:3], v[4:7]
 ds_read_b64_tr_b16 a[52:53], v207 offset:49152
 v_mfma_f32_16x16x32_bf16 v[8:11], a[24:27], a[0:3], v[8:11]
 ds_read_b64_tr_b16 a[54:55], v207 offset:57344
 v_mfma_f32_16x16x32_bf16 v[24:27], a[24:27], a[4:7], v[24:27]
 ds_read_b128 a[36:39], v201 offset:50176
 buffer_load_dwordx4 v210, s[12:15], s45 offen offset:1024  lds
 v_mfma_f32_16x16x32_bf16 v[28:31], a[28:31], a[4:7], v[28:31]
 ds_read_b64_tr_b16 a[56:57], v208 offset:49152
 v_mfma_f32_16x16x32_bf16 v[12:15], a[28:31], a[0:3], v[12:15]
 ds_read_b64_tr_b16 a[58:59], v208 offset:57344
 v_mfma_f32_16x16x32_bf16 v[44:47], a[28:31], a[8:11], v[44:47]
 ds_read_b128 a[40:43], v201 offset:53248
 buffer_load_dwordx4 v252, s[16:19], s46 offen offset:2048  lds
 v_mfma_f32_16x16x32_bf16 v[60:63], a[28:31], a[12:15], v[60:63]
 ds_read_b64_tr_b16 a[60:61], v209 offset:49152
 v_mfma_f32_16x16x32_bf16 v[56:59], a[24:27], a[12:15], v[56:59]
 ds_read_b64_tr_b16 a[62:63], v209 offset:57344
 v_mfma_f32_16x16x32_bf16 v[40:43], a[24:27], a[8:11], v[40:43]
 ds_read_b128 a[44:47], v201 offset:54272
 buffer_load_dwordx4 v253, s[16:19], s46 offen offset:3072  lds
 s_add_u32 s45, s45, 8192
 s_add_u32 s46, s46, 65536
 v_mfma_f32_16x16x32_bf16 v[36:39], a[20:23], a[8:11], v[36:39]
 s_mov_b32 s16, s76
 s_mov_b32 s17, s77
 v_mfma_f32_16x16x32_bf16 v[52:55], a[20:23], a[12:15], v[52:55]
 s_mov_b32 s18, 7344128
 v_mfma_f32_16x16x32_bf16 v[48:51], a[16:19], a[12:15], v[48:51]
 s_mov_b32 s45, s48
 v_mfma_f32_16x16x32_bf16 v[32:35], a[16:19], a[8:11], v[32:35]
 s_mov_b32 s46, s49
 s_waitcnt lgkmcnt(0)
 v_mfma_f32_16x16x32_bf16 v[0:3], a[48:51], a[32:35], v[0:3]
 ds_read_b64_tr_b16 a[16:17], v202 offset:0
 v_mfma_f32_16x16x32_bf16 v[16:19], a[48:51], a[36:39], v[16:19]
 ds_read_b64_tr_b16 a[18:19], v202 offset:8192
 s_add_u32 m0, s44, 98304
 v_mfma_f32_16x16x32_bf16 v[20:23], a[52:55], a[36:39], v[20:23]
 ds_read_b128 a[0:3], v200 offset:0
 buffer_load_dwordx4 v210, s[12:15], s45 offen  lds
 v_mfma_f32_16x16x32_bf16 v[4:7], a[52:55], a[32:35], v[4:7]
 ds_read_b64_tr_b16 a[20:21], v203 offset:0
 v_mfma_f32_16x16x32_bf16 v[8:11], a[56:59], a[32:35], v[8:11]
 ds_read_b64_tr_b16 a[22:23], v203 offset:8192
 v_mfma_f32_16x16x32_bf16 v[24:27], a[56:59], a[36:39], v[24:27]
 ds_read_b128 a[4:7], v200 offset:1024
 buffer_load_dwordx4 v210, s[12:15], s45 offen offset:1024  lds
 v_mfma_f32_16x16x32_bf16 v[28:31], a[60:63], a[36:39], v[28:31]
 ds_read_b64_tr_b16 a[24:25], v204 offset:0
 v_mfma_f32_16x16x32_bf16 v[12:15], a[60:63], a[32:35], v[12:15]
 ds_read_b64_tr_b16 a[26:27], v204 offset:8192
 v_mfma_f32_16x16x32_bf16 v[44:47], a[60:63], a[40:43], v[44:47]
 ds_read_b128 a[8:11], v200 offset:4096
 buffer_load_dwordx4 v252, s[16:19], s46 offen offset:2048  lds
 v_mfma_f32_16x16x32_bf16 v[60:63], a[60:63], a[44:47], v[60:63]
 ds_read_b64_tr_b16 a[28:29], v205 offset:0
 v_mfma_f32_16x16x32_bf16 v[56:59], a[56:59], a[44:47], v[56:59]
 ds_read_b64_tr_b16 a[30:31], v205 offset:8192
 v_mfma_f32_16x16x32_bf16 v[40:43], a[56:59], a[40:43], v[40:43]
 ds_read_b128 a[12:15], v200 offset:5120
 buffer_load_dwordx4 v253, s[16:19], s46 offen offset:3072  lds
 s_add_u32 s45, s45, 8192
 s_add_u32 s46, s46, 65536
 v_mfma_f32_16x16x32_bf16 v[36:39], a[52:55], a[40:43], v[36:39]
 v_mfma_f32_16x16x32_bf16 v[52:55], a[52:55], a[44:47], v[52:55]
 v_mfma_f32_16x16x32_bf16 v[48:51], a[48:51], a[44:47], v[48:51]
 v_mfma_f32_16x16x32_bf16 v[32:35], a[48:51], a[40:43], v[32:35]
 s_waitcnt lgkmcnt(0)
 s_waitcnt vmcnt(16)
 s_barrier
 v_mfma_f32_16x16x32_bf16 v[0:3], a[16:19], a[0:3], v[0:3]
 ds_read_b64_tr_b16 a[48:49], v202 offset:16384
 v_mfma_f32_16x16x32_bf16 v[16:19], a[16:19], a[4:7], v[16:19]
 ds_read_b64_tr_b16 a[50:51], v202 offset:24576
 s_add_u32 m0, s44, 114688
 v_mfma_f32_16x16x32_bf16 v[20:23], a[20:23], a[4:7], v[20:23]
 ds_read_b128 a[32:35], v200 offset:16384
 buffer_load_dwordx4 v210, s[12:15], s45 offen  lds
 v_mfma_f32_16x16x32_bf16 v[4:7], a[20:23], a[0:3], v[4:7]
 ds_read_b64_tr_b16 a[52:53], v203 offset:16384
 v_mfma_f32_16x16x32_bf16 v[8:11], a[24:27], a[0:3], v[8:11]
 ds_read_b64_tr_b16 a[54:55], v203 offset:24576
 v_mfma_f32_16x16x32_bf16 v[24:27], a[24:27], a[4:7], v[24:27]
 ds_read_b128 a[36:39], v200 offset:17408
 buffer_load_dwordx4 v210, s[12:15], s45 offen offset:1024  lds
 v_mfma_f32_16x16x32_bf16 v[28:31], a[28:31], a[4:7], v[28:31]
 ds_read_b64_tr_b16 a[56:57], v204 offset:16384
 v_mfma_f32_16x16x32_bf16 v[12:15], a[28:31], a[0:3], v[12:15]
 ds_read_b64_tr_b16 a[58:59], v204 offset:24576
 v_mfma_f32_16x16x32_bf16 v[44:47], a[28:31], a[8:11], v[44:47]
 ds_read_b128 a[40:43], v200 offset:20480
 buffer_load_dwordx4 v252, s[16:19], s46 offen offset:2048  lds
 v_mfma_f32_16x16x32_bf16 v[60:63], a[28:31], a[12:15], v[60:63]
 ds_read_b64_tr_b16 a[60:61], v205 offset:16384
 v_mfma_f32_16x16x32_bf16 v[56:59], a[24:27], a[12:15], v[56:59]
 ds_read_b64_tr_b16 a[62:63], v205 offset:24576
 v_mfma_f32_16x16x32_bf16 v[40:43], a[24:27], a[8:11], v[40:43]
 ds_read_b128 a[44:47], v200 offset:21504
 buffer_load_dwordx4 v253, s[16:19], s46 offen offset:3072  lds
 s_add_u32 s45, s45, 8192
 s_add_u32 s46, s46, 65536
 v_mfma_f32_16x16x32_bf16 v[36:39], a[20:23], a[8:11], v[36:39]
 v_mfma_f32_16x16x32_bf16 v[52:55], a[20:23], a[12:15], v[52:55]
 v_mfma_f32_16x16x32_bf16 v[48:51], a[16:19], a[12:15], v[48:51]
 v_mfma_f32_16x16x32_bf16 v[32:35], a[16:19], a[8:11], v[32:35]
 s_waitcnt lgkmcnt(0)
 v_mfma_f32_16x16x32_bf16 v[0:3], a[48:51], a[32:35], v[0:3]
 ds_read_b64_tr_b16 a[16:17], v202 offset:32768
 v_mfma_f32_16x16x32_bf16 v[16:19], a[48:51], a[36:39], v[16:19]
 ds_read_b64_tr_b16 a[18:19], v202 offset:40960
 s_add_u32 m0, s44, 0
 v_mfma_f32_16x16x32_bf16 v[20:23], a[52:55], a[36:39], v[20:23]
 ds_read_b128 a[0:3], v200 offset:32768
 buffer_load_dwordx4 v210, s[12:15], s45 offen  lds
 v_mfma_f32_16x16x32_bf16 v[4:7], a[52:55], a[32:35], v[4:7]
 ds_read_b64_tr_b16 a[20:21], v203 offset:32768
 v_mfma_f32_16x16x32_bf16 v[8:11], a[56:59], a[32:35], v[8:11]
 ds_read_b64_tr_b16 a[22:23], v203 offset:40960
 v_mfma_f32_16x16x32_bf16 v[24:27], a[56:59], a[36:39], v[24:27]
 ds_read_b128 a[4:7], v200 offset:33792
 buffer_load_dwordx4 v210, s[12:15], s45 offen offset:1024  lds
 v_mfma_f32_16x16x32_bf16 v[28:31], a[60:63], a[36:39], v[28:31]
 ds_read_b64_tr_b16 a[24:25], v204 offset:32768
 v_mfma_f32_16x16x32_bf16 v[12:15], a[60:63], a[32:35], v[12:15]
 ds_read_b64_tr_b16 a[26:27], v204 offset:40960
 v_mfma_f32_16x16x32_bf16 v[44:47], a[60:63], a[40:43], v[44:47]
 ds_read_b128 a[8:11], v200 offset:36864
 buffer_load_dwordx4 v252, s[16:19], s46 offen offset:2048  lds
 v_mfma_f32_16x16x32_bf16 v[60:63], a[60:63], a[44:47], v[60:63]
 ds_read_b64_tr_b16 a[28:29], v205 offset:32768
 v_mfma_f32_16x16x32_bf16 v[56:59], a[56:59], a[44:47], v[56:59]
 ds_read_b64_tr_b16 a[30:31], v205 offset:40960
 v_mfma_f32_16x16x32_bf16 v[40:43], a[56:59], a[40:43], v[40:43]
 ds_read_b128 a[12:15], v200 offset:37888
 buffer_load_dwordx4 v253, s[16:19], s46 offen offset:3072  lds
 s_add_u32 s45, s45, 8192
 s_add_u32 s46, s46, 65536
 v_mfma_f32_16x16x32_bf16 v[36:39], a[52:55], a[40:43], v[36:39]
 v_mfma_f32_16x16x32_bf16 v[52:55], a[52:55], a[44:47], v[52:55]
 v_mfma_f32_16x16x32_bf16 v[48:51], a[48:51], a[44:47], v[48:51]
 v_mfma_f32_16x16x32_bf16 v[32:35], a[48:51], a[40:43], v[32:35]
 s_waitcnt lgkmcnt(0)
 s_waitcnt vmcnt(16)
 s_barrier
 v_mfma_f32_16x16x32_bf16 v[0:3], a[16:19], a[0:3], v[0:3]
 ds_read_b64_tr_b16 a[48:49], v202 offset:49152
 v_mfma_f32_16x16x32_bf16 v[16:19], a[16:19], a[4:7], v[16:19]
 ds_read_b64_tr_b16 a[50:51], v202 offset:57344
 s_add_u32 m0, s44, 16384
 v_mfma_f32_16x16x32_bf16 v[20:23], a[20:23], a[4:7], v[20:23]
 ds_read_b128 a[32:35], v200 offset:49152
 buffer_load_dwordx4 v210, s[12:15], s45 offen  lds
 v_mfma_f32_16x16x32_bf16 v[4:7], a[20:23], a[0:3], v[4:7]
 ds_read_b64_tr_b16 a[52:53], v203 offset:49152
 v_mfma_f32_16x16x32_bf16 v[8:11], a[24:27], a[0:3], v[8:11]
 ds_read_b64_tr_b16 a[54:55], v203 offset:57344
 v_mfma_f32_16x16x32_bf16 v[24:27], a[24:27], a[4:7], v[24:27]
 ds_read_b128 a[36:39], v200 offset:50176
 buffer_load_dwordx4 v210, s[12:15], s45 offen offset:1024  lds
 v_mfma_f32_16x16x32_bf16 v[28:31], a[28:31], a[4:7], v[28:31]
 ds_read_b64_tr_b16 a[56:57], v204 offset:49152
 v_mfma_f32_16x16x32_bf16 v[12:15], a[28:31], a[0:3], v[12:15]
 ds_read_b64_tr_b16 a[58:59], v204 offset:57344
 v_mfma_f32_16x16x32_bf16 v[44:47], a[28:31], a[8:11], v[44:47]
 ds_read_b128 a[40:43], v200 offset:53248
 buffer_load_dwordx4 v252, s[16:19], s46 offen offset:2048  lds
 v_mfma_f32_16x16x32_bf16 v[60:63], a[28:31], a[12:15], v[60:63]
 ds_read_b64_tr_b16 a[60:61], v205 offset:49152
 v_mfma_f32_16x16x32_bf16 v[56:59], a[24:27], a[12:15], v[56:59]
 ds_read_b64_tr_b16 a[62:63], v205 offset:57344
 v_mfma_f32_16x16x32_bf16 v[40:43], a[24:27], a[8:11], v[40:43]
 ds_read_b128 a[44:47], v200 offset:54272
 buffer_load_dwordx4 v253, s[16:19], s46 offen offset:3072  lds
 s_add_u32 s45, s45, 8192
 s_add_u32 s46, s46, 65536
 v_mfma_f32_16x16x32_bf16 v[36:39], a[20:23], a[8:11], v[36:39]
 v_mfma_f32_16x16x32_bf16 v[52:55], a[20:23], a[12:15], v[52:55]
 v_mfma_f32_16x16x32_bf16 v[48:51], a[16:19], a[12:15], v[48:51]
 v_mfma_f32_16x16x32_bf16 v[32:35], a[16:19], a[8:11], v[32:35]
 s_waitcnt lgkmcnt(0)
 v_mfma_f32_16x16x32_bf16 v[0:3], a[48:51], a[32:35], v[0:3]
 ds_read_b64_tr_b16 a[16:17], v206 offset:0
 v_mfma_f32_16x16x32_bf16 v[16:19], a[48:51], a[36:39], v[16:19]
 ds_read_b64_tr_b16 a[18:19], v206 offset:8192
 s_add_u32 m0, s44, 32768
 v_mfma_f32_16x16x32_bf16 v[20:23], a[52:55], a[36:39], v[20:23]
 ds_read_b128 a[0:3], v201 offset:0
 buffer_load_dwordx4 v210, s[12:15], s45 offen  lds
 v_mfma_f32_16x16x32_bf16 v[4:7], a[52:55], a[32:35], v[4:7]
 ds_read_b64_tr_b16 a[20:21], v207 offset:0
 v_mfma_f32_16x16x32_bf16 v[8:11], a[56:59], a[32:35], v[8:11]
 ds_read_b64_tr_b16 a[22:23], v207 offset:8192
 v_mfma_f32_16x16x32_bf16 v[24:27], a[56:59], a[36:39], v[24:27]
 ds_read_b128 a[4:7], v201 offset:1024
 buffer_load_dwordx4 v210, s[12:15], s45 offen offset:1024  lds
 v_mfma_f32_16x16x32_bf16 v[28:31], a[60:63], a[36:39], v[28:31]
 ds_read_b64_tr_b16 a[24:25], v208 offset:0
 v_mfma_f32_16x16x32_bf16 v[12:15], a[60:63], a[32:35], v[12:15]
 ds_read_b64_tr_b16 a[26:27], v208 offset:8192
 v_mfma_f32_16x16x32_bf16 v[44:47], a[60:63], a[40:43], v[44:47]
 ds_read_b128 a[8:11], v201 offset:4096
 buffer_load_dwordx4 v252, s[16:19], s46 offen offset:2048  lds
 v_mfma_f32_16x16x32_bf16 v[60:63], a[60:63], a[44:47], v[60:63]
 ds_read_b64_tr_b16 a[28:29], v209 offset:0
 v_mfma_f32_16x16x32_bf16 v[56:59], a[56:59], a[44:47], v[56:59]
 ds_read_b64_tr_b16 a[30:31], v209 offset:8192
 v_mfma_f32_16x16x32_bf16 v[40:43], a[56:59], a[40:43], v[40:43]
 ds_read_b128 a[12:15], v201 offset:5120
 buffer_load_dwordx4 v253, s[16:19], s46 offen offset:3072  lds
 s_add_u32 s45, s45, 8192
 s_add_u32 s46, s46, 65536
 v_mfma_f32_16x16x32_bf16 v[36:39], a[52:55], a[40:43], v[36:39]
 v_mfma_f32_16x16x32_bf16 v[52:55], a[52:55], a[44:47], v[52:55]
 v_mfma_f32_16x16x32_bf16 v[48:51], a[48:51], a[44:47], v[48:51]
 v_mfma_f32_16x16x32_bf16 v[32:35], a[48:51], a[40:43], v[32:35]
 s_waitcnt lgkmcnt(0)
 s_waitcnt vmcnt(16)
 s_barrier
 v_mfma_f32_16x16x32_bf16 v[0:3], a[16:19], a[0:3], v[0:3]
 ds_read_b64_tr_b16 a[48:49], v206 offset:16384
 v_mfma_f32_16x16x32_bf16 v[16:19], a[16:19], a[4:7], v[16:19]
 ds_read_b64_tr_b16 a[50:51], v206 offset:24576
 s_add_u32 m0, s44, 49152
 v_mfma_f32_16x16x32_bf16 v[20:23], a[20:23], a[4:7], v[20:23]
 ds_read_b128 a[32:35], v201 offset:16384
 buffer_load_dwordx4 v210, s[12:15], s45 offen  lds
 v_mfma_f32_16x16x32_bf16 v[4:7], a[20:23], a[0:3], v[4:7]
 ds_read_b64_tr_b16 a[52:53], v207 offset:16384
 v_mfma_f32_16x16x32_bf16 v[8:11], a[24:27], a[0:3], v[8:11]
 ds_read_b64_tr_b16 a[54:55], v207 offset:24576
 v_mfma_f32_16x16x32_bf16 v[24:27], a[24:27], a[4:7], v[24:27]
 ds_read_b128 a[36:39], v201 offset:17408
 buffer_load_dwordx4 v210, s[12:15], s45 offen offset:1024  lds
 v_mfma_f32_16x16x32_bf16 v[28:31], a[28:31], a[4:7], v[28:31]
 ds_read_b64_tr_b16 a[56:57], v208 offset:16384
 v_mfma_f32_16x16x32_bf16 v[12:15], a[28:31], a[0:3], v[12:15]
 ds_read_b64_tr_b16 a[58:59], v208 offset:24576
 v_mfma_f32_16x16x32_bf16 v[44:47], a[28:31], a[8:11], v[44:47]
 ds_read_b128 a[40:43], v201 offset:20480
 buffer_load_dwordx4 v252, s[16:19], s46 offen offset:2048  lds
 v_mfma_f32_16x16x32_bf16 v[60:63], a[28:31], a[12:15], v[60:63]
 ds_read_b64_tr_b16 a[60:61], v209 offset:16384
 v_mfma_f32_16x16x32_bf16 v[56:59], a[24:27], a[12:15], v[56:59]
 ds_read_b64_tr_b16 a[62:63], v209 offset:24576
 v_mfma_f32_16x16x32_bf16 v[40:43], a[24:27], a[8:11], v[40:43]
 ds_read_b128 a[44:47], v201 offset:21504
 buffer_load_dwordx4 v253, s[16:19], s46 offen offset:3072  lds
 s_add_u32 s45, s45, 8192
 s_add_u32 s46, s46, 65536
 v_mfma_f32_16x16x32_bf16 v[36:39], a[20:23], a[8:11], v[36:39]
 v_mfma_f32_16x16x32_bf16 v[52:55], a[20:23], a[12:15], v[52:55]
 v_mfma_f32_16x16x32_bf16 v[48:51], a[16:19], a[12:15], v[48:51]
 v_mfma_f32_16x16x32_bf16 v[32:35], a[16:19], a[8:11], v[32:35]
 s_waitcnt lgkmcnt(0)
 v_mfma_f32_16x16x32_bf16 v[0:3], a[48:51], a[32:35], v[0:3]
 ds_read_b64_tr_b16 a[16:17], v206 offset:32768
 v_mfma_f32_16x16x32_bf16 v[16:19], a[48:51], a[36:39], v[16:19]
 ds_read_b64_tr_b16 a[18:19], v206 offset:40960
 s_add_u32 m0, s44, 65536
 v_mfma_f32_16x16x32_bf16 v[20:23], a[52:55], a[36:39], v[20:23]
 ds_read_b128 a[0:3], v201 offset:32768
 buffer_load_dwordx4 v210, s[12:15], s45 offen  lds
 v_mfma_f32_16x16x32_bf16 v[4:7], a[52:55], a[32:35], v[4:7]
 ds_read_b64_tr_b16 a[20:21], v207 offset:32768
 v_mfma_f32_16x16x32_bf16 v[8:11], a[56:59], a[32:35], v[8:11]
 ds_read_b64_tr_b16 a[22:23], v207 offset:40960
 v_mfma_f32_16x16x32_bf16 v[24:27], a[56:59], a[36:39], v[24:27]
 ds_read_b128 a[4:7], v201 offset:33792
 buffer_load_dwordx4 v210, s[12:15], s45 offen offset:1024  lds
 v_mfma_f32_16x16x32_bf16 v[28:31], a[60:63], a[36:39], v[28:31]
 ds_read_b64_tr_b16 a[24:25], v208 offset:32768
 v_mfma_f32_16x16x32_bf16 v[12:15], a[60:63], a[32:35], v[12:15]
 ds_read_b64_tr_b16 a[26:27], v208 offset:40960
 v_mfma_f32_16x16x32_bf16 v[44:47], a[60:63], a[40:43], v[44:47]
 ds_read_b128 a[8:11], v201 offset:36864
 buffer_load_dwordx4 v252, s[16:19], s46 offen offset:2048  lds
 v_mfma_f32_16x16x32_bf16 v[60:63], a[60:63], a[44:47], v[60:63]
 ds_read_b64_tr_b16 a[28:29], v209 offset:32768
 v_mfma_f32_16x16x32_bf16 v[56:59], a[56:59], a[44:47], v[56:59]
 ds_read_b64_tr_b16 a[30:31], v209 offset:40960
 v_mfma_f32_16x16x32_bf16 v[40:43], a[56:59], a[40:43], v[40:43]
 ds_read_b128 a[12:15], v201 offset:37888
 buffer_load_dwordx4 v253, s[16:19], s46 offen offset:3072  lds
 s_add_u32 s45, s45, 8192
 s_add_u32 s46, s46, 65536
 v_mfma_f32_16x16x32_bf16 v[36:39], a[52:55], a[40:43], v[36:39]
 v_mfma_f32_16x16x32_bf16 v[52:55], a[52:55], a[44:47], v[52:55]
 v_mfma_f32_16x16x32_bf16 v[48:51], a[48:51], a[44:47], v[48:51]
 v_mfma_f32_16x16x32_bf16 v[32:35], a[48:51], a[40:43], v[32:35]
 s_waitcnt lgkmcnt(0)
 s_waitcnt vmcnt(16)
 s_barrier
 v_mfma_f32_16x16x32_bf16 v[64:67], a[16:19], a[0:3], 0
 ds_read_b64_tr_b16 a[48:49], v206 offset:49152
 v_mfma_f32_16x16x32_bf16 v[80:83], a[16:19], a[4:7], 0
 ds_read_b64_tr_b16 a[50:51], v206 offset:57344
 s_add_u32 m0, s44, 81920
 v_mfma_f32_16x16x32_bf16 v[84:87], a[20:23], a[4:7], 0
 ds_read_b128 a[32:35], v201 offset:49152
 buffer_load_dwordx4 v210, s[12:15], s45 offen  lds
 v_mfma_f32_16x16x32_bf16 v[68:71], a[20:23], a[0:3], 0
 ds_read_b64_tr_b16 a[52:53], v207 offset:49152
 v_mfma_f32_16x16x32_bf16 v[72:75], a[24:27], a[0:3], 0
 ds_read_b64_tr_b16 a[54:55], v207 offset:57344
 v_mfma_f32_16x16x32_bf16 v[88:91], a[24:27], a[4:7], 0
 ds_read_b128 a[36:39], v201 offset:50176
 buffer_load_dwordx4 v210, s[12:15], s45 offen offset:1024  lds
 v_mfma_f32_16x16x32_bf16 v[92:95], a[28:31], a[4:7], 0
 ds_read_b64_tr_b16 a[56:57], v208 offset:49152
 v_mfma_f32_16x16x32_bf16 v[76:79], a[28:31], a[0:3], 0
 ds_read_b64_tr_b16 a[58:59], v208 offset:57344
 v_mfma_f32_16x16x32_bf16 v[108:111], a[28:31], a[8:11], 0
 ds_read_b128 a[40:43], v201 offset:53248
 buffer_load_dwordx4 v252, s[16:19], s46 offen offset:2048  lds
 v_mfma_f32_16x16x32_bf16 v[124:127], a[28:31], a[12:15], 0
 ds_read_b64_tr_b16 a[60:61], v209 offset:49152
 v_mfma_f32_16x16x32_bf16 v[120:123], a[24:27], a[12:15], 0
 ds_read_b64_tr_b16 a[62:63], v209 offset:57344
 v_mfma_f32_16x16x32_bf16 v[104:107], a[24:27], a[8:11], 0
 ds_read_b128 a[44:47], v201 offset:54272
 buffer_load_dwordx4 v253, s[16:19], s46 offen offset:3072  lds
 s_add_u32 s45, s45, 8192
 s_add_u32 s46, s46, 65536
 v_mfma_f32_16x16x32_bf16 v[100:103], a[20:23], a[8:11], 0
 v_mfma_f32_16x16x32_bf16 v[116:119], a[20:23], a[12:15], 0
 v_mfma_f32_16x16x32_bf16 v[112:115], a[16:19], a[12:15], 0
 v_mfma_f32_16x16x32_bf16 v[96:99], a[16:19], a[8:11], 0
 s_waitcnt lgkmcnt(0)
 v_mfma_f32_16x16x32_bf16 v[64:67], a[48:51], a[32:35], v[64:67]
 ds_read_b64_tr_b16 a[16:17], v202 offset:0
 v_mfma_f32_16x16x32_bf16 v[80:83], a[48:51], a[36:39], v[80:83]
 ds_read_b64_tr_b16 a[18:19], v202 offset:8192
 s_add_u32 m0, s44, 98304
 v_mfma_f32_16x16x32_bf16 v[84:87], a[52:55], a[36:39], v[84:87]
 ds_read_b128 a[0:3], v200 offset:0
 buffer_load_dwordx4 v210, s[12:15], s45 offen  lds
 v_mfma_f32_16x16x32_bf16 v[68:71], a[52:55], a[32:35], v[68:71]
 ds_read_b64_tr_b16 a[20:21], v203 offset:0
 v_mfma_f32_16x16x32_bf16 v[72:75], a[56:59], a[32:35], v[72:75]
 ds_read_b64_tr_b16 a[22:23], v203 offset:8192
 v_mfma_f32_16x16x32_bf16 v[88:91], a[56:59], a[36:39], v[88:91]
 ds_read_b128 a[4:7], v200 offset:1024
 buffer_load_dwordx4 v210, s[12:15], s45 offen offset:1024  lds
 v_mfma_f32_16x16x32_bf16 v[92:95], a[60:63], a[36:39], v[92:95]
 ds_read_b64_tr_b16 a[24:25], v204 offset:0
 v_mfma_f32_16x16x32_bf16 v[76:79], a[60:63], a[32:35], v[76:79]
 ds_read_b64_tr_b16 a[26:27], v204 offset:8192
 v_mfma_f32_16x16x32_bf16 v[108:111], a[60:63], a[40:43], v[108:111]
 ds_read_b128 a[8:11], v200 offset:4096
 buffer_load_dwordx4 v252, s[16:19], s46 offen offset:2048  lds
 v_mfma_f32_16x16x32_bf16 v[124:127], a[60:63], a[44:47], v[124:127]
 ds_read_b64_tr_b16 a[28:29], v205 offset:0
 v_mfma_f32_16x16x32_bf16 v[120:123], a[56:59], a[44:47], v[120:123]
 ds_read_b64_tr_b16 a[30:31], v205 offset:8192
 v_mfma_f32_16x16x32_bf16 v[104:107], a[56:59], a[40:43], v[104:107]
 ds_read_b128 a[12:15], v200 offset:5120
 buffer_load_dwordx4 v253, s[16:19], s46 offen offset:3072  lds
 s_add_u32 s45, s45, 8192
 s_add_u32 s46, s46, 65536
 v_mfma_f32_16x16x32_bf16 v[100:103], a[52:55], a[40:43], v[100:103]
 v_mfma_f32_16x16x32_bf16 v[116:119], a[52:55], a[44:47], v[116:119]
 v_mfma_f32_16x16x32_bf16 v[112:115], a[48:51], a[44:47], v[112:115]
 v_mfma_f32_16x16x32_bf16 v[96:99], a[48:51], a[40:43], v[96:99]
 s_mov_b32 s47, 5
.p2align 6
L2F_loop:
 s_waitcnt lgkmcnt(0)
 s_waitcnt vmcnt(16)
 s_barrier
 v_mfma_f32_16x16x32_bf16 v[64:67], a[16:19], a[0:3], v[64:67]
 ds_read_b64_tr_b16 a[48:49], v202 offset:16384
 v_mfma_f32_16x16x32_bf16 v[80:83], a[16:19], a[4:7], v[80:83]
 ds_read_b64_tr_b16 a[50:51], v202 offset:24576
 s_add_u32 m0, s44, 114688
 v_mfma_f32_16x16x32_bf16 v[84:87], a[20:23], a[4:7], v[84:87]
 ds_read_b128 a[32:35], v200 offset:16384
 buffer_load_dwordx4 v210, s[12:15], s45 offen  lds
 v_mfma_f32_16x16x32_bf16 v[68:71], a[20:23], a[0:3], v[68:71]
 ds_read_b64_tr_b16 a[52:53], v203 offset:16384
 v_mfma_f32_16x16x32_bf16 v[72:75], a[24:27], a[0:3], v[72:75]
 ds_read_b64_tr_b16 a[54:55], v203 offset:24576
 v_mfma_f32_16x16x32_bf16 v[88:91], a[24:27], a[4:7], v[88:91]
 ds_read_b128 a[36:39], v200 offset:17408
 buffer_load_dwordx4 v210, s[12:15], s45 offen offset:1024  lds
 v_mfma_f32_16x16x32_bf16 v[92:95], a[28:31], a[4:7], v[92:95]
 ds_read_b64_tr_b16 a[56:57], v204 offset:16384
 v_mfma_f32_16x16x32_bf16 v[76:79], a[28:31], a[0:3], v[76:79]
 ds_read_b64_tr_b16 a[58:59], v204 offset:24576
 v_mfma_f32_16x16x32_bf16 v[108:111], a[28:31], a[8:11], v[108:111]
 ds_read_b128 a[40:43], v200 offset:20480
 buffer_load_dwordx4 v252, s[16:19], s46 offen offset:2048  lds
 v_mfma_f32_16x16x32_bf16 v[124:127], a[28:31], a[12:15], v[124:127]
 ds_read_b64_tr_b16 a[60:61], v205 offset:16384
 v_mfma_f32_16x16x32_bf16 v[120:123], a[24:27], a[12:15], v[120:123]
 ds_read_b64_tr_b16 a[62:63], v205 offset:24576
 v_mfma_f32_16x16x32_bf16 v[104:107], a[24:27], a[8:11], v[104:107]
 ds_read_b128 a[44:47], v200 offset:21504
 buffer_load_dwordx4 v253, s[16:19], s46 offen offset:3072  lds
 s_add_u32 s45, s45, 8192
 s_add_u32 s46, s46, 65536
 v_mfma_f32_16x16x32_bf16 v[100:103], a[20:23], a[8:11], v[100:103]
 v_mfma_f32_16x16x32_bf16 v[116:119], a[20:23], a[12:15], v[116:119]
 v_mfma_f32_16x16x32_bf16 v[112:115], a[16:19], a[12:15], v[112:115]
 v_mfma_f32_16x16x32_bf16 v[96:99], a[16:19], a[8:11], v[96:99]
 s_waitcnt lgkmcnt(0)
 v_mfma_f32_16x16x32_bf16 v[64:67], a[48:51], a[32:35], v[64:67]
 ds_read_b64_tr_b16 a[16:17], v202 offset:32768
 v_mfma_f32_16x16x32_bf16 v[80:83], a[48:51], a[36:39], v[80:83]
 ds_read_b64_tr_b16 a[18:19], v202 offset:40960
 s_add_u32 m0, s44, 0
 v_mfma_f32_16x16x32_bf16 v[84:87], a[52:55], a[36:39], v[84:87]
 ds_read_b128 a[0:3], v200 offset:32768
 buffer_load_dwordx4 v210, s[12:15], s45 offen  lds
 v_mfma_f32_16x16x32_bf16 v[68:71], a[52:55], a[32:35], v[68:71]
 ds_read_b64_tr_b16 a[20:21], v203 offset:32768
 v_mfma_f32_16x16x32_bf16 v[72:75], a[56:59], a[32:35], v[72:75]
 ds_read_b64_tr_b16 a[22:23], v203 offset:40960
 v_mfma_f32_16x16x32_bf16 v[88:91], a[56:59], a[36:39], v[88:91]
 ds_read_b128 a[4:7], v200 offset:33792
 buffer_load_dwordx4 v210, s[12:15], s45 offen offset:1024  lds
 v_mfma_f32_16x16x32_bf16 v[92:95], a[60:63], a[36:39], v[92:95]
 ds_read_b64_tr_b16 a[24:25], v204 offset:32768
 v_mfma_f32_16x16x32_bf16 v[76:79], a[60:63], a[32:35], v[76:79]
 ds_read_b64_tr_b16 a[26:27], v204 offset:40960
 v_mfma_f32_16x16x32_bf16 v[108:111], a[60:63], a[40:43], v[108:111]
 ds_read_b128 a[8:11], v200 offset:36864
 buffer_load_dwordx4 v252, s[16:19], s46 offen offset:2048  lds
 v_mfma_f32_16x16x32_bf16 v[124:127], a[60:63], a[44:47], v[124:127]
 ds_read_b64_tr_b16 a[28:29], v205 offset:32768
 v_mfma_f32_16x16x32_bf16 v[120:123], a[56:59], a[44:47], v[120:123]
 ds_read_b64_tr_b16 a[30:31], v205 offset:40960
 v_mfma_f32_16x16x32_bf16 v[104:107], a[56:59], a[40:43], v[104:107]
 ds_read_b128 a[12:15], v200 offset:37888
 buffer_load_dwordx4 v253, s[16:19], s46 offen offset:3072  lds
 s_add_u32 s45, s45, 8192
 s_add_u32 s46, s46, 65536
 v_mfma_f32_16x16x32_bf16 v[100:103], a[52:55], a[40:43], v[100:103]
 v_mfma_f32_16x16x32_bf16 v[116:119], a[52:55], a[44:47], v[116:119]
 v_mfma_f32_16x16x32_bf16 v[112:115], a[48:51], a[44:47], v[112:115]
 v_mfma_f32_16x16x32_bf16 v[96:99], a[48:51], a[40:43], v[96:99]
 s_waitcnt lgkmcnt(0)
 s_waitcnt vmcnt(16)
 s_barrier
 v_mfma_f32_16x16x32_bf16 v[64:67], a[16:19], a[0:3], v[64:67]
 ds_read_b64_tr_b16 a[48:49], v202 offset:49152
 v_mfma_f32_16x16x32_bf16 v[80:83], a[16:19], a[4:7], v[80:83]
 ds_read_b64_tr_b16 a[50:51], v202 offset:57344
 s_add_u32 m0, s44, 16384
 v_mfma_f32_16x16x32_bf16 v[84:87], a[20:23], a[4:7], v[84:87]
 ds_read_b128 a[32:35], v200 offset:49152
 buffer_load_dwordx4 v210, s[12:15], s45 offen  lds
 v_mfma_f32_16x16x32_bf16 v[68:71], a[20:23], a[0:3], v[68:71]
 ds_read_b64_tr_b16 a[52:53], v203 offset:49152
 v_mfma_f32_16x16x32_bf16 v[72:75], a[24:27], a[0:3], v[72:75]
 ds_read_b64_tr_b16 a[54:55], v203 offset:57344
 v_mfma_f32_16x16x32_bf16 v[88:91], a[24:27], a[4:7], v[88:91]
 ds_read_b128 a[36:39], v200 offset:50176
 buffer_load_dwordx4 v210, s[12:15], s45 offen offset:1024  lds
 v_mfma_f32_16x16x32_bf16 v[92:95], a[28:31], a[4:7], v[92:95]
 ds_read_b64_tr_b16 a[56:57], v204 offset:49152
 v_mfma_f32_16x16x32_bf16 v[76:79], a[28:31], a[0:3], v[76:79]
 ds_read_b64_tr_b16 a[58:59], v204 offset:57344
 v_mfma_f32_16x16x32_bf16 v[108:111], a[28:31], a[8:11], v[108:111]
 ds_read_b128 a[40:43], v200 offset:53248
 buffer_load_dwordx4 v252, s[16:19], s46 offen offset:2048  lds
 v_mfma_f32_16x16x32_bf16 v[124:127], a[28:31], a[12:15], v[124:127]
 ds_read_b64_tr_b16 a[60:61], v205 offset:49152
 v_mfma_f32_16x16x32_bf16 v[120:123], a[24:27], a[12:15], v[120:123]
 ds_read_b64_tr_b16 a[62:63], v205 offset:57344
 v_mfma_f32_16x16x32_bf16 v[104:107], a[24:27], a[8:11], v[104:107]
 ds_read_b128 a[44:47], v200 offset:54272
 buffer_load_dwordx4 v253, s[16:19], s46 offen offset:3072  lds
 s_add_u32 s45, s45, 8192
 s_add_u32 s46, s46, 65536
 v_mfma_f32_16x16x32_bf16 v[100:103], a[20:23], a[8:11], v[100:103]
 v_mfma_f32_16x16x32_bf16 v[116:119], a[20:23], a[12:15], v[116:119]
 v_mfma_f32_16x16x32_bf16 v[112:115], a[16:19], a[12:15], v[112:115]
 v_mfma_f32_16x16x32_bf16 v[96:99], a[16:19], a[8:11], v[96:99]
 s_waitcnt lgkmcnt(0)
 v_mfma_f32_16x16x32_bf16 v[64:67], a[48:51], a[32:35], v[64:67]
 ds_read_b64_tr_b16 a[16:17], v206 offset:0
 v_mfma_f32_16x16x32_bf16 v[80:83], a[48:51], a[36:39], v[80:83]
 ds_read_b64_tr_b16 a[18:19], v206 offset:8192
 s_add_u32 m0, s44, 32768
 v_mfma_f32_16x16x32_bf16 v[84:87], a[52:55], a[36:39], v[84:87]
 ds_read_b128 a[0:3], v201 offset:0
 buffer_load_dwordx4 v210, s[12:15], s45 offen  lds
 v_mfma_f32_16x16x32_bf16 v[68:71], a[52:55], a[32:35], v[68:71]
 ds_read_b64_tr_b16 a[20:21], v207 offset:0
 v_mfma_f32_16x16x32_bf16 v[72:75], a[56:59], a[32:35], v[72:75]
 ds_read_b64_tr_b16 a[22:23], v207 offset:8192
 v_mfma_f32_16x16x32_bf16 v[88:91], a[56:59], a[36:39], v[88:91]
 ds_read_b128 a[4:7], v201 offset:1024
 buffer_load_dwordx4 v210, s[12:15], s45 offen offset:1024  lds
 v_mfma_f32_16x16x32_bf16 v[92:95], a[60:63], a[36:39], v[92:95]
 ds_read_b64_tr_b16 a[24:25], v208 offset:0
 v_mfma_f32_16x16x32_bf16 v[76:79], a[60:63], a[32:35], v[76:79]
 ds_read_b64_tr_b16 a[26:27], v208 offset:8192
 v_mfma_f32_16x16x32_bf16 v[108:111], a[60:63], a[40:43], v[108:111]
 ds_read_b128 a[8:11], v201 offset:4096
 buffer_load_dwordx4 v252, s[16:19], s46 offen offset:2048  lds
 v_mfma_f32_16x16x32_bf16 v[124:127], a[60:63], a[44:47], v[124:127]
 ds_read_b64_tr_b16 a[28:29], v209 offset:0
 v_mfma_f32_16x16x32_bf16 v[120:123], a[56:59], a[44:47], v[120:123]
 ds_read_b64_tr_b16 a[30:31], v209 offset:8192
 v_mfma_f32_16x16x32_bf16 v[104:107], a[56:59], a[40:43], v[104:107]
 ds_read_b128 a[12:15], v201 offset:5120
 buffer_load_dwordx4 v253, s[16:19], s46 offen offset:3072  lds
 s_add_u32 s45, s45, 8192
 s_add_u32 s46, s46, 65536
 v_mfma_f32_16x16x32_bf16 v[100:103], a[52:55], a[40:43], v[100:103]
 v_mfma_f32_16x16x32_bf16 v[116:119], a[52:55], a[44:47], v[116:119]
 v_mfma_f32_16x16x32_bf16 v[112:115], a[48:51], a[44:47], v[112:115]
 v_mfma_f32_16x16x32_bf16 v[96:99], a[48:51], a[40:43], v[96:99]
 s_waitcnt lgkmcnt(0)
 s_waitcnt vmcnt(16)
 s_barrier
 v_mfma_f32_16x16x32_bf16 v[64:67], a[16:19], a[0:3], v[64:67]
 ds_read_b64_tr_b16 a[48:49], v206 offset:16384
 v_mfma_f32_16x16x32_bf16 v[80:83], a[16:19], a[4:7], v[80:83]
 ds_read_b64_tr_b16 a[50:51], v206 offset:24576
 s_add_u32 m0, s44, 49152
 v_mfma_f32_16x16x32_bf16 v[84:87], a[20:23], a[4:7], v[84:87]
 ds_read_b128 a[32:35], v201 offset:16384
 buffer_load_dwordx4 v210, s[12:15], s45 offen  lds
 v_mfma_f32_16x16x32_bf16 v[68:71], a[20:23], a[0:3], v[68:71]
 ds_read_b64_tr_b16 a[52:53], v207 offset:16384
 v_mfma_f32_16x16x32_bf16 v[72:75], a[24:27], a[0:3], v[72:75]
 ds_read_b64_tr_b16 a[54:55], v207 offset:24576
 v_mfma_f32_16x16x32_bf16 v[88:91], a[24:27], a[4:7], v[88:91]
 ds_read_b128 a[36:39], v201 offset:17408
 buffer_load_dwordx4 v210, s[12:15], s45 offen offset:1024  lds
 v_mfma_f32_16x16x32_bf16 v[92:95], a[28:31], a[4:7], v[92:95]
 ds_read_b64_tr_b16 a[56:57], v208 offset:16384
 v_mfma_f32_16x16x32_bf16 v[76:79], a[28:31], a[0:3], v[76:79]
 ds_read_b64_tr_b16 a[58:59], v208 offset:24576
 v_mfma_f32_16x16x32_bf16 v[108:111], a[28:31], a[8:11], v[108:111]
 ds_read_b128 a[40:43], v201 offset:20480
 buffer_load_dwordx4 v252, s[16:19], s46 offen offset:2048  lds
 v_mfma_f32_16x16x32_bf16 v[124:127], a[28:31], a[12:15], v[124:127]
 ds_read_b64_tr_b16 a[60:61], v209 offset:16384
 v_mfma_f32_16x16x32_bf16 v[120:123], a[24:27], a[12:15], v[120:123]
 ds_read_b64_tr_b16 a[62:63], v209 offset:24576
 v_mfma_f32_16x16x32_bf16 v[104:107], a[24:27], a[8:11], v[104:107]
 ds_read_b128 a[44:47], v201 offset:21504
 buffer_load_dwordx4 v253, s[16:19], s46 offen offset:3072  lds
 s_add_u32 s45, s45, 8192
 s_add_u32 s46, s46, 65536
 v_mfma_f32_16x16x32_bf16 v[100:103], a[20:23], a[8:11], v[100:103]
 v_mfma_f32_16x16x32_bf16 v[116:119], a[20:23], a[12:15], v[116:119]
 v_mfma_f32_16x16x32_bf16 v[112:115], a[16:19], a[12:15], v[112:115]
 v_mfma_f32_16x16x32_bf16 v[96:99], a[16:19], a[8:11], v[96:99]
 s_waitcnt lgkmcnt(0)
 v_mfma_f32_16x16x32_bf16 v[64:67], a[48:51], a[32:35], v[64:67]
 ds_read_b64_tr_b16 a[16:17], v206 offset:32768
 v_mfma_f32_16x16x32_bf16 v[80:83], a[48:51], a[36:39], v[80:83]
 ds_read_b64_tr_b16 a[18:19], v206 offset:40960
 s_add_u32 m0, s44, 65536
 v_mfma_f32_16x16x32_bf16 v[84:87], a[52:55], a[36:39], v[84:87]
 ds_read_b128 a[0:3], v201 offset:32768
 buffer_load_dwordx4 v210, s[12:15], s45 offen  lds
 v_mfma_f32_16x16x32_bf16 v[68:71], a[52:55], a[32:35], v[68:71]
 ds_read_b64_tr_b16 a[20:21], v207 offset:32768
 v_mfma_f32_16x16x32_bf16 v[72:75], a[56:59], a[32:35], v[72:75]
 ds_read_b64_tr_b16 a[22:23], v207 offset:40960
 v_mfma_f32_16x16x32_bf16 v[88:91], a[56:59], a[36:39], v[88:91]
 ds_read_b128 a[4:7], v201 offset:33792
 buffer_load_dwordx4 v210, s[12:15], s45 offen offset:1024  lds
 v_mfma_f32_16x16x32_bf16 v[92:95], a[60:63], a[36:39], v[92:95]
 ds_read_b64_tr_b16 a[24:25], v208 offset:32768
 v_mfma_f32_16x16x32_bf16 v[76:79], a[60:63], a[32:35], v[76:79]
 ds_read_b64_tr_b16 a[26:27], v208 offset:40960
 v_mfma_f32_16x16x32_bf16 v[108:111], a[60:63], a[40:43], v[108:111]
 ds_read_b128 a[8:11], v201 offset:36864
 buffer_load_dwordx4 v252, s[16:19], s46 offen offset:2048  lds
 v_mfma_f32_16x16x32_bf16 v[124:127], a[60:63], a[44:47], v[124:127]
 ds_read_b64_tr_b16 a[28:29], v209 offset:32768
 v_mfma_f32_16x16x32_bf16 v[120:123], a[56:59], a[44:47], v[120:123]
 ds_read_b64_tr_b16 a[30:31], v209 offset:40960
 v_mfma_f32_16x16x32_bf16 v[104:107], a[56:59], a[40:43], v[104:107]
 ds_read_b128 a[12:15], v201 offset:37888
 buffer_load_dwordx4 v253, s[16:19], s46 offen offset:3072  lds
 s_add_u32 s45, s45, 8192
 s_add_u32 s46, s46, 65536
 v_mfma_f32_16x16x32_bf16 v[100:103], a[52:55], a[40:43], v[100:103]
 v_mfma_f32_16x16x32_bf16 v[116:119], a[52:55], a[44:47], v[116:119]
 v_mfma_f32_16x16x32_bf16 v[112:115], a[48:51], a[44:47], v[112:115]
 v_mfma_f32_16x16x32_bf16 v[96:99], a[48:51], a[40:43], v[96:99]
 s_waitcnt lgkmcnt(0)
 s_waitcnt vmcnt(16)
 s_barrier
 v_mfma_f32_16x16x32_bf16 v[64:67], a[16:19], a[0:3], v[64:67]
 ds_read_b64_tr_b16 a[48:49], v206 offset:49152
 v_mfma_f32_16x16x32_bf16 v[80:83], a[16:19], a[4:7], v[80:83]
 ds_read_b64_tr_b16 a[50:51], v206 offset:57344
 s_add_u32 m0, s44, 81920
 v_mfma_f32_16x16x32_bf16 v[84:87], a[20:23], a[4:7], v[84:87]
 ds_read_b128 a[32:35], v201 offset:49152
 buffer_load_dwordx4 v210, s[12:15], s45 offen  lds
 v_mfma_f32_16x16x32_bf16 v[68:71], a[20:23], a[0:3], v[68:71]
 ds_read_b64_tr_b16 a[52:53], v207 offset:49152
 v_mfma_f32_16x16x32_bf16 v[72:75], a[24:27], a[0:3], v[72:75]
 ds_read_b64_tr_b16 a[54:55], v207 offset:57344
 v_mfma_f32_16x16x32_bf16 v[88:91], a[24:27], a[4:7], v[88:91]
 ds_read_b128 a[36:39], v201 offset:50176
 buffer_load_dwordx4 v210, s[12:15], s45 offen offset:1024  lds
 v_mfma_f32_16x16x32_bf16 v[92:95], a[28:31], a[4:7], v[92:95]
 ds_read_b64_tr_b16 a[56:57], v208 offset:49152
 v_mfma_f32_16x16x32_bf16 v[76:79], a[28:31], a[0:3], v[76:79]
 ds_read_b64_tr_b16 a[58:59], v208 offset:57344
 v_mfma_f32_16x16x32_bf16 v[108:111], a[28:31], a[8:11], v[108:111]
 ds_read_b128 a[40:43], v201 offset:53248
 buffer_load_dwordx4 v252, s[16:19], s46 offen offset:2048  lds
 v_mfma_f32_16x16x32_bf16 v[124:127], a[28:31], a[12:15], v[124:127]
 ds_read_b64_tr_b16 a[60:61], v209 offset:49152
 v_mfma_f32_16x16x32_bf16 v[120:123], a[24:27], a[12:15], v[120:123]
 ds_read_b64_tr_b16 a[62:63], v209 offset:57344
 v_mfma_f32_16x16x32_bf16 v[104:107], a[24:27], a[8:11], v[104:107]
 ds_read_b128 a[44:47], v201 offset:54272
 buffer_load_dwordx4 v253, s[16:19], s46 offen offset:3072  lds
 s_add_u32 s45, s45, 8192
 s_add_u32 s46, s46, 65536
 v_mfma_f32_16x16x32_bf16 v[100:103], a[20:23], a[8:11], v[100:103]
 v_mfma_f32_16x16x32_bf16 v[116:119], a[20:23], a[12:15], v[116:119]
 v_mfma_f32_16x16x32_bf16 v[112:115], a[16:19], a[12:15], v[112:115]
 v_mfma_f32_16x16x32_bf16 v[96:99], a[16:19], a[8:11], v[96:99]
 s_waitcnt lgkmcnt(0)
 v_mfma_f32_16x16x32_bf16 v[64:67], a[48:51], a[32:35], v[64:67]
 ds_read_b64_tr_b16 a[16:17], v202 offset:0
 v_mfma_f32_16x16x32_bf16 v[80:83], a[48:51], a[36:39], v[80:83]
 ds_read_b64_tr_b16 a[18:19], v202 offset:8192
 s_add_u32 m0, s44, 98304
 v_mfma_f32_16x16x32_bf16 v[84:87], a[52:55], a[36:39], v[84:87]
 ds_read_b128 a[0:3], v200 offset:0
 buffer_load_dwordx4 v210, s[12:15], s45 offen  lds
 v_mfma_f32_16x16x32_bf16 v[68:71], a[52:55], a[32:35], v[68:71]
 ds_read_b64_tr_b16 a[20:21], v203 offset:0
 v_mfma_f32_16x16x32_bf16 v[72:75], a[56:59], a[32:35], v[72:75]
 ds_read_b64_tr_b16 a[22:23], v203 offset:8192
 v_mfma_f32_16x16x32_bf16 v[88:91], a[56:59], a[36:39], v[88:91]
 ds_read_b128 a[4:7], v200 offset:1024
 buffer_load_dwordx4 v210, s[12:15], s45 offen offset:1024  lds
 v_mfma_f32_16x16x32_bf16 v[92:95], a[60:63], a[36:39], v[92:95]
 ds_read_b64_tr_b16 a[24:25], v204 offset:0
 v_mfma_f32_16x16x32_bf16 v[76:79], a[60:63], a[32:35], v[76:79]
 ds_read_b64_tr_b16 a[26:27], v204 offset:8192
 v_mfma_f32_16x16x32_bf16 v[108:111], a[60:63], a[40:43], v[108:111]
 ds_read_b128 a[8:11], v200 offset:4096
 buffer_load_dwordx4 v252, s[16:19], s46 offen offset:2048  lds
 v_mfma_f32_16x16x32_bf16 v[124:127], a[60:63], a[44:47], v[124:127]
 ds_read_b64_tr_b16 a[28:29], v205 offset:0
 v_mfma_f32_16x16x32_bf16 v[120:123], a[56:59], a[44:47], v[120:123]
 ds_read_b64_tr_b16 a[30:31], v205 offset:8192
 v_mfma_f32_16x16x32_bf16 v[104:107], a[56:59], a[40:43], v[104:107]
 ds_read_b128 a[12:15], v200 offset:5120
 buffer_load_dwordx4 v253, s[16:19], s46 offen offset:3072  lds
 s_add_u32 s45, s45, 8192
 s_add_u32 s46, s46, 65536
 v_mfma_f32_16x16x32_bf16 v[100:103], a[52:55], a[40:43], v[100:103]
 s_sub_u32 s47, s47, 1
 v_mfma_f32_16x16x32_bf16 v[116:119], a[52:55], a[44:47], v[116:119]
 v_mfma_f32_16x16x32_bf16 v[112:115], a[48:51], a[44:47], v[112:115]
 v_mfma_f32_16x16x32_bf16 v[96:99], a[48:51], a[40:43], v[96:99]
 s_cmp_lg_u32 s47, 0
 s_cbranch_scc1 L2F_loop
 s_waitcnt lgkmcnt(0)
 s_waitcnt vmcnt(16)
 s_barrier
 v_mfma_f32_16x16x32_bf16 v[64:67], a[16:19], a[0:3], v[64:67]
 ds_read_b64_tr_b16 a[48:49], v202 offset:16384
 v_mfma_f32_16x16x32_bf16 v[80:83], a[16:19], a[4:7], v[80:83]
 ds_read_b64_tr_b16 a[50:51], v202 offset:24576
 s_add_u32 m0, s44, 114688
 v_mfma_f32_16x16x32_bf16 v[84:87], a[20:23], a[4:7], v[84:87]
 ds_read_b128 a[32:35], v200 offset:16384
 buffer_load_dwordx4 v210, s[12:15], s45 offen  lds
 v_mfma_f32_16x16x32_bf16 v[68:71], a[20:23], a[0:3], v[68:71]
 ds_read_b64_tr_b16 a[52:53], v203 offset:16384
 v_mfma_f32_16x16x32_bf16 v[72:75], a[24:27], a[0:3], v[72:75]
 ds_read_b64_tr_b16 a[54:55], v203 offset:24576
 v_mfma_f32_16x16x32_bf16 v[88:91], a[24:27], a[4:7], v[88:91]
 ds_read_b128 a[36:39], v200 offset:17408
 buffer_load_dwordx4 v210, s[12:15], s45 offen offset:1024  lds
 v_mfma_f32_16x16x32_bf16 v[92:95], a[28:31], a[4:7], v[92:95]
 ds_read_b64_tr_b16 a[56:57], v204 offset:16384
 v_mfma_f32_16x16x32_bf16 v[76:79], a[28:31], a[0:3], v[76:79]
 ds_read_b64_tr_b16 a[58:59], v204 offset:24576
 v_mfma_f32_16x16x32_bf16 v[108:111], a[28:31], a[8:11], v[108:111]
 ds_read_b128 a[40:43], v200 offset:20480
 buffer_load_dwordx4 v252, s[16:19], s46 offen offset:2048  lds
 v_mfma_f32_16x16x32_bf16 v[124:127], a[28:31], a[12:15], v[124:127]
 ds_read_b64_tr_b16 a[60:61], v205 offset:16384
 v_mfma_f32_16x16x32_bf16 v[120:123], a[24:27], a[12:15], v[120:123]
 ds_read_b64_tr_b16 a[62:63], v205 offset:24576
 v_mfma_f32_16x16x32_bf16 v[104:107], a[24:27], a[8:11], v[104:107]
 ds_read_b128 a[44:47], v200 offset:21504
 buffer_load_dwordx4 v253, s[16:19], s46 offen offset:3072  lds
 s_add_u32 s45, s45, 8192
 s_add_u32 s46, s46, 65536
 v_mfma_f32_16x16x32_bf16 v[100:103], a[20:23], a[8:11], v[100:103]
 v_mfma_f32_16x16x32_bf16 v[116:119], a[20:23], a[12:15], v[116:119]
 v_mfma_f32_16x16x32_bf16 v[112:115], a[16:19], a[12:15], v[112:115]
 v_mfma_f32_16x16x32_bf16 v[96:99], a[16:19], a[8:11], v[96:99]
 s_waitcnt lgkmcnt(0)
 v_mfma_f32_16x16x32_bf16 v[64:67], a[48:51], a[32:35], v[64:67]
 ds_read_b64_tr_b16 a[16:17], v202 offset:32768
 v_mfma_f32_16x16x32_bf16 v[80:83], a[48:51], a[36:39], v[80:83]
 ds_read_b64_tr_b16 a[18:19], v202 offset:40960
 s_add_u32 m0, s44, 0
 v_mfma_f32_16x16x32_bf16 v[84:87], a[52:55], a[36:39], v[84:87]
 ds_read_b128 a[0:3], v200 offset:32768
 buffer_load_dwordx4 v210, s[12:15], s45 offen  lds
 v_mfma_f32_16x16x32_bf16 v[68:71], a[52:55], a[32:35], v[68:71]
 ds_read_b64_tr_b16 a[20:21], v203 offset:32768
 v_mfma_f32_16x16x32_bf16 v[72:75], a[56:59], a[32:35], v[72:75]
 ds_read_b64_tr_b16 a[22:23], v203 offset:40960
 v_mfma_f32_16x16x32_bf16 v[88:91], a[56:59], a[36:39], v[88:91]
 ds_read_b128 a[4:7], v200 offset:33792
 buffer_load_dwordx4 v210, s[12:15], s45 offen offset:1024  lds
 v_mfma_f32_16x16x32_bf16 v[92:95], a[60:63], a[36:39], v[92:95]
 ds_read_b64_tr_b16 a[24:25], v204 offset:32768
 v_mfma_f32_16x16x32_bf16 v[76:79], a[60:63], a[32:35], v[76:79]
 ds_read_b64_tr_b16 a[26:27], v204 offset:40960
 v_mfma_f32_16x16x32_bf16 v[108:111], a[60:63], a[40:43], v[108:111]
 ds_read_b128 a[8:11], v200 offset:36864
 buffer_load_dwordx4 v252, s[16:19], s46 offen offset:2048  lds
 v_mfma_f32_16x16x32_bf16 v[124:127], a[60:63], a[44:47], v[124:127]
 ds_read_b64_tr_b16 a[28:29], v205 offset:32768
 v_mfma_f32_16x16x32_bf16 v[120:123], a[56:59], a[44:47], v[120:123]
 ds_read_b64_tr_b16 a[30:31], v205 offset:40960
 v_mfma_f32_16x16x32_bf16 v[104:107], a[56:59], a[40:43], v[104:107]
 ds_read_b128 a[12:15], v200 offset:37888
 buffer_load_dwordx4 v253, s[16:19], s46 offen offset:3072  lds
 s_add_u32 s45, s45, 8192
 s_add_u32 s46, s46, 65536
 v_mfma_f32_16x16x32_bf16 v[100:103], a[52:55], a[40:43], v[100:103]
 v_mfma_f32_16x16x32_bf16 v[116:119], a[52:55], a[44:47], v[116:119]
 v_mfma_f32_16x16x32_bf16 v[112:115], a[48:51], a[44:47], v[112:115]
 v_mfma_f32_16x16x32_bf16 v[96:99], a[48:51], a[40:43], v[96:99]
 s_waitcnt lgkmcnt(0)
 s_waitcnt vmcnt(16)
 s_barrier
 v_mfma_f32_16x16x32_bf16 v[64:67], a[16:19], a[0:3], v[64:67]
 ds_read_b64_tr_b16 a[48:49], v202 offset:49152
 v_mfma_f32_16x16x32_bf16 v[80:83], a[16:19], a[4:7], v[80:83]
 ds_read_b64_tr_b16 a[50:51], v202 offset:57344
 s_add_u32 m0, s44, 16384
 v_mfma_f32_16x16x32_bf16 v[84:87], a[20:23], a[4:7], v[84:87]
 ds_read_b128 a[32:35], v200 offset:49152
 buffer_load_dwordx4 v210, s[12:15], s45 offen  lds
 v_mfma_f32_16x16x32_bf16 v[68:71], a[20:23], a[0:3], v[68:71]
 ds_read_b64_tr_b16 a[52:53], v203 offset:49152
 v_mfma_f32_16x16x32_bf16 v[72:75], a[24:27], a[0:3], v[72:75]
 ds_read_b64_tr_b16 a[54:55], v203 offset:57344
 v_mfma_f32_16x16x32_bf16 v[88:91], a[24:27], a[4:7], v[88:91]
 ds_read_b128 a[36:39], v200 offset:50176
 buffer_load_dwordx4 v210, s[12:15], s45 offen offset:1024  lds
 v_mfma_f32_16x16x32_bf16 v[92:95], a[28:31], a[4:7], v[92:95]
 ds_read_b64_tr_b16 a[56:57], v204 offset:49152
 v_mfma_f32_16x16x32_bf16 v[76:79], a[28:31], a[0:3], v[76:79]
 ds_read_b64_tr_b16 a[58:59], v204 offset:57344
 v_mfma_f32_16x16x32_bf16 v[108:111], a[28:31], a[8:11], v[108:111]
 ds_read_b128 a[40:43], v200 offset:53248
 buffer_load_dwordx4 v252, s[16:19], s46 offen offset:2048  lds
 v_mfma_f32_16x16x32_bf16 v[124:127], a[28:31], a[12:15], v[124:127]
 ds_read_b64_tr_b16 a[60:61], v205 offset:49152
 v_mfma_f32_16x16x32_bf16 v[120:123], a[24:27], a[12:15], v[120:123]
 ds_read_b64_tr_b16 a[62:63], v205 offset:57344
 v_mfma_f32_16x16x32_bf16 v[104:107], a[24:27], a[8:11], v[104:107]
 ds_read_b128 a[44:47], v200 offset:54272
 buffer_load_dwordx4 v253, s[16:19], s46 offen offset:3072  lds
 s_add_u32 s45, s45, 8192
 s_add_u32 s46, s46, 65536
 v_mfma_f32_16x16x32_bf16 v[100:103], a[20:23], a[8:11], v[100:103]
 v_mfma_f32_16x16x32_bf16 v[116:119], a[20:23], a[12:15], v[116:119]
 v_mfma_f32_16x16x32_bf16 v[112:115], a[16:19], a[12:15], v[112:115]
 v_mfma_f32_16x16x32_bf16 v[96:99], a[16:19], a[8:11], v[96:99]
 s_waitcnt lgkmcnt(0)
 v_mfma_f32_16x16x32_bf16 v[64:67], a[48:51], a[32:35], v[64:67]
 ds_read_b64_tr_b16 a[16:17], v206 offset:0
 v_mfma_f32_16x16x32_bf16 v[80:83], a[48:51], a[36:39], v[80:83]
 ds_read_b64_tr_b16 a[18:19], v206 offset:8192
 s_add_u32 m0, s44, 32768
 v_mfma_f32_16x16x32_bf16 v[84:87], a[52:55], a[36:39], v[84:87]
 ds_read_b128 a[0:3], v201 offset:0
 buffer_load_dwordx4 v210, s[12:15], s45 offen  lds
 v_mfma_f32_16x16x32_bf16 v[68:71], a[52:55], a[32:35], v[68:71]
 ds_read_b64_tr_b16 a[20:21], v207 offset:0
 v_mfma_f32_16x16x32_bf16 v[72:75], a[56:59], a[32:35], v[72:75]
 ds_read_b64_tr_b16 a[22:23], v207 offset:8192
 buffer_load_dwordx4 v210, s[12:15], s45 offen offset:1024  lds
 v_mfma_f32_16x16x32_bf16 v[88:91], a[56:59], a[36:39], v[88:91]
 ds_read_b128 a[4:7], v201 offset:1024
 v_mfma_f32_16x16x32_bf16 v[92:95], a[60:63], a[36:39], v[92:95]
 ds_read_b64_tr_b16 a[24:25], v208 offset:0
 buffer_load_dwordx4 v252, s[16:19], s46 offen offset:2048  lds
 v_mfma_f32_16x16x32_bf16 v[76:79], a[60:63], a[32:35], v[76:79]
 ds_read_b64_tr_b16 a[26:27], v208 offset:8192
 v_mfma_f32_16x16x32_bf16 v[108:111], a[60:63], a[40:43], v[108:111]
 ds_read_b128 a[8:11], v201 offset:4096
 buffer_load_dwordx4 v253, s[16:19], s46 offen offset:3072  lds
 s_add_u32 s45, s45, 8192
 s_add_u32 s46, s46, 65536
 v_mfma_f32_16x16x32_bf16 v[124:127], a[60:63], a[44:47], v[124:127]
 ds_read_b64_tr_b16 a[28:29], v209 offset:0
 v_mfma_f32_16x16x32_bf16 v[120:123], a[56:59], a[44:47], v[120:123]
 ds_read_b64_tr_b16 a[30:31], v209 offset:8192
 buffer_load_dword v214, v215, s[20:23], s58 offen sc1
 v_mfma_f32_16x16x32_bf16 v[104:107], a[56:59], a[40:43], v[104:107]
 ds_read_b128 a[12:15], v201 offset:5120
 v_mfma_f32_16x16x32_bf16 v[100:103], a[52:55], a[40:43], v[100:103]
 v_mfma_f32_16x16x32_bf16 v[116:119], a[52:55], a[44:47], v[116:119]
 v_mfma_f32_16x16x32_bf16 v[112:115], a[48:51], a[44:47], v[112:115]
 v_mfma_f32_16x16x32_bf16 v[96:99], a[48:51], a[40:43], v[96:99]
 s_waitcnt lgkmcnt(0)
 s_waitcnt vmcnt(17)
 s_barrier
 v_mfma_f32_16x16x32_bf16 v[64:67], a[16:19], a[0:3], v[64:67]
 ds_read_b64_tr_b16 a[48:49], v206 offset:16384
 v_mfma_f32_16x16x32_bf16 v[80:83], a[16:19], a[4:7], v[80:83]
 ds_read_b64_tr_b16 a[50:51], v206 offset:24576
 s_add_u32 m0, s44, 49152
 v_mfma_f32_16x16x32_bf16 v[84:87], a[20:23], a[4:7], v[84:87]
 ds_read_b128 a[32:35], v201 offset:16384
 buffer_load_dwordx4 v210, s[12:15], s45 offen  lds
 v_mfma_f32_16x16x32_bf16 v[68:71], a[20:23], a[0:3], v[68:71]
 ds_read_b64_tr_b16 a[52:53], v207 offset:16384
 v_mfma_f32_16x16x32_bf16 v[72:75], a[24:27], a[0:3], v[72:75]
 ds_read_b64_tr_b16 a[54:55], v207 offset:24576
 v_mfma_f32_16x16x32_bf16 v[88:91], a[24:27], a[4:7], v[88:91]
 ds_read_b128 a[36:39], v201 offset:17408
 buffer_load_dwordx4 v210, s[12:15], s45 offen offset:1024  lds
 v_mfma_f32_16x16x32_bf16 v[92:95], a[28:31], a[4:7], v[92:95]
 ds_read_b64_tr_b16 a[56:57], v208 offset:16384
 v_mfma_f32_16x16x32_bf16 v[76:79], a[28:31], a[0:3], v[76:79]
 ds_read_b64_tr_b16 a[58:59], v208 offset:24576
 v_mfma_f32_16x16x32_bf16 v[108:111], a[28:31], a[8:11], v[108:111]
 ds_read_b128 a[40:43], v201 offset:20480
 buffer_load_dwordx4 v252, s[16:19], s46 offen offset:2048  lds
 v_mfma_f32_16x16x32_bf16 v[124:127], a[28:31], a[12:15], v[124:127]
 ds_read_b64_tr_b16 a[60:61], v209 offset:16384
 v_mfma_f32_16x16x32_bf16 v[120:123], a[24:27], a[12:15], v[120:123]
 ds_read_b64_tr_b16 a[62:63], v209 offset:24576
 v_mfma_f32_16x16x32_bf16 v[104:107], a[24:27], a[8:11], v[104:107]
 ds_read_b128 a[44:47], v201 offset:21504
 buffer_load_dwordx4 v253, s[16:19], s46 offen offset:3072  lds
 s_add_u32 s45, s45, 8192
 s_add_u32 s46, s46, 65536
 v_mfma_f32_16x16x32_bf16 v[100:103], a[20:23], a[8:11], v[100:103]
 v_mfma_f32_16x16x32_bf16 v[116:119], a[20:23], a[12:15], v[116:119]
 v_mfma_f32_16x16x32_bf16 v[112:115], a[16:19], a[12:15], v[112:115]
 v_mfma_f32_16x16x32_bf16 v[96:99], a[16:19], a[8:11], v[96:99]
 s_waitcnt lgkmcnt(0)
 v_mfma_f32_16x16x32_bf16 v[64:67], a[48:51], a[32:35], v[64:67]
 ds_read_b64_tr_b16 a[16:17], v206 offset:32768
 v_mfma_f32_16x16x32_bf16 v[80:83], a[48:51], a[36:39], v[80:83]
 ds_read_b64_tr_b16 a[18:19], v206 offset:40960
 s_add_u32 m0, s44, 65536
 v_mfma_f32_16x16x32_bf16 v[84:87], a[52:55], a[36:39], v[84:87]
 ds_read_b128 a[0:3], v201 offset:32768
 buffer_load_dwordx4 v210, s[12:15], s45 offen  lds
 v_mfma_f32_16x16x32_bf16 v[68:71], a[52:55], a[32:35], v[68:71]
 ds_read_b64_tr_b16 a[20:21], v207 offset:32768
 v_mfma_f32_16x16x32_bf16 v[72:75], a[56:59], a[32:35], v[72:75]
 ds_read_b64_tr_b16 a[22:23], v207 offset:40960
 v_mfma_f32_16x16x32_bf16 v[88:91], a[56:59], a[36:39], v[88:91]
 ds_read_b128 a[4:7], v201 offset:33792
 buffer_load_dwordx4 v210, s[12:15], s45 offen offset:1024  lds
 v_mfma_f32_16x16x32_bf16 v[92:95], a[60:63], a[36:39], v[92:95]
 ds_read_b64_tr_b16 a[24:25], v208 offset:32768
 v_mfma_f32_16x16x32_bf16 v[76:79], a[60:63], a[32:35], v[76:79]
 ds_read_b64_tr_b16 a[26:27], v208 offset:40960
 v_mfma_f32_16x16x32_bf16 v[108:111], a[60:63], a[40:43], v[108:111]
 ds_read_b128 a[8:11], v201 offset:36864
 buffer_load_dwordx4 v252, s[16:19], s46 offen offset:2048  lds
 v_mfma_f32_16x16x32_bf16 v[124:127], a[60:63], a[44:47], v[124:127]
 ds_read_b64_tr_b16 a[28:29], v209 offset:32768
 v_mfma_f32_16x16x32_bf16 v[120:123], a[56:59], a[44:47], v[120:123]
 ds_read_b64_tr_b16 a[30:31], v209 offset:40960
 v_mfma_f32_16x16x32_bf16 v[104:107], a[56:59], a[40:43], v[104:107]
 ds_read_b128 a[12:15], v201 offset:37888
 buffer_load_dwordx4 v253, s[16:19], s46 offen offset:3072  lds
 s_add_u32 s45, s45, 8192
 s_add_u32 s46, s46, 65536
 v_mfma_f32_16x16x32_bf16 v[100:103], a[52:55], a[40:43], v[100:103]
 v_mfma_f32_16x16x32_bf16 v[116:119], a[52:55], a[44:47], v[116:119]
 v_mfma_f32_16x16x32_bf16 v[112:115], a[48:51], a[44:47], v[112:115]
 v_mfma_f32_16x16x32_bf16 v[96:99], a[48:51], a[40:43], v[96:99]
 s_waitcnt lgkmcnt(0)
 s_waitcnt vmcnt(17)
 s_barrier
 v_mfma_f32_16x16x32_bf16 v[64:67], a[16:19], a[0:3], v[64:67]
 ds_read_b64_tr_b16 a[48:49], v206 offset:49152
 v_mfma_f32_16x16x32_bf16 v[80:83], a[16:19], a[4:7], v[80:83]
 ds_read_b64_tr_b16 a[50:51], v206 offset:57344
 s_add_u32 m0, s44, 81920
 v_mfma_f32_16x16x32_bf16 v[84:87], a[20:23], a[4:7], v[84:87]
 ds_read_b128 a[32:35], v201 offset:49152
 buffer_load_dwordx4 v210, s[12:15], s45 offen  lds
 v_mfma_f32_16x16x32_bf16 v[68:71], a[20:23], a[0:3], v[68:71]
 ds_read_b64_tr_b16 a[52:53], v207 offset:49152
 v_mfma_f32_16x16x32_bf16 v[72:75], a[24:27], a[0:3], v[72:75]
 ds_read_b64_tr_b16 a[54:55], v207 offset:57344
 v_mfma_f32_16x16x32_bf16 v[88:91], a[24:27], a[4:7], v[88:91]
 ds_read_b128 a[36:39], v201 offset:50176
 buffer_load_dwordx4 v210, s[12:15], s45 offen offset:1024  lds
 v_mfma_f32_16x16x32_bf16 v[92:95], a[28:31], a[4:7], v[92:95]
 ds_read_b64_tr_b16 a[56:57], v208 offset:49152
 v_mfma_f32_16x16x32_bf16 v[76:79], a[28:31], a[0:3], v[76:79]
 ds_read_b64_tr_b16 a[58:59], v208 offset:57344
 v_mfma_f32_16x16x32_bf16 v[108:111], a[28:31], a[8:11], v[108:111]
 ds_read_b128 a[40:43], v201 offset:53248
 buffer_load_dwordx4 v252, s[16:19], s46 offen offset:2048  lds
 v_mfma_f32_16x16x32_bf16 v[124:127], a[28:31], a[12:15], v[124:127]
 ds_read_b64_tr_b16 a[60:61], v209 offset:49152
 v_mfma_f32_16x16x32_bf16 v[120:123], a[24:27], a[12:15], v[120:123]
 ds_read_b64_tr_b16 a[62:63], v209 offset:57344
 v_mfma_f32_16x16x32_bf16 v[104:107], a[24:27], a[8:11], v[104:107]
 ds_read_b128 a[44:47], v201 offset:54272
 buffer_load_dwordx4 v253, s[16:19], s46 offen offset:3072  lds
 s_add_u32 s45, s45, 8192
 s_add_u32 s46, s46, 65536
 v_mfma_f32_16x16x32_bf16 v[100:103], a[20:23], a[8:11], v[100:103]
 v_mfma_f32_16x16x32_bf16 v[116:119], a[20:23], a[12:15], v[116:119]
 v_mfma_f32_16x16x32_bf16 v[112:115], a[16:19], a[12:15], v[112:115]
 v_mfma_f32_16x16x32_bf16 v[96:99], a[16:19], a[8:11], v[96:99]
 s_waitcnt lgkmcnt(0)
 v_mfma_f32_16x16x32_bf16 v[64:67], a[48:51], a[32:35], v[64:67]
 ds_read_b64_tr_b16 a[16:17], v202 offset:0
 v_mfma_f32_16x16x32_bf16 v[80:83], a[48:51], a[36:39], v[80:83]
 ds_read_b64_tr_b16 a[18:19], v202 offset:8192
 s_add_u32 m0, s44, 98304
 v_mfma_f32_16x16x32_bf16 v[84:87], a[52:55], a[36:39], v[84:87]
 ds_read_b128 a[0:3], v200 offset:0
 buffer_load_dwordx4 v210, s[12:15], s45 offen  lds
 v_mfma_f32_16x16x32_bf16 v[68:71], a[52:55], a[32:35], v[68:71]
 ds_read_b64_tr_b16 a[20:21], v203 offset:0
 v_mfma_f32_16x16x32_bf16 v[72:75], a[56:59], a[32:35], v[72:75]
 ds_read_b64_tr_b16 a[22:23], v203 offset:8192
 v_mfma_f32_16x16x32_bf16 v[88:91], a[56:59], a[36:39], v[88:91]
 ds_read_b128 a[4:7], v200 offset:1024
 buffer_load_dwordx4 v210, s[12:15], s45 offen offset:1024  lds
 v_mfma_f32_16x16x32_bf16 v[92:95], a[60:63], a[36:39], v[92:95]
 ds_read_b64_tr_b16 a[24:25], v204 offset:0
 v_mfma_f32_16x16x32_bf16 v[76:79], a[60:63], a[32:35], v[76:79]
 ds_read_b64_tr_b16 a[26:27], v204 offset:8192
 v_mfma_f32_16x16x32_bf16 v[108:111], a[60:63], a[40:43], v[108:111]
 ds_read_b128 a[8:11], v200 offset:4096
 buffer_load_dwordx4 v252, s[16:19], s46 offen offset:2048  lds
 v_mfma_f32_16x16x32_bf16 v[124:127], a[60:63], a[44:47], v[124:127]
 ds_read_b64_tr_b16 a[28:29], v205 offset:0
 v_mfma_f32_16x16x32_bf16 v[120:123], a[56:59], a[44:47], v[120:123]
 ds_read_b64_tr_b16 a[30:31], v205 offset:8192
 v_mfma_f32_16x16x32_bf16 v[104:107], a[56:59], a[40:43], v[104:107]
 ds_read_b128 a[12:15], v200 offset:5120
 buffer_load_dwordx4 v253, s[16:19], s46 offen offset:3072  lds
 s_add_u32 s45, s45, 8192
 s_add_u32 s46, s46, 65536
 v_mfma_f32_16x16x32_bf16 v[100:103], a[52:55], a[40:43], v[100:103]
 v_mfma_f32_16x16x32_bf16 v[116:119], a[52:55], a[44:47], v[116:119]
 v_mfma_f32_16x16x32_bf16 v[112:115], a[48:51], a[44:47], v[112:115]
 v_mfma_f32_16x16x32_bf16 v[96:99], a[48:51], a[40:43], v[96:99]
 s_waitcnt lgkmcnt(0)
 s_waitcnt vmcnt(17)
 s_barrier
 v_mfma_f32_16x16x32_bf16 v[64:67], a[16:19], a[0:3], v[64:67]
 ds_read_b64_tr_b16 a[48:49], v202 offset:16384
 v_mfma_f32_16x16x32_bf16 v[80:83], a[16:19], a[4:7], v[80:83]
 ds_read_b64_tr_b16 a[50:51], v202 offset:24576
 s_add_u32 m0, s44, 114688
 v_mfma_f32_16x16x32_bf16 v[84:87], a[20:23], a[4:7], v[84:87]
 ds_read_b128 a[32:35], v200 offset:16384
 buffer_load_dwordx4 v210, s[12:15], s45 offen  lds
 v_mfma_f32_16x16x32_bf16 v[68:71], a[20:23], a[0:3], v[68:71]
 ds_read_b64_tr_b16 a[52:53], v203 offset:16384
 v_mfma_f32_16x16x32_bf16 v[72:75], a[24:27], a[0:3], v[72:75]
 ds_read_b64_tr_b16 a[54:55], v203 offset:24576
 v_mfma_f32_16x16x32_bf16 v[88:91], a[24:27], a[4:7], v[88:91]
 ds_read_b128 a[36:39], v200 offset:17408
 buffer_load_dwordx4 v210, s[12:15], s45 offen offset:1024  lds
 v_mfma_f32_16x16x32_bf16 v[92:95], a[28:31], a[4:7], v[92:95]
 ds_read_b64_tr_b16 a[56:57], v204 offset:16384
 v_mfma_f32_16x16x32_bf16 v[76:79], a[28:31], a[0:3], v[76:79]
 ds_read_b64_tr_b16 a[58:59], v204 offset:24576
 v_mfma_f32_16x16x32_bf16 v[108:111], a[28:31], a[8:11], v[108:111]
 ds_read_b128 a[40:43], v200 offset:20480
 buffer_load_dwordx4 v252, s[16:19], s46 offen offset:2048  lds
 v_mfma_f32_16x16x32_bf16 v[124:127], a[28:31], a[12:15], v[124:127]
 ds_read_b64_tr_b16 a[60:61], v205 offset:16384
 v_mfma_f32_16x16x32_bf16 v[120:123], a[24:27], a[12:15], v[120:123]
 ds_read_b64_tr_b16 a[62:63], v205 offset:24576
 v_mfma_f32_16x16x32_bf16 v[104:107], a[24:27], a[8:11], v[104:107]
 ds_read_b128 a[44:47], v200 offset:21504
 buffer_load_dwordx4 v253, s[16:19], s46 offen offset:3072  lds
 s_add_u32 s45, s45, 8192
 s_add_u32 s46, s46, 65536
 v_mfma_f32_16x16x32_bf16 v[100:103], a[20:23], a[8:11], v[100:103]
 v_mfma_f32_16x16x32_bf16 v[116:119], a[20:23], a[12:15], v[116:119]
 v_mfma_f32_16x16x32_bf16 v[112:115], a[16:19], a[12:15], v[112:115]
 v_mfma_f32_16x16x32_bf16 v[96:99], a[16:19], a[8:11], v[96:99]
 s_waitcnt lgkmcnt(0)
 s_waitcnt vmcnt(20)
 v_cmp_eq_u32 vcc, 1, v214
    s_nop 1
 s_and_b32 s40, vcc_lo, s75
 s_cmp_eq_u32 s40, s75
 s_cbranch_scc1 L2F_og_ok
 s_mov_b32 s43, 0
L2F_og:
 s_waitcnt vmcnt(0)
 v_cmp_eq_u32 vcc, 1, v214
    s_nop 1
 s_and_b32 s40, vcc_lo, s75
 s_cmp_eq_u32 s40, s75
 s_cbranch_scc1 L2F_og_ok
 s_sleep 4
 buffer_load_dword v214, v215, s[20:23], s58 offen sc1
 s_add_u32 s43, s43, 1
 s_cmp_lt_u32 s43, 50000
 s_cbranch_scc1 L2F_og
L2F_og_ok:
 v_mfma_f32_16x16x32_bf16 v[64:67], a[48:51], a[32:35], v[64:67]
 ds_read_b64_tr_b16 a[16:17], v202 offset:32768
 v_mfma_f32_16x16x32_bf16 v[80:83], a[48:51], a[36:39], v[80:83]
 ds_read_b64_tr_b16 a[18:19], v202 offset:40960
 v_mfma_f32_16x16x32_bf16 v[84:87], a[52:55], a[36:39], v[84:87]
 ds_read_b128 a[0:3], v200 offset:32768
 buffer_load_dwordx2 v[192:193], v223, s[20:23], s53 offen offset:0 sc1
 buffer_load_dwordx2 v[194:195], v223, s[20:23], s53 offen offset:128 sc1
 buffer_load_dwordx2 v[196:197], v223, s[20:23], s53 offen offset:256 sc1
 buffer_load_dwordx2 v[198:199], v223, s[20:23], s53 offen offset:384 sc1
 v_mfma_f32_16x16x32_bf16 v[68:71], a[52:55], a[32:35], v[68:71]
 ds_read_b64_tr_b16 a[20:21], v203 offset:32768
 s_add_u32 m0, s44, 0
 v_mfma_f32_16x16x32_bf16 v[72:75], a[56:59], a[32:35], v[72:75]
 ds_read_b64_tr_b16 a[22:23], v203 offset:40960
 buffer_load_dwordx4 v210, s[12:15], s45 offen  lds
 v_mfma_f32_16x16x32_bf16 v[88:91], a[56:59], a[36:39], v[88:91]
 ds_read_b128 a[4:7], v200 offset:33792
 v_mfma_f32_16x16x32_bf16 v[92:95], a[60:63], a[36:39], v[92:95]
 ds_read_b64_tr_b16 a[24:25], v204 offset:32768
 buffer_load_dwordx4 v210, s[12:15], s45 offen offset:1024  lds
 v_mfma_f32_16x16x32_bf16 v[76:79], a[60:63], a[32:35], v[76:79]
 ds_read_b64_tr_b16 a[26:27], v204 offset:40960
 v_mfma_f32_16x16x32_bf16 v[108:111], a[60:63], a[40:43], v[108:111]
 ds_read_b128 a[8:11], v200 offset:36864
 buffer_load_dwordx4 v252, s[16:19], s46 offen offset:2048  lds
 v_mfma_f32_16x16x32_bf16 v[124:127], a[60:63], a[44:47], v[124:127]
 ds_read_b64_tr_b16 a[28:29], v205 offset:32768
 v_mfma_f32_16x16x32_bf16 v[120:123], a[56:59], a[44:47], v[120:123]
 ds_read_b64_tr_b16 a[30:31], v205 offset:40960
 buffer_load_dwordx4 v253, s[16:19], s46 offen offset:3072  lds
 s_add_u32 s45, s45, 8192
 s_add_u32 s46, s46, 65536
 v_mfma_f32_16x16x32_bf16 v[104:107], a[56:59], a[40:43], v[104:107]
 ds_read_b128 a[12:15], v200 offset:37888
 v_mfma_f32_16x16x32_bf16 v[100:103], a[52:55], a[40:43], v[100:103]
 v_mfma_f32_16x16x32_bf16 v[116:119], a[52:55], a[44:47], v[116:119]
 v_mfma_f32_16x16x32_bf16 v[112:115], a[48:51], a[44:47], v[112:115]
 v_mfma_f32_16x16x32_bf16 v[96:99], a[48:51], a[40:43], v[96:99]
 s_waitcnt lgkmcnt(0)
 s_waitcnt vmcnt(20)
 s_barrier
 v_mfma_f32_16x16x32_bf16 v[64:67], a[16:19], a[0:3], v[64:67]
 ds_read_b64_tr_b16 a[48:49], v202 offset:49152
 v_mfma_f32_16x16x32_bf16 v[80:83], a[16:19], a[4:7], v[80:83]
 ds_read_b64_tr_b16 a[50:51], v202 offset:57344
 s_add_u32 m0, s44, 16384
 v_mfma_f32_16x16x32_bf16 v[84:87], a[20:23], a[4:7], v[84:87]
 ds_read_b128 a[32:35], v200 offset:49152
 buffer_load_dwordx4 v210, s[12:15], s45 offen  lds
 v_mfma_f32_16x16x32_bf16 v[68:71], a[20:23], a[0:3], v[68:71]
 ds_read_b64_tr_b16 a[52:53], v203 offset:49152
 v_mfma_f32_16x16x32_bf16 v[72:75], a[24:27], a[0:3], v[72:75]
 ds_read_b64_tr_b16 a[54:55], v203 offset:57344
 v_mfma_f32_16x16x32_bf16 v[88:91], a[24:27], a[4:7], v[88:91]
 ds_read_b128 a[36:39], v200 offset:50176
 buffer_load_dwordx4 v210, s[12:15], s45 offen offset:1024  lds
 v_mfma_f32_16x16x32_bf16 v[92:95], a[28:31], a[4:7], v[92:95]
 ds_read_b64_tr_b16 a[56:57], v204 offset:49152
 v_mfma_f32_16x16x32_bf16 v[76:79], a[28:31], a[0:3], v[76:79]
 ds_read_b64_tr_b16 a[58:59], v204 offset:57344
 v_mfma_f32_16x16x32_bf16 v[108:111], a[28:31], a[8:11], v[108:111]
 ds_read_b128 a[40:43], v200 offset:53248
 buffer_load_dwordx4 v252, s[16:19], s46 offen offset:2048  lds
 v_mfma_f32_16x16x32_bf16 v[124:127], a[28:31], a[12:15], v[124:127]
 ds_read_b64_tr_b16 a[60:61], v205 offset:49152
 v_mfma_f32_16x16x32_bf16 v[120:123], a[24:27], a[12:15], v[120:123]
 ds_read_b64_tr_b16 a[62:63], v205 offset:57344
 v_mfma_f32_16x16x32_bf16 v[104:107], a[24:27], a[8:11], v[104:107]
 ds_read_b128 a[44:47], v200 offset:54272
 buffer_load_dwordx4 v253, s[16:19], s46 offen offset:3072  lds
 s_add_u32 s45, s45, 8192
 s_add_u32 s46, s46, 65536
 v_mfma_f32_16x16x32_bf16 v[100:103], a[20:23], a[8:11], v[100:103]
 v_mfma_f32_16x16x32_bf16 v[116:119], a[20:23], a[12:15], v[116:119]
 v_mfma_f32_16x16x32_bf16 v[112:115], a[16:19], a[12:15], v[112:115]
 v_mfma_f32_16x16x32_bf16 v[96:99], a[16:19], a[8:11], v[96:99]
 s_waitcnt lgkmcnt(0)
 v_mfma_f32_16x16x32_bf16 v[64:67], a[48:51], a[32:35], v[64:67]
 ds_read_b64_tr_b16 a[16:17], v206 offset:0
 v_mfma_f32_16x16x32_bf16 v[80:83], a[48:51], a[36:39], v[80:83]
 ds_read_b64_tr_b16 a[18:19], v206 offset:8192
 s_add_u32 m0, s44, 32768
 v_mfma_f32_16x16x32_bf16 v[84:87], a[52:55], a[36:39], v[84:87]
 ds_read_b128 a[0:3], v201 offset:0
 buffer_load_dwordx4 v210, s[12:15], s45 offen  lds
 v_mfma_f32_16x16x32_bf16 v[68:71], a[52:55], a[32:35], v[68:71]
 ds_read_b64_tr_b16 a[20:21], v207 offset:0
 v_mfma_f32_16x16x32_bf16 v[72:75], a[56:59], a[32:35], v[72:75]
 ds_read_b64_tr_b16 a[22:23], v207 offset:8192
 v_mfma_f32_16x16x32_bf16 v[88:91], a[56:59], a[36:39], v[88:91]
 ds_read_b128 a[4:7], v201 offset:1024
 buffer_load_dwordx4 v210, s[12:15], s45 offen offset:1024  lds
 v_mfma_f32_16x16x32_bf16 v[92:95], a[60:63], a[36:39], v[92:95]
 ds_read_b64_tr_b16 a[24:25], v208 offset:0
 v_mfma_f32_16x16x32_bf16 v[76:79], a[60:63], a[32:35], v[76:79]
 ds_read_b64_tr_b16 a[26:27], v208 offset:8192
 v_mfma_f32_16x16x32_bf16 v[108:111], a[60:63], a[40:43], v[108:111]
 ds_read_b128 a[8:11], v201 offset:4096
 buffer_load_dwordx4 v252, s[16:19], s46 offen offset:2048  lds
 v_mfma_f32_16x16x32_bf16 v[124:127], a[60:63], a[44:47], v[124:127]
 ds_read_b64_tr_b16 a[28:29], v209 offset:0
 v_mfma_f32_16x16x32_bf16 v[120:123], a[56:59], a[44:47], v[120:123]
 ds_read_b64_tr_b16 a[30:31], v209 offset:8192
 v_mfma_f32_16x16x32_bf16 v[104:107], a[56:59], a[40:43], v[104:107]
 ds_read_b128 a[12:15], v201 offset:5120
 buffer_load_dwordx4 v253, s[16:19], s46 offen offset:3072  lds
 s_add_u32 s45, s45, 8192
 s_add_u32 s46, s46, 65536
 v_mfma_f32_16x16x32_bf16 v[100:103], a[52:55], a[40:43], v[100:103]
 v_mfma_f32_16x16x32_bf16 v[116:119], a[52:55], a[44:47], v[116:119]
 v_mfma_f32_16x16x32_bf16 v[112:115], a[48:51], a[44:47], v[112:115]
 v_mfma_f32_16x16x32_bf16 v[96:99], a[48:51], a[40:43], v[96:99]
 s_waitcnt lgkmcnt(0)
 s_waitcnt vmcnt(20)
 s_barrier
 v_mfma_f32_16x16x32_bf16 v[64:67], a[16:19], a[0:3], v[64:67]
 ds_read_b64_tr_b16 a[48:49], v206 offset:16384
 v_mfma_f32_16x16x32_bf16 v[80:83], a[16:19], a[4:7], v[80:83]
 ds_read_b64_tr_b16 a[50:51], v206 offset:24576
 s_add_u32 m0, s44, 49152
 v_mfma_f32_16x16x32_bf16 v[84:87], a[20:23], a[4:7], v[84:87]
 ds_read_b128 a[32:35], v201 offset:16384
 buffer_load_dwordx4 v210, s[12:15], s45 offen  lds
 v_mfma_f32_16x16x32_bf16 v[68:71], a[20:23], a[0:3], v[68:71]
 ds_read_b64_tr_b16 a[52:53], v207 offset:16384
 v_mfma_f32_16x16x32_bf16 v[72:75], a[24:27], a[0:3], v[72:75]
 ds_read_b64_tr_b16 a[54:55], v207 offset:24576
 v_mfma_f32_16x16x32_bf16 v[88:91], a[24:27], a[4:7], v[88:91]
 ds_read_b128 a[36:39], v201 offset:17408
 buffer_load_dwordx4 v210, s[12:15], s45 offen offset:1024  lds
 v_mfma_f32_16x16x32_bf16 v[92:95], a[28:31], a[4:7], v[92:95]
 ds_read_b64_tr_b16 a[56:57], v208 offset:16384
 v_mfma_f32_16x16x32_bf16 v[76:79], a[28:31], a[0:3], v[76:79]
 ds_read_b64_tr_b16 a[58:59], v208 offset:24576
 v_mfma_f32_16x16x32_bf16 v[108:111], a[28:31], a[8:11], v[108:111]
 ds_read_b128 a[40:43], v201 offset:20480
 buffer_load_dwordx4 v252, s[16:19], s46 offen offset:2048  lds
 v_mfma_f32_16x16x32_bf16 v[124:127], a[28:31], a[12:15], v[124:127]
 ds_read_b64_tr_b16 a[60:61], v209 offset:16384
 v_mfma_f32_16x16x32_bf16 v[120:123], a[24:27], a[12:15], v[120:123]
 ds_read_b64_tr_b16 a[62:63], v209 offset:24576
 v_mfma_f32_16x16x32_bf16 v[104:107], a[24:27], a[8:11], v[104:107]
 ds_read_b128 a[44:47], v201 offset:21504
 buffer_load_dwordx4 v253, s[16:19], s46 offen offset:3072  lds
 s_add_u32 s45, s45, 8192
 s_add_u32 s46, s46, 65536
 v_mfma_f32_16x16x32_bf16 v[100:103], a[20:23], a[8:11], v[100:103]
 v_mfma_f32_16x16x32_bf16 v[116:119], a[20:23], a[12:15], v[116:119]
 v_mfma_f32_16x16x32_bf16 v[112:115], a[16:19], a[12:15], v[112:115]
 v_mfma_f32_16x16x32_bf16 v[96:99], a[16:19], a[8:11], v[96:99]
 s_waitcnt lgkmcnt(0)
 s_waitcnt vmcnt(16)
 v_mfma_f32_16x16x32_bf16 v[64:67], a[48:51], a[32:35], v[64:67]
 ds_read_b64_tr_b16 a[16:17], v206 offset:32768
 v_mfma_f32_16x16x32_bf16 v[80:83], a[48:51], a[36:39], v[80:83]
 ds_read_b64_tr_b16 a[18:19], v206 offset:40960
 s_add_u32 m0, s44, 65536
 v_mul_f32 v0, v192, v0
 v_mfma_f32_16x16x32_bf16 v[84:87], a[52:55], a[36:39], v[84:87]
 ds_read_b128 a[0:3], v201 offset:32768
 buffer_load_dwordx4 v210, s[12:15], s45 offen  lds
 v_mul_f32 v1, v192, v1
 v_mfma_f32_16x16x32_bf16 v[68:71], a[52:55], a[32:35], v[68:71]
 ds_read_b64_tr_b16 a[20:21], v207 offset:32768
 v_mul_f32 v2, v192, v2
 v_mfma_f32_16x16x32_bf16 v[72:75], a[56:59], a[32:35], v[72:75]
 ds_read_b64_tr_b16 a[22:23], v207 offset:40960
 v_mfma_f32_16x16x32_bf16 v[88:91], a[56:59], a[36:39], v[88:91]
 ds_read_b128 a[4:7], v201 offset:33792
 buffer_load_dwordx4 v210, s[12:15], s45 offen offset:1024  lds
 v_mul_f32 v3, v192, v3
 v_mfma_f32_16x16x32_bf16 v[92:95], a[60:63], a[36:39], v[92:95]
 ds_read_b64_tr_b16 a[24:25], v208 offset:32768
 v_mul_f32 v4, v192, v4
 v_mfma_f32_16x16x32_bf16 v[76:79], a[60:63], a[32:35], v[76:79]
 ds_read_b64_tr_b16 a[26:27], v208 offset:40960
 v_mul_f32 v5, v192, v5
 v_mfma_f32_16x16x32_bf16 v[108:111], a[60:63], a[40:43], v[108:111]
 ds_read_b128 a[8:11], v201 offset:36864
 buffer_load_dwordx4 v252, s[16:19], s46 offen offset:2048  lds
 v_mfma_f32_16x16x32_bf16 v[124:127], a[60:63], a[44:47], v[124:127]
 ds_read_b64_tr_b16 a[28:29], v209 offset:32768
 v_mul_f32 v6, v192, v6
 v_mfma_f32_16x16x32_bf16 v[120:123], a[56:59], a[44:47], v[120:123]
 ds_read_b64_tr_b16 a[30:31], v209 offset:40960
 v_mul_f32 v7, v192, v7
 v_mfma_f32_16x16x32_bf16 v[104:107], a[56:59], a[40:43], v[104:107]
 ds_read_b128 a[12:15], v201 offset:37888
 buffer_load_dwordx4 v253, s[16:19], s46 offen offset:3072  lds
 s_add_u32 s45, s45, 8192
 s_add_u32 s46, s46, 65536
 v_mul_f32 v8, v192, v8
 v_mfma_f32_16x16x32_bf16 v[100:103], a[52:55], a[40:43], v[100:103]
 v_mfma_f32_16x16x32_bf16 v[116:119], a[52:55], a[44:47], v[116:119]
 v_mul_f32 v9, v192, v9
 v_mfma_f32_16x16x32_bf16 v[112:115], a[48:51], a[44:47], v[112:115]
 v_mul_f32 v10, v192, v10
 v_mfma_f32_16x16x32_bf16 v[96:99], a[48:51], a[40:43], v[96:99]
 s_waitcnt lgkmcnt(0)
 s_waitcnt vmcnt(16)
 s_barrier
 v_mfma_f32_16x16x32_bf16 v[64:67], a[16:19], a[0:3], v[64:67]
 ds_read_b64_tr_b16 a[48:49], v206 offset:49152
 v_mfma_f32_16x16x32_bf16 v[80:83], a[16:19], a[4:7], v[80:83]
 ds_read_b64_tr_b16 a[50:51], v206 offset:57344
 v_mul_f32 v11, v192, v11
 v_mfma_f32_16x16x32_bf16 v[84:87], a[20:23], a[4:7], v[84:87]
 ds_read_b128 a[32:35], v201 offset:49152
 buffer_load_dword v214, v213, s[20:23], s51 offen sc1
 v_mul_f32 v12, v192, v12
 v_mfma_f32_16x16x32_bf16 v[68:71], a[20:23], a[0:3], v[68:71]
 ds_read_b64_tr_b16 a[52:53], v207 offset:49152
 v_mul_f32 v13, v192, v13
 v_mfma_f32_16x16x32_bf16 v[72:75], a[24:27], a[0:3], v[72:75]
 ds_read_b64_tr_b16 a[54:55], v207 offset:57344
 v_mul_f32 v14, v192, v14
 v_mfma_f32_16x16x32_bf16 v[88:91], a[24:27], a[4:7], v[88:91]
 ds_read_b128 a[36:39], v201 offset:50176
 v_mul_f32 v15, v192, v15
 v_mfma_f32_16x16x32_bf16 v[92:95], a[28:31], a[4:7], v[92:95]
 ds_read_b64_tr_b16 a[56:57], v208 offset:49152
 v_mul_f32 v16, v194, v16
 v_mfma_f32_16x16x32_bf16 v[76:79], a[28:31], a[0:3], v[76:79]
 ds_read_b64_tr_b16 a[58:59], v208 offset:57344
 v_mul_f32 v17, v194, v17
 v_mfma_f32_16x16x32_bf16 v[108:111], a[28:31], a[8:11], v[108:111]
 ds_read_b128 a[40:43], v201 offset:53248
 v_mul_f32 v18, v194, v18
 v_mfma_f32_16x16x32_bf16 v[124:127], a[28:31], a[12:15], v[124:127]
 ds_read_b64_tr_b16 a[60:61], v209 offset:49152
 v_mul_f32 v19, v194, v19
 v_mfma_f32_16x16x32_bf16 v[120:123], a[24:27], a[12:15], v[120:123]
 ds_read_b64_tr_b16 a[62:63], v209 offset:57344
 v_mul_f32 v20, v194, v20
 v_mfma_f32_16x16x32_bf16 v[104:107], a[24:27], a[8:11], v[104:107]
 ds_read_b128 a[44:47], v201 offset:54272
 v_mul_f32 v21, v194, v21
 v_mfma_f32_16x16x32_bf16 v[100:103], a[20:23], a[8:11], v[100:103]
 s_mov_b32 s64, s20
 v_mfma_f32_16x16x32_bf16 v[116:119], a[20:23], a[12:15], v[116:119]
 s_mov_b32 s65, s21
 v_mfma_f32_16x16x32_bf16 v[112:115], a[16:19], a[12:15], v[112:115]
 s_mov_b32 s67, 0x20000
 v_mfma_f32_16x16x32_bf16 v[96:99], a[16:19], a[8:11], v[96:99]
 s_mov_b32 s54, s50
 s_waitcnt lgkmcnt(0)
 v_mfma_f32_16x16x32_bf16 v[64:67], a[48:51], a[32:35], v[64:67]
 ds_read_b64_tr_b16 a[16:17], v202 offset:0
 v_mfma_f32_16x16x32_bf16 v[80:83], a[48:51], a[36:39], v[80:83]
 ds_read_b64_tr_b16 a[18:19], v202 offset:8192
 v_mul_f32 v22, v194, v22
 v_mfma_f32_16x16x32_bf16 v[84:87], a[52:55], a[36:39], v[84:87]
 ds_read_b128 a[0:3], v200 offset:0
 v_mul_f32 v23, v194, v23
 v_mfma_f32_16x16x32_bf16 v[68:71], a[52:55], a[32:35], v[68:71]
 ds_read_b64_tr_b16 a[20:21], v203 offset:0
 v_mul_f32 v24, v194, v24
 v_mfma_f32_16x16x32_bf16 v[72:75], a[56:59], a[32:35], v[72:75]
 ds_read_b64_tr_b16 a[22:23], v203 offset:8192
 v_mfma_f32_16x16x32_bf16 v[88:91], a[56:59], a[36:39], v[88:91]
 ds_read_b128 a[4:7], v200 offset:1024
 v_mul_f32 v25, v194, v25
 v_mfma_f32_16x16x32_bf16 v[92:95], a[60:63], a[36:39], v[92:95]
 ds_read_b64_tr_b16 a[24:25], v204 offset:0
 v_mul_f32 v26, v194, v26
 v_mfma_f32_16x16x32_bf16 v[76:79], a[60:63], a[32:35], v[76:79]
 ds_read_b64_tr_b16 a[26:27], v204 offset:8192
 v_mul_f32 v27, v194, v27
 v_mfma_f32_16x16x32_bf16 v[108:111], a[60:63], a[40:43], v[108:111]
 ds_read_b128 a[8:11], v200 offset:4096
 v_mfma_f32_16x16x32_bf16 v[124:127], a[60:63], a[44:47], v[124:127]
 ds_read_b64_tr_b16 a[28:29], v205 offset:0
 v_mul_f32 v28, v194, v28
 v_mfma_f32_16x16x32_bf16 v[120:123], a[56:59], a[44:47], v[120:123]
 ds_read_b64_tr_b16 a[30:31], v205 offset:8192
 v_mul_f32 v29, v194, v29
 v_mfma_f32_16x16x32_bf16 v[104:107], a[56:59], a[40:43], v[104:107]
 ds_read_b128 a[12:15], v200 offset:5120
 v_mul_f32 v30, v194, v30
 v_mfma_f32_16x16x32_bf16 v[100:103], a[52:55], a[40:43], v[100:103]
 v_mfma_f32_16x16x32_bf16 v[116:119], a[52:55], a[44:47], v[116:119]
 v_mul_f32 v31, v194, v31
 v_mfma_f32_16x16x32_bf16 v[112:115], a[48:51], a[44:47], v[112:115]
 v_mul_f32 v32, v196, v32
 v_mfma_f32_16x16x32_bf16 v[96:99], a[48:51], a[40:43], v[96:99]
 s_waitcnt lgkmcnt(0)
 s_waitcnt vmcnt(9)
 s_barrier
 v_mfma_f32_16x16x32_bf16 v[64:67], a[16:19], a[0:3], v[64:67]
 ds_read_b64_tr_b16 a[48:49], v202 offset:16384
 v_mfma_f32_16x16x32_bf16 v[80:83], a[16:19], a[4:7], v[80:83]
 ds_read_b64_tr_b16 a[50:51], v202 offset:24576
 v_mul_f32 v33, v196, v33
 v_mfma_f32_16x16x32_bf16 v[84:87], a[20:23], a[4:7], v[84:87]
 ds_read_b128 a[32:35], v200 offset:16384
 v_mul_f32 v34, v196, v34
 v_mfma_f32_16x16x32_bf16 v[68:71], a[20:23], a[0:3], v[68:71]
 ds_read_b64_tr_b16 a[52:53], v203 offset:16384
 v_mul_f32 v35, v196, v35
 v_mfma_f32_16x16x32_bf16 v[72:75], a[24:27], a[0:3], v[72:75]
 ds_read_b64_tr_b16 a[54:55], v203 offset:24576
 v_mfma_f32_16x16x32_bf16 v[88:91], a[24:27], a[4:7], v[88:91]
 ds_read_b128 a[36:39], v200 offset:17408
 v_mul_f32 v36, v196, v36
 v_mfma_f32_16x16x32_bf16 v[92:95], a[28:31], a[4:7], v[92:95]
 ds_read_b64_tr_b16 a[56:57], v204 offset:16384
 v_mul_f32 v37, v196, v37
 v_mfma_f32_16x16x32_bf16 v[76:79], a[28:31], a[0:3], v[76:79]
 ds_read_b64_tr_b16 a[58:59], v204 offset:24576
 v_mul_f32 v38, v196, v38
 v_mfma_f32_16x16x32_bf16 v[108:111], a[28:31], a[8:11], v[108:111]
 ds_read_b128 a[40:43], v200 offset:20480
 v_mfma_f32_16x16x32_bf16 v[124:127], a[28:31], a[12:15], v[124:127]
 ds_read_b64_tr_b16 a[60:61], v205 offset:16384
 v_mul_f32 v39, v196, v39
 v_mfma_f32_16x16x32_bf16 v[120:123], a[24:27], a[12:15], v[120:123]
 ds_read_b64_tr_b16 a[62:63], v205 offset:24576
 v_mul_f32 v40, v196, v40
 v_mfma_f32_16x16x32_bf16 v[104:107], a[24:27], a[8:11], v[104:107]
 ds_read_b128 a[44:47], v200 offset:21504
 v_mul_f32 v41, v196, v41
 v_mfma_f32_16x16x32_bf16 v[100:103], a[20:23], a[8:11], v[100:103]
 v_mfma_f32_16x16x32_bf16 v[116:119], a[20:23], a[12:15], v[116:119]
 v_mul_f32 v42, v196, v42
 v_mfma_f32_16x16x32_bf16 v[112:115], a[16:19], a[12:15], v[112:115]
 v_mul_f32 v43, v196, v43
 v_mfma_f32_16x16x32_bf16 v[96:99], a[16:19], a[8:11], v[96:99]
 s_waitcnt lgkmcnt(0)
 v_mfma_f32_16x16x32_bf16 v[64:67], a[48:51], a[32:35], v[64:67]
 ds_read_b64_tr_b16 a[16:17], v202 offset:32768
 v_mfma_f32_16x16x32_bf16 v[80:83], a[48:51], a[36:39], v[80:83]
 ds_read_b64_tr_b16 a[18:19], v202 offset:40960
 v_mul_f32 v44, v196, v44
 v_mfma_f32_16x16x32_bf16 v[84:87], a[52:55], a[36:39], v[84:87]
 ds_read_b128 a[0:3], v200 offset:32768
 v_mul_f32 v45, v196, v45
 v_mfma_f32_16x16x32_bf16 v[68:71], a[52:55], a[32:35], v[68:71]
 ds_read_b64_tr_b16 a[20:21], v203 offset:32768
 v_mul_f32 v46, v196, v46
 v_mfma_f32_16x16x32_bf16 v[72:75], a[56:59], a[32:35], v[72:75]
 ds_read_b64_tr_b16 a[22:23], v203 offset:40960
 v_mfma_f32_16x16x32_bf16 v[88:91], a[56:59], a[36:39], v[88:91]
 ds_read_b128 a[4:7], v200 offset:33792
 v_mul_f32 v47, v196, v47
 v_mfma_f32_16x16x32_bf16 v[92:95], a[60:63], a[36:39], v[92:95]
 ds_read_b64_tr_b16 a[24:25], v204 offset:32768
 v_mul_f32 v48, v198, v48
 v_mfma_f32_16x16x32_bf16 v[76:79], a[60:63], a[32:35], v[76:79]
 ds_read_b64_tr_b16 a[26:27], v204 offset:40960
 v_mul_f32 v49, v198, v49
 v_mfma_f32_16x16x32_bf16 v[108:111], a[60:63], a[40:43], v[108:111]
 ds_read_b128 a[8:11], v200 offset:36864
 v_mfma_f32_16x16x32_bf16 v[124:127], a[60:63], a[44:47], v[124:127]
 ds_read_b64_tr_b16 a[28:29], v205 offset:32768
 v_mul_f32 v50, v198, v50
 v_mfma_f32_16x16x32_bf16 v[120:123], a[56:59], a[44:47], v[120:123]
 ds_read_b64_tr_b16 a[30:31], v205 offset:40960
 v_mul_f32 v51, v198, v51
 v_mfma_f32_16x16x32_bf16 v[104:107], a[56:59], a[40:43], v[104:107]
 ds_read_b128 a[12:15], v200 offset:37888
 v_mul_f32 v52, v198, v52
 v_mfma_f32_16x16x32_bf16 v[100:103], a[52:55], a[40:43], v[100:103]
 v_mfma_f32_16x16x32_bf16 v[116:119], a[52:55], a[44:47], v[116:119]
 v_mul_f32 v53, v198, v53
 v_mfma_f32_16x16x32_bf16 v[112:115], a[48:51], a[44:47], v[112:115]
 v_mul_f32 v54, v198, v54
 v_mfma_f32_16x16x32_bf16 v[96:99], a[48:51], a[40:43], v[96:99]
 s_waitcnt lgkmcnt(0)
 s_waitcnt vmcnt(0)
 v_readfirstlane_b32 s55, v214
    s_nop 1
 s_cmp_eq_u32 s55, 1
 s_cselect_b32 s66, 0x10000000, 0
 s_barrier
 v_mfma_f32_16x16x32_bf16 v[64:67], a[16:19], a[0:3], v[64:67]
 ds_read_b64_tr_b16 a[48:49], v202 offset:49152
 v_mfma_f32_16x16x32_bf16 v[80:83], a[16:19], a[4:7], v[80:83]
 ds_read_b64_tr_b16 a[50:51], v202 offset:57344
 v_mul_f32 v55, v198, v55
 v_mfma_f32_16x16x32_bf16 v[84:87], a[20:23], a[4:7], v[84:87]
 ds_read_b128 a[32:35], v200 offset:49152
 buffer_load_dwordx4 v[128:131], v211, s[64:67], s54 offen offset:0 sc1
 v_mul_f32 v56, v198, v56
 v_mfma_f32_16x16x32_bf16 v[68:71], a[20:23], a[0:3], v[68:71]
 ds_read_b64_tr_b16 a[52:53], v203 offset:49152
 v_mfma_f32_16x16x32_bf16 v[72:75], a[24:27], a[0:3], v[72:75]
 ds_read_b64_tr_b16 a[54:55], v203 offset:57344
 v_mul_f32 v57, v198, v57
 v_mfma_f32_16x16x32_bf16 v[88:91], a[24:27], a[4:7], v[88:91]
 ds_read_b128 a[36:39], v200 offset:50176
 buffer_load_dwordx4 v[132:135], v211, s[64:67], s54 offen offset:1024 sc1
 v_mfma_f32_16x16x32_bf16 v[92:95], a[28:31], a[4:7], v[92:95]
 ds_read_b64_tr_b16 a[56:57], v204 offset:49152
 v_mul_f32 v58, v198, v58
 v_mfma_f32_16x16x32_bf16 v[76:79], a[28:31], a[0:3], v[76:79]
 ds_read_b64_tr_b16 a[58:59], v204 offset:57344
 v_mul_f32 v59, v198, v59
 v_mfma_f32_16x16x32_bf16 v[108:111], a[28:31], a[8:11], v[108:111]
 ds_read_b128 a[40:43], v200 offset:53248
 buffer_load_dwordx4 v[136:139], v211, s[64:67], s54 offen offset:2048 sc1
 v_mfma_f32_16x16x32_bf16 v[124:127], a[28:31], a[12:15], v[124:127]
 ds_read_b64_tr_b16 a[60:61], v205 offset:49152
 v_mul_f32 v60, v198, v60
 v_mfma_f32_16x16x32_bf16 v[120:123], a[24:27], a[12:15], v[120:123]
 ds_read_b64_tr_b16 a[62:63], v205 offset:57344
 v_mfma_f32_16x16x32_bf16 v[104:107], a[24:27], a[8:11], v[104:107]
 ds_read_b128 a[44:47], v200 offset:54272
 buffer_load_dwordx4 v[140:143], v211, s[64:67], s54 offen offset:3072 sc1
 s_add_u32 s54, s54, 4096
 v_mul_f32 v61, v198, v61
 v_mfma_f32_16x16x32_bf16 v[100:103], a[20:23], a[8:11], v[100:103]
 v_mul_f32 v62, v198, v62
 v_mfma_f32_16x16x32_bf16 v[116:119], a[20:23], a[12:15], v[116:119]
 v_mfma_f32_16x16x32_bf16 v[112:115], a[16:19], a[12:15], v[112:115]
 v_mul_f32 v63, v198, v63
 v_mfma_f32_16x16x32_bf16 v[96:99], a[16:19], a[8:11], v[96:99]
 s_waitcnt lgkmcnt(0)
 v_mfma_f32_16x16x32_bf16 v[64:67], a[48:51], a[32:35], v[64:67]
 ds_read_b64_tr_b16 a[16:17], v206 offset:0
 v_mfma_f32_16x16x32_bf16 v[80:83], a[48:51], a[36:39], v[80:83]
 ds_read_b64_tr_b16 a[18:19], v206 offset:8192
 v_mfma_f32_16x16x32_bf16 v[84:87], a[52:55], a[36:39], v[84:87]
 ds_read_b128 a[0:3], v201 offset:0
 buffer_load_dwordx4 v[144:147], v211, s[64:67], s54 offen offset:0 sc1
 v_mfma_f32_16x16x32_bf16 v[68:71], a[52:55], a[32:35], v[68:71]
 ds_read_b64_tr_b16 a[20:21], v207 offset:0
 v_mfma_f32_16x16x32_bf16 v[72:75], a[56:59], a[32:35], v[72:75]
 ds_read_b64_tr_b16 a[22:23], v207 offset:8192
 v_mfma_f32_16x16x32_bf16 v[88:91], a[56:59], a[36:39], v[88:91]
 ds_read_b128 a[4:7], v201 offset:1024
 buffer_load_dwordx4 v[148:151], v211, s[64:67], s54 offen offset:1024 sc1
 v_mfma_f32_16x16x32_bf16 v[92:95], a[60:63], a[36:39], v[92:95]
 ds_read_b64_tr_b16 a[24:25], v208 offset:0
 v_mfma_f32_16x16x32_bf16 v[76:79], a[60:63], a[32:35], v[76:79]
 ds_read_b64_tr_b16 a[26:27], v208 offset:8192
 v_mfma_f32_16x16x32_bf16 v[108:111], a[60:63], a[40:43], v[108:111]
 ds_read_b128 a[8:11], v201 offset:4096
 buffer_load_dwordx4 v[152:155], v211, s[64:67], s54 offen offset:2048 sc1
 v_mfma_f32_16x16x32_bf16 v[124:127], a[60:63], a[44:47], v[124:127]
 ds_read_b64_tr_b16 a[28:29], v209 offset:0
 v_mfma_f32_16x16x32_bf16 v[120:123], a[56:59], a[44:47], v[120:123]
 ds_read_b64_tr_b16 a[30:31], v209 offset:8192
 v_mfma_f32_16x16x32_bf16 v[104:107], a[56:59], a[40:43], v[104:107]
 ds_read_b128 a[12:15], v201 offset:5120
 buffer_load_dwordx4 v[156:159], v211, s[64:67], s54 offen offset:3072 sc1
 s_add_u32 s54, s54, 4096
 v_mfma_f32_16x16x32_bf16 v[100:103], a[52:55], a[40:43], v[100:103]
 v_mfma_f32_16x16x32_bf16 v[116:119], a[52:55], a[44:47], v[116:119]
 v_mfma_f32_16x16x32_bf16 v[112:115], a[48:51], a[44:47], v[112:115]
 v_mfma_f32_16x16x32_bf16 v[96:99], a[48:51], a[40:43], v[96:99]
 s_waitcnt lgkmcnt(0)
 s_barrier
 v_mfma_f32_16x16x32_bf16 v[64:67], a[16:19], a[0:3], v[64:67]
 v_mfma_f32_16x16x32_bf16 v[80:83], a[16:19], a[4:7], v[80:83]
 v_mfma_f32_16x16x32_bf16 v[84:87], a[20:23], a[4:7], v[84:87]
 v_mfma_f32_16x16x32_bf16 v[68:71], a[20:23], a[0:3], v[68:71]
 v_mfma_f32_16x16x32_bf16 v[72:75], a[24:27], a[0:3], v[72:75]
 v_mfma_f32_16x16x32_bf16 v[88:91], a[24:27], a[4:7], v[88:91]
 v_mfma_f32_16x16x32_bf16 v[92:95], a[28:31], a[4:7], v[92:95]
 v_mfma_f32_16x16x32_bf16 v[76:79], a[28:31], a[0:3], v[76:79]
 v_mfma_f32_16x16x32_bf16 v[108:111], a[28:31], a[8:11], v[108:111]
 v_mfma_f32_16x16x32_bf16 v[124:127], a[28:31], a[12:15], v[124:127]
 v_mfma_f32_16x16x32_bf16 v[120:123], a[24:27], a[12:15], v[120:123]
 v_mfma_f32_16x16x32_bf16 v[104:107], a[24:27], a[8:11], v[104:107]
 v_mfma_f32_16x16x32_bf16 v[100:103], a[20:23], a[8:11], v[100:103]
 v_mfma_f32_16x16x32_bf16 v[116:119], a[20:23], a[12:15], v[116:119]
 v_mfma_f32_16x16x32_bf16 v[112:115], a[16:19], a[12:15], v[112:115]
 v_mfma_f32_16x16x32_bf16 v[96:99], a[16:19], a[8:11], v[96:99]
 s_cmp_eq_u32 s55, 1
 s_cbranch_scc1 L2_got
 s_mov_b32 s43, 0
L2_poll:
 buffer_load_dword v214, v213, s[20:23], s51 offen sc1
 s_waitcnt vmcnt(0)
 v_readfirstlane_b32 s55, v214
    s_nop 1
 s_cmp_eq_u32 s55, 1
 s_cbranch_scc1 L2_reld
 s_add_u32 s43, s43, 1
 s_cmp_lt_u32 s43, 50000
 s_cbranch_scc1 L2_poll
L2_reld:
 s_mov_b32 s54, s50
 buffer_load_dwordx4 v[128:131], v211, s[20:23], s54 offen offset:0 sc1
 buffer_load_dwordx4 v[132:135], v211, s[20:23], s54 offen offset:1024 sc1
 buffer_load_dwordx4 v[136:139], v211, s[20:23], s54 offen offset:2048 sc1
 buffer_load_dwordx4 v[140:143], v211, s[20:23], s54 offen offset:3072 sc1
 s_add_u32 s54, s54, 4096
 buffer_load_dwordx4 v[144:147], v211, s[20:23], s54 offen offset:0 sc1
 buffer_load_dwordx4 v[148:151], v211, s[20:23], s54 offen offset:1024 sc1
 buffer_load_dwordx4 v[152:155], v211, s[20:23], s54 offen offset:2048 sc1
 buffer_load_dwordx4 v[156:159], v211, s[20:23], s54 offen offset:3072 sc1
 s_add_u32 s54, s54, 4096
L2_got:
 s_mov_b32 s68, 0x00003f80
 s_mov_b32 s69, 0x3f800000
 v_pk_fma_f32 v[0:1], v[192:193], v[64:65], v[0:1] op_sel:[1,0,0] op_sel_hi:[1,1,1]
 v_pk_fma_f32 v[2:3], v[192:193], v[66:67], v[2:3] op_sel:[1,0,0] op_sel_hi:[1,1,1]
 v_pk_fma_f32 v[4:5], v[192:193], v[68:69], v[4:5] op_sel:[1,0,0] op_sel_hi:[1,1,1]
 v_pk_fma_f32 v[6:7], v[192:193], v[70:71], v[6:7] op_sel:[1,0,0] op_sel_hi:[1,1,1]
 v_pk_fma_f32 v[8:9], v[192:193], v[72:73], v[8:9] op_sel:[1,0,0] op_sel_hi:[1,1,1]
 v_pk_fma_f32 v[10:11], v[192:193], v[74:75], v[10:11] op_sel:[1,0,0] op_sel_hi:[1,1,1]
 v_pk_fma_f32 v[12:13], v[192:193], v[76:77], v[12:13] op_sel:[1,0,0] op_sel_hi:[1,1,1]
 v_pk_fma_f32 v[14:15], v[192:193], v[78:79], v[14:15] op_sel:[1,0,0] op_sel_hi:[1,1,1]
 v_pk_fma_f32 v[16:17], v[194:195], v[80:81], v[16:17] op_sel:[1,0,0] op_sel_hi:[1,1,1]
 v_pk_fma_f32 v[18:19], v[194:195], v[82:83], v[18:19] op_sel:[1,0,0] op_sel_hi:[1,1,1]
 v_pk_fma_f32 v[20:21], v[194:195], v[84:85], v[20:21] op_sel:[1,0,0] op_sel_hi:[1,1,1]
 v_pk_fma_f32 v[22:23], v[194:195], v[86:87], v[22:23] op_sel:[1,0,0] op_sel_hi:[1,1,1]
 v_pk_fma_f32 v[24:25], v[194:195], v[88:89], v[24:25] op_sel:[1,0,0] op_sel_hi:[1,1,1]
 v_pk_fma_f32 v[26:27], v[194:195], v[90:91], v[26:27] op_sel:[1,0,0] op_sel_hi:[1,1,1]
 v_pk_fma_f32 v[28:29], v[194:195], v[92:93], v[28:29] op_sel:[1,0,0] op_sel_hi:[1,1,1]
 v_pk_fma_f32 v[30:31], v[194:195], v[94:95], v[30:31] op_sel:[1,0,0] op_sel_hi:[1,1,1]
 v_pk_fma_f32 v[32:33], v[196:197], v[96:97], v[32:33] op_sel:[1,0,0] op_sel_hi:[1,1,1]
 v_pk_fma_f32 v[34:35], v[196:197], v[98:99], v[34:35] op_sel:[1,0,0] op_sel_hi:[1,1,1]
 v_pk_fma_f32 v[36:37], v[196:197], v[100:101], v[36:37] op_sel:[1,0,0] op_sel_hi:[1,1,1]
 v_pk_fma_f32 v[38:39], v[196:197], v[102:103], v[38:39] op_sel:[1,0,0] op_sel_hi:[1,1,1]
 v_pk_fma_f32 v[40:41], v[196:197], v[104:105], v[40:41] op_sel:[1,0,0] op_sel_hi:[1,1,1]
 v_pk_fma_f32 v[42:43], v[196:197], v[106:107], v[42:43] op_sel:[1,0,0] op_sel_hi:[1,1,1]
 v_pk_fma_f32 v[44:45], v[196:197], v[108:109], v[44:45] op_sel:[1,0,0] op_sel_hi:[1,1,1]
 v_pk_fma_f32 v[46:47], v[196:197], v[110:111], v[46:47] op_sel:[1,0,0] op_sel_hi:[1,1,1]
 v_pk_fma_f32 v[48:49], v[198:199], v[112:113], v[48:49] op_sel:[1,0,0] op_sel_hi:[1,1,1]
 v_pk_fma_f32 v[50:51], v[198:199], v[114:115], v[50:51] op_sel:[1,0,0] op_sel_hi:[1,1,1]
 v_pk_fma_f32 v[52:53], v[198:199], v[116:117], v[52:53] op_sel:[1,0,0] op_sel_hi:[1,1,1]
 v_pk_fma_f32 v[54:55], v[198:199], v[118:119], v[54:55] op_sel:[1,0,0] op_sel_hi:[1,1,1]
 v_pk_fma_f32 v[56:57], v[198:199], v[120:121], v[56:57] op_sel:[1,0,0] op_sel_hi:[1,1,1]
 v_pk_fma_f32 v[58:59], v[198:199], v[122:123], v[58:59] op_sel:[1,0,0] op_sel_hi:[1,1,1]
 v_pk_fma_f32 v[60:61], v[198:199], v[124:125], v[60:61] op_sel:[1,0,0] op_sel_hi:[1,1,1]
 v_pk_fma_f32 v[62:63], v[198:199], v[126:127], v[62:63] op_sel:[1,0,0] op_sel_hi:[1,1,1]
 s_waitcnt vmcnt(6)
 v_dot2_f32_bf16 v0, v128, s68, v0
 v_dot2_f32_bf16 v1, v128, s69, v1
 v_dot2_f32_bf16 v2, v129, s68, v2
 v_dot2_f32_bf16 v3, v129, s69, v3
 v_dot2_f32_bf16 v4, v130, s68, v4
 v_dot2_f32_bf16 v5, v130, s69, v5
 v_dot2_f32_bf16 v6, v131, s68, v6
 v_dot2_f32_bf16 v7, v131, s69, v7
 v_dot2_f32_bf16 v8, v132, s68, v8
 v_dot2_f32_bf16 v9, v132, s69, v9
 v_dot2_f32_bf16 v10, v133, s68, v10
 v_dot2_f32_bf16 v11, v133, s69, v11
 v_dot2_f32_bf16 v12, v134, s68, v12
 v_dot2_f32_bf16 v13, v134, s69, v13
 v_dot2_f32_bf16 v14, v135, s68, v14
 v_dot2_f32_bf16 v15, v135, s69, v15
 v_cvt_pk_bf16_f32 v0, v0, v1
 v_cvt_pk_bf16_f32 v1, v2, v3
 v_cvt_pk_bf16_f32 v2, v4, v5
 v_cvt_pk_bf16_f32 v3, v6, v7
 v_cvt_pk_bf16_f32 v8, v8, v9
 v_cvt_pk_bf16_f32 v9, v10, v11
 v_cvt_pk_bf16_f32 v10, v12, v13
 v_cvt_pk_bf16_f32 v11, v14, v15
 v_permlane16_swap_b32 v0, v2
 v_permlane16_swap_b32 v1, v3
 v_permlane16_swap_b32 v8, v10
 v_permlane16_swap_b32 v9, v11
 buffer_store_dwordx4 v[0:3], v212, s[24:27], s52 offen offset:0 nt
 buffer_store_dwordx4 v[8:11], v212, s[24:27], s52 offen offset:64 nt
 s_add_u32 s52, s52, 32768
 s_waitcnt vmcnt(6)
 v_dot2_f32_bf16 v16, v136, s68, v16
 v_dot2_f32_bf16 v17, v136, s69, v17
 v_dot2_f32_bf16 v18, v137, s68, v18
 v_dot2_f32_bf16 v19, v137, s69, v19
 v_dot2_f32_bf16 v20, v138, s68, v20
 v_dot2_f32_bf16 v21, v138, s69, v21
 v_dot2_f32_bf16 v22, v139, s68, v22
 v_dot2_f32_bf16 v23, v139, s69, v23
 v_dot2_f32_bf16 v24, v140, s68, v24
 v_dot2_f32_bf16 v25, v140, s69, v25
 v_dot2_f32_bf16 v26, v141, s68, v26
 v_dot2_f32_bf16 v27, v141, s69, v27
 v_dot2_f32_bf16 v28, v142, s68, v28
 v_dot2_f32_bf16 v29, v142, s69, v29
 v_dot2_f32_bf16 v30, v143, s68, v30
 v_dot2_f32_bf16 v31, v143, s69, v31
 v_cvt_pk_bf16_f32 v16, v16, v17
 v_cvt_pk_bf16_f32 v17, v18, v19
 v_cvt_pk_bf16_f32 v18, v20, v21
 v_cvt_pk_bf16_f32 v19, v22, v23
 v_cvt_pk_bf16_f32 v24, v24, v25
 v_cvt_pk_bf16_f32 v25, v26, v27
 v_cvt_pk_bf16_f32 v26, v28, v29
 v_cvt_pk_bf16_f32 v27, v30, v31
 v_permlane16_swap_b32 v16, v18
 v_permlane16_swap_b32 v17, v19
 v_permlane16_swap_b32 v24, v26
 v_permlane16_swap_b32 v25, v27
 buffer_store_dwordx4 v[16:19], v212, s[24:27], s52 offen offset:0 nt
 buffer_store_dwordx4 v[24:27], v212, s[24:27], s52 offen offset:64 nt
 s_add_u32 s52, s52, 32768
 s_waitcnt vmcnt(6)
 v_dot2_f32_bf16 v32, v144, s68, v32
 v_dot2_f32_bf16 v33, v144, s69, v33
 v_dot2_f32_bf16 v34, v145, s68, v34
 v_dot2_f32_bf16 v35, v145, s69, v35
 v_dot2_f32_bf16 v36, v146, s68, v36
 v_dot2_f32_bf16 v37, v146, s69, v37
 v_dot2_f32_bf16 v38, v147, s68, v38
 v_dot2_f32_bf16 v39, v147, s69, v39
 v_dot2_f32_bf16 v40, v148, s68, v40
 v_dot2_f32_bf16 v41, v148, s69, v41
 v_dot2_f32_bf16 v42, v149, s68, v42
 v_dot2_f32_bf16 v43, v149, s69, v43
 v_dot2_f32_bf16 v44, v150, s68, v44
 v_dot2_f32_bf16 v45, v150, s69, v45
 v_dot2_f32_bf16 v46, v151, s68, v46
 v_dot2_f32_bf16 v47, v151, s69, v47
 v_cvt_pk_bf16_f32 v32, v32, v33
 v_cvt_pk_bf16_f32 v33, v34, v35
 v_cvt_pk_bf16_f32 v34, v36, v37
 v_cvt_pk_bf16_f32 v35, v38, v39
 v_cvt_pk_bf16_f32 v40, v40, v41
 v_cvt_pk_bf16_f32 v41, v42, v43
 v_cvt_pk_bf16_f32 v42, v44, v45
 v_cvt_pk_bf16_f32 v43, v46, v47
 v_permlane16_swap_b32 v32, v34
 v_permlane16_swap_b32 v33, v35
 v_permlane16_swap_b32 v40, v42
 v_permlane16_swap_b32 v41, v43
 buffer_store_dwordx4 v[32:35], v212, s[24:27], s52 offen offset:0 nt
 buffer_store_dwordx4 v[40:43], v212, s[24:27], s52 offen offset:64 nt
 s_add_u32 s52, s52, 32768
 s_waitcnt vmcnt(6)
 v_dot2_f32_bf16 v48, v152, s68, v48
 v_dot2_f32_bf16 v49, v152, s69, v49
 v_dot2_f32_bf16 v50, v153, s68, v50
 v_dot2_f32_bf16 v51, v153, s69, v51
 v_dot2_f32_bf16 v52, v154, s68, v52
 v_dot2_f32_bf16 v53, v154, s69, v53
 v_dot2_f32_bf16 v54, v155, s68, v54
 v_dot2_f32_bf16 v55, v155, s69, v55
 v_dot2_f32_bf16 v56, v156, s68, v56
 v_dot2_f32_bf16 v57, v156, s69, v57
 v_dot2_f32_bf16 v58, v157, s68, v58
 v_dot2_f32_bf16 v59, v157, s69, v59
 v_dot2_f32_bf16 v60, v158, s68, v60
 v_dot2_f32_bf16 v61, v158, s69, v61
 v_dot2_f32_bf16 v62, v159, s68, v62
 v_dot2_f32_bf16 v63, v159, s69, v63
 v_cvt_pk_bf16_f32 v48, v48, v49
 v_cvt_pk_bf16_f32 v49, v50, v51
 v_cvt_pk_bf16_f32 v50, v52, v53
 v_cvt_pk_bf16_f32 v51, v54, v55
 v_cvt_pk_bf16_f32 v56, v56, v57
 v_cvt_pk_bf16_f32 v57, v58, v59
 v_cvt_pk_bf16_f32 v58, v60, v61
 v_cvt_pk_bf16_f32 v59, v62, v63
 v_permlane16_swap_b32 v48, v50
 v_permlane16_swap_b32 v49, v51
 v_permlane16_swap_b32 v56, v58
 v_permlane16_swap_b32 v57, v59
 buffer_store_dwordx4 v[48:51], v212, s[24:27], s52 offen offset:0 nt
 buffer_store_dwordx4 v[56:59], v212, s[24:27], s52 offen offset:64 nt
 s_add_u32 s52, s52, 32768
 s_endpgm
L2_P:
 s_waitcnt lgkmcnt(0)
 s_waitcnt vmcnt(8)
 s_barrier
 v_mfma_f32_16x16x32_bf16 v[0:3], a[16:19], a[0:3], 0
 ds_read_b64_tr_b16 a[48:49], v202 offset:16384
 v_mfma_f32_16x16x32_bf16 v[16:19], a[16:19], a[4:7], 0
 ds_read_b64_tr_b16 a[50:51], v202 offset:24576
 s_add_u32 m0, s44, 114688
 v_mfma_f32_16x16x32_bf16 v[20:23], a[20:23], a[4:7], 0
 ds_read_b128 a[32:35], v200 offset:16384
 buffer_load_dwordx4 v210, s[12:15], s45 offen  lds
 v_mfma_f32_16x16x32_bf16 v[4:7], a[20:23], a[0:3], 0
 ds_read_b64_tr_b16 a[52:53], v203 offset:16384
 v_mfma_f32_16x16x32_bf16 v[8:11], a[24:27], a[0:3], 0
 ds_read_b64_tr_b16 a[54:55], v203 offset:24576
 v_mfma_f32_16x16x32_bf16 v[24:27], a[24:27], a[4:7], 0
 ds_read_b128 a[36:39], v200 offset:17408
 buffer_load_dwordx4 v210, s[12:15], s45 offen offset:1024  lds
 v_mfma_f32_16x16x32_bf16 v[28:31], a[28:31], a[4:7], 0
 ds_read_b64_tr_b16 a[56:57], v204 offset:16384
 v_mfma_f32_16x16x32_bf16 v[12:15], a[28:31], a[0:3], 0
 ds_read_b64_tr_b16 a[58:59], v204 offset:24576
 v_mfma_f32_16x16x32_bf16 v[44:47], a[28:31], a[8:11], 0
 ds_read_b128 a[40:43], v200 offset:20480
 buffer_load_dwordx4 v252, s[16:19], s46 offen offset:2048  lds
 v_mfma_f32_16x16x32_bf16 v[60:63], a[28:31], a[12:15], 0
 ds_read_b64_tr_b16 a[60:61], v205 offset:16384
 v_mfma_f32_16x16x32_bf16 v[56:59], a[24:27], a[12:15], 0
 ds_read_b64_tr_b16 a[62:63], v205 offset:24576
 v_mfma_f32_16x16x32_bf16 v[40:43], a[24:27], a[8:11], 0
 ds_read_b128 a[44:47], v200 offset:21504
 buffer_load_dwordx4 v253, s[16:19], s46 offen offset:3072  lds
 s_add_u32 s45, s45, 8192
 s_add_u32 s46, s46, 65536
 v_mfma_f32_16x16x32_bf16 v[36:39], a[20:23], a[8:11], 0
 v_mfma_f32_16x16x32_bf16 v[52:55], a[20:23], a[12:15], 0
 v_mfma_f32_16x16x32_bf16 v[48:51], a[16:19], a[12:15], 0
 v_mfma_f32_16x16x32_bf16 v[32:35], a[16:19], a[8:11], 0
 s_waitcnt lgkmcnt(0)
 v_mfma_f32_16x16x32_bf16 v[0:3], a[48:51], a[32:35], v[0:3]
 ds_read_b64_tr_b16 a[16:17], v202 offset:32768
 v_mfma_f32_16x16x32_bf16 v[16:19], a[48:51], a[36:39], v[16:19]
 ds_read_b64_tr_b16 a[18:19], v202 offset:40960
 s_add_u32 m0, s44, 0
 v_mfma_f32_16x16x32_bf16 v[20:23], a[52:55], a[36:39], v[20:23]
 ds_read_b128 a[0:3], v200 offset:32768
 buffer_load_dwordx4 v210, s[12:15], s45 offen  lds
 v_mfma_f32_16x16x32_bf16 v[4:7], a[52:55], a[32:35], v[4:7]
 ds_read_b64_tr_b16 a[20:21], v203 offset:32768
 v_mfma_f32_16x16x32_bf16 v[8:11], a[56:59], a[32:35], v[8:11]
 ds_read_b64_tr_b16 a[22:23], v203 offset:40960
 v_mfma_f32_16x16x32_bf16 v[24:27], a[56:59], a[36:39], v[24:27]
 ds_read_b128 a[4:7], v200 offset:33792
 buffer_load_dwordx4 v210, s[12:15], s45 offen offset:1024  lds
 v_mfma_f32_16x16x32_bf16 v[28:31], a[60:63], a[36:39], v[28:31]
 ds_read_b64_tr_b16 a[24:25], v204 offset:32768
 v_mfma_f32_16x16x32_bf16 v[12:15], a[60:63], a[32:35], v[12:15]
 ds_read_b64_tr_b16 a[26:27], v204 offset:40960
 v_mfma_f32_16x16x32_bf16 v[44:47], a[60:63], a[40:43], v[44:47]
 ds_read_b128 a[8:11], v200 offset:36864
 buffer_load_dwordx4 v252, s[16:19], s46 offen offset:2048  lds
 v_mfma_f32_16x16x32_bf16 v[60:63], a[60:63], a[44:47], v[60:63]
 ds_read_b64_tr_b16 a[28:29], v205 offset:32768
 v_mfma_f32_16x16x32_bf16 v[56:59], a[56:59], a[44:47], v[56:59]
 ds_read_b64_tr_b16 a[30:31], v205 offset:40960
 v_mfma_f32_16x16x32_bf16 v[40:43], a[56:59], a[40:43], v[40:43]
 ds_read_b128 a[12:15], v200 offset:37888
 buffer_load_dwordx4 v253, s[16:19], s46 offen offset:3072  lds
 s_add_u32 s45, s45, 8192
 s_add_u32 s46, s46, 65536
 v_mfma_f32_16x16x32_bf16 v[36:39], a[52:55], a[40:43], v[36:39]
 v_mfma_f32_16x16x32_bf16 v[52:55], a[52:55], a[44:47], v[52:55]
 v_mfma_f32_16x16x32_bf16 v[48:51], a[48:51], a[44:47], v[48:51]
 v_mfma_f32_16x16x32_bf16 v[32:35], a[48:51], a[40:43], v[32:35]
 s_waitcnt lgkmcnt(0)
 s_waitcnt vmcnt(12)
 s_barrier
 v_mfma_f32_16x16x32_bf16 v[0:3], a[16:19], a[0:3], v[0:3]
 ds_read_b64_tr_b16 a[48:49], v202 offset:49152
 v_mfma_f32_16x16x32_bf16 v[16:19], a[16:19], a[4:7], v[16:19]
 ds_read_b64_tr_b16 a[50:51], v202 offset:57344
 s_add_u32 m0, s44, 16384
 v_mfma_f32_16x16x32_bf16 v[20:23], a[20:23], a[4:7], v[20:23]
 ds_read_b128 a[32:35], v200 offset:49152
 buffer_load_dwordx4 v210, s[12:15], s45 offen  lds
 v_mfma_f32_16x16x32_bf16 v[4:7], a[20:23], a[0:3], v[4:7]
 ds_read_b64_tr_b16 a[52:53], v203 offset:49152
 v_mfma_f32_16x16x32_bf16 v[8:11], a[24:27], a[0:3], v[8:11]
 ds_read_b64_tr_b16 a[54:55], v203 offset:57344
 v_mfma_f32_16x16x32_bf16 v[24:27], a[24:27], a[4:7], v[24:27]
 ds_read_b128 a[36:39], v200 offset:50176
 buffer_load_dwordx4 v210, s[12:15], s45 offen offset:1024  lds
 v_mfma_f32_16x16x32_bf16 v[28:31], a[28:31], a[4:7], v[28:31]
 ds_read_b64_tr_b16 a[56:57], v204 offset:49152
 v_mfma_f32_16x16x32_bf16 v[12:15], a[28:31], a[0:3], v[12:15]
 ds_read_b64_tr_b16 a[58:59], v204 offset:57344
 v_mfma_f32_16x16x32_bf16 v[44:47], a[28:31], a[8:11], v[44:47]
 ds_read_b128 a[40:43], v200 offset:53248
 buffer_load_dwordx4 v252, s[16:19], s46 offen offset:2048  lds
 v_mfma_f32_16x16x32_bf16 v[60:63], a[28:31], a[12:15], v[60:63]
 ds_read_b64_tr_b16 a[60:61], v205 offset:49152
 v_mfma_f32_16x16x32_bf16 v[56:59], a[24:27], a[12:15], v[56:59]
 ds_read_b64_tr_b16 a[62:63], v205 offset:57344
 v_mfma_f32_16x16x32_bf16 v[40:43], a[24:27], a[8:11], v[40:43]
 ds_read_b128 a[44:47], v200 offset:54272
 buffer_load_dwordx4 v253, s[16:19], s46 offen offset:3072  lds
 s_add_u32 s45, s45, 8192
 s_add_u32 s46, s46, 65536
 v_mfma_f32_16x16x32_bf16 v[36:39], a[20:23], a[8:11], v[36:39]
 v_mfma_f32_16x16x32_bf16 v[52:55], a[20:23], a[12:15], v[52:55]
 v_mfma_f32_16x16x32_bf16 v[48:51], a[16:19], a[12:15], v[48:51]
 v_mfma_f32_16x16x32_bf16 v[32:35], a[16:19], a[8:11], v[32:35]
 s_waitcnt lgkmcnt(0)
 v_mfma_f32_16x16x32_bf16 v[0:3], a[48:51], a[32:35], v[0:3]
 ds_read_b64_tr_b16 a[16:17], v206 offset:0
 v_mfma_f32_16x16x32_bf16 v[16:19], a[48:51], a[36:39], v[16:19]
 ds_read_b64_tr_b16 a[18:19], v206 offset:8192
 s_add_u32 m0, s44, 32768
 v_mfma_f32_16x16x32_bf16 v[20:23], a[52:55], a[36:39], v[20:23]
 ds_read_b128 a[0:3], v201 offset:0
 buffer_load_dwordx4 v210, s[12:15], s45 offen  lds
 v_mfma_f32_16x16x32_bf16 v[4:7], a[52:55], a[32:35], v[4:7]
 ds_read_b64_tr_b16 a[20:21], v207 offset:0
 v_mfma_f32_16x16x32_bf16 v[8:11], a[56:59], a[32:35], v[8:11]
 ds_read_b64_tr_b16 a[22:23], v207 offset:8192
 v_mfma_f32_16x16x32_bf16 v[24:27], a[56:59], a[36:39], v[24:27]
 ds_read_b128 a[4:7], v201 offset:1024
 buffer_load_dwordx4 v210, s[12:15], s45 offen offset:1024  lds
 v_mfma_f32_16x16x32_bf16 v[28:31], a[60:63], a[36:39], v[28:31]
 ds_read_b64_tr_b16 a[24:25], v208 offset:0
 v_mfma_f32_16x16x32_bf16 v[12:15], a[60:63], a[32:35], v[12:15]
 ds_read_b64_tr_b16 a[26:27], v208 offset:8192
 v_mfma_f32_16x16x32_bf16 v[44:47], a[60:63], a[40:43], v[44:47]
 ds_read_b128 a[8:11], v201 offset:4096
 buffer_load_dwordx4 v252, s[16:19], s46 offen offset:2048  lds
 v_mfma_f32_16x16x32_bf16 v[60:63], a[60:63], a[44:47], v[60:63]
 ds_read_b64_tr_b16 a[28:29], v209 offset:0
 v_mfma_f32_16x16x32_bf16 v[56:59], a[56:59], a[44:47], v[56:59]
 ds_read_b64_tr_b16 a[30:31], v209 offset:8192
 v_mfma_f32_16x16x32_bf16 v[40:43], a[56:59], a[40:43], v[40:43]
 ds_read_b128 a[12:15], v201 offset:5120
 buffer_load_dwordx4 v253, s[16:19], s46 offen offset:3072  lds
 s_add_u32 s45, s45, 8192
 s_add_u32 s46, s46, 65536
 v_mfma_f32_16x16x32_bf16 v[36:39], a[52:55], a[40:43], v[36:39]
 v_mfma_f32_16x16x32_bf16 v[52:55], a[52:55], a[44:47], v[52:55]
 v_mfma_f32_16x16x32_bf16 v[48:51], a[48:51], a[44:47], v[48:51]
 v_mfma_f32_16x16x32_bf16 v[32:35], a[48:51], a[40:43], v[32:35]
 s_waitcnt lgkmcnt(0)
 s_waitcnt vmcnt(16)
 s_barrier
 v_mfma_f32_16x16x32_bf16 v[0:3], a[16:19], a[0:3], v[0:3]
 ds_read_b64_tr_b16 a[48:49], v206 offset:16384
 v_mfma_f32_16x16x32_bf16 v[16:19], a[16:19], a[4:7], v[16:19]
 ds_read_b64_tr_b16 a[50:51], v206 offset:24576
 s_add_u32 m0, s44, 49152
 v_mfma_f32_16x16x32_bf16 v[20:23], a[20:23], a[4:7], v[20:23]
 ds_read_b128 a[32:35], v201 offset:16384
 buffer_load_dwordx4 v210, s[12:15], s45 offen  lds
 v_mfma_f32_16x16x32_bf16 v[4:7], a[20:23], a[0:3], v[4:7]
 ds_read_b64_tr_b16 a[52:53], v207 offset:16384
 v_mfma_f32_16x16x32_bf16 v[8:11], a[24:27], a[0:3], v[8:11]
 ds_read_b64_tr_b16 a[54:55], v207 offset:24576
 v_mfma_f32_16x16x32_bf16 v[24:27], a[24:27], a[4:7], v[24:27]
 ds_read_b128 a[36:39], v201 offset:17408
 buffer_load_dwordx4 v210, s[12:15], s45 offen offset:1024  lds
 v_mfma_f32_16x16x32_bf16 v[28:31], a[28:31], a[4:7], v[28:31]
 ds_read_b64_tr_b16 a[56:57], v208 offset:16384
 v_mfma_f32_16x16x32_bf16 v[12:15], a[28:31], a[0:3], v[12:15]
 ds_read_b64_tr_b16 a[58:59], v208 offset:24576
 v_mfma_f32_16x16x32_bf16 v[44:47], a[28:31], a[8:11], v[44:47]
 ds_read_b128 a[40:43], v201 offset:20480
 buffer_load_dwordx4 v252, s[16:19], s46 offen offset:2048  lds
 v_mfma_f32_16x16x32_bf16 v[60:63], a[28:31], a[12:15], v[60:63]
 ds_read_b64_tr_b16 a[60:61], v209 offset:16384
 v_mfma_f32_16x16x32_bf16 v[56:59], a[24:27], a[12:15], v[56:59]
 ds_read_b64_tr_b16 a[62:63], v209 offset:24576
 v_mfma_f32_16x16x32_bf16 v[40:43], a[24:27], a[8:11], v[40:43]
 ds_read_b128 a[44:47], v201 offset:21504
 buffer_load_dwordx4 v253, s[16:19], s46 offen offset:3072  lds
 s_add_u32 s45, s45, 8192
 s_add_u32 s46, s46, 65536
 v_mfma_f32_16x16x32_bf16 v[36:39], a[20:23], a[8:11], v[36:39]
 v_mfma_f32_16x16x32_bf16 v[52:55], a[20:23], a[12:15], v[52:55]
 v_mfma_f32_16x16x32_bf16 v[48:51], a[16:19], a[12:15], v[48:51]
 v_mfma_f32_16x16x32_bf16 v[32:35], a[16:19], a[8:11], v[32:35]
 s_waitcnt lgkmcnt(0)
 v_mfma_f32_16x16x32_bf16 v[0:3], a[48:51], a[32:35], v[0:3]
 ds_read_b64_tr_b16 a[16:17], v206 offset:32768
 v_mfma_f32_16x16x32_bf16 v[16:19], a[48:51], a[36:39], v[16:19]
 ds_read_b64_tr_b16 a[18:19], v206 offset:40960
 s_add_u32 m0, s44, 65536
 v_mfma_f32_16x16x32_bf16 v[20:23], a[52:55], a[36:39], v[20:23]
 ds_read_b128 a[0:3], v201 offset:32768
 buffer_load_dwordx4 v210, s[12:15], s45 offen  lds
 v_mfma_f32_16x16x32_bf16 v[4:7], a[52:55], a[32:35], v[4:7]
 ds_read_b64_tr_b16 a[20:21], v207 offset:32768
 v_mfma_f32_16x16x32_bf16 v[8:11], a[56:59], a[32:35], v[8:11]
 ds_read_b64_tr_b16 a[22:23], v207 offset:40960
 v_mfma_f32_16x16x32_bf16 v[24:27], a[56:59], a[36:39], v[24:27]
 ds_read_b128 a[4:7], v201 offset:33792
 buffer_load_dwordx4 v210, s[12:15], s45 offen offset:1024  lds
 v_mfma_f32_16x16x32_bf16 v[28:31], a[60:63], a[36:39], v[28:31]
 ds_read_b64_tr_b16 a[24:25], v208 offset:32768
 v_mfma_f32_16x16x32_bf16 v[12:15], a[60:63], a[32:35], v[12:15]
 ds_read_b64_tr_b16 a[26:27], v208 offset:40960
 v_mfma_f32_16x16x32_bf16 v[44:47], a[60:63], a[40:43], v[44:47]
 ds_read_b128 a[8:11], v201 offset:36864
 buffer_load_dwordx4 v252, s[16:19], s46 offen offset:2048  lds
 v_mfma_f32_16x16x32_bf16 v[60:63], a[60:63], a[44:47], v[60:63]
 ds_read_b64_tr_b16 a[28:29], v209 offset:32768
 v_mfma_f32_16x16x32_bf16 v[56:59], a[56:59], a[44:47], v[56:59]
 ds_read_b64_tr_b16 a[30:31], v209 offset:40960
 v_mfma_f32_16x16x32_bf16 v[40:43], a[56:59], a[40:43], v[40:43]
 ds_read_b128 a[12:15], v201 offset:37888
 buffer_load_dwordx4 v253, s[16:19], s46 offen offset:3072  lds
 s_add_u32 s45, s45, 8192
 s_add_u32 s46, s46, 65536
 v_mfma_f32_16x16x32_bf16 v[36:39], a[52:55], a[40:43], v[36:39]
 v_mfma_f32_16x16x32_bf16 v[52:55], a[52:55], a[44:47], v[52:55]
 v_mfma_f32_16x16x32_bf16 v[48:51], a[48:51], a[44:47], v[48:51]
 v_mfma_f32_16x16x32_bf16 v[32:35], a[48:51], a[40:43], v[32:35]
 s_waitcnt lgkmcnt(0)
 s_waitcnt vmcnt(16)
 s_barrier
 v_mfma_f32_16x16x32_bf16 v[0:3], a[16:19], a[0:3], v[0:3]
 ds_read_b64_tr_b16 a[48:49], v206 offset:49152
 v_mfma_f32_16x16x32_bf16 v[16:19], a[16:19], a[4:7], v[16:19]
 ds_read_b64_tr_b16 a[50:51], v206 offset:57344
 s_add_u32 m0, s44, 81920
 v_mfma_f32_16x16x32_bf16 v[20:23], a[20:23], a[4:7], v[20:23]
 ds_read_b128 a[32:35], v201 offset:49152
 buffer_load_dwordx4 v210, s[12:15], s45 offen  lds
 v_mfma_f32_16x16x32_bf16 v[4:7], a[20:23], a[0:3], v[4:7]
 ds_read_b64_tr_b16 a[52:53], v207 offset:49152
 v_mfma_f32_16x16x32_bf16 v[8:11], a[24:27], a[0:3], v[8:11]
 ds_read_b64_tr_b16 a[54:55], v207 offset:57344
 v_mfma_f32_16x16x32_bf16 v[24:27], a[24:27], a[4:7], v[24:27]
 ds_read_b128 a[36:39], v201 offset:50176
 buffer_load_dwordx4 v210, s[12:15], s45 offen offset:1024  lds
 v_mfma_f32_16x16x32_bf16 v[28:31], a[28:31], a[4:7], v[28:31]
 ds_read_b64_tr_b16 a[56:57], v208 offset:49152
 v_mfma_f32_16x16x32_bf16 v[12:15], a[28:31], a[0:3], v[12:15]
 ds_read_b64_tr_b16 a[58:59], v208 offset:57344
 v_mfma_f32_16x16x32_bf16 v[44:47], a[28:31], a[8:11], v[44:47]
 ds_read_b128 a[40:43], v201 offset:53248
 buffer_load_dwordx4 v252, s[16:19], s46 offen offset:2048  lds
 v_mfma_f32_16x16x32_bf16 v[60:63], a[28:31], a[12:15], v[60:63]
 ds_read_b64_tr_b16 a[60:61], v209 offset:49152
 v_mfma_f32_16x16x32_bf16 v[56:59], a[24:27], a[12:15], v[56:59]
 ds_read_b64_tr_b16 a[62:63], v209 offset:57344
 v_mfma_f32_16x16x32_bf16 v[40:43], a[24:27], a[8:11], v[40:43]
 ds_read_b128 a[44:47], v201 offset:54272
 buffer_load_dwordx4 v253, s[16:19], s46 offen offset:3072  lds
 s_add_u32 s45, s45, 8192
 s_add_u32 s46, s46, 65536
 v_mfma_f32_16x16x32_bf16 v[36:39], a[20:23], a[8:11], v[36:39]
 v_mfma_f32_16x16x32_bf16 v[52:55], a[20:23], a[12:15], v[52:55]
 v_mfma_f32_16x16x32_bf16 v[48:51], a[16:19], a[12:15], v[48:51]
 v_mfma_f32_16x16x32_bf16 v[32:35], a[16:19], a[8:11], v[32:35]
 s_waitcnt lgkmcnt(0)
 v_mfma_f32_16x16x32_bf16 v[0:3], a[48:51], a[32:35], v[0:3]
 ds_read_b64_tr_b16 a[16:17], v202 offset:0
 v_mfma_f32_16x16x32_bf16 v[16:19], a[48:51], a[36:39], v[16:19]
 ds_read_b64_tr_b16 a[18:19], v202 offset:8192
 s_add_u32 m0, s44, 98304
 v_mfma_f32_16x16x32_bf16 v[20:23], a[52:55], a[36:39], v[20:23]
 ds_read_b128 a[0:3], v200 offset:0
 buffer_load_dwordx4 v210, s[12:15], s45 offen  lds
 v_mfma_f32_16x16x32_bf16 v[4:7], a[52:55], a[32:35], v[4:7]
 ds_read_b64_tr_b16 a[20:21], v203 offset:0
 v_mfma_f32_16x16x32_bf16 v[8:11], a[56:59], a[32:35], v[8:11]
 ds_read_b64_tr_b16 a[22:23], v203 offset:8192
 v_mfma_f32_16x16x32_bf16 v[24:27], a[56:59], a[36:39], v[24:27]
 ds_read_b128 a[4:7], v200 offset:1024
 buffer_load_dwordx4 v210, s[12:15], s45 offen offset:1024  lds
 v_mfma_f32_16x16x32_bf16 v[28:31], a[60:63], a[36:39], v[28:31]
 ds_read_b64_tr_b16 a[24:25], v204 offset:0
 v_mfma_f32_16x16x32_bf16 v[12:15], a[60:63], a[32:35], v[12:15]
 ds_read_b64_tr_b16 a[26:27], v204 offset:8192
 v_mfma_f32_16x16x32_bf16 v[44:47], a[60:63], a[40:43], v[44:47]
 ds_read_b128 a[8:11], v200 offset:4096
 buffer_load_dwordx4 v252, s[16:19], s46 offen offset:2048  lds
 v_mfma_f32_16x16x32_bf16 v[60:63], a[60:63], a[44:47], v[60:63]
 ds_read_b64_tr_b16 a[28:29], v205 offset:0
 v_mfma_f32_16x16x32_bf16 v[56:59], a[56:59], a[44:47], v[56:59]
 ds_read_b64_tr_b16 a[30:31], v205 offset:8192
 v_mfma_f32_16x16x32_bf16 v[40:43], a[56:59], a[40:43], v[40:43]
 ds_read_b128 a[12:15], v200 offset:5120
 buffer_load_dwordx4 v253, s[16:19], s46 offen offset:3072  lds
 s_add_u32 s45, s45, 8192
 s_add_u32 s46, s46, 65536
 v_mfma_f32_16x16x32_bf16 v[36:39], a[52:55], a[40:43], v[36:39]
 v_mfma_f32_16x16x32_bf16 v[52:55], a[52:55], a[44:47], v[52:55]
 v_mfma_f32_16x16x32_bf16 v[48:51], a[48:51], a[44:47], v[48:51]
 v_mfma_f32_16x16x32_bf16 v[32:35], a[48:51], a[40:43], v[32:35]
 s_waitcnt lgkmcnt(0)
 s_waitcnt vmcnt(16)
 s_barrier
 v_mfma_f32_16x16x32_bf16 v[0:3], a[16:19], a[0:3], v[0:3]
 ds_read_b64_tr_b16 a[48:49], v202 offset:16384
 v_mfma_f32_16x16x32_bf16 v[16:19], a[16:19], a[4:7], v[16:19]
 ds_read_b64_tr_b16 a[50:51], v202 offset:24576
 s_add_u32 m0, s44, 114688
 v_mfma_f32_16x16x32_bf16 v[20:23], a[20:23], a[4:7], v[20:23]
 ds_read_b128 a[32:35], v200 offset:16384
 buffer_load_dwordx4 v210, s[12:15], s45 offen  lds
 v_mfma_f32_16x16x32_bf16 v[4:7], a[20:23], a[0:3], v[4:7]
 ds_read_b64_tr_b16 a[52:53], v203 offset:16384
 v_mfma_f32_16x16x32_bf16 v[8:11], a[24:27], a[0:3], v[8:11]
 ds_read_b64_tr_b16 a[54:55], v203 offset:24576
 v_mfma_f32_16x16x32_bf16 v[24:27], a[24:27], a[4:7], v[24:27]
 ds_read_b128 a[36:39], v200 offset:17408
 buffer_load_dwordx4 v210, s[12:15], s45 offen offset:1024  lds
 v_mfma_f32_16x16x32_bf16 v[28:31], a[28:31], a[4:7], v[28:31]
 ds_read_b64_tr_b16 a[56:57], v204 offset:16384
 v_mfma_f32_16x16x32_bf16 v[12:15], a[28:31], a[0:3], v[12:15]
 ds_read_b64_tr_b16 a[58:59], v204 offset:24576
 v_mfma_f32_16x16x32_bf16 v[44:47], a[28:31], a[8:11], v[44:47]
 ds_read_b128 a[40:43], v200 offset:20480
 buffer_load_dwordx4 v252, s[16:19], s46 offen offset:2048  lds
 v_mfma_f32_16x16x32_bf16 v[60:63], a[28:31], a[12:15], v[60:63]
 ds_read_b64_tr_b16 a[60:61], v205 offset:16384
 v_mfma_f32_16x16x32_bf16 v[56:59], a[24:27], a[12:15], v[56:59]
 ds_read_b64_tr_b16 a[62:63], v205 offset:24576
 v_mfma_f32_16x16x32_bf16 v[40:43], a[24:27], a[8:11], v[40:43]
 ds_read_b128 a[44:47], v200 offset:21504
 buffer_load_dwordx4 v253, s[16:19], s46 offen offset:3072  lds
 s_add_u32 s45, s45, 8192
 s_add_u32 s46, s46, 65536
 v_mfma_f32_16x16x32_bf16 v[36:39], a[20:23], a[8:11], v[36:39]
 v_mfma_f32_16x16x32_bf16 v[52:55], a[20:23], a[12:15], v[52:55]
 v_mfma_f32_16x16x32_bf16 v[48:51], a[16:19], a[12:15], v[48:51]
 v_mfma_f32_16x16x32_bf16 v[32:35], a[16:19], a[8:11], v[32:35]
 s_waitcnt lgkmcnt(0)
 v_mfma_f32_16x16x32_bf16 v[0:3], a[48:51], a[32:35], v[0:3]
 ds_read_b64_tr_b16 a[16:17], v202 offset:32768
 v_mfma_f32_16x16x32_bf16 v[16:19], a[48:51], a[36:39], v[16:19]
 ds_read_b64_tr_b16 a[18:19], v202 offset:40960
 s_add_u32 m0, s44, 0
 v_mfma_f32_16x16x32_bf16 v[20:23], a[52:55], a[36:39], v[20:23]
 ds_read_b128 a[0:3], v200 offset:32768
 buffer_load_dwordx4 v210, s[12:15], s45 offen  lds
 v_mfma_f32_16x16x32_bf16 v[4:7], a[52:55], a[32:35], v[4:7]
 ds_read_b64_tr_b16 a[20:21], v203 offset:32768
 v_mfma_f32_16x16x32_bf16 v[8:11], a[56:59], a[32:35], v[8:11]
 ds_read_b64_tr_b16 a[22:23], v203 offset:40960
 v_mfma_f32_16x16x32_bf16 v[24:27], a[56:59], a[36:39], v[24:27]
 ds_read_b128 a[4:7], v200 offset:33792
 buffer_load_dwordx4 v210, s[12:15], s45 offen offset:1024  lds
 v_mfma_f32_16x16x32_bf16 v[28:31], a[60:63], a[36:39], v[28:31]
 ds_read_b64_tr_b16 a[24:25], v204 offset:32768
 v_mfma_f32_16x16x32_bf16 v[12:15], a[60:63], a[32:35], v[12:15]
 ds_read_b64_tr_b16 a[26:27], v204 offset:40960
 v_mfma_f32_16x16x32_bf16 v[44:47], a[60:63], a[40:43], v[44:47]
 ds_read_b128 a[8:11], v200 offset:36864
 buffer_load_dwordx4 v252, s[16:19], s46 offen offset:2048  lds
 v_mfma_f32_16x16x32_bf16 v[60:63], a[60:63], a[44:47], v[60:63]
 ds_read_b64_tr_b16 a[28:29], v205 offset:32768
 v_mfma_f32_16x16x32_bf16 v[56:59], a[56:59], a[44:47], v[56:59]
 ds_read_b64_tr_b16 a[30:31], v205 offset:40960
 v_mfma_f32_16x16x32_bf16 v[40:43], a[56:59], a[40:43], v[40:43]
 ds_read_b128 a[12:15], v200 offset:37888
 buffer_load_dwordx4 v253, s[16:19], s46 offen offset:3072  lds
 s_add_u32 s45, s45, 8192
 s_add_u32 s46, s46, 65536
 v_mfma_f32_16x16x32_bf16 v[36:39], a[52:55], a[40:43], v[36:39]
 v_mfma_f32_16x16x32_bf16 v[52:55], a[52:55], a[44:47], v[52:55]
 v_mfma_f32_16x16x32_bf16 v[48:51], a[48:51], a[44:47], v[48:51]
 v_mfma_f32_16x16x32_bf16 v[32:35], a[48:51], a[40:43], v[32:35]
 s_waitcnt lgkmcnt(0)
 s_waitcnt vmcnt(16)
 s_barrier
 v_mfma_f32_16x16x32_bf16 v[0:3], a[16:19], a[0:3], v[0:3]
 ds_read_b64_tr_b16 a[48:49], v202 offset:49152
 v_mfma_f32_16x16x32_bf16 v[16:19], a[16:19], a[4:7], v[16:19]
 ds_read_b64_tr_b16 a[50:51], v202 offset:57344
 s_add_u32 m0, s44, 16384
 v_mfma_f32_16x16x32_bf16 v[20:23], a[20:23], a[4:7], v[20:23]
 ds_read_b128 a[32:35], v200 offset:49152
 buffer_load_dwordx4 v210, s[12:15], s45 offen  lds
 v_mfma_f32_16x16x32_bf16 v[4:7], a[20:23], a[0:3], v[4:7]
 ds_read_b64_tr_b16 a[52:53], v203 offset:49152
 v_mfma_f32_16x16x32_bf16 v[8:11], a[24:27], a[0:3], v[8:11]
 ds_read_b64_tr_b16 a[54:55], v203 offset:57344
 v_mfma_f32_16x16x32_bf16 v[24:27], a[24:27], a[4:7], v[24:27]
 ds_read_b128 a[36:39], v200 offset:50176
 buffer_load_dwordx4 v210, s[12:15], s45 offen offset:1024  lds
 v_mfma_f32_16x16x32_bf16 v[28:31], a[28:31], a[4:7], v[28:31]
 ds_read_b64_tr_b16 a[56:57], v204 offset:49152
 v_mfma_f32_16x16x32_bf16 v[12:15], a[28:31], a[0:3], v[12:15]
 ds_read_b64_tr_b16 a[58:59], v204 offset:57344
 v_mfma_f32_16x16x32_bf16 v[44:47], a[28:31], a[8:11], v[44:47]
 ds_read_b128 a[40:43], v200 offset:53248
 buffer_load_dwordx4 v252, s[16:19], s46 offen offset:2048  lds
 v_mfma_f32_16x16x32_bf16 v[60:63], a[28:31], a[12:15], v[60:63]
 ds_read_b64_tr_b16 a[60:61], v205 offset:49152
 v_mfma_f32_16x16x32_bf16 v[56:59], a[24:27], a[12:15], v[56:59]
 ds_read_b64_tr_b16 a[62:63], v205 offset:57344
 v_mfma_f32_16x16x32_bf16 v[40:43], a[24:27], a[8:11], v[40:43]
 ds_read_b128 a[44:47], v200 offset:54272
 buffer_load_dwordx4 v253, s[16:19], s46 offen offset:3072  lds
 s_add_u32 s45, s45, 8192
 s_add_u32 s46, s46, 65536
 v_mfma_f32_16x16x32_bf16 v[36:39], a[20:23], a[8:11], v[36:39]
 s_mov_b32 s16, s76
 s_mov_b32 s17, s77
 v_mfma_f32_16x16x32_bf16 v[52:55], a[20:23], a[12:15], v[52:55]
 s_mov_b32 s18, 7344128
 v_mfma_f32_16x16x32_bf16 v[48:51], a[16:19], a[12:15], v[48:51]
 s_mov_b32 s45, s48
 v_mfma_f32_16x16x32_bf16 v[32:35], a[16:19], a[8:11], v[32:35]
 s_mov_b32 s46, s49
 s_waitcnt lgkmcnt(0)
 v_mfma_f32_16x16x32_bf16 v[0:3], a[48:51], a[32:35], v[0:3]
 ds_read_b64_tr_b16 a[16:17], v206 offset:0
 v_mfma_f32_16x16x32_bf16 v[16:19], a[48:51], a[36:39], v[16:19]
 ds_read_b64_tr_b16 a[18:19], v206 offset:8192
 s_add_u32 m0, s44, 32768
 v_mfma_f32_16x16x32_bf16 v[20:23], a[52:55], a[36:39], v[20:23]
 ds_read_b128 a[0:3], v201 offset:0
 buffer_load_dwordx4 v210, s[12:15], s45 offen  lds
 v_mfma_f32_16x16x32_bf16 v[4:7], a[52:55], a[32:35], v[4:7]
 ds_read_b64_tr_b16 a[20:21], v207 offset:0
 v_mfma_f32_16x16x32_bf16 v[8:11], a[56:59], a[32:35], v[8:11]
 ds_read_b64_tr_b16 a[22:23], v207 offset:8192
 v_mfma_f32_16x16x32_bf16 v[24:27], a[56:59], a[36:39], v[24:27]
 ds_read_b128 a[4:7], v201 offset:1024
 buffer_load_dwordx4 v210, s[12:15], s45 offen offset:1024  lds
 v_mfma_f32_16x16x32_bf16 v[28:31], a[60:63], a[36:39], v[28:31]
 ds_read_b64_tr_b16 a[24:25], v208 offset:0
 v_mfma_f32_16x16x32_bf16 v[12:15], a[60:63], a[32:35], v[12:15]
 ds_read_b64_tr_b16 a[26:27], v208 offset:8192
 v_mfma_f32_16x16x32_bf16 v[44:47], a[60:63], a[40:43], v[44:47]
 ds_read_b128 a[8:11], v201 offset:4096
 buffer_load_dwordx4 v252, s[16:19], s46 offen offset:2048  lds
 v_mfma_f32_16x16x32_bf16 v[60:63], a[60:63], a[44:47], v[60:63]
 ds_read_b64_tr_b16 a[28:29], v209 offset:0
 v_mfma_f32_16x16x32_bf16 v[56:59], a[56:59], a[44:47], v[56:59]
 ds_read_b64_tr_b16 a[30:31], v209 offset:8192
 v_mfma_f32_16x16x32_bf16 v[40:43], a[56:59], a[40:43], v[40:43]
 ds_read_b128 a[12:15], v201 offset:5120
 buffer_load_dwordx4 v253, s[16:19], s46 offen offset:3072  lds
 s_add_u32 s45, s45, 8192
 s_add_u32 s46, s46, 65536
 v_mfma_f32_16x16x32_bf16 v[36:39], a[52:55], a[40:43], v[36:39]
 v_mfma_f32_16x16x32_bf16 v[52:55], a[52:55], a[44:47], v[52:55]
 v_mfma_f32_16x16x32_bf16 v[48:51], a[48:51], a[44:47], v[48:51]
 v_mfma_f32_16x16x32_bf16 v[32:35], a[48:51], a[40:43], v[32:35]
 s_waitcnt lgkmcnt(0)
 s_waitcnt vmcnt(16)
 s_barrier
 v_mfma_f32_16x16x32_bf16 v[0:3], a[16:19], a[0:3], v[0:3]
 ds_read_b64_tr_b16 a[48:49], v206 offset:16384
 v_mfma_f32_16x16x32_bf16 v[16:19], a[16:19], a[4:7], v[16:19]
 ds_read_b64_tr_b16 a[50:51], v206 offset:24576
 s_add_u32 m0, s44, 49152
 v_mfma_f32_16x16x32_bf16 v[20:23], a[20:23], a[4:7], v[20:23]
 ds_read_b128 a[32:35], v201 offset:16384
 buffer_load_dwordx4 v210, s[12:15], s45 offen  lds
 v_mfma_f32_16x16x32_bf16 v[4:7], a[20:23], a[0:3], v[4:7]
 ds_read_b64_tr_b16 a[52:53], v207 offset:16384
 v_mfma_f32_16x16x32_bf16 v[8:11], a[24:27], a[0:3], v[8:11]
 ds_read_b64_tr_b16 a[54:55], v207 offset:24576
 v_mfma_f32_16x16x32_bf16 v[24:27], a[24:27], a[4:7], v[24:27]
 ds_read_b128 a[36:39], v201 offset:17408
 buffer_load_dwordx4 v210, s[12:15], s45 offen offset:1024  lds
 v_mfma_f32_16x16x32_bf16 v[28:31], a[28:31], a[4:7], v[28:31]
 ds_read_b64_tr_b16 a[56:57], v208 offset:16384
 v_mfma_f32_16x16x32_bf16 v[12:15], a[28:31], a[0:3], v[12:15]
 ds_read_b64_tr_b16 a[58:59], v208 offset:24576
 v_mfma_f32_16x16x32_bf16 v[44:47], a[28:31], a[8:11], v[44:47]
 ds_read_b128 a[40:43], v201 offset:20480
 buffer_load_dwordx4 v252, s[16:19], s46 offen offset:2048  lds
 v_mfma_f32_16x16x32_bf16 v[60:63], a[28:31], a[12:15], v[60:63]
 ds_read_b64_tr_b16 a[60:61], v209 offset:16384
 v_mfma_f32_16x16x32_bf16 v[56:59], a[24:27], a[12:15], v[56:59]
 ds_read_b64_tr_b16 a[62:63], v209 offset:24576
 v_mfma_f32_16x16x32_bf16 v[40:43], a[24:27], a[8:11], v[40:43]
 ds_read_b128 a[44:47], v201 offset:21504
 buffer_load_dwordx4 v253, s[16:19], s46 offen offset:3072  lds
 s_add_u32 s45, s45, 8192
 s_add_u32 s46, s46, 65536
 v_mfma_f32_16x16x32_bf16 v[36:39], a[20:23], a[8:11], v[36:39]
 v_mfma_f32_16x16x32_bf16 v[52:55], a[20:23], a[12:15], v[52:55]
 v_mfma_f32_16x16x32_bf16 v[48:51], a[16:19], a[12:15], v[48:51]
 v_mfma_f32_16x16x32_bf16 v[32:35], a[16:19], a[8:11], v[32:35]
 s_waitcnt lgkmcnt(0)
 v_mfma_f32_16x16x32_bf16 v[0:3], a[48:51], a[32:35], v[0:3]
 ds_read_b64_tr_b16 a[16:17], v206 offset:32768
 v_mfma_f32_16x16x32_bf16 v[16:19], a[48:51], a[36:39], v[16:19]
 ds_read_b64_tr_b16 a[18:19], v206 offset:40960
 s_add_u32 m0, s44, 65536
 v_mfma_f32_16x16x32_bf16 v[20:23], a[52:55], a[36:39], v[20:23]
 ds_read_b128 a[0:3], v201 offset:32768
 buffer_load_dwordx4 v210, s[12:15], s45 offen  lds
 v_mfma_f32_16x16x32_bf16 v[4:7], a[52:55], a[32:35], v[4:7]
 ds_read_b64_tr_b16 a[20:21], v207 offset:32768
 v_mfma_f32_16x16x32_bf16 v[8:11], a[56:59], a[32:35], v[8:11]
 ds_read_b64_tr_b16 a[22:23], v207 offset:40960
 v_mfma_f32_16x16x32_bf16 v[24:27], a[56:59], a[36:39], v[24:27]
 ds_read_b128 a[4:7], v201 offset:33792
 buffer_load_dwordx4 v210, s[12:15], s45 offen offset:1024  lds
 v_mfma_f32_16x16x32_bf16 v[28:31], a[60:63], a[36:39], v[28:31]
 ds_read_b64_tr_b16 a[24:25], v208 offset:32768
 v_mfma_f32_16x16x32_bf16 v[12:15], a[60:63], a[32:35], v[12:15]
 ds_read_b64_tr_b16 a[26:27], v208 offset:40960
 v_mfma_f32_16x16x32_bf16 v[44:47], a[60:63], a[40:43], v[44:47]
 ds_read_b128 a[8:11], v201 offset:36864
 buffer_load_dwordx4 v252, s[16:19], s46 offen offset:2048  lds
 v_mfma_f32_16x16x32_bf16 v[60:63], a[60:63], a[44:47], v[60:63]
 ds_read_b64_tr_b16 a[28:29], v209 offset:32768
 v_mfma_f32_16x16x32_bf16 v[56:59], a[56:59], a[44:47], v[56:59]
 ds_read_b64_tr_b16 a[30:31], v209 offset:40960
 v_mfma_f32_16x16x32_bf16 v[40:43], a[56:59], a[40:43], v[40:43]
 ds_read_b128 a[12:15], v201 offset:37888
 buffer_load_dwordx4 v253, s[16:19], s46 offen offset:3072  lds
 s_add_u32 s45, s45, 8192
 s_add_u32 s46, s46, 65536
 v_mfma_f32_16x16x32_bf16 v[36:39], a[52:55], a[40:43], v[36:39]
 v_mfma_f32_16x16x32_bf16 v[52:55], a[52:55], a[44:47], v[52:55]
 v_mfma_f32_16x16x32_bf16 v[48:51], a[48:51], a[44:47], v[48:51]
 v_mfma_f32_16x16x32_bf16 v[32:35], a[48:51], a[40:43], v[32:35]
 s_waitcnt lgkmcnt(0)
 s_waitcnt vmcnt(16)
 s_barrier
 v_mfma_f32_16x16x32_bf16 v[0:3], a[16:19], a[0:3], v[0:3]
 ds_read_b64_tr_b16 a[48:49], v206 offset:49152
 v_mfma_f32_16x16x32_bf16 v[16:19], a[16:19], a[4:7], v[16:19]
 ds_read_b64_tr_b16 a[50:51], v206 offset:57344
 s_add_u32 m0, s44, 81920
 v_mfma_f32_16x16x32_bf16 v[20:23], a[20:23], a[4:7], v[20:23]
 ds_read_b128 a[32:35], v201 offset:49152
 buffer_load_dwordx4 v210, s[12:15], s45 offen  lds
 v_mfma_f32_16x16x32_bf16 v[4:7], a[20:23], a[0:3], v[4:7]
 ds_read_b64_tr_b16 a[52:53], v207 offset:49152
 v_mfma_f32_16x16x32_bf16 v[8:11], a[24:27], a[0:3], v[8:11]
 ds_read_b64_tr_b16 a[54:55], v207 offset:57344
 v_mfma_f32_16x16x32_bf16 v[24:27], a[24:27], a[4:7], v[24:27]
 ds_read_b128 a[36:39], v201 offset:50176
 buffer_load_dwordx4 v210, s[12:15], s45 offen offset:1024  lds
 v_mfma_f32_16x16x32_bf16 v[28:31], a[28:31], a[4:7], v[28:31]
 ds_read_b64_tr_b16 a[56:57], v208 offset:49152
 v_mfma_f32_16x16x32_bf16 v[12:15], a[28:31], a[0:3], v[12:15]
 ds_read_b64_tr_b16 a[58:59], v208 offset:57344
 v_mfma_f32_16x16x32_bf16 v[44:47], a[28:31], a[8:11], v[44:47]
 ds_read_b128 a[40:43], v201 offset:53248
 buffer_load_dwordx4 v252, s[16:19], s46 offen offset:2048  lds
 v_mfma_f32_16x16x32_bf16 v[60:63], a[28:31], a[12:15], v[60:63]
 ds_read_b64_tr_b16 a[60:61], v209 offset:49152
 v_mfma_f32_16x16x32_bf16 v[56:59], a[24:27], a[12:15], v[56:59]
 ds_read_b64_tr_b16 a[62:63], v209 offset:57344
 v_mfma_f32_16x16x32_bf16 v[40:43], a[24:27], a[8:11], v[40:43]
 ds_read_b128 a[44:47], v201 offset:54272
 buffer_load_dwordx4 v253, s[16:19], s46 offen offset:3072  lds
 s_add_u32 s45, s45, 8192
 s_add_u32 s46, s46, 65536
 v_mfma_f32_16x16x32_bf16 v[36:39], a[20:23], a[8:11], v[36:39]
 v_mfma_f32_16x16x32_bf16 v[52:55], a[20:23], a[12:15], v[52:55]
 v_mfma_f32_16x16x32_bf16 v[48:51], a[16:19], a[12:15], v[48:51]
 v_mfma_f32_16x16x32_bf16 v[32:35], a[16:19], a[8:11], v[32:35]
 s_waitcnt lgkmcnt(0)
 v_mfma_f32_16x16x32_bf16 v[0:3], a[48:51], a[32:35], v[0:3]
 ds_read_b64_tr_b16 a[16:17], v202 offset:0
 v_mfma_f32_16x16x32_bf16 v[16:19], a[48:51], a[36:39], v[16:19]
 ds_read_b64_tr_b16 a[18:19], v202 offset:8192
 s_add_u32 m0, s44, 98304
 v_mfma_f32_16x16x32_bf16 v[20:23], a[52:55], a[36:39], v[20:23]
 ds_read_b128 a[0:3], v200 offset:0
 buffer_load_dwordx4 v210, s[12:15], s45 offen  lds
 v_mfma_f32_16x16x32_bf16 v[4:7], a[52:55], a[32:35], v[4:7]
 ds_read_b64_tr_b16 a[20:21], v203 offset:0
 v_mfma_f32_16x16x32_bf16 v[8:11], a[56:59], a[32:35], v[8:11]
 ds_read_b64_tr_b16 a[22:23], v203 offset:8192
 v_mfma_f32_16x16x32_bf16 v[24:27], a[56:59], a[36:39], v[24:27]
 ds_read_b128 a[4:7], v200 offset:1024
 buffer_load_dwordx4 v210, s[12:15], s45 offen offset:1024  lds
 v_mfma_f32_16x16x32_bf16 v[28:31], a[60:63], a[36:39], v[28:31]
 ds_read_b64_tr_b16 a[24:25], v204 offset:0
 v_mfma_f32_16x16x32_bf16 v[12:15], a[60:63], a[32:35], v[12:15]
 ds_read_b64_tr_b16 a[26:27], v204 offset:8192
 v_mfma_f32_16x16x32_bf16 v[44:47], a[60:63], a[40:43], v[44:47]
 ds_read_b128 a[8:11], v200 offset:4096
 buffer_load_dwordx4 v252, s[16:19], s46 offen offset:2048  lds
 v_mfma_f32_16x16x32_bf16 v[60:63], a[60:63], a[44:47], v[60:63]
 ds_read_b64_tr_b16 a[28:29], v205 offset:0
 v_mfma_f32_16x16x32_bf16 v[56:59], a[56:59], a[44:47], v[56:59]
 ds_read_b64_tr_b16 a[30:31], v205 offset:8192
 v_mfma_f32_16x16x32_bf16 v[40:43], a[56:59], a[40:43], v[40:43]
 ds_read_b128 a[12:15], v200 offset:5120
 buffer_load_dwordx4 v253, s[16:19], s46 offen offset:3072  lds
 s_add_u32 s45, s45, 8192
 s_add_u32 s46, s46, 65536
 v_mfma_f32_16x16x32_bf16 v[36:39], a[52:55], a[40:43], v[36:39]
 v_mfma_f32_16x16x32_bf16 v[52:55], a[52:55], a[44:47], v[52:55]
 v_mfma_f32_16x16x32_bf16 v[48:51], a[48:51], a[44:47], v[48:51]
 v_mfma_f32_16x16x32_bf16 v[32:35], a[48:51], a[40:43], v[32:35]
 s_waitcnt lgkmcnt(0)
 s_waitcnt vmcnt(16)
 s_barrier
 v_mfma_f32_16x16x32_bf16 v[0:3], a[16:19], a[0:3], v[0:3]
 ds_read_b64_tr_b16 a[48:49], v202 offset:16384
 v_mfma_f32_16x16x32_bf16 v[16:19], a[16:19], a[4:7], v[16:19]
 ds_read_b64_tr_b16 a[50:51], v202 offset:24576
 s_add_u32 m0, s44, 114688
 v_mfma_f32_16x16x32_bf16 v[20:23], a[20:23], a[4:7], v[20:23]
 ds_read_b128 a[32:35], v200 offset:16384
 buffer_load_dwordx4 v210, s[12:15], s45 offen  lds
 v_mfma_f32_16x16x32_bf16 v[4:7], a[20:23], a[0:3], v[4:7]
 ds_read_b64_tr_b16 a[52:53], v203 offset:16384
 v_mfma_f32_16x16x32_bf16 v[8:11], a[24:27], a[0:3], v[8:11]
 ds_read_b64_tr_b16 a[54:55], v203 offset:24576
 v_mfma_f32_16x16x32_bf16 v[24:27], a[24:27], a[4:7], v[24:27]
 ds_read_b128 a[36:39], v200 offset:17408
 buffer_load_dwordx4 v210, s[12:15], s45 offen offset:1024  lds
 v_mfma_f32_16x16x32_bf16 v[28:31], a[28:31], a[4:7], v[28:31]
 ds_read_b64_tr_b16 a[56:57], v204 offset:16384
 v_mfma_f32_16x16x32_bf16 v[12:15], a[28:31], a[0:3], v[12:15]
 ds_read_b64_tr_b16 a[58:59], v204 offset:24576
 v_mfma_f32_16x16x32_bf16 v[44:47], a[28:31], a[8:11], v[44:47]
 ds_read_b128 a[40:43], v200 offset:20480
 buffer_load_dwordx4 v252, s[16:19], s46 offen offset:2048  lds
 v_mfma_f32_16x16x32_bf16 v[60:63], a[28:31], a[12:15], v[60:63]
 ds_read_b64_tr_b16 a[60:61], v205 offset:16384
 v_mfma_f32_16x16x32_bf16 v[56:59], a[24:27], a[12:15], v[56:59]
 ds_read_b64_tr_b16 a[62:63], v205 offset:24576
 v_mfma_f32_16x16x32_bf16 v[40:43], a[24:27], a[8:11], v[40:43]
 ds_read_b128 a[44:47], v200 offset:21504
 buffer_load_dwordx4 v253, s[16:19], s46 offen offset:3072  lds
 s_add_u32 s45, s45, 8192
 s_add_u32 s46, s46, 65536
 v_mfma_f32_16x16x32_bf16 v[36:39], a[20:23], a[8:11], v[36:39]
 v_mfma_f32_16x16x32_bf16 v[52:55], a[20:23], a[12:15], v[52:55]
 v_mfma_f32_16x16x32_bf16 v[48:51], a[16:19], a[12:15], v[48:51]
 v_mfma_f32_16x16x32_bf16 v[32:35], a[16:19], a[8:11], v[32:35]
 s_waitcnt lgkmcnt(0)
 v_mfma_f32_16x16x32_bf16 v[0:3], a[48:51], a[32:35], v[0:3]
 ds_read_b64_tr_b16 a[16:17], v202 offset:32768
 v_mfma_f32_16x16x32_bf16 v[16:19], a[48:51], a[36:39], v[16:19]
 ds_read_b64_tr_b16 a[18:19], v202 offset:40960
 s_add_u32 m0, s44, 0
 v_mfma_f32_16x16x32_bf16 v[20:23], a[52:55], a[36:39], v[20:23]
 ds_read_b128 a[0:3], v200 offset:32768
 buffer_load_dwordx4 v210, s[12:15], s45 offen  lds
 v_mfma_f32_16x16x32_bf16 v[4:7], a[52:55], a[32:35], v[4:7]
 ds_read_b64_tr_b16 a[20:21], v203 offset:32768
 v_mfma_f32_16x16x32_bf16 v[8:11], a[56:59], a[32:35], v[8:11]
 ds_read_b64_tr_b16 a[22:23], v203 offset:40960
 v_mfma_f32_16x16x32_bf16 v[24:27], a[56:59], a[36:39], v[24:27]
 ds_read_b128 a[4:7], v200 offset:33792
 buffer_load_dwordx4 v210, s[12:15], s45 offen offset:1024  lds
 v_mfma_f32_16x16x32_bf16 v[28:31], a[60:63], a[36:39], v[28:31]
 ds_read_b64_tr_b16 a[24:25], v204 offset:32768
 v_mfma_f32_16x16x32_bf16 v[12:15], a[60:63], a[32:35], v[12:15]
 ds_read_b64_tr_b16 a[26:27], v204 offset:40960
 v_mfma_f32_16x16x32_bf16 v[44:47], a[60:63], a[40:43], v[44:47]
 ds_read_b128 a[8:11], v200 offset:36864
 buffer_load_dwordx4 v252, s[16:19], s46 offen offset:2048  lds
 v_mfma_f32_16x16x32_bf16 v[60:63], a[60:63], a[44:47], v[60:63]
 ds_read_b64_tr_b16 a[28:29], v205 offset:32768
 v_mfma_f32_16x16x32_bf16 v[56:59], a[56:59], a[44:47], v[56:59]
 ds_read_b64_tr_b16 a[30:31], v205 offset:40960
 v_mfma_f32_16x16x32_bf16 v[40:43], a[56:59], a[40:43], v[40:43]
 ds_read_b128 a[12:15], v200 offset:37888
 buffer_load_dwordx4 v253, s[16:19], s46 offen offset:3072  lds
 s_add_u32 s45, s45, 8192
 s_add_u32 s46, s46, 65536
 v_mfma_f32_16x16x32_bf16 v[36:39], a[52:55], a[40:43], v[36:39]
 v_mfma_f32_16x16x32_bf16 v[52:55], a[52:55], a[44:47], v[52:55]
 v_mfma_f32_16x16x32_bf16 v[48:51], a[48:51], a[44:47], v[48:51]
 v_mfma_f32_16x16x32_bf16 v[32:35], a[48:51], a[40:43], v[32:35]
 s_waitcnt lgkmcnt(0)
 s_waitcnt vmcnt(16)
 s_barrier
 v_mfma_f32_16x16x32_bf16 v[64:67], a[16:19], a[0:3], 0
 ds_read_b64_tr_b16 a[48:49], v202 offset:49152
 v_mfma_f32_16x16x32_bf16 v[80:83], a[16:19], a[4:7], 0
 ds_read_b64_tr_b16 a[50:51], v202 offset:57344
 s_add_u32 m0, s44, 16384
 v_mfma_f32_16x16x32_bf16 v[84:87], a[20:23], a[4:7], 0
 ds_read_b128 a[32:35], v200 offset:49152
 buffer_load_dwordx4 v210, s[12:15], s45 offen  lds
 v_mfma_f32_16x16x32_bf16 v[68:71], a[20:23], a[0:3], 0
 ds_read_b64_tr_b16 a[52:53], v203 offset:49152
 v_mfma_f32_16x16x32_bf16 v[72:75], a[24:27], a[0:3], 0
 ds_read_b64_tr_b16 a[54:55], v203 offset:57344
 v_mfma_f32_16x16x32_bf16 v[88:91], a[24:27], a[4:7], 0
 ds_read_b128 a[36:39], v200 offset:50176
 buffer_load_dwordx4 v210, s[12:15], s45 offen offset:1024  lds
 v_mfma_f32_16x16x32_bf16 v[92:95], a[28:31], a[4:7], 0
 ds_read_b64_tr_b16 a[56:57], v204 offset:49152
 v_mfma_f32_16x16x32_bf16 v[76:79], a[28:31], a[0:3], 0
 ds_read_b64_tr_b16 a[58:59], v204 offset:57344
 v_mfma_f32_16x16x32_bf16 v[108:111], a[28:31], a[8:11], 0
 ds_read_b128 a[40:43], v200 offset:53248
 buffer_load_dwordx4 v252, s[16:19], s46 offen offset:2048  lds
 v_mfma_f32_16x16x32_bf16 v[124:127], a[28:31], a[12:15], 0
 ds_read_b64_tr_b16 a[60:61], v205 offset:49152
 v_mfma_f32_16x16x32_bf16 v[120:123], a[24:27], a[12:15], 0
 ds_read_b64_tr_b16 a[62:63], v205 offset:57344
 v_mfma_f32_16x16x32_bf16 v[104:107], a[24:27], a[8:11], 0
 ds_read_b128 a[44:47], v200 offset:54272
 buffer_load_dwordx4 v253, s[16:19], s46 offen offset:3072  lds
 s_add_u32 s45, s45, 8192
 s_add_u32 s46, s46, 65536
 v_mfma_f32_16x16x32_bf16 v[100:103], a[20:23], a[8:11], 0
 v_mfma_f32_16x16x32_bf16 v[116:119], a[20:23], a[12:15], 0
 v_mfma_f32_16x16x32_bf16 v[112:115], a[16:19], a[12:15], 0
 v_mfma_f32_16x16x32_bf16 v[96:99], a[16:19], a[8:11], 0
 s_waitcnt lgkmcnt(0)
 v_mfma_f32_16x16x32_bf16 v[64:67], a[48:51], a[32:35], v[64:67]
 ds_read_b64_tr_b16 a[16:17], v206 offset:0
 v_mfma_f32_16x16x32_bf16 v[80:83], a[48:51], a[36:39], v[80:83]
 ds_read_b64_tr_b16 a[18:19], v206 offset:8192
 s_add_u32 m0, s44, 32768
 v_mfma_f32_16x16x32_bf16 v[84:87], a[52:55], a[36:39], v[84:87]
 ds_read_b128 a[0:3], v201 offset:0
 buffer_load_dwordx4 v210, s[12:15], s45 offen  lds
 v_mfma_f32_16x16x32_bf16 v[68:71], a[52:55], a[32:35], v[68:71]
 ds_read_b64_tr_b16 a[20:21], v207 offset:0
 v_mfma_f32_16x16x32_bf16 v[72:75], a[56:59], a[32:35], v[72:75]
 ds_read_b64_tr_b16 a[22:23], v207 offset:8192
 v_mfma_f32_16x16x32_bf16 v[88:91], a[56:59], a[36:39], v[88:91]
 ds_read_b128 a[4:7], v201 offset:1024
 buffer_load_dwordx4 v210, s[12:15], s45 offen offset:1024  lds
 v_mfma_f32_16x16x32_bf16 v[92:95], a[60:63], a[36:39], v[92:95]
 ds_read_b64_tr_b16 a[24:25], v208 offset:0
 v_mfma_f32_16x16x32_bf16 v[76:79], a[60:63], a[32:35], v[76:79]
 ds_read_b64_tr_b16 a[26:27], v208 offset:8192
 v_mfma_f32_16x16x32_bf16 v[108:111], a[60:63], a[40:43], v[108:111]
 ds_read_b128 a[8:11], v201 offset:4096
 buffer_load_dwordx4 v252, s[16:19], s46 offen offset:2048  lds
 v_mfma_f32_16x16x32_bf16 v[124:127], a[60:63], a[44:47], v[124:127]
 ds_read_b64_tr_b16 a[28:29], v209 offset:0
 v_mfma_f32_16x16x32_bf16 v[120:123], a[56:59], a[44:47], v[120:123]
 ds_read_b64_tr_b16 a[30:31], v209 offset:8192
 v_mfma_f32_16x16x32_bf16 v[104:107], a[56:59], a[40:43], v[104:107]
 ds_read_b128 a[12:15], v201 offset:5120
 buffer_load_dwordx4 v253, s[16:19], s46 offen offset:3072  lds
 s_add_u32 s45, s45, 8192
 s_add_u32 s46, s46, 65536
 v_mfma_f32_16x16x32_bf16 v[100:103], a[52:55], a[40:43], v[100:103]
 v_mfma_f32_16x16x32_bf16 v[116:119], a[52:55], a[44:47], v[116:119]
 v_mfma_f32_16x16x32_bf16 v[112:115], a[48:51], a[44:47], v[112:115]
 v_mfma_f32_16x16x32_bf16 v[96:99], a[48:51], a[40:43], v[96:99]
 s_waitcnt lgkmcnt(0)
 s_waitcnt vmcnt(16)
 s_barrier
 v_mfma_f32_16x16x32_bf16 v[64:67], a[16:19], a[0:3], v[64:67]
 ds_read_b64_tr_b16 a[48:49], v206 offset:16384
 v_mfma_f32_16x16x32_bf16 v[80:83], a[16:19], a[4:7], v[80:83]
 ds_read_b64_tr_b16 a[50:51], v206 offset:24576
 s_add_u32 m0, s44, 49152
 v_mfma_f32_16x16x32_bf16 v[84:87], a[20:23], a[4:7], v[84:87]
 ds_read_b128 a[32:35], v201 offset:16384
 buffer_load_dwordx4 v210, s[12:15], s45 offen  lds
 v_mfma_f32_16x16x32_bf16 v[68:71], a[20:23], a[0:3], v[68:71]
 ds_read_b64_tr_b16 a[52:53], v207 offset:16384
 v_mfma_f32_16x16x32_bf16 v[72:75], a[24:27], a[0:3], v[72:75]
 ds_read_b64_tr_b16 a[54:55], v207 offset:24576
 v_mfma_f32_16x16x32_bf16 v[88:91], a[24:27], a[4:7], v[88:91]
 ds_read_b128 a[36:39], v201 offset:17408
 buffer_load_dwordx4 v210, s[12:15], s45 offen offset:1024  lds
 v_mfma_f32_16x16x32_bf16 v[92:95], a[28:31], a[4:7], v[92:95]
 ds_read_b64_tr_b16 a[56:57], v208 offset:16384
 v_mfma_f32_16x16x32_bf16 v[76:79], a[28:31], a[0:3], v[76:79]
 ds_read_b64_tr_b16 a[58:59], v208 offset:24576
 v_mfma_f32_16x16x32_bf16 v[108:111], a[28:31], a[8:11], v[108:111]
 ds_read_b128 a[40:43], v201 offset:20480
 buffer_load_dwordx4 v252, s[16:19], s46 offen offset:2048  lds
 v_mfma_f32_16x16x32_bf16 v[124:127], a[28:31], a[12:15], v[124:127]
 ds_read_b64_tr_b16 a[60:61], v209 offset:16384
 v_mfma_f32_16x16x32_bf16 v[120:123], a[24:27], a[12:15], v[120:123]
 ds_read_b64_tr_b16 a[62:63], v209 offset:24576
 v_mfma_f32_16x16x32_bf16 v[104:107], a[24:27], a[8:11], v[104:107]
 ds_read_b128 a[44:47], v201 offset:21504
 buffer_load_dwordx4 v253, s[16:19], s46 offen offset:3072  lds
 s_add_u32 s45, s45, 8192
 s_add_u32 s46, s46, 65536
 v_mfma_f32_16x16x32_bf16 v[100:103], a[20:23], a[8:11], v[100:103]
 v_mfma_f32_16x16x32_bf16 v[116:119], a[20:23], a[12:15], v[116:119]
 v_mfma_f32_16x16x32_bf16 v[112:115], a[16:19], a[12:15], v[112:115]
 v_mfma_f32_16x16x32_bf16 v[96:99], a[16:19], a[8:11], v[96:99]
 s_waitcnt lgkmcnt(0)
 v_mfma_f32_16x16x32_bf16 v[64:67], a[48:51], a[32:35], v[64:67]
 ds_read_b64_tr_b16 a[16:17], v206 offset:32768
 v_mfma_f32_16x16x32_bf16 v[80:83], a[48:51], a[36:39], v[80:83]
 ds_read_b64_tr_b16 a[18:19], v206 offset:40960
 s_add_u32 m0, s44, 65536
 v_mfma_f32_16x16x32_bf16 v[84:87], a[52:55], a[36:39], v[84:87]
 ds_read_b128 a[0:3], v201 offset:32768
 buffer_load_dwordx4 v210, s[12:15], s45 offen  lds
 v_mfma_f32_16x16x32_bf16 v[68:71], a[52:55], a[32:35], v[68:71]
 ds_read_b64_tr_b16 a[20:21], v207 offset:32768
 v_mfma_f32_16x16x32_bf16 v[72:75], a[56:59], a[32:35], v[72:75]
 ds_read_b64_tr_b16 a[22:23], v207 offset:40960
 v_mfma_f32_16x16x32_bf16 v[88:91], a[56:59], a[36:39], v[88:91]
 ds_read_b128 a[4:7], v201 offset:33792
 buffer_load_dwordx4 v210, s[12:15], s45 offen offset:1024  lds
 v_mfma_f32_16x16x32_bf16 v[92:95], a[60:63], a[36:39], v[92:95]
 ds_read_b64_tr_b16 a[24:25], v208 offset:32768
 v_mfma_f32_16x16x32_bf16 v[76:79], a[60:63], a[32:35], v[76:79]
 ds_read_b64_tr_b16 a[26:27], v208 offset:40960
 v_mfma_f32_16x16x32_bf16 v[108:111], a[60:63], a[40:43], v[108:111]
 ds_read_b128 a[8:11], v201 offset:36864
 buffer_load_dwordx4 v252, s[16:19], s46 offen offset:2048  lds
 v_mfma_f32_16x16x32_bf16 v[124:127], a[60:63], a[44:47], v[124:127]
 ds_read_b64_tr_b16 a[28:29], v209 offset:32768
 v_mfma_f32_16x16x32_bf16 v[120:123], a[56:59], a[44:47], v[120:123]
 ds_read_b64_tr_b16 a[30:31], v209 offset:40960
 v_mfma_f32_16x16x32_bf16 v[104:107], a[56:59], a[40:43], v[104:107]
 ds_read_b128 a[12:15], v201 offset:37888
 buffer_load_dwordx4 v253, s[16:19], s46 offen offset:3072  lds
 s_add_u32 s45, s45, 8192
 s_add_u32 s46, s46, 65536
 v_mfma_f32_16x16x32_bf16 v[100:103], a[52:55], a[40:43], v[100:103]
 v_mfma_f32_16x16x32_bf16 v[116:119], a[52:55], a[44:47], v[116:119]
 v_mfma_f32_16x16x32_bf16 v[112:115], a[48:51], a[44:47], v[112:115]
 v_mfma_f32_16x16x32_bf16 v[96:99], a[48:51], a[40:43], v[96:99]
 s_waitcnt lgkmcnt(0)
 s_waitcnt vmcnt(16)
 s_barrier
 v_mfma_f32_16x16x32_bf16 v[64:67], a[16:19], a[0:3], v[64:67]
 ds_read_b64_tr_b16 a[48:49], v206 offset:49152
 v_mfma_f32_16x16x32_bf16 v[80:83], a[16:19], a[4:7], v[80:83]
 ds_read_b64_tr_b16 a[50:51], v206 offset:57344
 s_add_u32 m0, s44, 81920
 v_mfma_f32_16x16x32_bf16 v[84:87], a[20:23], a[4:7], v[84:87]
 ds_read_b128 a[32:35], v201 offset:49152
 buffer_load_dwordx4 v210, s[12:15], s45 offen  lds
 v_mfma_f32_16x16x32_bf16 v[68:71], a[20:23], a[0:3], v[68:71]
 ds_read_b64_tr_b16 a[52:53], v207 offset:49152
 v_mfma_f32_16x16x32_bf16 v[72:75], a[24:27], a[0:3], v[72:75]
 ds_read_b64_tr_b16 a[54:55], v207 offset:57344
 v_mfma_f32_16x16x32_bf16 v[88:91], a[24:27], a[4:7], v[88:91]
 ds_read_b128 a[36:39], v201 offset:50176
 buffer_load_dwordx4 v210, s[12:15], s45 offen offset:1024  lds
 v_mfma_f32_16x16x32_bf16 v[92:95], a[28:31], a[4:7], v[92:95]
 ds_read_b64_tr_b16 a[56:57], v208 offset:49152
 v_mfma_f32_16x16x32_bf16 v[76:79], a[28:31], a[0:3], v[76:79]
 ds_read_b64_tr_b16 a[58:59], v208 offset:57344
 v_mfma_f32_16x16x32_bf16 v[108:111], a[28:31], a[8:11], v[108:111]
 ds_read_b128 a[40:43], v201 offset:53248
 buffer_load_dwordx4 v252, s[16:19], s46 offen offset:2048  lds
 v_mfma_f32_16x16x32_bf16 v[124:127], a[28:31], a[12:15], v[124:127]
 ds_read_b64_tr_b16 a[60:61], v209 offset:49152
 v_mfma_f32_16x16x32_bf16 v[120:123], a[24:27], a[12:15], v[120:123]
 ds_read_b64_tr_b16 a[62:63], v209 offset:57344
 v_mfma_f32_16x16x32_bf16 v[104:107], a[24:27], a[8:11], v[104:107]
 ds_read_b128 a[44:47], v201 offset:54272
 buffer_load_dwordx4 v253, s[16:19], s46 offen offset:3072  lds
 s_add_u32 s45, s45, 8192
 s_add_u32 s46, s46, 65536
 v_mfma_f32_16x16x32_bf16 v[100:103], a[20:23], a[8:11], v[100:103]
 v_mfma_f32_16x16x32_bf16 v[116:119], a[20:23], a[12:15], v[116:119]
 v_mfma_f32_16x16x32_bf16 v[112:115], a[16:19], a[12:15], v[112:115]
 v_mfma_f32_16x16x32_bf16 v[96:99], a[16:19], a[8:11], v[96:99]
 s_waitcnt lgkmcnt(0)
 v_mfma_f32_16x16x32_bf16 v[64:67], a[48:51], a[32:35], v[64:67]
 ds_read_b64_tr_b16 a[16:17], v202 offset:0
 v_mfma_f32_16x16x32_bf16 v[80:83], a[48:51], a[36:39], v[80:83]
 ds_read_b64_tr_b16 a[18:19], v202 offset:8192
 s_add_u32 m0, s44, 98304
 v_mfma_f32_16x16x32_bf16 v[84:87], a[52:55], a[36:39], v[84:87]
 ds_read_b128 a[0:3], v200 offset:0
 buffer_load_dwordx4 v210, s[12:15], s45 offen  lds
 v_mfma_f32_16x16x32_bf16 v[68:71], a[52:55], a[32:35], v[68:71]
 ds_read_b64_tr_b16 a[20:21], v203 offset:0
 v_mfma_f32_16x16x32_bf16 v[72:75], a[56:59], a[32:35], v[72:75]
 ds_read_b64_tr_b16 a[22:23], v203 offset:8192
 v_mfma_f32_16x16x32_bf16 v[88:91], a[56:59], a[36:39], v[88:91]
 ds_read_b128 a[4:7], v200 offset:1024
 buffer_load_dwordx4 v210, s[12:15], s45 offen offset:1024  lds
 v_mfma_f32_16x16x32_bf16 v[92:95], a[60:63], a[36:39], v[92:95]
 ds_read_b64_tr_b16 a[24:25], v204 offset:0
 v_mfma_f32_16x16x32_bf16 v[76:79], a[60:63], a[32:35], v[76:79]
 ds_read_b64_tr_b16 a[26:27], v204 offset:8192
 v_mfma_f32_16x16x32_bf16 v[108:111], a[60:63], a[40:43], v[108:111]
 ds_read_b128 a[8:11], v200 offset:4096
 buffer_load_dwordx4 v252, s[16:19], s46 offen offset:2048  lds
 v_mfma_f32_16x16x32_bf16 v[124:127], a[60:63], a[44:47], v[124:127]
 ds_read_b64_tr_b16 a[28:29], v205 offset:0
 v_mfma_f32_16x16x32_bf16 v[120:123], a[56:59], a[44:47], v[120:123]
 ds_read_b64_tr_b16 a[30:31], v205 offset:8192
 v_mfma_f32_16x16x32_bf16 v[104:107], a[56:59], a[40:43], v[104:107]
 ds_read_b128 a[12:15], v200 offset:5120
 buffer_load_dwordx4 v253, s[16:19], s46 offen offset:3072  lds
 s_add_u32 s45, s45, 8192
 s_add_u32 s46, s46, 65536
 v_mfma_f32_16x16x32_bf16 v[100:103], a[52:55], a[40:43], v[100:103]
 v_mfma_f32_16x16x32_bf16 v[116:119], a[52:55], a[44:47], v[116:119]
 v_mfma_f32_16x16x32_bf16 v[112:115], a[48:51], a[44:47], v[112:115]
 v_mfma_f32_16x16x32_bf16 v[96:99], a[48:51], a[40:43], v[96:99]
 s_mov_b32 s47, 3
.p2align 6
L2P_loop:
 s_waitcnt lgkmcnt(0)
 s_waitcnt vmcnt(16)
 s_barrier
 v_mfma_f32_16x16x32_bf16 v[64:67], a[16:19], a[0:3], v[64:67]
 ds_read_b64_tr_b16 a[48:49], v202 offset:16384
 v_mfma_f32_16x16x32_bf16 v[80:83], a[16:19], a[4:7], v[80:83]
 ds_read_b64_tr_b16 a[50:51], v202 offset:24576
 s_add_u32 m0, s44, 114688
 v_mfma_f32_16x16x32_bf16 v[84:87], a[20:23], a[4:7], v[84:87]
 ds_read_b128 a[32:35], v200 offset:16384
 buffer_load_dwordx4 v210, s[12:15], s45 offen  lds
 v_mfma_f32_16x16x32_bf16 v[68:71], a[20:23], a[0:3], v[68:71]
 ds_read_b64_tr_b16 a[52:53], v203 offset:16384
 v_mfma_f32_16x16x32_bf16 v[72:75], a[24:27], a[0:3], v[72:75]
 ds_read_b64_tr_b16 a[54:55], v203 offset:24576
 v_mfma_f32_16x16x32_bf16 v[88:91], a[24:27], a[4:7], v[88:91]
 ds_read_b128 a[36:39], v200 offset:17408
 buffer_load_dwordx4 v210, s[12:15], s45 offen offset:1024  lds
 v_mfma_f32_16x16x32_bf16 v[92:95], a[28:31], a[4:7], v[92:95]
 ds_read_b64_tr_b16 a[56:57], v204 offset:16384
 v_mfma_f32_16x16x32_bf16 v[76:79], a[28:31], a[0:3], v[76:79]
 ds_read_b64_tr_b16 a[58:59], v204 offset:24576
 v_mfma_f32_16x16x32_bf16 v[108:111], a[28:31], a[8:11], v[108:111]
 ds_read_b128 a[40:43], v200 offset:20480
 buffer_load_dwordx4 v252, s[16:19], s46 offen offset:2048  lds
 v_mfma_f32_16x16x32_bf16 v[124:127], a[28:31], a[12:15], v[124:127]
 ds_read_b64_tr_b16 a[60:61], v205 offset:16384
 v_mfma_f32_16x16x32_bf16 v[120:123], a[24:27], a[12:15], v[120:123]
 ds_read_b64_tr_b16 a[62:63], v205 offset:24576
 v_mfma_f32_16x16x32_bf16 v[104:107], a[24:27], a[8:11], v[104:107]
 ds_read_b128 a[44:47], v200 offset:21504
 buffer_load_dwordx4 v253, s[16:19], s46 offen offset:3072  lds
 s_add_u32 s45, s45, 8192
 s_add_u32 s46, s46, 65536
 v_mfma_f32_16x16x32_bf16 v[100:103], a[20:23], a[8:11], v[100:103]
 v_mfma_f32_16x16x32_bf16 v[116:119], a[20:23], a[12:15], v[116:119]
 v_mfma_f32_16x16x32_bf16 v[112:115], a[16:19], a[12:15], v[112:115]
 v_mfma_f32_16x16x32_bf16 v[96:99], a[16:19], a[8:11], v[96:99]
 s_waitcnt lgkmcnt(0)
 v_mfma_f32_16x16x32_bf16 v[64:67], a[48:51], a[32:35], v[64:67]
 ds_read_b64_tr_b16 a[16:17], v202 offset:32768
 v_mfma_f32_16x16x32_bf16 v[80:83], a[48:51], a[36:39], v[80:83]
 ds_read_b64_tr_b16 a[18:19], v202 offset:40960
 s_add_u32 m0, s44, 0
 v_mfma_f32_16x16x32_bf16 v[84:87], a[52:55], a[36:39], v[84:87]
 ds_read_b128 a[0:3], v200 offset:32768
 buffer_load_dwordx4 v210, s[12:15], s45 offen  lds
 v_mfma_f32_16x16x32_bf16 v[68:71], a[52:55], a[32:35], v[68:71]
 ds_read_b64_tr_b16 a[20:21], v203 offset:32768
 v_mfma_f32_16x16x32_bf16 v[72:75], a[56:59], a[32:35], v[72:75]
 ds_read_b64_tr_b16 a[22:23], v203 offset:40960
 v_mfma_f32_16x16x32_bf16 v[88:91], a[56:59], a[36:39], v[88:91]
 ds_read_b128 a[4:7], v200 offset:33792
 buffer_load_dwordx4 v210, s[12:15], s45 offen offset:1024  lds
 v_mfma_f32_16x16x32_bf16 v[92:95], a[60:63], a[36:39], v[92:95]
 ds_read_b64_tr_b16 a[24:25], v204 offset:32768
 v_mfma_f32_16x16x32_bf16 v[76:79], a[60:63], a[32:35], v[76:79]
 ds_read_b64_tr_b16 a[26:27], v204 offset:40960
 v_mfma_f32_16x16x32_bf16 v[108:111], a[60:63], a[40:43], v[108:111]
 ds_read_b128 a[8:11], v200 offset:36864
 buffer_load_dwordx4 v252, s[16:19], s46 offen offset:2048  lds
 v_mfma_f32_16x16x32_bf16 v[124:127], a[60:63], a[44:47], v[124:127]
 ds_read_b64_tr_b16 a[28:29], v205 offset:32768
 v_mfma_f32_16x16x32_bf16 v[120:123], a[56:59], a[44:47], v[120:123]
 ds_read_b64_tr_b16 a[30:31], v205 offset:40960
 v_mfma_f32_16x16x32_bf16 v[104:107], a[56:59], a[40:43], v[104:107]
 ds_read_b128 a[12:15], v200 offset:37888
 buffer_load_dwordx4 v253, s[16:19], s46 offen offset:3072  lds
 s_add_u32 s45, s45, 8192
 s_add_u32 s46, s46, 65536
 v_mfma_f32_16x16x32_bf16 v[100:103], a[52:55], a[40:43], v[100:103]
 v_mfma_f32_16x16x32_bf16 v[116:119], a[52:55], a[44:47], v[116:119]
 v_mfma_f32_16x16x32_bf16 v[112:115], a[48:51], a[44:47], v[112:115]
 v_mfma_f32_16x16x32_bf16 v[96:99], a[48:51], a[40:43], v[96:99]
 s_waitcnt lgkmcnt(0)
 s_waitcnt vmcnt(16)
 s_barrier
 v_mfma_f32_16x16x32_bf16 v[64:67], a[16:19], a[0:3], v[64:67]
 ds_read_b64_tr_b16 a[48:49], v202 offset:49152
 v_mfma_f32_16x16x32_bf16 v[80:83], a[16:19], a[4:7], v[80:83]
 ds_read_b64_tr_b16 a[50:51], v202 offset:57344
 s_add_u32 m0, s44, 16384
 v_mfma_f32_16x16x32_bf16 v[84:87], a[20:23], a[4:7], v[84:87]
 ds_read_b128 a[32:35], v200 offset:49152
 buffer_load_dwordx4 v210, s[12:15], s45 offen  lds
 v_mfma_f32_16x16x32_bf16 v[68:71], a[20:23], a[0:3], v[68:71]
 ds_read_b64_tr_b16 a[52:53], v203 offset:49152
 v_mfma_f32_16x16x32_bf16 v[72:75], a[24:27], a[0:3], v[72:75]
 ds_read_b64_tr_b16 a[54:55], v203 offset:57344
 v_mfma_f32_16x16x32_bf16 v[88:91], a[24:27], a[4:7], v[88:91]
 ds_read_b128 a[36:39], v200 offset:50176
 buffer_load_dwordx4 v210, s[12:15], s45 offen offset:1024  lds
 v_mfma_f32_16x16x32_bf16 v[92:95], a[28:31], a[4:7], v[92:95]
 ds_read_b64_tr_b16 a[56:57], v204 offset:49152
 v_mfma_f32_16x16x32_bf16 v[76:79], a[28:31], a[0:3], v[76:79]
 ds_read_b64_tr_b16 a[58:59], v204 offset:57344
 v_mfma_f32_16x16x32_bf16 v[108:111], a[28:31], a[8:11], v[108:111]
 ds_read_b128 a[40:43], v200 offset:53248
 buffer_load_dwordx4 v252, s[16:19], s46 offen offset:2048  lds
 v_mfma_f32_16x16x32_bf16 v[124:127], a[28:31], a[12:15], v[124:127]
 ds_read_b64_tr_b16 a[60:61], v205 offset:49152
 v_mfma_f32_16x16x32_bf16 v[120:123], a[24:27], a[12:15], v[120:123]
 ds_read_b64_tr_b16 a[62:63], v205 offset:57344
 v_mfma_f32_16x16x32_bf16 v[104:107], a[24:27], a[8:11], v[104:107]
 ds_read_b128 a[44:47], v200 offset:54272
 buffer_load_dwordx4 v253, s[16:19], s46 offen offset:3072  lds
 s_add_u32 s45, s45, 8192
 s_add_u32 s46, s46, 65536
 v_mfma_f32_16x16x32_bf16 v[100:103], a[20:23], a[8:11], v[100:103]
 v_mfma_f32_16x16x32_bf16 v[116:119], a[20:23], a[12:15], v[116:119]
 v_mfma_f32_16x16x32_bf16 v[112:115], a[16:19], a[12:15], v[112:115]
 v_mfma_f32_16x16x32_bf16 v[96:99], a[16:19], a[8:11], v[96:99]
 s_waitcnt lgkmcnt(0)
 v_mfma_f32_16x16x32_bf16 v[64:67], a[48:51], a[32:35], v[64:67]
 ds_read_b64_tr_b16 a[16:17], v206 offset:0
 v_mfma_f32_16x16x32_bf16 v[80:83], a[48:51], a[36:39], v[80:83]
 ds_read_b64_tr_b16 a[18:19], v206 offset:8192
 s_add_u32 m0, s44, 32768
 v_mfma_f32_16x16x32_bf16 v[84:87], a[52:55], a[36:39], v[84:87]
 ds_read_b128 a[0:3], v201 offset:0
 buffer_load_dwordx4 v210, s[12:15], s45 offen  lds
 v_mfma_f32_16x16x32_bf16 v[68:71], a[52:55], a[32:35], v[68:71]
 ds_read_b64_tr_b16 a[20:21], v207 offset:0
 v_mfma_f32_16x16x32_bf16 v[72:75], a[56:59], a[32:35], v[72:75]
 ds_read_b64_tr_b16 a[22:23], v207 offset:8192
 v_mfma_f32_16x16x32_bf16 v[88:91], a[56:59], a[36:39], v[88:91]
 ds_read_b128 a[4:7], v201 offset:1024
 buffer_load_dwordx4 v210, s[12:15], s45 offen offset:1024  lds
 v_mfma_f32_16x16x32_bf16 v[92:95], a[60:63], a[36:39], v[92:95]
 ds_read_b64_tr_b16 a[24:25], v208 offset:0
 v_mfma_f32_16x16x32_bf16 v[76:79], a[60:63], a[32:35], v[76:79]
 ds_read_b64_tr_b16 a[26:27], v208 offset:8192
 v_mfma_f32_16x16x32_bf16 v[108:111], a[60:63], a[40:43], v[108:111]
 ds_read_b128 a[8:11], v201 offset:4096
 buffer_load_dwordx4 v252, s[16:19], s46 offen offset:2048  lds
 v_mfma_f32_16x16x32_bf16 v[124:127], a[60:63], a[44:47], v[124:127]
 ds_read_b64_tr_b16 a[28:29], v209 offset:0
 v_mfma_f32_16x16x32_bf16 v[120:123], a[56:59], a[44:47], v[120:123]
 ds_read_b64_tr_b16 a[30:31], v209 offset:8192
 v_mfma_f32_16x16x32_bf16 v[104:107], a[56:59], a[40:43], v[104:107]
 ds_read_b128 a[12:15], v201 offset:5120
 buffer_load_dwordx4 v253, s[16:19], s46 offen offset:3072  lds
 s_add_u32 s45, s45, 8192
 s_add_u32 s46, s46, 65536
 v_mfma_f32_16x16x32_bf16 v[100:103], a[52:55], a[40:43], v[100:103]
 v_mfma_f32_16x16x32_bf16 v[116:119], a[52:55], a[44:47], v[116:119]
 v_mfma_f32_16x16x32_bf16 v[112:115], a[48:51], a[44:47], v[112:115]
 v_mfma_f32_16x16x32_bf16 v[96:99], a[48:51], a[40:43], v[96:99]
 s_waitcnt lgkmcnt(0)
 s_waitcnt vmcnt(16)
 s_barrier
 v_mfma_f32_16x16x32_bf16 v[64:67], a[16:19], a[0:3], v[64:67]
 ds_read_b64_tr_b16 a[48:49], v206 offset:16384
 v_mfma_f32_16x16x32_bf16 v[80:83], a[16:19], a[4:7], v[80:83]
 ds_read_b64_tr_b16 a[50:51], v206 offset:24576
 s_add_u32 m0, s44, 49152
 v_mfma_f32_16x16x32_bf16 v[84:87], a[20:23], a[4:7], v[84:87]
 ds_read_b128 a[32:35], v201 offset:16384
 buffer_load_dwordx4 v210, s[12:15], s45 offen  lds
 v_mfma_f32_16x16x32_bf16 v[68:71], a[20:23], a[0:3], v[68:71]
 ds_read_b64_tr_b16 a[52:53], v207 offset:16384
 v_mfma_f32_16x16x32_bf16 v[72:75], a[24:27], a[0:3], v[72:75]
 ds_read_b64_tr_b16 a[54:55], v207 offset:24576
 v_mfma_f32_16x16x32_bf16 v[88:91], a[24:27], a[4:7], v[88:91]
 ds_read_b128 a[36:39], v201 offset:17408
 buffer_load_dwordx4 v210, s[12:15], s45 offen offset:1024  lds
 v_mfma_f32_16x16x32_bf16 v[92:95], a[28:31], a[4:7], v[92:95]
 ds_read_b64_tr_b16 a[56:57], v208 offset:16384
 v_mfma_f32_16x16x32_bf16 v[76:79], a[28:31], a[0:3], v[76:79]
 ds_read_b64_tr_b16 a[58:59], v208 offset:24576
 v_mfma_f32_16x16x32_bf16 v[108:111], a[28:31], a[8:11], v[108:111]
 ds_read_b128 a[40:43], v201 offset:20480
 buffer_load_dwordx4 v252, s[16:19], s46 offen offset:2048  lds
 v_mfma_f32_16x16x32_bf16 v[124:127], a[28:31], a[12:15], v[124:127]
 ds_read_b64_tr_b16 a[60:61], v209 offset:16384
 v_mfma_f32_16x16x32_bf16 v[120:123], a[24:27], a[12:15], v[120:123]
 ds_read_b64_tr_b16 a[62:63], v209 offset:24576
 v_mfma_f32_16x16x32_bf16 v[104:107], a[24:27], a[8:11], v[104:107]
 ds_read_b128 a[44:47], v201 offset:21504
 buffer_load_dwordx4 v253, s[16:19], s46 offen offset:3072  lds
 s_add_u32 s45, s45, 8192
 s_add_u32 s46, s46, 65536
 v_mfma_f32_16x16x32_bf16 v[100:103], a[20:23], a[8:11], v[100:103]
 v_mfma_f32_16x16x32_bf16 v[116:119], a[20:23], a[12:15], v[116:119]
 v_mfma_f32_16x16x32_bf16 v[112:115], a[16:19], a[12:15], v[112:115]
 v_mfma_f32_16x16x32_bf16 v[96:99], a[16:19], a[8:11], v[96:99]
 s_waitcnt lgkmcnt(0)
 v_mfma_f32_16x16x32_bf16 v[64:67], a[48:51], a[32:35], v[64:67]
 ds_read_b64_tr_b16 a[16:17], v206 offset:32768
 v_mfma_f32_16x16x32_bf16 v[80:83], a[48:51], a[36:39], v[80:83]
 ds_read_b64_tr_b16 a[18:19], v206 offset:40960
 s_add_u32 m0, s44, 65536
 v_mfma_f32_16x16x32_bf16 v[84:87], a[52:55], a[36:39], v[84:87]
 ds_read_b128 a[0:3], v201 offset:32768
 buffer_load_dwordx4 v210, s[12:15], s45 offen  lds
 v_mfma_f32_16x16x32_bf16 v[68:71], a[52:55], a[32:35], v[68:71]
 ds_read_b64_tr_b16 a[20:21], v207 offset:32768
 v_mfma_f32_16x16x32_bf16 v[72:75], a[56:59], a[32:35], v[72:75]
 ds_read_b64_tr_b16 a[22:23], v207 offset:40960
 v_mfma_f32_16x16x32_bf16 v[88:91], a[56:59], a[36:39], v[88:91]
 ds_read_b128 a[4:7], v201 offset:33792
 buffer_load_dwordx4 v210, s[12:15], s45 offen offset:1024  lds
 v_mfma_f32_16x16x32_bf16 v[92:95], a[60:63], a[36:39], v[92:95]
 ds_read_b64_tr_b16 a[24:25], v208 offset:32768
 v_mfma_f32_16x16x32_bf16 v[76:79], a[60:63], a[32:35], v[76:79]
 ds_read_b64_tr_b16 a[26:27], v208 offset:40960
 v_mfma_f32_16x16x32_bf16 v[108:111], a[60:63], a[40:43], v[108:111]
 ds_read_b128 a[8:11], v201 offset:36864
 buffer_load_dwordx4 v252, s[16:19], s46 offen offset:2048  lds
 v_mfma_f32_16x16x32_bf16 v[124:127], a[60:63], a[44:47], v[124:127]
 ds_read_b64_tr_b16 a[28:29], v209 offset:32768
 v_mfma_f32_16x16x32_bf16 v[120:123], a[56:59], a[44:47], v[120:123]
 ds_read_b64_tr_b16 a[30:31], v209 offset:40960
 v_mfma_f32_16x16x32_bf16 v[104:107], a[56:59], a[40:43], v[104:107]
 ds_read_b128 a[12:15], v201 offset:37888
 buffer_load_dwordx4 v253, s[16:19], s46 offen offset:3072  lds
 s_add_u32 s45, s45, 8192
 s_add_u32 s46, s46, 65536
 v_mfma_f32_16x16x32_bf16 v[100:103], a[52:55], a[40:43], v[100:103]
 v_mfma_f32_16x16x32_bf16 v[116:119], a[52:55], a[44:47], v[116:119]
 v_mfma_f32_16x16x32_bf16 v[112:115], a[48:51], a[44:47], v[112:115]
 v_mfma_f32_16x16x32_bf16 v[96:99], a[48:51], a[40:43], v[96:99]
 s_waitcnt lgkmcnt(0)
 s_waitcnt vmcnt(16)
 s_barrier
 v_mfma_f32_16x16x32_bf16 v[64:67], a[16:19], a[0:3], v[64:67]
 ds_read_b64_tr_b16 a[48:49], v206 offset:49152
 v_mfma_f32_16x16x32_bf16 v[80:83], a[16:19], a[4:7], v[80:83]
 ds_read_b64_tr_b16 a[50:51], v206 offset:57344
 s_add_u32 m0, s44, 81920
 v_mfma_f32_16x16x32_bf16 v[84:87], a[20:23], a[4:7], v[84:87]
 ds_read_b128 a[32:35], v201 offset:49152
 buffer_load_dwordx4 v210, s[12:15], s45 offen  lds
 v_mfma_f32_16x16x32_bf16 v[68:71], a[20:23], a[0:3], v[68:71]
 ds_read_b64_tr_b16 a[52:53], v207 offset:49152
 v_mfma_f32_16x16x32_bf16 v[72:75], a[24:27], a[0:3], v[72:75]
 ds_read_b64_tr_b16 a[54:55], v207 offset:57344
 v_mfma_f32_16x16x32_bf16 v[88:91], a[24:27], a[4:7], v[88:91]
 ds_read_b128 a[36:39], v201 offset:50176
 buffer_load_dwordx4 v210, s[12:15], s45 offen offset:1024  lds
 v_mfma_f32_16x16x32_bf16 v[92:95], a[28:31], a[4:7], v[92:95]
 ds_read_b64_tr_b16 a[56:57], v208 offset:49152
 v_mfma_f32_16x16x32_bf16 v[76:79], a[28:31], a[0:3], v[76:79]
 ds_read_b64_tr_b16 a[58:59], v208 offset:57344
 v_mfma_f32_16x16x32_bf16 v[108:111], a[28:31], a[8:11], v[108:111]
 ds_read_b128 a[40:43], v201 offset:53248
 buffer_load_dwordx4 v252, s[16:19], s46 offen offset:2048  lds
 v_mfma_f32_16x16x32_bf16 v[124:127], a[28:31], a[12:15], v[124:127]
 ds_read_b64_tr_b16 a[60:61], v209 offset:49152
 v_mfma_f32_16x16x32_bf16 v[120:123], a[24:27], a[12:15], v[120:123]
 ds_read_b64_tr_b16 a[62:63], v209 offset:57344
 v_mfma_f32_16x16x32_bf16 v[104:107], a[24:27], a[8:11], v[104:107]
 ds_read_b128 a[44:47], v201 offset:54272
 buffer_load_dwordx4 v253, s[16:19], s46 offen offset:3072  lds
 s_add_u32 s45, s45, 8192
 s_add_u32 s46, s46, 65536
 v_mfma_f32_16x16x32_bf16 v[100:103], a[20:23], a[8:11], v[100:103]
 v_mfma_f32_16x16x32_bf16 v[116:119], a[20:23], a[12:15], v[116:119]
 v_mfma_f32_16x16x32_bf16 v[112:115], a[16:19], a[12:15], v[112:115]
 v_mfma_f32_16x16x32_bf16 v[96:99], a[16:19], a[8:11], v[96:99]
 s_waitcnt lgkmcnt(0)
 v_mfma_f32_16x16x32_bf16 v[64:67], a[48:51], a[32:35], v[64:67]
 ds_read_b64_tr_b16 a[16:17], v202 offset:0
 v_mfma_f32_16x16x32_bf16 v[80:83], a[48:51], a[36:39], v[80:83]
 ds_read_b64_tr_b16 a[18:19], v202 offset:8192
 s_add_u32 m0, s44, 98304
 v_mfma_f32_16x16x32_bf16 v[84:87], a[52:55], a[36:39], v[84:87]
 ds_read_b128 a[0:3], v200 offset:0
 buffer_load_dwordx4 v210, s[12:15], s45 offen  lds
 v_mfma_f32_16x16x32_bf16 v[68:71], a[52:55], a[32:35], v[68:71]
 ds_read_b64_tr_b16 a[20:21], v203 offset:0
 v_mfma_f32_16x16x32_bf16 v[72:75], a[56:59], a[32:35], v[72:75]
 ds_read_b64_tr_b16 a[22:23], v203 offset:8192
 v_mfma_f32_16x16x32_bf16 v[88:91], a[56:59], a[36:39], v[88:91]
 ds_read_b128 a[4:7], v200 offset:1024
 buffer_load_dwordx4 v210, s[12:15], s45 offen offset:1024  lds
 v_mfma_f32_16x16x32_bf16 v[92:95], a[60:63], a[36:39], v[92:95]
 ds_read_b64_tr_b16 a[24:25], v204 offset:0
 v_mfma_f32_16x16x32_bf16 v[76:79], a[60:63], a[32:35], v[76:79]
 ds_read_b64_tr_b16 a[26:27], v204 offset:8192
 v_mfma_f32_16x16x32_bf16 v[108:111], a[60:63], a[40:43], v[108:111]
 ds_read_b128 a[8:11], v200 offset:4096
 buffer_load_dwordx4 v252, s[16:19], s46 offen offset:2048  lds
 v_mfma_f32_16x16x32_bf16 v[124:127], a[60:63], a[44:47], v[124:127]
 ds_read_b64_tr_b16 a[28:29], v205 offset:0
 v_mfma_f32_16x16x32_bf16 v[120:123], a[56:59], a[44:47], v[120:123]
 ds_read_b64_tr_b16 a[30:31], v205 offset:8192
 v_mfma_f32_16x16x32_bf16 v[104:107], a[56:59], a[40:43], v[104:107]
 ds_read_b128 a[12:15], v200 offset:5120
 buffer_load_dwordx4 v253, s[16:19], s46 offen offset:3072  lds
 s_add_u32 s45, s45, 8192
 s_add_u32 s46, s46, 65536
 v_mfma_f32_16x16x32_bf16 v[100:103], a[52:55], a[40:43], v[100:103]
 s_sub_u32 s47, s47, 1
 v_mfma_f32_16x16x32_bf16 v[116:119], a[52:55], a[44:47], v[116:119]
 v_mfma_f32_16x16x32_bf16 v[112:115], a[48:51], a[44:47], v[112:115]
 v_mfma_f32_16x16x32_bf16 v[96:99], a[48:51], a[40:43], v[96:99]
 s_cmp_lg_u32 s47, 0
 s_cbranch_scc1 L2P_loop
 s_waitcnt lgkmcnt(0)
 s_waitcnt vmcnt(16)
 s_barrier
 v_mfma_f32_16x16x32_bf16 v[64:67], a[16:19], a[0:3], v[64:67]
 ds_read_b64_tr_b16 a[48:49], v202 offset:16384
 v_mfma_f32_16x16x32_bf16 v[80:83], a[16:19], a[4:7], v[80:83]
 ds_read_b64_tr_b16 a[50:51], v202 offset:24576
 s_add_u32 m0, s44, 114688
 v_mfma_f32_16x16x32_bf16 v[84:87], a[20:23], a[4:7], v[84:87]
 ds_read_b128 a[32:35], v200 offset:16384
 buffer_load_dwordx4 v210, s[12:15], s45 offen  lds
 v_mfma_f32_16x16x32_bf16 v[68:71], a[20:23], a[0:3], v[68:71]
 ds_read_b64_tr_b16 a[52:53], v203 offset:16384
 v_mfma_f32_16x16x32_bf16 v[72:75], a[24:27], a[0:3], v[72:75]
 ds_read_b64_tr_b16 a[54:55], v203 offset:24576
 v_mfma_f32_16x16x32_bf16 v[88:91], a[24:27], a[4:7], v[88:91]
 ds_read_b128 a[36:39], v200 offset:17408
 buffer_load_dwordx4 v210, s[12:15], s45 offen offset:1024  lds
 v_mfma_f32_16x16x32_bf16 v[92:95], a[28:31], a[4:7], v[92:95]
 ds_read_b64_tr_b16 a[56:57], v204 offset:16384
 v_mfma_f32_16x16x32_bf16 v[76:79], a[28:31], a[0:3], v[76:79]
 ds_read_b64_tr_b16 a[58:59], v204 offset:24576
 v_mfma_f32_16x16x32_bf16 v[108:111], a[28:31], a[8:11], v[108:111]
 ds_read_b128 a[40:43], v200 offset:20480
 buffer_load_dwordx4 v252, s[16:19], s46 offen offset:2048  lds
 v_mfma_f32_16x16x32_bf16 v[124:127], a[28:31], a[12:15], v[124:127]
 ds_read_b64_tr_b16 a[60:61], v205 offset:16384
 v_mfma_f32_16x16x32_bf16 v[120:123], a[24:27], a[12:15], v[120:123]
 ds_read_b64_tr_b16 a[62:63], v205 offset:24576
 v_mfma_f32_16x16x32_bf16 v[104:107], a[24:27], a[8:11], v[104:107]
 ds_read_b128 a[44:47], v200 offset:21504
 buffer_load_dwordx4 v253, s[16:19], s46 offen offset:3072  lds
 s_add_u32 s45, s45, 8192
 s_add_u32 s46, s46, 65536
 v_mfma_f32_16x16x32_bf16 v[100:103], a[20:23], a[8:11], v[100:103]
 v_mfma_f32_16x16x32_bf16 v[116:119], a[20:23], a[12:15], v[116:119]
 v_mfma_f32_16x16x32_bf16 v[112:115], a[16:19], a[12:15], v[112:115]
 v_mfma_f32_16x16x32_bf16 v[96:99], a[16:19], a[8:11], v[96:99]
 s_waitcnt lgkmcnt(0)
 v_mfma_f32_16x16x32_bf16 v[64:67], a[48:51], a[32:35], v[64:67]
 ds_read_b64_tr_b16 a[16:17], v202 offset:32768
 v_mfma_f32_16x16x32_bf16 v[80:83], a[48:51], a[36:39], v[80:83]
 ds_read_b64_tr_b16 a[18:19], v202 offset:40960
 s_add_u32 m0, s44, 0
 v_mfma_f32_16x16x32_bf16 v[84:87], a[52:55], a[36:39], v[84:87]
 ds_read_b128 a[0:3], v200 offset:32768
 buffer_load_dwordx4 v210, s[12:15], s45 offen  lds
 v_mfma_f32_16x16x32_bf16 v[68:71], a[52:55], a[32:35], v[68:71]
 ds_read_b64_tr_b16 a[20:21], v203 offset:32768
 v_mfma_f32_16x16x32_bf16 v[72:75], a[56:59], a[32:35], v[72:75]
 ds_read_b64_tr_b16 a[22:23], v203 offset:40960
 buffer_load_dwordx4 v210, s[12:15], s45 offen offset:1024  lds
 v_mfma_f32_16x16x32_bf16 v[88:91], a[56:59], a[36:39], v[88:91]
 ds_read_b128 a[4:7], v200 offset:33792
 v_mfma_f32_16x16x32_bf16 v[92:95], a[60:63], a[36:39], v[92:95]
 ds_read_b64_tr_b16 a[24:25], v204 offset:32768
 buffer_load_dwordx4 v252, s[16:19], s46 offen offset:2048  lds
 v_mfma_f32_16x16x32_bf16 v[76:79], a[60:63], a[32:35], v[76:79]
 ds_read_b64_tr_b16 a[26:27], v204 offset:40960
 v_mfma_f32_16x16x32_bf16 v[108:111], a[60:63], a[40:43], v[108:111]
 ds_read_b128 a[8:11], v200 offset:36864
 buffer_load_dwordx4 v253, s[16:19], s46 offen offset:3072  lds
 s_add_u32 s45, s45, 8192
 s_add_u32 s46, s46, 65536
 v_mfma_f32_16x16x32_bf16 v[124:127], a[60:63], a[44:47], v[124:127]
 ds_read_b64_tr_b16 a[28:29], v205 offset:32768
 v_mfma_f32_16x16x32_bf16 v[120:123], a[56:59], a[44:47], v[120:123]
 ds_read_b64_tr_b16 a[30:31], v205 offset:40960
 buffer_load_dword v214, v215, s[20:23], s58 offen sc1
 v_mfma_f32_16x16x32_bf16 v[104:107], a[56:59], a[40:43], v[104:107]
 ds_read_b128 a[12:15], v200 offset:37888
 v_mfma_f32_16x16x32_bf16 v[100:103], a[52:55], a[40:43], v[100:103]
 v_mfma_f32_16x16x32_bf16 v[116:119], a[52:55], a[44:47], v[116:119]
 v_mfma_f32_16x16x32_bf16 v[112:115], a[48:51], a[44:47], v[112:115]
 v_mfma_f32_16x16x32_bf16 v[96:99], a[48:51], a[40:43], v[96:99]
 s_waitcnt lgkmcnt(0)
 s_waitcnt vmcnt(17)
 s_barrier
 v_mfma_f32_16x16x32_bf16 v[64:67], a[16:19], a[0:3], v[64:67]
 ds_read_b64_tr_b16 a[48:49], v202 offset:49152
 v_mfma_f32_16x16x32_bf16 v[80:83], a[16:19], a[4:7], v[80:83]
 ds_read_b64_tr_b16 a[50:51], v202 offset:57344
 s_add_u32 m0, s44, 16384
 v_mfma_f32_16x16x32_bf16 v[84:87], a[20:23], a[4:7], v[84:87]
 ds_read_b128 a[32:35], v200 offset:49152
 buffer_load_dwordx4 v210, s[12:15], s45 offen  lds
 v_mfma_f32_16x16x32_bf16 v[68:71], a[20:23], a[0:3], v[68:71]
 ds_read_b64_tr_b16 a[52:53], v203 offset:49152
 v_mfma_f32_16x16x32_bf16 v[72:75], a[24:27], a[0:3], v[72:75]
 ds_read_b64_tr_b16 a[54:55], v203 offset:57344
 v_mfma_f32_16x16x32_bf16 v[88:91], a[24:27], a[4:7], v[88:91]
 ds_read_b128 a[36:39], v200 offset:50176
 buffer_load_dwordx4 v210, s[12:15], s45 offen offset:1024  lds
 v_mfma_f32_16x16x32_bf16 v[92:95], a[28:31], a[4:7], v[92:95]
 ds_read_b64_tr_b16 a[56:57], v204 offset:49152
 v_mfma_f32_16x16x32_bf16 v[76:79], a[28:31], a[0:3], v[76:79]
 ds_read_b64_tr_b16 a[58:59], v204 offset:57344
 v_mfma_f32_16x16x32_bf16 v[108:111], a[28:31], a[8:11], v[108:111]
 ds_read_b128 a[40:43], v200 offset:53248
 buffer_load_dwordx4 v252, s[16:19], s46 offen offset:2048  lds
 v_mfma_f32_16x16x32_bf16 v[124:127], a[28:31], a[12:15], v[124:127]
 ds_read_b64_tr_b16 a[60:61], v205 offset:49152
 v_mfma_f32_16x16x32_bf16 v[120:123], a[24:27], a[12:15], v[120:123]
 ds_read_b64_tr_b16 a[62:63], v205 offset:57344
 v_mfma_f32_16x16x32_bf16 v[104:107], a[24:27], a[8:11], v[104:107]
 ds_read_b128 a[44:47], v200 offset:54272
 buffer_load_dwordx4 v253, s[16:19], s46 offen offset:3072  lds
 s_add_u32 s45, s45, 8192
 s_add_u32 s46, s46, 65536
 v_mfma_f32_16x16x32_bf16 v[100:103], a[20:23], a[8:11], v[100:103]
 v_mfma_f32_16x16x32_bf16 v[116:119], a[20:23], a[12:15], v[116:119]
 v_mfma_f32_16x16x32_bf16 v[112:115], a[16:19], a[12:15], v[112:115]
 v_mfma_f32_16x16x32_bf16 v[96:99], a[16:19], a[8:11], v[96:99]
 s_waitcnt lgkmcnt(0)
 v_mfma_f32_16x16x32_bf16 v[64:67], a[48:51], a[32:35], v[64:67]
 ds_read_b64_tr_b16 a[16:17], v206 offset:0
 v_mfma_f32_16x16x32_bf16 v[80:83], a[48:51], a[36:39], v[80:83]
 ds_read_b64_tr_b16 a[18:19], v206 offset:8192
 s_add_u32 m0, s44, 32768
 v_mfma_f32_16x16x32_bf16 v[84:87], a[52:55], a[36:39], v[84:87]
 ds_read_b128 a[0:3], v201 offset:0
 buffer_load_dwordx4 v210, s[12:15], s45 offen  lds
 v_mfma_f32_16x16x32_bf16 v[68:71], a[52:55], a[32:35], v[68:71]
 ds_read_b64_tr_b16 a[20:21], v207 offset:0
 v_mfma_f32_16x16x32_bf16 v[72:75], a[56:59], a[32:35], v[72:75]
 ds_read_b64_tr_b16 a[22:23], v207 offset:8192
 v_mfma_f32_16x16x32_bf16 v[88:91], a[56:59], a[36:39], v[88:91]
 ds_read_b128 a[4:7], v201 offset:1024
 buffer_load_dwordx4 v210, s[12:15], s45 offen offset:1024  lds
 v_mfma_f32_16x16x32_bf16 v[92:95], a[60:63], a[36:39], v[92:95]
 ds_read_b64_tr_b16 a[24:25], v208 offset:0
 v_mfma_f32_16x16x32_bf16 v[76:79], a[60:63], a[32:35], v[76:79]
 ds_read_b64_tr_b16 a[26:27], v208 offset:8192
 v_mfma_f32_16x16x32_bf16 v[108:111], a[60:63], a[40:43], v[108:111]
 ds_read_b128 a[8:11], v201 offset:4096
 buffer_load_dwordx4 v252, s[16:19], s46 offen offset:2048  lds
 v_mfma_f32_16x16x32_bf16 v[124:127], a[60:63], a[44:47], v[124:127]
 ds_read_b64_tr_b16 a[28:29], v209 offset:0
 v_mfma_f32_16x16x32_bf16 v[120:123], a[56:59], a[44:47], v[120:123]
 ds_read_b64_tr_b16 a[30:31], v209 offset:8192
 v_mfma_f32_16x16x32_bf16 v[104:107], a[56:59], a[40:43], v[104:107]
 ds_read_b128 a[12:15], v201 offset:5120
 buffer_load_dwordx4 v253, s[16:19], s46 offen offset:3072  lds
 s_add_u32 s45, s45, 8192
 s_add_u32 s46, s46, 65536
 v_mfma_f32_16x16x32_bf16 v[100:103], a[52:55], a[40:43], v[100:103]
 v_mfma_f32_16x16x32_bf16 v[116:119], a[52:55], a[44:47], v[116:119]
 v_mfma_f32_16x16x32_bf16 v[112:115], a[48:51], a[44:47], v[112:115]
 v_mfma_f32_16x16x32_bf16 v[96:99], a[48:51], a[40:43], v[96:99]
 s_waitcnt lgkmcnt(0)
 s_waitcnt vmcnt(17)
 s_barrier
 v_mfma_f32_16x16x32_bf16 v[64:67], a[16:19], a[0:3], v[64:67]
 ds_read_b64_tr_b16 a[48:49], v206 offset:16384
 v_mfma_f32_16x16x32_bf16 v[80:83], a[16:19], a[4:7], v[80:83]
 ds_read_b64_tr_b16 a[50:51], v206 offset:24576
 s_add_u32 m0, s44, 49152
 v_mfma_f32_16x16x32_bf16 v[84:87], a[20:23], a[4:7], v[84:87]
 ds_read_b128 a[32:35], v201 offset:16384
 buffer_load_dwordx4 v210, s[12:15], s45 offen  lds
 v_mfma_f32_16x16x32_bf16 v[68:71], a[20:23], a[0:3], v[68:71]
 ds_read_b64_tr_b16 a[52:53], v207 offset:16384
 v_mfma_f32_16x16x32_bf16 v[72:75], a[24:27], a[0:3], v[72:75]
 ds_read_b64_tr_b16 a[54:55], v207 offset:24576
 v_mfma_f32_16x16x32_bf16 v[88:91], a[24:27], a[4:7], v[88:91]
 ds_read_b128 a[36:39], v201 offset:17408
 buffer_load_dwordx4 v210, s[12:15], s45 offen offset:1024  lds
 v_mfma_f32_16x16x32_bf16 v[92:95], a[28:31], a[4:7], v[92:95]
 ds_read_b64_tr_b16 a[56:57], v208 offset:16384
 v_mfma_f32_16x16x32_bf16 v[76:79], a[28:31], a[0:3], v[76:79]
 ds_read_b64_tr_b16 a[58:59], v208 offset:24576
 v_mfma_f32_16x16x32_bf16 v[108:111], a[28:31], a[8:11], v[108:111]
 ds_read_b128 a[40:43], v201 offset:20480
 buffer_load_dwordx4 v252, s[16:19], s46 offen offset:2048  lds
 v_mfma_f32_16x16x32_bf16 v[124:127], a[28:31], a[12:15], v[124:127]
 ds_read_b64_tr_b16 a[60:61], v209 offset:16384
 v_mfma_f32_16x16x32_bf16 v[120:123], a[24:27], a[12:15], v[120:123]
 ds_read_b64_tr_b16 a[62:63], v209 offset:24576
 v_mfma_f32_16x16x32_bf16 v[104:107], a[24:27], a[8:11], v[104:107]
 ds_read_b128 a[44:47], v201 offset:21504
 buffer_load_dwordx4 v253, s[16:19], s46 offen offset:3072  lds
 s_add_u32 s45, s45, 8192
 s_add_u32 s46, s46, 65536
 v_mfma_f32_16x16x32_bf16 v[100:103], a[20:23], a[8:11], v[100:103]
 v_mfma_f32_16x16x32_bf16 v[116:119], a[20:23], a[12:15], v[116:119]
 v_mfma_f32_16x16x32_bf16 v[112:115], a[16:19], a[12:15], v[112:115]
 v_mfma_f32_16x16x32_bf16 v[96:99], a[16:19], a[8:11], v[96:99]
 s_waitcnt lgkmcnt(0)
 v_mfma_f32_16x16x32_bf16 v[64:67], a[48:51], a[32:35], v[64:67]
 ds_read_b64_tr_b16 a[16:17], v206 offset:32768
 v_mfma_f32_16x16x32_bf16 v[80:83], a[48:51], a[36:39], v[80:83]
 ds_read_b64_tr_b16 a[18:19], v206 offset:40960
 s_add_u32 m0, s44, 65536
 v_mfma_f32_16x16x32_bf16 v[84:87], a[52:55], a[36:39], v[84:87]
 ds_read_b128 a[0:3], v201 offset:32768
 buffer_load_dwordx4 v210, s[12:15], s45 offen  lds
 v_mfma_f32_16x16x32_bf16 v[68:71], a[52:55], a[32:35], v[68:71]
 ds_read_b64_tr_b16 a[20:21], v207 offset:32768
 v_mfma_f32_16x16x32_bf16 v[72:75], a[56:59], a[32:35], v[72:75]
 ds_read_b64_tr_b16 a[22:23], v207 offset:40960
 v_mfma_f32_16x16x32_bf16 v[88:91], a[56:59], a[36:39], v[88:91]
 ds_read_b128 a[4:7], v201 offset:33792
 buffer_load_dwordx4 v210, s[12:15], s45 offen offset:1024  lds
 v_mfma_f32_16x16x32_bf16 v[92:95], a[60:63], a[36:39], v[92:95]
 ds_read_b64_tr_b16 a[24:25], v208 offset:32768
 v_mfma_f32_16x16x32_bf16 v[76:79], a[60:63], a[32:35], v[76:79]
 ds_read_b64_tr_b16 a[26:27], v208 offset:40960
 v_mfma_f32_16x16x32_bf16 v[108:111], a[60:63], a[40:43], v[108:111]
 ds_read_b128 a[8:11], v201 offset:36864
 buffer_load_dwordx4 v252, s[16:19], s46 offen offset:2048  lds
 v_mfma_f32_16x16x32_bf16 v[124:127], a[60:63], a[44:47], v[124:127]
 ds_read_b64_tr_b16 a[28:29], v209 offset:32768
 v_mfma_f32_16x16x32_bf16 v[120:123], a[56:59], a[44:47], v[120:123]
 ds_read_b64_tr_b16 a[30:31], v209 offset:40960
 v_mfma_f32_16x16x32_bf16 v[104:107], a[56:59], a[40:43], v[104:107]
 ds_read_b128 a[12:15], v201 offset:37888
 buffer_load_dwordx4 v253, s[16:19], s46 offen offset:3072  lds
 s_add_u32 s45, s45, 8192
 s_add_u32 s46, s46, 65536
 v_mfma_f32_16x16x32_bf16 v[100:103], a[52:55], a[40:43], v[100:103]
 v_mfma_f32_16x16x32_bf16 v[116:119], a[52:55], a[44:47], v[116:119]
 v_mfma_f32_16x16x32_bf16 v[112:115], a[48:51], a[44:47], v[112:115]
 v_mfma_f32_16x16x32_bf16 v[96:99], a[48:51], a[40:43], v[96:99]
 s_waitcnt lgkmcnt(0)
 s_waitcnt vmcnt(17)
 s_barrier
 v_mfma_f32_16x16x32_bf16 v[64:67], a[16:19], a[0:3], v[64:67]
 ds_read_b64_tr_b16 a[48:49], v206 offset:49152
 v_mfma_f32_16x16x32_bf16 v[80:83], a[16:19], a[4:7], v[80:83]
 ds_read_b64_tr_b16 a[50:51], v206 offset:57344
 s_add_u32 m0, s44, 81920
 v_mfma_f32_16x16x32_bf16 v[84:87], a[20:23], a[4:7], v[84:87]
 ds_read_b128 a[32:35], v201 offset:49152
 buffer_load_dwordx4 v210, s[12:15], s45 offen  lds
 v_mfma_f32_16x16x32_bf16 v[68:71], a[20:23], a[0:3], v[68:71]
 ds_read_b64_tr_b16 a[52:53], v207 offset:49152
 v_mfma_f32_16x16x32_bf16 v[72:75], a[24:27], a[0:3], v[72:75]
 ds_read_b64_tr_b16 a[54:55], v207 offset:57344
 v_mfma_f32_16x16x32_bf16 v[88:91], a[24:27], a[4:7], v[88:91]
 ds_read_b128 a[36:39], v201 offset:50176
 buffer_load_dwordx4 v210, s[12:15], s45 offen offset:1024  lds
 v_mfma_f32_16x16x32_bf16 v[92:95], a[28:31], a[4:7], v[92:95]
 ds_read_b64_tr_b16 a[56:57], v208 offset:49152
 v_mfma_f32_16x16x32_bf16 v[76:79], a[28:31], a[0:3], v[76:79]
 ds_read_b64_tr_b16 a[58:59], v208 offset:57344
 v_mfma_f32_16x16x32_bf16 v[108:111], a[28:31], a[8:11], v[108:111]
 ds_read_b128 a[40:43], v201 offset:53248
 buffer_load_dwordx4 v252, s[16:19], s46 offen offset:2048  lds
 v_mfma_f32_16x16x32_bf16 v[124:127], a[28:31], a[12:15], v[124:127]
 ds_read_b64_tr_b16 a[60:61], v209 offset:49152
 v_mfma_f32_16x16x32_bf16 v[120:123], a[24:27], a[12:15], v[120:123]
 ds_read_b64_tr_b16 a[62:63], v209 offset:57344
 v_mfma_f32_16x16x32_bf16 v[104:107], a[24:27], a[8:11], v[104:107]
 ds_read_b128 a[44:47], v201 offset:54272
 buffer_load_dwordx4 v253, s[16:19], s46 offen offset:3072  lds
 s_add_u32 s45, s45, 8192
 s_add_u32 s46, s46, 65536
 v_mfma_f32_16x16x32_bf16 v[100:103], a[20:23], a[8:11], v[100:103]
 v_mfma_f32_16x16x32_bf16 v[116:119], a[20:23], a[12:15], v[116:119]
 v_mfma_f32_16x16x32_bf16 v[112:115], a[16:19], a[12:15], v[112:115]
 v_mfma_f32_16x16x32_bf16 v[96:99], a[16:19], a[8:11], v[96:99]
 s_waitcnt lgkmcnt(0)
 s_waitcnt vmcnt(20)
 v_cmp_eq_u32 vcc, 1, v214
    s_nop 1
 s_and_b32 s40, vcc_lo, s75
 s_cmp_eq_u32 s40, s75
 s_cbranch_scc1 L2P_og_ok
 s_mov_b32 s43, 0
L2P_og:
 s_waitcnt vmcnt(0)
 v_cmp_eq_u32 vcc, 1, v214
    s_nop 1
 s_and_b32 s40, vcc_lo, s75
 s_cmp_eq_u32 s40, s75
 s_cbranch_scc1 L2P_og_ok
 s_sleep 4
 buffer_load_dword v214, v215, s[20:23], s58 offen sc1
 s_add_u32 s43, s43, 1
 s_cmp_lt_u32 s43, 50000
 s_cbranch_scc1 L2P_og
L2P_og_ok:
 v_mfma_f32_16x16x32_bf16 v[64:67], a[48:51], a[32:35], v[64:67]
 ds_read_b64_tr_b16 a[16:17], v202 offset:0
 v_mfma_f32_16x16x32_bf16 v[80:83], a[48:51], a[36:39], v[80:83]
 ds_read_b64_tr_b16 a[18:19], v202 offset:8192
 v_mfma_f32_16x16x32_bf16 v[84:87], a[52:55], a[36:39], v[84:87]
 ds_read_b128 a[0:3], v200 offset:0
 buffer_load_dwordx2 v[192:193], v223, s[20:23], s53 offen offset:0 sc1
 buffer_load_dwordx2 v[194:195], v223, s[20:23], s53 offen offset:128 sc1
 buffer_load_dwordx2 v[196:197], v223, s[20:23], s53 offen offset:256 sc1
 buffer_load_dwordx2 v[198:199], v223, s[20:23], s53 offen offset:384 sc1
 v_mfma_f32_16x16x32_bf16 v[68:71], a[52:55], a[32:35], v[68:71]
 ds_read_b64_tr_b16 a[20:21], v203 offset:0
 s_add_u32 m0, s44, 98304
 v_mfma_f32_16x16x32_bf16 v[72:75], a[56:59], a[32:35], v[72:75]
 ds_read_b64_tr_b16 a[22:23], v203 offset:8192
 buffer_load_dwordx4 v210, s[12:15], s45 offen  lds
 v_mfma_f32_16x16x32_bf16 v[88:91], a[56:59], a[36:39], v[88:91]
 ds_read_b128 a[4:7], v200 offset:1024
 v_mfma_f32_16x16x32_bf16 v[92:95], a[60:63], a[36:39], v[92:95]
 ds_read_b64_tr_b16 a[24:25], v204 offset:0
 buffer_load_dwordx4 v210, s[12:15], s45 offen offset:1024  lds
 v_mfma_f32_16x16x32_bf16 v[76:79], a[60:63], a[32:35], v[76:79]
 ds_read_b64_tr_b16 a[26:27], v204 offset:8192
 v_mfma_f32_16x16x32_bf16 v[108:111], a[60:63], a[40:43], v[108:111]
 ds_read_b128 a[8:11], v200 offset:4096
 buffer_load_dwordx4 v252, s[16:19], s46 offen offset:2048  lds
 v_mfma_f32_16x16x32_bf16 v[124:127], a[60:63], a[44:47], v[124:127]
 ds_read_b64_tr_b16 a[28:29], v205 offset:0
 v_mfma_f32_16x16x32_bf16 v[120:123], a[56:59], a[44:47], v[120:123]
 ds_read_b64_tr_b16 a[30:31], v205 offset:8192
 buffer_load_dwordx4 v253, s[16:19], s46 offen offset:3072  lds
 s_add_u32 s45, s45, 8192
 s_add_u32 s46, s46, 65536
 v_mfma_f32_16x16x32_bf16 v[104:107], a[56:59], a[40:43], v[104:107]
 ds_read_b128 a[12:15], v200 offset:5120
 v_mfma_f32_16x16x32_bf16 v[100:103], a[52:55], a[40:43], v[100:103]
 v_mfma_f32_16x16x32_bf16 v[116:119], a[52:55], a[44:47], v[116:119]
 v_mfma_f32_16x16x32_bf16 v[112:115], a[48:51], a[44:47], v[112:115]
 v_mfma_f32_16x16x32_bf16 v[96:99], a[48:51], a[40:43], v[96:99]
 s_waitcnt lgkmcnt(0)
 s_waitcnt vmcnt(20)
 s_barrier
 v_mfma_f32_16x16x32_bf16 v[64:67], a[16:19], a[0:3], v[64:67]
 ds_read_b64_tr_b16 a[48:49], v202 offset:16384
 v_mfma_f32_16x16x32_bf16 v[80:83], a[16:19], a[4:7], v[80:83]
 ds_read_b64_tr_b16 a[50:51], v202 offset:24576
 s_add_u32 m0, s44, 114688
 v_mfma_f32_16x16x32_bf16 v[84:87], a[20:23], a[4:7], v[84:87]
 ds_read_b128 a[32:35], v200 offset:16384
 buffer_load_dwordx4 v210, s[12:15], s45 offen  lds
 v_mfma_f32_16x16x32_bf16 v[68:71], a[20:23], a[0:3], v[68:71]
 ds_read_b64_tr_b16 a[52:53], v203 offset:16384
 v_mfma_f32_16x16x32_bf16 v[72:75], a[24:27], a[0:3], v[72:75]
 ds_read_b64_tr_b16 a[54:55], v203 offset:24576
 v_mfma_f32_16x16x32_bf16 v[88:91], a[24:27], a[4:7], v[88:91]
 ds_read_b128 a[36:39], v200 offset:17408
 buffer_load_dwordx4 v210, s[12:15], s45 offen offset:1024  lds
 v_mfma_f32_16x16x32_bf16 v[92:95], a[28:31], a[4:7], v[92:95]
 ds_read_b64_tr_b16 a[56:57], v204 offset:16384
 v_mfma_f32_16x16x32_bf16 v[76:79], a[28:31], a[0:3], v[76:79]
 ds_read_b64_tr_b16 a[58:59], v204 offset:24576
 v_mfma_f32_16x16x32_bf16 v[108:111], a[28:31], a[8:11], v[108:111]
 ds_read_b128 a[40:43], v200 offset:20480
 buffer_load_dwordx4 v252, s[16:19], s46 offen offset:2048  lds
 v_mfma_f32_16x16x32_bf16 v[124:127], a[28:31], a[12:15], v[124:127]
 ds_read_b64_tr_b16 a[60:61], v205 offset:16384
 v_mfma_f32_16x16x32_bf16 v[120:123], a[24:27], a[12:15], v[120:123]
 ds_read_b64_tr_b16 a[62:63], v205 offset:24576
 v_mfma_f32_16x16x32_bf16 v[104:107], a[24:27], a[8:11], v[104:107]
 ds_read_b128 a[44:47], v200 offset:21504
 buffer_load_dwordx4 v253, s[16:19], s46 offen offset:3072  lds
 s_add_u32 s45, s45, 8192
 s_add_u32 s46, s46, 65536
 v_mfma_f32_16x16x32_bf16 v[100:103], a[20:23], a[8:11], v[100:103]
 v_mfma_f32_16x16x32_bf16 v[116:119], a[20:23], a[12:15], v[116:119]
 v_mfma_f32_16x16x32_bf16 v[112:115], a[16:19], a[12:15], v[112:115]
 v_mfma_f32_16x16x32_bf16 v[96:99], a[16:19], a[8:11], v[96:99]
 s_waitcnt lgkmcnt(0)
 v_mfma_f32_16x16x32_bf16 v[64:67], a[48:51], a[32:35], v[64:67]
 ds_read_b64_tr_b16 a[16:17], v202 offset:32768
 v_mfma_f32_16x16x32_bf16 v[80:83], a[48:51], a[36:39], v[80:83]
 ds_read_b64_tr_b16 a[18:19], v202 offset:40960
 s_add_u32 m0, s44, 0
 v_mfma_f32_16x16x32_bf16 v[84:87], a[52:55], a[36:39], v[84:87]
 ds_read_b128 a[0:3], v200 offset:32768
 buffer_load_dwordx4 v210, s[12:15], s45 offen  lds
 v_mfma_f32_16x16x32_bf16 v[68:71], a[52:55], a[32:35], v[68:71]
 ds_read_b64_tr_b16 a[20:21], v203 offset:32768
 v_mfma_f32_16x16x32_bf16 v[72:75], a[56:59], a[32:35], v[72:75]
 ds_read_b64_tr_b16 a[22:23], v203 offset:40960
 v_mfma_f32_16x16x32_bf16 v[88:91], a[56:59], a[36:39], v[88:91]
 ds_read_b128 a[4:7], v200 offset:33792
 buffer_load_dwordx4 v210, s[12:15], s45 offen offset:1024  lds
 v_mfma_f32_16x16x32_bf16 v[92:95], a[60:63], a[36:39], v[92:95]
 ds_read_b64_tr_b16 a[24:25], v204 offset:32768
 v_mfma_f32_16x16x32_bf16 v[76:79], a[60:63], a[32:35], v[76:79]
 ds_read_b64_tr_b16 a[26:27], v204 offset:40960
 v_mfma_f32_16x16x32_bf16 v[108:111], a[60:63], a[40:43], v[108:111]
 ds_read_b128 a[8:11], v200 offset:36864
 buffer_load_dwordx4 v252, s[16:19], s46 offen offset:2048  lds
 v_mfma_f32_16x16x32_bf16 v[124:127], a[60:63], a[44:47], v[124:127]
 ds_read_b64_tr_b16 a[28:29], v205 offset:32768
 v_mfma_f32_16x16x32_bf16 v[120:123], a[56:59], a[44:47], v[120:123]
 ds_read_b64_tr_b16 a[30:31], v205 offset:40960
 v_mfma_f32_16x16x32_bf16 v[104:107], a[56:59], a[40:43], v[104:107]
 ds_read_b128 a[12:15], v200 offset:37888
 buffer_load_dwordx4 v253, s[16:19], s46 offen offset:3072  lds
 s_add_u32 s45, s45, 8192
 s_add_u32 s46, s46, 65536
 v_mfma_f32_16x16x32_bf16 v[100:103], a[52:55], a[40:43], v[100:103]
 v_mfma_f32_16x16x32_bf16 v[116:119], a[52:55], a[44:47], v[116:119]
 v_mfma_f32_16x16x32_bf16 v[112:115], a[48:51], a[44:47], v[112:115]
 v_mfma_f32_16x16x32_bf16 v[96:99], a[48:51], a[40:43], v[96:99]
 s_waitcnt lgkmcnt(0)
 s_waitcnt vmcnt(20)
 s_barrier
 v_mfma_f32_16x16x32_bf16 v[64:67], a[16:19], a[0:3], v[64:67]
 ds_read_b64_tr_b16 a[48:49], v202 offset:49152
 v_mfma_f32_16x16x32_bf16 v[80:83], a[16:19], a[4:7], v[80:83]
 ds_read_b64_tr_b16 a[50:51], v202 offset:57344
 s_add_u32 m0, s44, 16384
 v_mfma_f32_16x16x32_bf16 v[84:87], a[20:23], a[4:7], v[84:87]
 ds_read_b128 a[32:35], v200 offset:49152
 buffer_load_dwordx4 v210, s[12:15], s45 offen  lds
 v_mfma_f32_16x16x32_bf16 v[68:71], a[20:23], a[0:3], v[68:71]
 ds_read_b64_tr_b16 a[52:53], v203 offset:49152
 v_mfma_f32_16x16x32_bf16 v[72:75], a[24:27], a[0:3], v[72:75]
 ds_read_b64_tr_b16 a[54:55], v203 offset:57344
 v_mfma_f32_16x16x32_bf16 v[88:91], a[24:27], a[4:7], v[88:91]
 ds_read_b128 a[36:39], v200 offset:50176
 buffer_load_dwordx4 v210, s[12:15], s45 offen offset:1024  lds
 v_mfma_f32_16x16x32_bf16 v[92:95], a[28:31], a[4:7], v[92:95]
 ds_read_b64_tr_b16 a[56:57], v204 offset:49152
 v_mfma_f32_16x16x32_bf16 v[76:79], a[28:31], a[0:3], v[76:79]
 ds_read_b64_tr_b16 a[58:59], v204 offset:57344
 v_mfma_f32_16x16x32_bf16 v[108:111], a[28:31], a[8:11], v[108:111]
 ds_read_b128 a[40:43], v200 offset:53248
 buffer_load_dwordx4 v252, s[16:19], s46 offen offset:2048  lds
 v_mfma_f32_16x16x32_bf16 v[124:127], a[28:31], a[12:15], v[124:127]
 ds_read_b64_tr_b16 a[60:61], v205 offset:49152
 v_mfma_f32_16x16x32_bf16 v[120:123], a[24:27], a[12:15], v[120:123]
 ds_read_b64_tr_b16 a[62:63], v205 offset:57344
 v_mfma_f32_16x16x32_bf16 v[104:107], a[24:27], a[8:11], v[104:107]
 ds_read_b128 a[44:47], v200 offset:54272
 buffer_load_dwordx4 v253, s[16:19], s46 offen offset:3072  lds
 s_add_u32 s45, s45, 8192
 s_add_u32 s46, s46, 65536
 v_mfma_f32_16x16x32_bf16 v[100:103], a[20:23], a[8:11], v[100:103]
 v_mfma_f32_16x16x32_bf16 v[116:119], a[20:23], a[12:15], v[116:119]
 v_mfma_f32_16x16x32_bf16 v[112:115], a[16:19], a[12:15], v[112:115]
 v_mfma_f32_16x16x32_bf16 v[96:99], a[16:19], a[8:11], v[96:99]
 s_waitcnt lgkmcnt(0)
 s_waitcnt vmcnt(16)
 v_mfma_f32_16x16x32_bf16 v[64:67], a[48:51], a[32:35], v[64:67]
 ds_read_b64_tr_b16 a[16:17], v206 offset:0
 v_mfma_f32_16x16x32_bf16 v[80:83], a[48:51], a[36:39], v[80:83]
 ds_read_b64_tr_b16 a[18:19], v206 offset:8192
 s_add_u32 m0, s44, 32768
 v_mul_f32 v0, v192, v0
 v_mfma_f32_16x16x32_bf16 v[84:87], a[52:55], a[36:39], v[84:87]
 ds_read_b128 a[0:3], v201 offset:0
 buffer_load_dwordx4 v210, s[12:15], s45 offen  lds
 v_mul_f32 v1, v192, v1
 v_mfma_f32_16x16x32_bf16 v[68:71], a[52:55], a[32:35], v[68:71]
 ds_read_b64_tr_b16 a[20:21], v207 offset:0
 v_mul_f32 v2, v192, v2
 v_mfma_f32_16x16x32_bf16 v[72:75], a[56:59], a[32:35], v[72:75]
 ds_read_b64_tr_b16 a[22:23], v207 offset:8192
 v_mfma_f32_16x16x32_bf16 v[88:91], a[56:59], a[36:39], v[88:91]
 ds_read_b128 a[4:7], v201 offset:1024
 buffer_load_dwordx4 v210, s[12:15], s45 offen offset:1024  lds
 v_mul_f32 v3, v192, v3
 v_mfma_f32_16x16x32_bf16 v[92:95], a[60:63], a[36:39], v[92:95]
 ds_read_b64_tr_b16 a[24:25], v208 offset:0
 v_mul_f32 v4, v192, v4
 v_mfma_f32_16x16x32_bf16 v[76:79], a[60:63], a[32:35], v[76:79]
 ds_read_b64_tr_b16 a[26:27], v208 offset:8192
 v_mul_f32 v5, v192, v5
 v_mfma_f32_16x16x32_bf16 v[108:111], a[60:63], a[40:43], v[108:111]
 ds_read_b128 a[8:11], v201 offset:4096
 buffer_load_dwordx4 v252, s[16:19], s46 offen offset:2048  lds
 v_mfma_f32_16x16x32_bf16 v[124:127], a[60:63], a[44:47], v[124:127]
 ds_read_b64_tr_b16 a[28:29], v209 offset:0
 v_mul_f32 v6, v192, v6
 v_mfma_f32_16x16x32_bf16 v[120:123], a[56:59], a[44:47], v[120:123]
 ds_read_b64_tr_b16 a[30:31], v209 offset:8192
 v_mul_f32 v7, v192, v7
 v_mfma_f32_16x16x32_bf16 v[104:107], a[56:59], a[40:43], v[104:107]
 ds_read_b128 a[12:15], v201 offset:5120
 buffer_load_dwordx4 v253, s[16:19], s46 offen offset:3072  lds
 s_add_u32 s45, s45, 8192
 s_add_u32 s46, s46, 65536
 v_mul_f32 v8, v192, v8
 v_mfma_f32_16x16x32_bf16 v[100:103], a[52:55], a[40:43], v[100:103]
 v_mfma_f32_16x16x32_bf16 v[116:119], a[52:55], a[44:47], v[116:119]
 v_mul_f32 v9, v192, v9
 v_mfma_f32_16x16x32_bf16 v[112:115], a[48:51], a[44:47], v[112:115]
 v_mul_f32 v10, v192, v10
 v_mfma_f32_16x16x32_bf16 v[96:99], a[48:51], a[40:43], v[96:99]
 s_waitcnt lgkmcnt(0)
 s_waitcnt vmcnt(16)
 s_barrier
 v_mfma_f32_16x16x32_bf16 v[64:67], a[16:19], a[0:3], v[64:67]
 ds_read_b64_tr_b16 a[48:49], v206 offset:16384
 v_mfma_f32_16x16x32_bf16 v[80:83], a[16:19], a[4:7], v[80:83]
 ds_read_b64_tr_b16 a[50:51], v206 offset:24576
 v_mul_f32 v11, v192, v11
 v_mfma_f32_16x16x32_bf16 v[84:87], a[20:23], a[4:7], v[84:87]
 ds_read_b128 a[32:35], v201 offset:16384
 v_mul_f32 v12, v192, v12
 v_mfma_f32_16x16x32_bf16 v[68:71], a[20:23], a[0:3], v[68:71]
 ds_read_b64_tr_b16 a[52:53], v207 offset:16384
 v_mul_f32 v13, v192, v13
 v_mfma_f32_16x16x32_bf16 v[72:75], a[24:27], a[0:3], v[72:75]
 ds_read_b64_tr_b16 a[54:55], v207 offset:24576
 v_mfma_f32_16x16x32_bf16 v[88:91], a[24:27], a[4:7], v[88:91]
 ds_read_b128 a[36:39], v201 offset:17408
 v_mul_f32 v14, v192, v14
 v_mfma_f32_16x16x32_bf16 v[92:95], a[28:31], a[4:7], v[92:95]
 ds_read_b64_tr_b16 a[56:57], v208 offset:16384
 v_mul_f32 v15, v192, v15
 v_mfma_f32_16x16x32_bf16 v[76:79], a[28:31], a[0:3], v[76:79]
 ds_read_b64_tr_b16 a[58:59], v208 offset:24576
 v_mul_f32 v16, v194, v16
 v_mfma_f32_16x16x32_bf16 v[108:111], a[28:31], a[8:11], v[108:111]
 ds_read_b128 a[40:43], v201 offset:20480
 v_mfma_f32_16x16x32_bf16 v[124:127], a[28:31], a[12:15], v[124:127]
 ds_read_b64_tr_b16 a[60:61], v209 offset:16384
 v_mul_f32 v17, v194, v17
 v_mfma_f32_16x16x32_bf16 v[120:123], a[24:27], a[12:15], v[120:123]
 ds_read_b64_tr_b16 a[62:63], v209 offset:24576
 v_mul_f32 v18, v194, v18
 v_mfma_f32_16x16x32_bf16 v[104:107], a[24:27], a[8:11], v[104:107]
 ds_read_b128 a[44:47], v201 offset:21504
 v_mul_f32 v19, v194, v19
 v_mfma_f32_16x16x32_bf16 v[100:103], a[20:23], a[8:11], v[100:103]
 v_mfma_f32_16x16x32_bf16 v[116:119], a[20:23], a[12:15], v[116:119]
 v_mul_f32 v20, v194, v20
 v_mfma_f32_16x16x32_bf16 v[112:115], a[16:19], a[12:15], v[112:115]
 v_mul_f32 v21, v194, v21
 v_mfma_f32_16x16x32_bf16 v[96:99], a[16:19], a[8:11], v[96:99]
 s_waitcnt lgkmcnt(0)
 v_mfma_f32_16x16x32_bf16 v[64:67], a[48:51], a[32:35], v[64:67]
 ds_read_b64_tr_b16 a[16:17], v206 offset:32768
 v_mfma_f32_16x16x32_bf16 v[80:83], a[48:51], a[36:39], v[80:83]
 ds_read_b64_tr_b16 a[18:19], v206 offset:40960
 v_mul_f32 v22, v194, v22
 v_mfma_f32_16x16x32_bf16 v[84:87], a[52:55], a[36:39], v[84:87]
 ds_read_b128 a[0:3], v201 offset:32768
 v_mul_f32 v23, v194, v23
 v_mfma_f32_16x16x32_bf16 v[68:71], a[52:55], a[32:35], v[68:71]
 ds_read_b64_tr_b16 a[20:21], v207 offset:32768
 v_mul_f32 v24, v194, v24
 v_mfma_f32_16x16x32_bf16 v[72:75], a[56:59], a[32:35], v[72:75]
 ds_read_b64_tr_b16 a[22:23], v207 offset:40960
 v_mfma_f32_16x16x32_bf16 v[88:91], a[56:59], a[36:39], v[88:91]
 ds_read_b128 a[4:7], v201 offset:33792
 v_mul_f32 v25, v194, v25
 v_mfma_f32_16x16x32_bf16 v[92:95], a[60:63], a[36:39], v[92:95]
 ds_read_b64_tr_b16 a[24:25], v208 offset:32768
 v_mul_f32 v26, v194, v26
 v_mfma_f32_16x16x32_bf16 v[76:79], a[60:63], a[32:35], v[76:79]
 ds_read_b64_tr_b16 a[26:27], v208 offset:40960
 v_mul_f32 v27, v194, v27
 v_mfma_f32_16x16x32_bf16 v[108:111], a[60:63], a[40:43], v[108:111]
 ds_read_b128 a[8:11], v201 offset:36864
 v_mfma_f32_16x16x32_bf16 v[124:127], a[60:63], a[44:47], v[124:127]
 ds_read_b64_tr_b16 a[28:29], v209 offset:32768
 v_mul_f32 v28, v194, v28
 v_mfma_f32_16x16x32_bf16 v[120:123], a[56:59], a[44:47], v[120:123]
 ds_read_b64_tr_b16 a[30:31], v209 offset:40960
 v_mul_f32 v29, v194, v29
 v_mfma_f32_16x16x32_bf16 v[104:107], a[56:59], a[40:43], v[104:107]
 ds_read_b128 a[12:15], v201 offset:37888
 v_mul_f32 v30, v194, v30
 v_mfma_f32_16x16x32_bf16 v[100:103], a[52:55], a[40:43], v[100:103]
 v_mfma_f32_16x16x32_bf16 v[116:119], a[52:55], a[44:47], v[116:119]
 v_mul_f32 v31, v194, v31
 v_mfma_f32_16x16x32_bf16 v[112:115], a[48:51], a[44:47], v[112:115]
 v_mul_f32 v32, v196, v32
 v_mfma_f32_16x16x32_bf16 v[96:99], a[48:51], a[40:43], v[96:99]
 s_waitcnt lgkmcnt(0)
 s_waitcnt vmcnt(8)
 s_barrier
 v_mfma_f32_16x16x32_bf16 v[64:67], a[16:19], a[0:3], v[64:67]
 ds_read_b64_tr_b16 a[48:49], v206 offset:49152
 v_mfma_f32_16x16x32_bf16 v[80:83], a[16:19], a[4:7], v[80:83]
 ds_read_b64_tr_b16 a[50:51], v206 offset:57344
 v_mul_f32 v33, v196, v33
 v_mfma_f32_16x16x32_bf16 v[84:87], a[20:23], a[4:7], v[84:87]
 ds_read_b128 a[32:35], v201 offset:49152
 v_mul_f32 v34, v196, v34
 v_mfma_f32_16x16x32_bf16 v[68:71], a[20:23], a[0:3], v[68:71]
 ds_read_b64_tr_b16 a[52:53], v207 offset:49152
 v_mul_f32 v35, v196, v35
 v_mfma_f32_16x16x32_bf16 v[72:75], a[24:27], a[0:3], v[72:75]
 ds_read_b64_tr_b16 a[54:55], v207 offset:57344
 v_mfma_f32_16x16x32_bf16 v[88:91], a[24:27], a[4:7], v[88:91]
 ds_read_b128 a[36:39], v201 offset:50176
 v_mul_f32 v36, v196, v36
 v_mfma_f32_16x16x32_bf16 v[92:95], a[28:31], a[4:7], v[92:95]
 ds_read_b64_tr_b16 a[56:57], v208 offset:49152
 v_mul_f32 v37, v196, v37
 v_mfma_f32_16x16x32_bf16 v[76:79], a[28:31], a[0:3], v[76:79]
 ds_read_b64_tr_b16 a[58:59], v208 offset:57344
 v_mul_f32 v38, v196, v38
 v_mfma_f32_16x16x32_bf16 v[108:111], a[28:31], a[8:11], v[108:111]
 ds_read_b128 a[40:43], v201 offset:53248
 v_mfma_f32_16x16x32_bf16 v[124:127], a[28:31], a[12:15], v[124:127]
 ds_read_b64_tr_b16 a[60:61], v209 offset:49152
 v_mul_f32 v39, v196, v39
 v_mfma_f32_16x16x32_bf16 v[120:123], a[24:27], a[12:15], v[120:123]
 ds_read_b64_tr_b16 a[62:63], v209 offset:57344
 v_mul_f32 v40, v196, v40
 v_mfma_f32_16x16x32_bf16 v[104:107], a[24:27], a[8:11], v[104:107]
 ds_read_b128 a[44:47], v201 offset:54272
 v_mul_f32 v41, v196, v41
 v_mfma_f32_16x16x32_bf16 v[100:103], a[20:23], a[8:11], v[100:103]
 v_mfma_f32_16x16x32_bf16 v[116:119], a[20:23], a[12:15], v[116:119]
 v_mul_f32 v42, v196, v42
 v_mfma_f32_16x16x32_bf16 v[112:115], a[16:19], a[12:15], v[112:115]
 v_mul_f32 v43, v196, v43
 v_mfma_f32_16x16x32_bf16 v[96:99], a[16:19], a[8:11], v[96:99]
 s_waitcnt lgkmcnt(0)
 v_mfma_f32_16x16x32_bf16 v[64:67], a[48:51], a[32:35], v[64:67]
 ds_read_b64_tr_b16 a[16:17], v202 offset:0
 v_mfma_f32_16x16x32_bf16 v[80:83], a[48:51], a[36:39], v[80:83]
 ds_read_b64_tr_b16 a[18:19], v202 offset:8192
 v_mul_f32 v44, v196, v44
 v_mfma_f32_16x16x32_bf16 v[84:87], a[52:55], a[36:39], v[84:87]
 ds_read_b128 a[0:3], v200 offset:0
 v_mul_f32 v45, v196, v45
 v_mfma_f32_16x16x32_bf16 v[68:71], a[52:55], a[32:35], v[68:71]
 ds_read_b64_tr_b16 a[20:21], v203 offset:0
 v_mul_f32 v46, v196, v46
 v_mfma_f32_16x16x32_bf16 v[72:75], a[56:59], a[32:35], v[72:75]
 ds_read_b64_tr_b16 a[22:23], v203 offset:8192
 v_mfma_f32_16x16x32_bf16 v[88:91], a[56:59], a[36:39], v[88:91]
 ds_read_b128 a[4:7], v200 offset:1024
 v_mul_f32 v47, v196, v47
 v_mfma_f32_16x16x32_bf16 v[92:95], a[60:63], a[36:39], v[92:95]
 ds_read_b64_tr_b16 a[24:25], v204 offset:0
 v_mul_f32 v48, v198, v48
 v_mfma_f32_16x16x32_bf16 v[76:79], a[60:63], a[32:35], v[76:79]
 ds_read_b64_tr_b16 a[26:27], v204 offset:8192
 v_mul_f32 v49, v198, v49
 v_mfma_f32_16x16x32_bf16 v[108:111], a[60:63], a[40:43], v[108:111]
 ds_read_b128 a[8:11], v200 offset:4096
 v_mfma_f32_16x16x32_bf16 v[124:127], a[60:63], a[44:47], v[124:127]
 ds_read_b64_tr_b16 a[28:29], v205 offset:0
 v_mul_f32 v50, v198, v50
 v_mfma_f32_16x16x32_bf16 v[120:123], a[56:59], a[44:47], v[120:123]
 ds_read_b64_tr_b16 a[30:31], v205 offset:8192
 v_mul_f32 v51, v198, v51
 v_mfma_f32_16x16x32_bf16 v[104:107], a[56:59], a[40:43], v[104:107]
 ds_read_b128 a[12:15], v200 offset:5120
 v_mul_f32 v52, v198, v52
 v_mfma_f32_16x16x32_bf16 v[100:103], a[52:55], a[40:43], v[100:103]
 v_mfma_f32_16x16x32_bf16 v[116:119], a[52:55], a[44:47], v[116:119]
 v_mul_f32 v53, v198, v53
 v_mfma_f32_16x16x32_bf16 v[112:115], a[48:51], a[44:47], v[112:115]
 v_mul_f32 v54, v198, v54
 v_mfma_f32_16x16x32_bf16 v[96:99], a[48:51], a[40:43], v[96:99]
 s_waitcnt lgkmcnt(0)
 s_waitcnt vmcnt(0)
 s_barrier
 v_mfma_f32_16x16x32_bf16 v[64:67], a[16:19], a[0:3], v[64:67]
 ds_read_b64_tr_b16 a[48:49], v202 offset:16384
 ds_read_b64_tr_b16 a[50:51], v202 offset:24576
 v_mfma_f32_16x16x32_bf16 v[80:83], a[16:19], a[4:7], v[80:83]
 ds_read_b128 a[32:35], v200 offset:16384
 ds_read_b64_tr_b16 a[52:53], v203 offset:16384
 v_mul_f32 v55, v198, v55
 v_mfma_f32_16x16x32_bf16 v[84:87], a[20:23], a[4:7], v[84:87]
 ds_read_b64_tr_b16 a[54:55], v203 offset:24576
 ds_read_b128 a[36:39], v200 offset:17408
 v_mul_f32 v56, v198, v56
 v_mfma_f32_16x16x32_bf16 v[68:71], a[20:23], a[0:3], v[68:71]
 ds_read_b64_tr_b16 a[56:57], v204 offset:16384
 v_mfma_f32_16x16x32_bf16 v[72:75], a[24:27], a[0:3], v[72:75]
 ds_read_b64_tr_b16 a[58:59], v204 offset:24576
 ds_read_b128 a[40:43], v200 offset:20480
 v_mul_f32 v57, v198, v57
 v_mfma_f32_16x16x32_bf16 v[88:91], a[24:27], a[4:7], v[88:91]
 ds_read_b64_tr_b16 a[60:61], v205 offset:16384
 ds_read_b64_tr_b16 a[62:63], v205 offset:24576
 v_mfma_f32_16x16x32_bf16 v[92:95], a[28:31], a[4:7], v[92:95]
 ds_read_b128 a[44:47], v200 offset:21504
 v_mul_f32 v58, v198, v58
 v_mfma_f32_16x16x32_bf16 v[76:79], a[28:31], a[0:3], v[76:79]
 ds_read_b64_tr_b16 a[80:81], v202 offset:32768
 ds_read_b64_tr_b16 a[82:83], v202 offset:40960
 v_mul_f32 v59, v198, v59
 v_mfma_f32_16x16x32_bf16 v[108:111], a[28:31], a[8:11], v[108:111]
 ds_read_b128 a[64:67], v200 offset:32768
 ds_read_b64_tr_b16 a[84:85], v203 offset:32768
 v_mfma_f32_16x16x32_bf16 v[124:127], a[28:31], a[12:15], v[124:127]
 ds_read_b64_tr_b16 a[86:87], v203 offset:40960
 ds_read_b128 a[68:71], v200 offset:33792
 v_mul_f32 v60, v198, v60
 v_mfma_f32_16x16x32_bf16 v[120:123], a[24:27], a[12:15], v[120:123]
 ds_read_b64_tr_b16 a[88:89], v204 offset:32768
 v_mfma_f32_16x16x32_bf16 v[104:107], a[24:27], a[8:11], v[104:107]
 ds_read_b64_tr_b16 a[90:91], v204 offset:40960
 ds_read_b128 a[72:75], v200 offset:36864
 v_mul_f32 v61, v198, v61
 v_mfma_f32_16x16x32_bf16 v[100:103], a[20:23], a[8:11], v[100:103]
 ds_read_b64_tr_b16 a[92:93], v205 offset:32768
 ds_read_b64_tr_b16 a[94:95], v205 offset:40960
 v_mul_f32 v62, v198, v62
 v_mfma_f32_16x16x32_bf16 v[116:119], a[20:23], a[12:15], v[116:119]
 ds_read_b128 a[76:79], v200 offset:37888
 v_mfma_f32_16x16x32_bf16 v[112:115], a[16:19], a[12:15], v[112:115]
 v_mul_f32 v63, v198, v63
 v_mfma_f32_16x16x32_bf16 v[96:99], a[16:19], a[8:11], v[96:99]
 s_waitcnt lgkmcnt(0)
 s_mov_b32 s68, -100
 v_mfma_f32_16x16x32_bf16 v[64:67], a[48:51], a[32:35], v[64:67]
 v_mfma_f32_16x16x32_bf16 v[68:71], a[52:55], a[32:35], v[68:71]
 v_mfma_f32_16x16x32_bf16 v[72:75], a[56:59], a[32:35], v[72:75]
 v_mfma_f32_16x16x32_bf16 v[76:79], a[60:63], a[32:35], v[76:79]
 v_mfma_f32_16x16x32_bf16 v[64:67], a[80:83], a[64:67], v[64:67]
 v_mfma_f32_16x16x32_bf16 v[68:71], a[84:87], a[64:67], v[68:71]
 v_mfma_f32_16x16x32_bf16 v[72:75], a[88:91], a[64:67], v[72:75]
 v_mfma_f32_16x16x32_bf16 v[76:79], a[92:95], a[64:67], v[76:79]
 v_mfma_f32_16x16x32_bf16 v[80:83], a[48:51], a[36:39], v[80:83]
 v_mfma_f32_16x16x32_bf16 v[84:87], a[52:55], a[36:39], v[84:87]
 v_mfma_f32_16x16x32_bf16 v[88:91], a[56:59], a[36:39], v[88:91]
    s_nop 1
 v_fma_f32 v0, v193, v64, v0
 v_fma_f32 v1, v193, v65, v1
 v_fma_f32 v2, v193, v66, v2
 v_fma_f32 v3, v193, v67, v3
 v_fma_f32 v4, v193, v68, v4
 v_mfma_f32_16x16x32_bf16 v[92:95], a[60:63], a[36:39], v[92:95]
 v_fma_f32 v5, v193, v69, v5
 v_fma_f32 v6, v193, v70, v6
 v_fma_f32 v7, v193, v71, v7
 v_cvt_pk_bf16_f32 v0, v0, v1
 v_mfma_f32_16x16x32_bf16 v[80:83], a[80:83], a[68:71], v[80:83]
 v_cvt_pk_bf16_f32 v1, v2, v3
 v_cvt_pk_bf16_f32 v2, v4, v5
 v_cvt_pk_bf16_f32 v3, v6, v7
 buffer_store_dwordx4 v[0:3], v211, s[20:23], s50 offen offset:0 sc1
 v_mfma_f32_16x16x32_bf16 v[84:87], a[84:87], a[68:71], v[84:87]
 v_fma_f32 v8, v193, v72, v8
 v_fma_f32 v9, v193, v73, v9
 v_fma_f32 v10, v193, v74, v10
 v_fma_f32 v11, v193, v75, v11
 v_fma_f32 v12, v193, v76, v12
 v_mfma_f32_16x16x32_bf16 v[88:91], a[88:91], a[68:71], v[88:91]
 v_fma_f32 v13, v193, v77, v13
 v_fma_f32 v14, v193, v78, v14
 v_fma_f32 v15, v193, v79, v15
 v_cvt_pk_bf16_f32 v8, v8, v9
 v_mfma_f32_16x16x32_bf16 v[92:95], a[92:95], a[68:71], v[92:95]
 v_cvt_pk_bf16_f32 v9, v10, v11
 v_cvt_pk_bf16_f32 v10, v12, v13
 v_cvt_pk_bf16_f32 v11, v14, v15
 buffer_store_dwordx4 v[8:11], v211, s[20:23], s50 offen offset:1024 sc1
 v_mfma_f32_16x16x32_bf16 v[96:99], a[48:51], a[40:43], v[96:99]
 v_mfma_f32_16x16x32_bf16 v[100:103], a[52:55], a[40:43], v[100:103]
 v_mfma_f32_16x16x32_bf16 v[104:107], a[56:59], a[40:43], v[104:107]
 v_fma_f32 v16, v195, v80, v16
 v_fma_f32 v17, v195, v81, v17
 v_fma_f32 v18, v195, v82, v18
 v_fma_f32 v19, v195, v83, v19
 v_fma_f32 v20, v195, v84, v20
 v_mfma_f32_16x16x32_bf16 v[108:111], a[60:63], a[40:43], v[108:111]
 v_fma_f32 v21, v195, v85, v21
 v_fma_f32 v22, v195, v86, v22
 v_fma_f32 v23, v195, v87, v23
 v_cvt_pk_bf16_f32 v16, v16, v17
 v_mfma_f32_16x16x32_bf16 v[96:99], a[80:83], a[72:75], v[96:99]
 v_cvt_pk_bf16_f32 v17, v18, v19
 v_cvt_pk_bf16_f32 v18, v20, v21
 v_cvt_pk_bf16_f32 v19, v22, v23
 buffer_store_dwordx4 v[16:19], v211, s[20:23], s50 offen offset:2048 sc1
 v_fma_f32 v24, v195, v88, v24
 v_mfma_f32_16x16x32_bf16 v[100:103], a[84:87], a[72:75], v[100:103]
 v_fma_f32 v25, v195, v89, v25
 v_fma_f32 v26, v195, v90, v26
 v_fma_f32 v27, v195, v91, v27
 v_fma_f32 v28, v195, v92, v28
 v_mfma_f32_16x16x32_bf16 v[104:107], a[88:91], a[72:75], v[104:107]
 v_fma_f32 v29, v195, v93, v29
 v_fma_f32 v30, v195, v94, v30
 v_fma_f32 v31, v195, v95, v31
 v_cvt_pk_bf16_f32 v24, v24, v25
 v_cvt_pk_bf16_f32 v25, v26, v27
 v_mfma_f32_16x16x32_bf16 v[108:111], a[92:95], a[72:75], v[108:111]
 v_cvt_pk_bf16_f32 v26, v28, v29
 v_cvt_pk_bf16_f32 v27, v30, v31
 buffer_store_dwordx4 v[24:27], v211, s[20:23], s50 offen offset:3072 sc1
 s_add_u32 s50, s50, 4096
 v_mfma_f32_16x16x32_bf16 v[112:115], a[48:51], a[44:47], v[112:115]
 v_mfma_f32_16x16x32_bf16 v[116:119], a[52:55], a[44:47], v[116:119]
 v_mfma_f32_16x16x32_bf16 v[120:123], a[56:59], a[44:47], v[120:123]
 v_fma_f32 v32, v197, v96, v32
 v_fma_f32 v33, v197, v97, v33
 v_fma_f32 v34, v197, v98, v34
 v_fma_f32 v35, v197, v99, v35
 v_fma_f32 v36, v197, v100, v36
 v_mfma_f32_16x16x32_bf16 v[124:127], a[60:63], a[44:47], v[124:127]
 v_fma_f32 v37, v197, v101, v37
 v_fma_f32 v38, v197, v102, v38
 v_fma_f32 v39, v197, v103, v39
 v_cvt_pk_bf16_f32 v32, v32, v33
 v_mfma_f32_16x16x32_bf16 v[112:115], a[80:83], a[76:79], v[112:115]
 v_cvt_pk_bf16_f32 v33, v34, v35
 v_cvt_pk_bf16_f32 v34, v36, v37
 v_cvt_pk_bf16_f32 v35, v38, v39
 buffer_store_dwordx4 v[32:35], v211, s[20:23], s50 offen offset:0 sc1
 v_mfma_f32_16x16x32_bf16 v[116:119], a[84:87], a[76:79], v[116:119]
 v_fma_f32 v40, v197, v104, v40
 v_fma_f32 v41, v197, v105, v41
 v_fma_f32 v42, v197, v106, v42
 v_fma_f32 v43, v197, v107, v43
 v_fma_f32 v44, v197, v108, v44
 v_mfma_f32_16x16x32_bf16 v[120:123], a[88:91], a[76:79], v[120:123]
 v_fma_f32 v45, v197, v109, v45
 v_fma_f32 v46, v197, v110, v46
 v_fma_f32 v47, v197, v111, v47
 v_cvt_pk_bf16_f32 v40, v40, v41
 v_mfma_f32_16x16x32_bf16 v[124:127], a[92:95], a[76:79], v[124:127]
 v_cvt_pk_bf16_f32 v41, v42, v43
 v_cvt_pk_bf16_f32 v42, v44, v45
 v_cvt_pk_bf16_f32 v43, v46, v47
 buffer_store_dwordx4 v[40:43], v211, s[20:23], s50 offen offset:1024 sc1
 v_fma_f32 v48, v199, v112, v48
 v_fma_f32 v49, v199, v113, v49
 v_fma_f32 v50, v199, v114, v50
 v_fma_f32 v51, v199, v115, v51
 v_fma_f32 v52, v199, v116, v52
 v_fma_f32 v53, v199, v117, v53
 v_fma_f32 v54, v199, v118, v54
 v_fma_f32 v55, v199, v119, v55
 v_cvt_pk_bf16_f32 v48, v48, v49
 v_cvt_pk_bf16_f32 v49, v50, v51
 v_cvt_pk_bf16_f32 v50, v52, v53
 v_cvt_pk_bf16_f32 v51, v54, v55
 buffer_store_dwordx4 v[48:51], v211, s[20:23], s50 offen offset:2048 sc1
 v_fma_f32 v56, v199, v120, v56
 v_fma_f32 v57, v199, v121, v57
 v_fma_f32 v58, v199, v122, v58
 v_fma_f32 v59, v199, v123, v59
 v_fma_f32 v60, v199, v124, v60
 v_fma_f32 v61, v199, v125, v61
 v_fma_f32 v62, v199, v126, v62
 v_fma_f32 v63, v199, v127, v63
 v_cvt_pk_bf16_f32 v56, v56, v57
 v_cvt_pk_bf16_f32 v57, v58, v59
 v_cvt_pk_bf16_f32 v58, v60, v61
 v_cvt_pk_bf16_f32 v59, v62, v63
 buffer_store_dwordx4 v[56:59], v211, s[20:23], s50 offen offset:3072 sc1
 s_add_u32 s50, s50, 4096
 s_waitcnt vmcnt(0)
 s_barrier
 s_cmp_lg_u32 s33, 0
 s_cbranch_scc1 L2_pdone
 v_mov_b32 v218, 1
 s_mov_b64 exec, 1
 buffer_store_dword v218, v213, s[20:23], s51 offen sc1
 s_mov_b64 exec, -1
L2_pdone:
 s_endpgm
L1_end:
    s_endpgm
.section .rodata,"a"
.p2align 6
.amdhsa_kernel gated_mix__sliding_local_dilated__dense_activation_relu__prompt_kernel
  .amdhsa_next_free_vgpr 512
  .amdhsa_next_free_sgpr 102
  .amdhsa_accum_offset 256
  .amdhsa_group_segment_fixed_size 0
  .amdhsa_kernarg_size 80
  .amdhsa_user_sgpr_count 2
  .amdhsa_user_sgpr_kernarg_segment_ptr 1
  .amdhsa_system_sgpr_workgroup_id_x 1
  .amdhsa_float_denorm_mode_32 3
.end_amdhsa_kernel
```
